```python
import torch

def _softmax(x, axis=-1):
    return torch.softmax(x, dim=axis)
def _gelu(x):
    return torch.nn.functional.gelu(x, approximate="tanh")
def _silu(x):
    return torch.nn.functional.silu(x)
def _sigmoid(x):
    return torch.sigmoid(x)
def _layernorm(x, axis=-1, eps=1e-5):
    m = x.mean(dim=axis, keepdim=True)
    v = x.var(dim=axis, keepdim=True, unbiased=False)
    return (x - m) / torch.sqrt(v + eps)
def _scatter_add(tgt, idx, src, axis=0):
    return tgt.clone().index_add_(axis, idx, src)
def _segment_sum(src, seg, n):
    out = torch.zeros((n,) + src.shape[1:], dtype=src.dtype)
    return out.index_add_(0, seg, src)
def _pad(x, pw):
    flat = tuple(v for pair in reversed(pw) for v in pair)
    return torch.nn.functional.pad(x, flat)

kernel_name = 'gated_mix__softmax_full_mha__mixer_channel_mlp__prompt'

def setup_inputs():

    _w = (lambda a: (lambda t: t.to(torch.bfloat16) if t.is_floating_point() else t)(torch.as_tensor(a)))
    def _A_setup():
        B, S, D = 1, 2048, 576
        return {
            "x": _w((lambda *s: torch.randn(*s, dtype=torch.bfloat16) * 0.05)(B, S, D)),
            "wqkv": _w((lambda *s: torch.randn(*s, dtype=torch.bfloat16) * 0.8)(D, 3 * D)),
            "wo": _w((lambda *s: torch.randn(*s, dtype=torch.bfloat16) * 0.1)(D, D)),
        }
    _A_in = _A_setup()

    def _B_setup():
        B, S, D, F = 1, 2048, 576, 4608
        return {
            "x": _w((lambda *s: torch.randn(*s, dtype=torch.bfloat16) * 0.05)(B, S, D)),
            "w1": _w((lambda *s: torch.randn(*s, dtype=torch.bfloat16) * 1.6)(D, F) * (D ** -0.5)),
            "b1": _w((lambda *s: torch.randn(*s, dtype=torch.bfloat16) * 0.8)(F)),
            "w2": _w((lambda *s: torch.randn(*s, dtype=torch.bfloat16) * 0.05)(F, D) * (F ** -0.5)),
            "b2": _w((lambda *s: torch.randn(*s, dtype=torch.bfloat16) * 0.05)(D)),
        }
    _B_in = _B_setup()

    return {
        "A_x": _A_in["x"],
        "A_wqkv": _A_in["wqkv"],
        "A_wo": _A_in["wo"],
        "B_x": _B_in["x"],
        "B_w1": _B_in["w1"],
        "B_b1": _B_in["b1"],
        "B_w2": _B_in["w2"],
        "B_b2": _B_in["b2"],
        "gate_w": _w((lambda *s: torch.randn(*s, dtype=torch.bfloat16) * 0.05)(576) * 16.0),
    }

def reference(A_x, A_wqkv, A_wo, B_x, B_w1, B_b1, B_w2, B_b2, gate_w):
    def _A_ref(x, wqkv, wo):
        B, S, D = x.shape
        H = 32; Dh = D // H
        qkv = (lambda x, *d: x.permute(*d))((x @ wqkv).reshape(B, S, 3, H, Dh), 2, 0, 3, 1, 4)
        q, k, v = qkv[0], qkv[1], qkv[2]
        scale = Dh ** -0.5
        scores = torch.einsum("bhqd,bhkd->bhqk", q, k) * scale
        p = _softmax(scores, axis=-1)
        o = torch.einsum("bhqk,bhkd->bhqd", p, v)
        return (lambda x, *d: x.permute(*d))(o, 0, 2, 1, 3).reshape(B, S, D) @ wo

    def _B_ref(x, w1, b1, w2, b2):
        y = _layernorm(x, axis=-1)
        h = _gelu(torch.einsum("bsd,df->bsf", y, w1) + b1)
        return torch.einsum("bsf,fd->bsd", h, w2) + b2

    x = A_x
    g = _sigmoid((x * gate_w).sum(-1, keepdims=True))
    a = _A_ref(x, A_wqkv, A_wo)
    b = _B_ref(x, B_w1, B_b1, B_w2, B_b2)
    return g * a + (1 - g) * b
```

```asm
; @launch kernel=k1_kernel grid=(256,1,1) block=(256,1,1) lds=65536
; @launch kernel=k2_kernel grid=(512,1,1) block=(256,1,1) lds=73728
.amdgcn_target "amdgcn-amd-amdhsa--gfx950"
.text
.globl k1_kernel
.p2align 8
.type k1_kernel,@function
k1_kernel:
    s_load_dwordx8 s[64:71], s[0:1], 0
    s_load_dwordx8 s[72:79], s[0:1], 32
    s_load_dwordx8 s[80:87], s[0:1], 64
    v_and_b32 v1, 63, v0
    v_lshrrev_b32 v2, 6, v0
    s_nop 0
    v_readfirstlane_b32 s27, v2
    s_cmp_ge_u32 s2, 256
    s_cbranch_scc1 k1_exit
    s_waitcnt lgkmcnt(0)
    s_mov_b32 s3, s2
    s_cmp_lt_u32 s2, 192
    s_cbranch_scc1 k1_q
    s_sub_u32 s3, s2, 192
    s_mov_b32 s8, s64
    s_mov_b32 s9, s65
    s_mov_b32 s10, 0x240000
    s_mov_b32 s11, 0x00020000
    s_mov_b32 s12, s80
    s_mov_b32 s13, s81
    s_mov_b32 s14, 0x480
    s_mov_b32 s15, 0x00020000
    s_mov_b32 s16, s86
    s_mov_b32 s17, s87
    s_mov_b32 s18, 0x240000
    s_mov_b32 s19, 0x00020000
    s_add_u32 s20, s86, 0x240000
    s_addc_u32 s21, s87, 0
    s_mov_b32 s22, 0x2000
    s_mov_b32 s23, 0x00020000
    s_and_b32 s28, s3, 7
    s_lshl_b32 s28, s28, 7
    s_bfe_u32 s29, s3, 0x10005
    s_lshl_b32 s29, s29, 10
    s_add_u32 s28, s28, s29
    s_bfe_u32 s29, s3, 0x20003
    s_lshl_b32 s29, s29, 5
    s_add_u32 s28, s28, s29
    s_lshl_b32 s29, s27, 3
    s_add_u32 s28, s28, s29
    v_lshrrev_b32 v2, 3, v1
    v_add_u32 v2, s28, v2
    v_and_b32 v3, 7, v1
    v_lshlrev_b32 v4, 4, v3
    v_mul_u32_u24 v5, 1152, v2
    v_add_u32 v5, v5, v4
    buffer_load_dwordx4 v[16:19], v5, s[8:11], 0 offen offset:0
    buffer_load_dwordx4 v[20:23], v5, s[8:11], 0 offen offset:128
    buffer_load_dwordx4 v[24:27], v5, s[8:11], 0 offen offset:256
    buffer_load_dwordx4 v[28:31], v5, s[8:11], 0 offen offset:384
    buffer_load_dwordx4 v[32:35], v5, s[8:11], 0 offen offset:512
    buffer_load_dwordx4 v[36:39], v5, s[8:11], 0 offen offset:640
    buffer_load_dwordx4 v[40:43], v5, s[8:11], 0 offen offset:768
    buffer_load_dwordx4 v[44:47], v5, s[8:11], 0 offen offset:896
    buffer_load_dwordx4 v[48:51], v5, s[8:11], 0 offen offset:1024
    buffer_load_dwordx4 v[52:55], v4, s[12:15], 0 offen offset:0
    buffer_load_dwordx4 v[56:59], v4, s[12:15], 0 offen offset:128
    buffer_load_dwordx4 v[60:63], v4, s[12:15], 0 offen offset:256
    buffer_load_dwordx4 v[64:67], v4, s[12:15], 0 offen offset:384
    buffer_load_dwordx4 v[68:71], v4, s[12:15], 0 offen offset:512
    buffer_load_dwordx4 v[72:75], v4, s[12:15], 0 offen offset:640
    buffer_load_dwordx4 v[76:79], v4, s[12:15], 0 offen offset:768
    buffer_load_dwordx4 v[80:83], v4, s[12:15], 0 offen offset:896
    buffer_load_dwordx4 v[84:87], v4, s[12:15], 0 offen offset:1024
    s_mov_b32 s32, s66
    s_mov_b32 s33, s67
    s_mov_b32 s34, 0x1e6000
    s_mov_b32 s35, 0x00020000
    s_lshr_b32 s28, s3, 3
    s_lshl_b32 s28, s28, 2
    s_add_u32 s28, s28, s27
    s_lshl_b32 s28, s28, 10
    v_lshlrev_b32 v6, 4, v1
    v_add_u32 v6, s28, v6
    s_mov_b32 s28, 0
    buffer_load_dwordx4 v[160:163], v6, s[32:35], s28 offen
    s_mov_b32 s28, 32768
    buffer_load_dwordx4 v[164:167], v6, s[32:35], s28 offen
    s_mov_b32 s28, 65536
    buffer_load_dwordx4 v[168:171], v6, s[32:35], s28 offen
    s_mov_b32 s28, 98304
    buffer_load_dwordx4 v[172:175], v6, s[32:35], s28 offen
    s_mov_b32 s28, 131072
    buffer_load_dwordx4 v[176:179], v6, s[32:35], s28 offen
    s_mov_b32 s28, 163840
    buffer_load_dwordx4 v[180:183], v6, s[32:35], s28 offen
    s_mov_b32 s28, 196608
    buffer_load_dwordx4 v[184:187], v6, s[32:35], s28 offen
    s_mov_b32 s28, 229376
    buffer_load_dwordx4 v[188:191], v6, s[32:35], s28 offen
    s_mov_b32 s28, 262144
    buffer_load_dwordx4 v[160:163], v6, s[32:35], s28 offen
    s_mov_b32 s28, 294912
    buffer_load_dwordx4 v[164:167], v6, s[32:35], s28 offen
    s_mov_b32 s28, 327680
    buffer_load_dwordx4 v[168:171], v6, s[32:35], s28 offen
    s_mov_b32 s28, 360448
    buffer_load_dwordx4 v[172:175], v6, s[32:35], s28 offen
    s_mov_b32 s28, 393216
    buffer_load_dwordx4 v[176:179], v6, s[32:35], s28 offen
    s_mov_b32 s28, 425984
    buffer_load_dwordx4 v[180:183], v6, s[32:35], s28 offen
    s_mov_b32 s28, 458752
    buffer_load_dwordx4 v[184:187], v6, s[32:35], s28 offen
    s_mov_b32 s28, 491520
    buffer_load_dwordx4 v[188:191], v6, s[32:35], s28 offen
    s_mov_b32 s28, 524288
    buffer_load_dwordx4 v[160:163], v6, s[32:35], s28 offen
    s_mov_b32 s28, 557056
    buffer_load_dwordx4 v[164:167], v6, s[32:35], s28 offen
    s_mov_b32 s28, 589824
    buffer_load_dwordx4 v[168:171], v6, s[32:35], s28 offen
    s_mov_b32 s28, 622592
    buffer_load_dwordx4 v[172:175], v6, s[32:35], s28 offen
    s_mov_b32 s28, 655360
    buffer_load_dwordx4 v[176:179], v6, s[32:35], s28 offen
    s_mov_b32 s28, 688128
    buffer_load_dwordx4 v[180:183], v6, s[32:35], s28 offen
    s_mov_b32 s28, 720896
    buffer_load_dwordx4 v[184:187], v6, s[32:35], s28 offen
    s_mov_b32 s28, 753664
    buffer_load_dwordx4 v[188:191], v6, s[32:35], s28 offen
    s_mov_b32 s28, 786432
    buffer_load_dwordx4 v[160:163], v6, s[32:35], s28 offen
    s_mov_b32 s28, 819200
    buffer_load_dwordx4 v[164:167], v6, s[32:35], s28 offen
    s_mov_b32 s28, 851968
    buffer_load_dwordx4 v[168:171], v6, s[32:35], s28 offen
    s_mov_b32 s28, 884736
    buffer_load_dwordx4 v[172:175], v6, s[32:35], s28 offen
    s_mov_b32 s28, 917504
    buffer_load_dwordx4 v[176:179], v6, s[32:35], s28 offen
    s_mov_b32 s28, 950272
    buffer_load_dwordx4 v[180:183], v6, s[32:35], s28 offen
    s_mov_b32 s28, 983040
    buffer_load_dwordx4 v[184:187], v6, s[32:35], s28 offen
    s_mov_b32 s28, 1015808
    buffer_load_dwordx4 v[188:191], v6, s[32:35], s28 offen
    s_mov_b32 s28, 1048576
    buffer_load_dwordx4 v[160:163], v6, s[32:35], s28 offen
    s_mov_b32 s28, 1081344
    buffer_load_dwordx4 v[164:167], v6, s[32:35], s28 offen
    s_mov_b32 s28, 1114112
    buffer_load_dwordx4 v[168:171], v6, s[32:35], s28 offen
    s_mov_b32 s28, 1146880
    buffer_load_dwordx4 v[172:175], v6, s[32:35], s28 offen
    s_mov_b32 s28, 1179648
    buffer_load_dwordx4 v[176:179], v6, s[32:35], s28 offen
    s_mov_b32 s28, 1212416
    buffer_load_dwordx4 v[180:183], v6, s[32:35], s28 offen
    s_mov_b32 s28, 1245184
    buffer_load_dwordx4 v[184:187], v6, s[32:35], s28 offen
    s_mov_b32 s28, 1277952
    buffer_load_dwordx4 v[188:191], v6, s[32:35], s28 offen
    s_mov_b32 s28, 1310720
    buffer_load_dwordx4 v[160:163], v6, s[32:35], s28 offen
    s_mov_b32 s28, 1343488
    buffer_load_dwordx4 v[164:167], v6, s[32:35], s28 offen
    s_mov_b32 s28, 1376256
    buffer_load_dwordx4 v[168:171], v6, s[32:35], s28 offen
    s_mov_b32 s28, 1409024
    buffer_load_dwordx4 v[172:175], v6, s[32:35], s28 offen
    s_mov_b32 s28, 1441792
    buffer_load_dwordx4 v[176:179], v6, s[32:35], s28 offen
    s_mov_b32 s28, 1474560
    buffer_load_dwordx4 v[180:183], v6, s[32:35], s28 offen
    s_mov_b32 s28, 1507328
    buffer_load_dwordx4 v[184:187], v6, s[32:35], s28 offen
    s_mov_b32 s28, 1540096
    buffer_load_dwordx4 v[188:191], v6, s[32:35], s28 offen
    s_mov_b32 s28, 1572864
    buffer_load_dwordx4 v[160:163], v6, s[32:35], s28 offen
    s_mov_b32 s28, 1605632
    buffer_load_dwordx4 v[164:167], v6, s[32:35], s28 offen
    s_mov_b32 s28, 1638400
    buffer_load_dwordx4 v[168:171], v6, s[32:35], s28 offen
    s_mov_b32 s28, 1671168
    buffer_load_dwordx4 v[172:175], v6, s[32:35], s28 offen
    s_mov_b32 s28, 1703936
    buffer_load_dwordx4 v[176:179], v6, s[32:35], s28 offen
    s_mov_b32 s28, 1736704
    buffer_load_dwordx4 v[180:183], v6, s[32:35], s28 offen
    s_mov_b32 s28, 1769472
    buffer_load_dwordx4 v[184:187], v6, s[32:35], s28 offen
    s_mov_b32 s28, 1802240
    buffer_load_dwordx4 v[188:191], v6, s[32:35], s28 offen
    s_mov_b32 s28, 1835008
    buffer_load_dwordx4 v[160:163], v6, s[32:35], s28 offen
    s_mov_b32 s28, 1867776
    buffer_load_dwordx4 v[164:167], v6, s[32:35], s28 offen
    s_mov_b32 s28, 1900544
    buffer_load_dwordx4 v[168:171], v6, s[32:35], s28 offen
    s_mov_b32 s28, 1933312
    buffer_load_dwordx4 v[172:175], v6, s[32:35], s28 offen
    s_mov_b32 s28, 1966080
    buffer_load_dwordx4 v[176:179], v6, s[32:35], s28 offen
    s_waitcnt vmcnt(61)
    v_lshlrev_b32 v88, 16, v16
    v_and_b32 v89, 0xffff0000, v16
    v_lshlrev_b32 v90, 16, v17
    v_and_b32 v91, 0xffff0000, v17
    v_lshlrev_b32 v92, 16, v18
    v_and_b32 v93, 0xffff0000, v18
    v_lshlrev_b32 v94, 16, v19
    v_and_b32 v95, 0xffff0000, v19
    v_lshlrev_b32 v96, 16, v20
    v_and_b32 v97, 0xffff0000, v20
    v_lshlrev_b32 v98, 16, v21
    v_and_b32 v99, 0xffff0000, v21
    v_lshlrev_b32 v100, 16, v22
    v_and_b32 v101, 0xffff0000, v22
    v_lshlrev_b32 v102, 16, v23
    v_and_b32 v103, 0xffff0000, v23
    v_lshlrev_b32 v104, 16, v24
    v_and_b32 v105, 0xffff0000, v24
    v_lshlrev_b32 v106, 16, v25
    v_and_b32 v107, 0xffff0000, v25
    v_lshlrev_b32 v108, 16, v26
    v_and_b32 v109, 0xffff0000, v26
    v_lshlrev_b32 v110, 16, v27
    v_and_b32 v111, 0xffff0000, v27
    v_lshlrev_b32 v112, 16, v28
    v_and_b32 v113, 0xffff0000, v28
    v_lshlrev_b32 v114, 16, v29
    v_and_b32 v115, 0xffff0000, v29
    v_lshlrev_b32 v116, 16, v30
    v_and_b32 v117, 0xffff0000, v30
    v_lshlrev_b32 v118, 16, v31
    v_and_b32 v119, 0xffff0000, v31
    v_lshlrev_b32 v120, 16, v32
    v_and_b32 v121, 0xffff0000, v32
    v_lshlrev_b32 v122, 16, v33
    v_and_b32 v123, 0xffff0000, v33
    v_lshlrev_b32 v124, 16, v34
    v_and_b32 v125, 0xffff0000, v34
    v_lshlrev_b32 v126, 16, v35
    v_and_b32 v127, 0xffff0000, v35
    v_lshlrev_b32 v128, 16, v36
    v_and_b32 v129, 0xffff0000, v36
    v_lshlrev_b32 v130, 16, v37
    v_and_b32 v131, 0xffff0000, v37
    v_lshlrev_b32 v132, 16, v38
    v_and_b32 v133, 0xffff0000, v38
    v_lshlrev_b32 v134, 16, v39
    v_and_b32 v135, 0xffff0000, v39
    v_lshlrev_b32 v136, 16, v40
    v_and_b32 v137, 0xffff0000, v40
    v_lshlrev_b32 v138, 16, v41
    v_and_b32 v139, 0xffff0000, v41
    v_lshlrev_b32 v140, 16, v42
    v_and_b32 v141, 0xffff0000, v42
    v_lshlrev_b32 v142, 16, v43
    v_and_b32 v143, 0xffff0000, v43
    v_lshlrev_b32 v144, 16, v44
    v_and_b32 v145, 0xffff0000, v44
    v_lshlrev_b32 v146, 16, v45
    v_and_b32 v147, 0xffff0000, v45
    v_lshlrev_b32 v148, 16, v46
    v_and_b32 v149, 0xffff0000, v46
    v_lshlrev_b32 v150, 16, v47
    v_and_b32 v151, 0xffff0000, v47
    v_lshlrev_b32 v152, 16, v48
    v_and_b32 v153, 0xffff0000, v48
    v_lshlrev_b32 v154, 16, v49
    v_and_b32 v155, 0xffff0000, v49
    v_lshlrev_b32 v156, 16, v50
    v_and_b32 v157, 0xffff0000, v50
    v_lshlrev_b32 v158, 16, v51
    v_and_b32 v159, 0xffff0000, v51
    v_add_f32 v6, v88, v89
    v_add_f32 v7, v90, v91
    v_add_f32 v6, v6, v92
    v_add_f32 v6, v6, v93
    v_add_f32 v7, v7, v94
    v_add_f32 v7, v7, v95
    v_add_f32 v6, v6, v96
    v_add_f32 v6, v6, v97
    v_add_f32 v7, v7, v98
    v_add_f32 v7, v7, v99
    v_add_f32 v6, v6, v100
    v_add_f32 v6, v6, v101
    v_add_f32 v7, v7, v102
    v_add_f32 v7, v7, v103
    v_add_f32 v6, v6, v104
    v_add_f32 v6, v6, v105
    v_add_f32 v7, v7, v106
    v_add_f32 v7, v7, v107
    v_add_f32 v6, v6, v108
    v_add_f32 v6, v6, v109
    v_add_f32 v7, v7, v110
    v_add_f32 v7, v7, v111
    v_add_f32 v6, v6, v112
    v_add_f32 v6, v6, v113
    v_add_f32 v7, v7, v114
    v_add_f32 v7, v7, v115
    v_add_f32 v6, v6, v116
    v_add_f32 v6, v6, v117
    v_add_f32 v7, v7, v118
    v_add_f32 v7, v7, v119
    v_add_f32 v6, v6, v120
    v_add_f32 v6, v6, v121
    v_add_f32 v7, v7, v122
    v_add_f32 v7, v7, v123
    v_add_f32 v6, v6, v124
    v_add_f32 v6, v6, v125
    v_add_f32 v7, v7, v126
    v_add_f32 v7, v7, v127
    v_add_f32 v6, v6, v128
    v_add_f32 v6, v6, v129
    v_add_f32 v7, v7, v130
    v_add_f32 v7, v7, v131
    v_add_f32 v6, v6, v132
    v_add_f32 v6, v6, v133
    v_add_f32 v7, v7, v134
    v_add_f32 v7, v7, v135
    v_add_f32 v6, v6, v136
    v_add_f32 v6, v6, v137
    v_add_f32 v7, v7, v138
    v_add_f32 v7, v7, v139
    v_add_f32 v6, v6, v140
    v_add_f32 v6, v6, v141
    v_add_f32 v7, v7, v142
    v_add_f32 v7, v7, v143
    v_add_f32 v6, v6, v144
    v_add_f32 v6, v6, v145
    v_add_f32 v7, v7, v146
    v_add_f32 v7, v7, v147
    v_add_f32 v6, v6, v148
    v_add_f32 v6, v6, v149
    v_add_f32 v7, v7, v150
    v_add_f32 v7, v7, v151
    v_add_f32 v6, v6, v152
    v_add_f32 v6, v6, v153
    v_add_f32 v7, v7, v154
    v_add_f32 v7, v7, v155
    v_add_f32 v6, v6, v156
    v_add_f32 v6, v6, v157
    v_add_f32 v7, v7, v158
    v_add_f32 v7, v7, v159
    v_add_f32 v6, v6, v7
    s_nop 1
    v_add_f32_dpp v7, v6, v6 quad_perm:[1,0,3,2] row_mask:0xf bank_mask:0xf
    s_nop 1
    v_add_f32_dpp v6, v7, v7 quad_perm:[2,3,0,1] row_mask:0xf bank_mask:0xf
    s_nop 1
    v_add_f32_dpp v7, v6, v6 row_half_mirror row_mask:0xf bank_mask:0xf
    v_mov_b32 v6, v7
    v_mul_f32 v6, 0x3ae38e39, v6
    v_mov_b32 v10, 0
    v_mov_b32 v11, 0
    v_lshlrev_b32 v8, 16, v52
    v_and_b32 v9, 0xffff0000, v52
    v_mul_f32 v8, v8, v88
    v_mul_f32 v9, v9, v89
    v_cvt_pk_bf16_f32 v8, v8, v9
    v_and_b32 v9, 0xffff0000, v8
    v_lshlrev_b32 v8, 16, v8
    v_add_f32 v10, v10, v8
    v_add_f32 v11, v11, v9
    v_lshlrev_b32 v8, 16, v53
    v_and_b32 v9, 0xffff0000, v53
    v_mul_f32 v8, v8, v90
    v_mul_f32 v9, v9, v91
    v_cvt_pk_bf16_f32 v8, v8, v9
    v_and_b32 v9, 0xffff0000, v8
    v_lshlrev_b32 v8, 16, v8
    v_add_f32 v10, v10, v8
    v_add_f32 v11, v11, v9
    v_lshlrev_b32 v8, 16, v54
    v_and_b32 v9, 0xffff0000, v54
    v_mul_f32 v8, v8, v92
    v_mul_f32 v9, v9, v93
    v_cvt_pk_bf16_f32 v8, v8, v9
    v_and_b32 v9, 0xffff0000, v8
    v_lshlrev_b32 v8, 16, v8
    v_add_f32 v10, v10, v8
    v_add_f32 v11, v11, v9
    v_lshlrev_b32 v8, 16, v55
    v_and_b32 v9, 0xffff0000, v55
    v_mul_f32 v8, v8, v94
    v_mul_f32 v9, v9, v95
    v_cvt_pk_bf16_f32 v8, v8, v9
    v_and_b32 v9, 0xffff0000, v8
    v_lshlrev_b32 v8, 16, v8
    v_add_f32 v10, v10, v8
    v_add_f32 v11, v11, v9
    v_lshlrev_b32 v8, 16, v56
    v_and_b32 v9, 0xffff0000, v56
    v_mul_f32 v8, v8, v96
    v_mul_f32 v9, v9, v97
    v_cvt_pk_bf16_f32 v8, v8, v9
    v_and_b32 v9, 0xffff0000, v8
    v_lshlrev_b32 v8, 16, v8
    v_add_f32 v10, v10, v8
    v_add_f32 v11, v11, v9
    v_lshlrev_b32 v8, 16, v57
    v_and_b32 v9, 0xffff0000, v57
    v_mul_f32 v8, v8, v98
    v_mul_f32 v9, v9, v99
    v_cvt_pk_bf16_f32 v8, v8, v9
    v_and_b32 v9, 0xffff0000, v8
    v_lshlrev_b32 v8, 16, v8
    v_add_f32 v10, v10, v8
    v_add_f32 v11, v11, v9
    v_lshlrev_b32 v8, 16, v58
    v_and_b32 v9, 0xffff0000, v58
    v_mul_f32 v8, v8, v100
    v_mul_f32 v9, v9, v101
    v_cvt_pk_bf16_f32 v8, v8, v9
    v_and_b32 v9, 0xffff0000, v8
    v_lshlrev_b32 v8, 16, v8
    v_add_f32 v10, v10, v8
    v_add_f32 v11, v11, v9
    v_lshlrev_b32 v8, 16, v59
    v_and_b32 v9, 0xffff0000, v59
    v_mul_f32 v8, v8, v102
    v_mul_f32 v9, v9, v103
    v_cvt_pk_bf16_f32 v8, v8, v9
    v_and_b32 v9, 0xffff0000, v8
    v_lshlrev_b32 v8, 16, v8
    v_add_f32 v10, v10, v8
    v_add_f32 v11, v11, v9
    v_lshlrev_b32 v8, 16, v60
    v_and_b32 v9, 0xffff0000, v60
    v_mul_f32 v8, v8, v104
    v_mul_f32 v9, v9, v105
    v_cvt_pk_bf16_f32 v8, v8, v9
    v_and_b32 v9, 0xffff0000, v8
    v_lshlrev_b32 v8, 16, v8
    v_add_f32 v10, v10, v8
    v_add_f32 v11, v11, v9
    v_lshlrev_b32 v8, 16, v61
    v_and_b32 v9, 0xffff0000, v61
    v_mul_f32 v8, v8, v106
    v_mul_f32 v9, v9, v107
    v_cvt_pk_bf16_f32 v8, v8, v9
    v_and_b32 v9, 0xffff0000, v8
    v_lshlrev_b32 v8, 16, v8
    v_add_f32 v10, v10, v8
    v_add_f32 v11, v11, v9
    v_lshlrev_b32 v8, 16, v62
    v_and_b32 v9, 0xffff0000, v62
    v_mul_f32 v8, v8, v108
    v_mul_f32 v9, v9, v109
    v_cvt_pk_bf16_f32 v8, v8, v9
    v_and_b32 v9, 0xffff0000, v8
    v_lshlrev_b32 v8, 16, v8
    v_add_f32 v10, v10, v8
    v_add_f32 v11, v11, v9
    v_lshlrev_b32 v8, 16, v63
    v_and_b32 v9, 0xffff0000, v63
    v_mul_f32 v8, v8, v110
    v_mul_f32 v9, v9, v111
    v_cvt_pk_bf16_f32 v8, v8, v9
    v_and_b32 v9, 0xffff0000, v8
    v_lshlrev_b32 v8, 16, v8
    v_add_f32 v10, v10, v8
    v_add_f32 v11, v11, v9
    v_lshlrev_b32 v8, 16, v64
    v_and_b32 v9, 0xffff0000, v64
    v_mul_f32 v8, v8, v112
    v_mul_f32 v9, v9, v113
    v_cvt_pk_bf16_f32 v8, v8, v9
    v_and_b32 v9, 0xffff0000, v8
    v_lshlrev_b32 v8, 16, v8
    v_add_f32 v10, v10, v8
    v_add_f32 v11, v11, v9
    v_lshlrev_b32 v8, 16, v65
    v_and_b32 v9, 0xffff0000, v65
    v_mul_f32 v8, v8, v114
    v_mul_f32 v9, v9, v115
    v_cvt_pk_bf16_f32 v8, v8, v9
    v_and_b32 v9, 0xffff0000, v8
    v_lshlrev_b32 v8, 16, v8
    v_add_f32 v10, v10, v8
    v_add_f32 v11, v11, v9
    v_lshlrev_b32 v8, 16, v66
    v_and_b32 v9, 0xffff0000, v66
    v_mul_f32 v8, v8, v116
    v_mul_f32 v9, v9, v117
    v_cvt_pk_bf16_f32 v8, v8, v9
    v_and_b32 v9, 0xffff0000, v8
    v_lshlrev_b32 v8, 16, v8
    v_add_f32 v10, v10, v8
    v_add_f32 v11, v11, v9
    v_lshlrev_b32 v8, 16, v67
    v_and_b32 v9, 0xffff0000, v67
    v_mul_f32 v8, v8, v118
    v_mul_f32 v9, v9, v119
    v_cvt_pk_bf16_f32 v8, v8, v9
    v_and_b32 v9, 0xffff0000, v8
    v_lshlrev_b32 v8, 16, v8
    v_add_f32 v10, v10, v8
    v_add_f32 v11, v11, v9
    v_lshlrev_b32 v8, 16, v68
    v_and_b32 v9, 0xffff0000, v68
    v_mul_f32 v8, v8, v120
    v_mul_f32 v9, v9, v121
    v_cvt_pk_bf16_f32 v8, v8, v9
    v_and_b32 v9, 0xffff0000, v8
    v_lshlrev_b32 v8, 16, v8
    v_add_f32 v10, v10, v8
    v_add_f32 v11, v11, v9
    v_lshlrev_b32 v8, 16, v69
    v_and_b32 v9, 0xffff0000, v69
    v_mul_f32 v8, v8, v122
    v_mul_f32 v9, v9, v123
    v_cvt_pk_bf16_f32 v8, v8, v9
    v_and_b32 v9, 0xffff0000, v8
    v_lshlrev_b32 v8, 16, v8
    v_add_f32 v10, v10, v8
    v_add_f32 v11, v11, v9
    v_lshlrev_b32 v8, 16, v70
    v_and_b32 v9, 0xffff0000, v70
    v_mul_f32 v8, v8, v124
    v_mul_f32 v9, v9, v125
    v_cvt_pk_bf16_f32 v8, v8, v9
    v_and_b32 v9, 0xffff0000, v8
    v_lshlrev_b32 v8, 16, v8
    v_add_f32 v10, v10, v8
    v_add_f32 v11, v11, v9
    v_lshlrev_b32 v8, 16, v71
    v_and_b32 v9, 0xffff0000, v71
    v_mul_f32 v8, v8, v126
    v_mul_f32 v9, v9, v127
    v_cvt_pk_bf16_f32 v8, v8, v9
    v_and_b32 v9, 0xffff0000, v8
    v_lshlrev_b32 v8, 16, v8
    v_add_f32 v10, v10, v8
    v_add_f32 v11, v11, v9
    v_lshlrev_b32 v8, 16, v72
    v_and_b32 v9, 0xffff0000, v72
    v_mul_f32 v8, v8, v128
    v_mul_f32 v9, v9, v129
    v_cvt_pk_bf16_f32 v8, v8, v9
    v_and_b32 v9, 0xffff0000, v8
    v_lshlrev_b32 v8, 16, v8
    v_add_f32 v10, v10, v8
    v_add_f32 v11, v11, v9
    v_lshlrev_b32 v8, 16, v73
    v_and_b32 v9, 0xffff0000, v73
    v_mul_f32 v8, v8, v130
    v_mul_f32 v9, v9, v131
    v_cvt_pk_bf16_f32 v8, v8, v9
    v_and_b32 v9, 0xffff0000, v8
    v_lshlrev_b32 v8, 16, v8
    v_add_f32 v10, v10, v8
    v_add_f32 v11, v11, v9
    v_lshlrev_b32 v8, 16, v74
    v_and_b32 v9, 0xffff0000, v74
    v_mul_f32 v8, v8, v132
    v_mul_f32 v9, v9, v133
    v_cvt_pk_bf16_f32 v8, v8, v9
    v_and_b32 v9, 0xffff0000, v8
    v_lshlrev_b32 v8, 16, v8
    v_add_f32 v10, v10, v8
    v_add_f32 v11, v11, v9
    v_lshlrev_b32 v8, 16, v75
    v_and_b32 v9, 0xffff0000, v75
    v_mul_f32 v8, v8, v134
    v_mul_f32 v9, v9, v135
    v_cvt_pk_bf16_f32 v8, v8, v9
    v_and_b32 v9, 0xffff0000, v8
    v_lshlrev_b32 v8, 16, v8
    v_add_f32 v10, v10, v8
    v_add_f32 v11, v11, v9
    v_lshlrev_b32 v8, 16, v76
    v_and_b32 v9, 0xffff0000, v76
    v_mul_f32 v8, v8, v136
    v_mul_f32 v9, v9, v137
    v_cvt_pk_bf16_f32 v8, v8, v9
    v_and_b32 v9, 0xffff0000, v8
    v_lshlrev_b32 v8, 16, v8
    v_add_f32 v10, v10, v8
    v_add_f32 v11, v11, v9
    v_lshlrev_b32 v8, 16, v77
    v_and_b32 v9, 0xffff0000, v77
    v_mul_f32 v8, v8, v138
    v_mul_f32 v9, v9, v139
    v_cvt_pk_bf16_f32 v8, v8, v9
    v_and_b32 v9, 0xffff0000, v8
    v_lshlrev_b32 v8, 16, v8
    v_add_f32 v10, v10, v8
    v_add_f32 v11, v11, v9
    v_lshlrev_b32 v8, 16, v78
    v_and_b32 v9, 0xffff0000, v78
    v_mul_f32 v8, v8, v140
    v_mul_f32 v9, v9, v141
    v_cvt_pk_bf16_f32 v8, v8, v9
    v_and_b32 v9, 0xffff0000, v8
    v_lshlrev_b32 v8, 16, v8
    v_add_f32 v10, v10, v8
    v_add_f32 v11, v11, v9
    v_lshlrev_b32 v8, 16, v79
    v_and_b32 v9, 0xffff0000, v79
    v_mul_f32 v8, v8, v142
    v_mul_f32 v9, v9, v143
    v_cvt_pk_bf16_f32 v8, v8, v9
    v_and_b32 v9, 0xffff0000, v8
    v_lshlrev_b32 v8, 16, v8
    v_add_f32 v10, v10, v8
    v_add_f32 v11, v11, v9
    v_lshlrev_b32 v8, 16, v80
    v_and_b32 v9, 0xffff0000, v80
    v_mul_f32 v8, v8, v144
    v_mul_f32 v9, v9, v145
    v_cvt_pk_bf16_f32 v8, v8, v9
    v_and_b32 v9, 0xffff0000, v8
    v_lshlrev_b32 v8, 16, v8
    v_add_f32 v10, v10, v8
    v_add_f32 v11, v11, v9
    v_lshlrev_b32 v8, 16, v81
    v_and_b32 v9, 0xffff0000, v81
    v_mul_f32 v8, v8, v146
    v_mul_f32 v9, v9, v147
    v_cvt_pk_bf16_f32 v8, v8, v9
    v_and_b32 v9, 0xffff0000, v8
    v_lshlrev_b32 v8, 16, v8
    v_add_f32 v10, v10, v8
    v_add_f32 v11, v11, v9
    v_lshlrev_b32 v8, 16, v82
    v_and_b32 v9, 0xffff0000, v82
    v_mul_f32 v8, v8, v148
    v_mul_f32 v9, v9, v149
    v_cvt_pk_bf16_f32 v8, v8, v9
    v_and_b32 v9, 0xffff0000, v8
    v_lshlrev_b32 v8, 16, v8
    v_add_f32 v10, v10, v8
    v_add_f32 v11, v11, v9
    v_lshlrev_b32 v8, 16, v83
    v_and_b32 v9, 0xffff0000, v83
    v_mul_f32 v8, v8, v150
    v_mul_f32 v9, v9, v151
    v_cvt_pk_bf16_f32 v8, v8, v9
    v_and_b32 v9, 0xffff0000, v8
    v_lshlrev_b32 v8, 16, v8
    v_add_f32 v10, v10, v8
    v_add_f32 v11, v11, v9
    v_lshlrev_b32 v8, 16, v84
    v_and_b32 v9, 0xffff0000, v84
    v_mul_f32 v8, v8, v152
    v_mul_f32 v9, v9, v153
    v_cvt_pk_bf16_f32 v8, v8, v9
    v_and_b32 v9, 0xffff0000, v8
    v_lshlrev_b32 v8, 16, v8
    v_add_f32 v10, v10, v8
    v_add_f32 v11, v11, v9
    v_lshlrev_b32 v8, 16, v85
    v_and_b32 v9, 0xffff0000, v85
    v_mul_f32 v8, v8, v154
    v_mul_f32 v9, v9, v155
    v_cvt_pk_bf16_f32 v8, v8, v9
    v_and_b32 v9, 0xffff0000, v8
    v_lshlrev_b32 v8, 16, v8
    v_add_f32 v10, v10, v8
    v_add_f32 v11, v11, v9
    v_lshlrev_b32 v8, 16, v86
    v_and_b32 v9, 0xffff0000, v86
    v_mul_f32 v8, v8, v156
    v_mul_f32 v9, v9, v157
    v_cvt_pk_bf16_f32 v8, v8, v9
    v_and_b32 v9, 0xffff0000, v8
    v_lshlrev_b32 v8, 16, v8
    v_add_f32 v10, v10, v8
    v_add_f32 v11, v11, v9
    v_lshlrev_b32 v8, 16, v87
    v_and_b32 v9, 0xffff0000, v87
    v_mul_f32 v8, v8, v158
    v_mul_f32 v9, v9, v159
    v_cvt_pk_bf16_f32 v8, v8, v9
    v_and_b32 v9, 0xffff0000, v8
    v_lshlrev_b32 v8, 16, v8
    v_add_f32 v10, v10, v8
    v_add_f32 v11, v11, v9
    v_add_f32 v10, v10, v11
    s_nop 1
    v_add_f32_dpp v11, v10, v10 quad_perm:[1,0,3,2] row_mask:0xf bank_mask:0xf
    s_nop 1
    v_add_f32_dpp v10, v11, v11 quad_perm:[2,3,0,1] row_mask:0xf bank_mask:0xf
    s_nop 1
    v_add_f32_dpp v11, v10, v10 row_half_mirror row_mask:0xf bank_mask:0xf
    v_mov_b32 v10, v11
    v_cvt_pk_bf16_f32 v10, v10, v10
    v_lshlrev_b32 v10, 16, v10
    v_mul_f32 v10, 0xbfb8aa3b, v10
    v_exp_f32 v10, v10
    s_nop 0
    v_add_f32 v10, 1.0, v10
    v_rcp_f32 v10, v10
    s_nop 0
    v_cvt_pk_bf16_f32 v10, v10, v10
    v_lshlrev_b32 v10, 16, v10
    v_lshlrev_b32 v11, 2, v2
    v_cmp_eq_u32 vcc, 0, v3
    s_and_saveexec_b64 s[30:31], vcc
    buffer_store_dword v10, v11, s[20:23], 0 offen
    s_mov_b64 exec, s[30:31]
    s_lshl_b32 s6, s3, 2
    s_add_u32 s6, s6, s27
    s_lshl_b32 s6, s6, 10
    v_lshlrev_b32 v200, 4, v1
    v_add_u32 v200, s6, v200
    s_mov_b32 s36, s72
    s_mov_b32 s37, s73
    s_mov_b32 s38, 0x510000
    s_mov_b32 s39, 0x00020000
    s_mov_b32 s40, s68
    s_mov_b32 s41, s69
    s_mov_b32 s42, 0xa2000
    s_mov_b32 s43, 0x00020000
    s_mov_b32 s32, s76
    s_mov_b32 s33, s77
    s_mov_b32 s34, 0x510000
    s_mov_b32 s35, 0x00020000
    s_mov_b32 s6, 0
    buffer_load_dwordx4 v[160:163], v200, s[36:39], s6 offen
    v_mov_b32 v8, 0
    v_mov_b32 v9, 0
    v_sub_f32 v12, v88, v6
    v_fma_f32 v8, v12, v12, v8
    v_sub_f32 v12, v89, v6
    v_fma_f32 v9, v12, v12, v9
    v_sub_f32 v12, v90, v6
    v_fma_f32 v8, v12, v12, v8
    v_sub_f32 v12, v91, v6
    v_fma_f32 v9, v12, v12, v9
    v_sub_f32 v12, v92, v6
    v_fma_f32 v8, v12, v12, v8
    v_sub_f32 v12, v93, v6
    v_fma_f32 v9, v12, v12, v9
    v_sub_f32 v12, v94, v6
    v_fma_f32 v8, v12, v12, v8
    v_sub_f32 v12, v95, v6
    v_fma_f32 v9, v12, v12, v9
    v_sub_f32 v12, v96, v6
    v_fma_f32 v8, v12, v12, v8
    v_sub_f32 v12, v97, v6
    v_fma_f32 v9, v12, v12, v9
    v_sub_f32 v12, v98, v6
    v_fma_f32 v8, v12, v12, v8
    s_mov_b32 s6, 262144
    buffer_load_dwordx4 v[164:167], v200, s[36:39], s6 offen
    v_sub_f32 v12, v99, v6
    v_fma_f32 v9, v12, v12, v9
    v_sub_f32 v12, v100, v6
    v_fma_f32 v8, v12, v12, v8
    v_sub_f32 v12, v101, v6
    v_fma_f32 v9, v12, v12, v9
    v_sub_f32 v12, v102, v6
    v_fma_f32 v8, v12, v12, v8
    v_sub_f32 v12, v103, v6
    v_fma_f32 v9, v12, v12, v9
    v_sub_f32 v12, v104, v6
    v_fma_f32 v8, v12, v12, v8
    v_sub_f32 v12, v105, v6
    v_fma_f32 v9, v12, v12, v9
    v_sub_f32 v12, v106, v6
    v_fma_f32 v8, v12, v12, v8
    v_sub_f32 v12, v107, v6
    v_fma_f32 v9, v12, v12, v9
    v_sub_f32 v12, v108, v6
    v_fma_f32 v8, v12, v12, v8
    v_sub_f32 v12, v109, v6
    v_fma_f32 v9, v12, v12, v9
    v_sub_f32 v12, v110, v6
    v_fma_f32 v8, v12, v12, v8
    s_mov_b32 s6, 524288
    buffer_load_dwordx4 v[168:171], v200, s[36:39], s6 offen
    v_sub_f32 v12, v111, v6
    v_fma_f32 v9, v12, v12, v9
    v_sub_f32 v12, v112, v6
    v_fma_f32 v8, v12, v12, v8
    v_sub_f32 v12, v113, v6
    v_fma_f32 v9, v12, v12, v9
    v_sub_f32 v12, v114, v6
    v_fma_f32 v8, v12, v12, v8
    v_sub_f32 v12, v115, v6
    v_fma_f32 v9, v12, v12, v9
    v_sub_f32 v12, v116, v6
    v_fma_f32 v8, v12, v12, v8
    v_sub_f32 v12, v117, v6
    v_fma_f32 v9, v12, v12, v9
    v_sub_f32 v12, v118, v6
    v_fma_f32 v8, v12, v12, v8
    v_sub_f32 v12, v119, v6
    v_fma_f32 v9, v12, v12, v9
    v_sub_f32 v12, v120, v6
    v_fma_f32 v8, v12, v12, v8
    v_sub_f32 v12, v121, v6
    v_fma_f32 v9, v12, v12, v9
    v_sub_f32 v12, v122, v6
    v_fma_f32 v8, v12, v12, v8
    s_mov_b32 s6, 786432
    buffer_load_dwordx4 v[172:175], v200, s[36:39], s6 offen
    v_sub_f32 v12, v123, v6
    v_fma_f32 v9, v12, v12, v9
    v_sub_f32 v12, v124, v6
    v_fma_f32 v8, v12, v12, v8
    v_sub_f32 v12, v125, v6
    v_fma_f32 v9, v12, v12, v9
    v_sub_f32 v12, v126, v6
    v_fma_f32 v8, v12, v12, v8
    v_sub_f32 v12, v127, v6
    v_fma_f32 v9, v12, v12, v9
    v_sub_f32 v12, v128, v6
    v_fma_f32 v8, v12, v12, v8
    v_sub_f32 v12, v129, v6
    v_fma_f32 v9, v12, v12, v9
    v_sub_f32 v12, v130, v6
    v_fma_f32 v8, v12, v12, v8
    v_sub_f32 v12, v131, v6
    v_fma_f32 v9, v12, v12, v9
    v_sub_f32 v12, v132, v6
    v_fma_f32 v8, v12, v12, v8
    v_sub_f32 v12, v133, v6
    v_fma_f32 v9, v12, v12, v9
    v_sub_f32 v12, v134, v6
    v_fma_f32 v8, v12, v12, v8
    s_mov_b32 s6, 1048576
    buffer_load_dwordx4 v[176:179], v200, s[36:39], s6 offen
    v_sub_f32 v12, v135, v6
    v_fma_f32 v9, v12, v12, v9
    v_sub_f32 v12, v136, v6
    v_fma_f32 v8, v12, v12, v8
    v_sub_f32 v12, v137, v6
    v_fma_f32 v9, v12, v12, v9
    v_sub_f32 v12, v138, v6
    v_fma_f32 v8, v12, v12, v8
    v_sub_f32 v12, v139, v6
    v_fma_f32 v9, v12, v12, v9
    v_sub_f32 v12, v140, v6
    v_fma_f32 v8, v12, v12, v8
    v_sub_f32 v12, v141, v6
    v_fma_f32 v9, v12, v12, v9
    v_sub_f32 v12, v142, v6
    v_fma_f32 v8, v12, v12, v8
    v_sub_f32 v12, v143, v6
    v_fma_f32 v9, v12, v12, v9
    v_sub_f32 v12, v144, v6
    v_fma_f32 v8, v12, v12, v8
    v_sub_f32 v12, v145, v6
    v_fma_f32 v9, v12, v12, v9
    v_sub_f32 v12, v146, v6
    v_fma_f32 v8, v12, v12, v8
    s_mov_b32 s6, 1310720
    buffer_load_dwordx4 v[180:183], v200, s[36:39], s6 offen
    v_sub_f32 v12, v147, v6
    v_fma_f32 v9, v12, v12, v9
    v_sub_f32 v12, v148, v6
    v_fma_f32 v8, v12, v12, v8
    v_sub_f32 v12, v149, v6
    v_fma_f32 v9, v12, v12, v9
    v_sub_f32 v12, v150, v6
    v_fma_f32 v8, v12, v12, v8
    v_sub_f32 v12, v151, v6
    v_fma_f32 v9, v12, v12, v9
    v_sub_f32 v12, v152, v6
    v_fma_f32 v8, v12, v12, v8
    v_sub_f32 v12, v153, v6
    v_fma_f32 v9, v12, v12, v9
    v_sub_f32 v12, v154, v6
    v_fma_f32 v8, v12, v12, v8
    v_sub_f32 v12, v155, v6
    v_fma_f32 v9, v12, v12, v9
    v_sub_f32 v12, v156, v6
    v_fma_f32 v8, v12, v12, v8
    v_sub_f32 v12, v157, v6
    v_fma_f32 v9, v12, v12, v9
    v_sub_f32 v12, v158, v6
    v_fma_f32 v8, v12, v12, v8
    s_mov_b32 s6, 1572864
    buffer_load_dwordx4 v[184:187], v200, s[36:39], s6 offen
    v_sub_f32 v12, v159, v6
    v_fma_f32 v9, v12, v12, v9
    v_add_f32 v8, v8, v9
    s_nop 1
    v_add_f32_dpp v9, v8, v8 quad_perm:[1,0,3,2] row_mask:0xf bank_mask:0xf
    s_nop 1
    v_add_f32_dpp v8, v9, v9 quad_perm:[2,3,0,1] row_mask:0xf bank_mask:0xf
    s_nop 1
    v_add_f32_dpp v9, v8, v8 row_half_mirror row_mask:0xf bank_mask:0xf
    v_mov_b32 v8, v9
    v_mul_f32 v8, 0x3ae38e39, v8
    v_cvt_pk_bf16_f32 v8, v8, v8
    v_lshlrev_b32 v8, 16, v8
    v_add_f32 v8, 0x3727c5ac, v8
    v_cvt_pk_bf16_f32 v8, v8, v8
    v_lshlrev_b32 v8, 16, v8
    v_sqrt_f32 v8, v8
    s_nop 0
    v_cvt_pk_bf16_f32 v8, v8, v8
    v_lshlrev_b32 v8, 16, v8
    v_rcp_f32 v9, v8
    v_cvt_pk_bf16_f32 v6, v6, v6
    v_lshlrev_b32 v6, 16, v6
    v_sub_f32 v88, v88, v6
    s_mov_b32 s6, 1835008
    buffer_load_dwordx4 v[188:191], v200, s[36:39], s6 offen
    v_sub_f32 v89, v89, v6
    v_cvt_pk_bf16_f32 v12, v88, v89
    v_lshlrev_b32 v88, 16, v12
    v_and_b32 v89, 0xffff0000, v12
    v_mul_f32 v12, v88, v9
    v_fma_f32 v13, -v12, v8, v88
    v_fma_f32 v12, v13, v9, v12
    v_mul_f32 v14, v89, v9
    v_fma_f32 v15, -v14, v8, v89
    v_fma_f32 v14, v15, v9, v14
    v_cvt_pk_bf16_f32 v16, v12, v14
    v_sub_f32 v90, v90, v6
    v_sub_f32 v91, v91, v6
    v_cvt_pk_bf16_f32 v12, v90, v91
    v_lshlrev_b32 v90, 16, v12
    v_and_b32 v91, 0xffff0000, v12
    v_mul_f32 v12, v90, v9
    v_fma_f32 v13, -v12, v8, v90
    v_fma_f32 v12, v13, v9, v12
    v_mul_f32 v14, v91, v9
    v_fma_f32 v15, -v14, v8, v91
    v_fma_f32 v14, v15, v9, v14
    v_cvt_pk_bf16_f32 v17, v12, v14
    v_sub_f32 v92, v92, v6
    s_mov_b32 s6, 2097152
    buffer_load_dwordx4 v[160:163], v200, s[36:39], s6 offen
    v_sub_f32 v93, v93, v6
    v_cvt_pk_bf16_f32 v12, v92, v93
    v_lshlrev_b32 v92, 16, v12
    v_and_b32 v93, 0xffff0000, v12
    v_mul_f32 v12, v92, v9
    v_fma_f32 v13, -v12, v8, v92
    v_fma_f32 v12, v13, v9, v12
    v_mul_f32 v14, v93, v9
    v_fma_f32 v15, -v14, v8, v93
    v_fma_f32 v14, v15, v9, v14
    v_cvt_pk_bf16_f32 v18, v12, v14
    v_sub_f32 v94, v94, v6
    v_sub_f32 v95, v95, v6
    v_cvt_pk_bf16_f32 v12, v94, v95
    v_lshlrev_b32 v94, 16, v12
    v_and_b32 v95, 0xffff0000, v12
    v_mul_f32 v12, v94, v9
    v_fma_f32 v13, -v12, v8, v94
    v_fma_f32 v12, v13, v9, v12
    v_mul_f32 v14, v95, v9
    v_fma_f32 v15, -v14, v8, v95
    v_fma_f32 v14, v15, v9, v14
    v_cvt_pk_bf16_f32 v19, v12, v14
    v_sub_f32 v96, v96, v6
    s_mov_b32 s6, 2359296
    buffer_load_dwordx4 v[164:167], v200, s[36:39], s6 offen
    v_sub_f32 v97, v97, v6
    v_cvt_pk_bf16_f32 v12, v96, v97
    v_lshlrev_b32 v96, 16, v12
    v_and_b32 v97, 0xffff0000, v12
    v_mul_f32 v12, v96, v9
    v_fma_f32 v13, -v12, v8, v96
    v_fma_f32 v12, v13, v9, v12
    v_mul_f32 v14, v97, v9
    v_fma_f32 v15, -v14, v8, v97
    v_fma_f32 v14, v15, v9, v14
    v_cvt_pk_bf16_f32 v20, v12, v14
    v_sub_f32 v98, v98, v6
    v_sub_f32 v99, v99, v6
    v_cvt_pk_bf16_f32 v12, v98, v99
    v_lshlrev_b32 v98, 16, v12
    v_and_b32 v99, 0xffff0000, v12
    v_mul_f32 v12, v98, v9
    v_fma_f32 v13, -v12, v8, v98
    v_fma_f32 v12, v13, v9, v12
    v_mul_f32 v14, v99, v9
    v_fma_f32 v15, -v14, v8, v99
    v_fma_f32 v14, v15, v9, v14
    v_cvt_pk_bf16_f32 v21, v12, v14
    v_sub_f32 v100, v100, v6
    s_mov_b32 s6, 2621440
    buffer_load_dwordx4 v[168:171], v200, s[36:39], s6 offen
    v_sub_f32 v101, v101, v6
    v_cvt_pk_bf16_f32 v12, v100, v101
    v_lshlrev_b32 v100, 16, v12
    v_and_b32 v101, 0xffff0000, v12
    v_mul_f32 v12, v100, v9
    v_fma_f32 v13, -v12, v8, v100
    v_fma_f32 v12, v13, v9, v12
    v_mul_f32 v14, v101, v9
    v_fma_f32 v15, -v14, v8, v101
    v_fma_f32 v14, v15, v9, v14
    v_cvt_pk_bf16_f32 v22, v12, v14
    v_sub_f32 v102, v102, v6
    v_sub_f32 v103, v103, v6
    v_cvt_pk_bf16_f32 v12, v102, v103
    v_lshlrev_b32 v102, 16, v12
    v_and_b32 v103, 0xffff0000, v12
    v_mul_f32 v12, v102, v9
    v_fma_f32 v13, -v12, v8, v102
    v_fma_f32 v12, v13, v9, v12
    v_mul_f32 v14, v103, v9
    v_fma_f32 v15, -v14, v8, v103
    v_fma_f32 v14, v15, v9, v14
    v_cvt_pk_bf16_f32 v23, v12, v14
    v_sub_f32 v104, v104, v6
    s_mov_b32 s6, 2883584
    buffer_load_dwordx4 v[172:175], v200, s[36:39], s6 offen
    v_sub_f32 v105, v105, v6
    v_cvt_pk_bf16_f32 v12, v104, v105
    v_lshlrev_b32 v104, 16, v12
    v_and_b32 v105, 0xffff0000, v12
    v_mul_f32 v12, v104, v9
    v_fma_f32 v13, -v12, v8, v104
    v_fma_f32 v12, v13, v9, v12
    v_mul_f32 v14, v105, v9
    v_fma_f32 v15, -v14, v8, v105
    v_fma_f32 v14, v15, v9, v14
    v_cvt_pk_bf16_f32 v24, v12, v14
    v_sub_f32 v106, v106, v6
    v_sub_f32 v107, v107, v6
    v_cvt_pk_bf16_f32 v12, v106, v107
    v_lshlrev_b32 v106, 16, v12
    v_and_b32 v107, 0xffff0000, v12
    v_mul_f32 v12, v106, v9
    v_fma_f32 v13, -v12, v8, v106
    v_fma_f32 v12, v13, v9, v12
    v_mul_f32 v14, v107, v9
    v_fma_f32 v15, -v14, v8, v107
    v_fma_f32 v14, v15, v9, v14
    v_cvt_pk_bf16_f32 v25, v12, v14
    v_sub_f32 v108, v108, v6
    s_mov_b32 s6, 3145728
    buffer_load_dwordx4 v[176:179], v200, s[36:39], s6 offen
    v_sub_f32 v109, v109, v6
    v_cvt_pk_bf16_f32 v12, v108, v109
    v_lshlrev_b32 v108, 16, v12
    v_and_b32 v109, 0xffff0000, v12
    v_mul_f32 v12, v108, v9
    v_fma_f32 v13, -v12, v8, v108
    v_fma_f32 v12, v13, v9, v12
    v_mul_f32 v14, v109, v9
    v_fma_f32 v15, -v14, v8, v109
    v_fma_f32 v14, v15, v9, v14
    v_cvt_pk_bf16_f32 v26, v12, v14
    v_sub_f32 v110, v110, v6
    v_sub_f32 v111, v111, v6
    v_cvt_pk_bf16_f32 v12, v110, v111
    v_lshlrev_b32 v110, 16, v12
    v_and_b32 v111, 0xffff0000, v12
    v_mul_f32 v12, v110, v9
    v_fma_f32 v13, -v12, v8, v110
    v_fma_f32 v12, v13, v9, v12
    v_mul_f32 v14, v111, v9
    v_fma_f32 v15, -v14, v8, v111
    v_fma_f32 v14, v15, v9, v14
    v_cvt_pk_bf16_f32 v27, v12, v14
    v_sub_f32 v112, v112, v6
    s_mov_b32 s6, 3407872
    buffer_load_dwordx4 v[180:183], v200, s[36:39], s6 offen
    v_sub_f32 v113, v113, v6
    v_cvt_pk_bf16_f32 v12, v112, v113
    v_lshlrev_b32 v112, 16, v12
    v_and_b32 v113, 0xffff0000, v12
    v_mul_f32 v12, v112, v9
    v_fma_f32 v13, -v12, v8, v112
    v_fma_f32 v12, v13, v9, v12
    v_mul_f32 v14, v113, v9
    v_fma_f32 v15, -v14, v8, v113
    v_fma_f32 v14, v15, v9, v14
    v_cvt_pk_bf16_f32 v28, v12, v14
    v_sub_f32 v114, v114, v6
    v_sub_f32 v115, v115, v6
    v_cvt_pk_bf16_f32 v12, v114, v115
    v_lshlrev_b32 v114, 16, v12
    v_and_b32 v115, 0xffff0000, v12
    v_mul_f32 v12, v114, v9
    v_fma_f32 v13, -v12, v8, v114
    v_fma_f32 v12, v13, v9, v12
    v_mul_f32 v14, v115, v9
    v_fma_f32 v15, -v14, v8, v115
    v_fma_f32 v14, v15, v9, v14
    v_cvt_pk_bf16_f32 v29, v12, v14
    v_sub_f32 v116, v116, v6
    s_mov_b32 s6, 3670016
    buffer_load_dwordx4 v[184:187], v200, s[36:39], s6 offen
    v_sub_f32 v117, v117, v6
    v_cvt_pk_bf16_f32 v12, v116, v117
    v_lshlrev_b32 v116, 16, v12
    v_and_b32 v117, 0xffff0000, v12
    v_mul_f32 v12, v116, v9
    v_fma_f32 v13, -v12, v8, v116
    v_fma_f32 v12, v13, v9, v12
    v_mul_f32 v14, v117, v9
    v_fma_f32 v15, -v14, v8, v117
    v_fma_f32 v14, v15, v9, v14
    v_cvt_pk_bf16_f32 v30, v12, v14
    v_sub_f32 v118, v118, v6
    v_sub_f32 v119, v119, v6
    v_cvt_pk_bf16_f32 v12, v118, v119
    v_lshlrev_b32 v118, 16, v12
    v_and_b32 v119, 0xffff0000, v12
    v_mul_f32 v12, v118, v9
    v_fma_f32 v13, -v12, v8, v118
    v_fma_f32 v12, v13, v9, v12
    v_mul_f32 v14, v119, v9
    v_fma_f32 v15, -v14, v8, v119
    v_fma_f32 v14, v15, v9, v14
    v_cvt_pk_bf16_f32 v31, v12, v14
    v_sub_f32 v120, v120, v6
    s_mov_b32 s6, 3932160
    buffer_load_dwordx4 v[188:191], v200, s[36:39], s6 offen
    v_sub_f32 v121, v121, v6
    v_cvt_pk_bf16_f32 v12, v120, v121
    v_lshlrev_b32 v120, 16, v12
    v_and_b32 v121, 0xffff0000, v12
    v_mul_f32 v12, v120, v9
    v_fma_f32 v13, -v12, v8, v120
    v_fma_f32 v12, v13, v9, v12
    v_mul_f32 v14, v121, v9
    v_fma_f32 v15, -v14, v8, v121
    v_fma_f32 v14, v15, v9, v14
    v_cvt_pk_bf16_f32 v32, v12, v14
    v_sub_f32 v122, v122, v6
    v_sub_f32 v123, v123, v6
    v_cvt_pk_bf16_f32 v12, v122, v123
    v_lshlrev_b32 v122, 16, v12
    v_and_b32 v123, 0xffff0000, v12
    v_mul_f32 v12, v122, v9
    v_fma_f32 v13, -v12, v8, v122
    v_fma_f32 v12, v13, v9, v12
    v_mul_f32 v14, v123, v9
    v_fma_f32 v15, -v14, v8, v123
    v_fma_f32 v14, v15, v9, v14
    v_cvt_pk_bf16_f32 v33, v12, v14
    v_sub_f32 v124, v124, v6
    s_mov_b32 s6, 4194304
    buffer_load_dwordx4 v[160:163], v200, s[36:39], s6 offen
    v_sub_f32 v125, v125, v6
    v_cvt_pk_bf16_f32 v12, v124, v125
    v_lshlrev_b32 v124, 16, v12
    v_and_b32 v125, 0xffff0000, v12
    v_mul_f32 v12, v124, v9
    v_fma_f32 v13, -v12, v8, v124
    v_fma_f32 v12, v13, v9, v12
    v_mul_f32 v14, v125, v9
    v_fma_f32 v15, -v14, v8, v125
    v_fma_f32 v14, v15, v9, v14
    v_cvt_pk_bf16_f32 v34, v12, v14
    v_sub_f32 v126, v126, v6
    v_sub_f32 v127, v127, v6
    v_cvt_pk_bf16_f32 v12, v126, v127
    v_lshlrev_b32 v126, 16, v12
    v_and_b32 v127, 0xffff0000, v12
    v_mul_f32 v12, v126, v9
    v_fma_f32 v13, -v12, v8, v126
    v_fma_f32 v12, v13, v9, v12
    v_mul_f32 v14, v127, v9
    v_fma_f32 v15, -v14, v8, v127
    v_fma_f32 v14, v15, v9, v14
    v_cvt_pk_bf16_f32 v35, v12, v14
    v_sub_f32 v128, v128, v6
    s_mov_b32 s6, 4456448
    buffer_load_dwordx4 v[164:167], v200, s[36:39], s6 offen
    v_sub_f32 v129, v129, v6
    v_cvt_pk_bf16_f32 v12, v128, v129
    v_lshlrev_b32 v128, 16, v12
    v_and_b32 v129, 0xffff0000, v12
    v_mul_f32 v12, v128, v9
    v_fma_f32 v13, -v12, v8, v128
    v_fma_f32 v12, v13, v9, v12
    v_mul_f32 v14, v129, v9
    v_fma_f32 v15, -v14, v8, v129
    v_fma_f32 v14, v15, v9, v14
    v_cvt_pk_bf16_f32 v36, v12, v14
    v_sub_f32 v130, v130, v6
    v_sub_f32 v131, v131, v6
    v_cvt_pk_bf16_f32 v12, v130, v131
    v_lshlrev_b32 v130, 16, v12
    v_and_b32 v131, 0xffff0000, v12
    v_mul_f32 v12, v130, v9
    v_fma_f32 v13, -v12, v8, v130
    v_fma_f32 v12, v13, v9, v12
    v_mul_f32 v14, v131, v9
    v_fma_f32 v15, -v14, v8, v131
    v_fma_f32 v14, v15, v9, v14
    v_cvt_pk_bf16_f32 v37, v12, v14
    v_sub_f32 v132, v132, v6
    s_mov_b32 s6, 4718592
    buffer_load_dwordx4 v[168:171], v200, s[36:39], s6 offen
    v_sub_f32 v133, v133, v6
    v_cvt_pk_bf16_f32 v12, v132, v133
    v_lshlrev_b32 v132, 16, v12
    v_and_b32 v133, 0xffff0000, v12
    v_mul_f32 v12, v132, v9
    v_fma_f32 v13, -v12, v8, v132
    v_fma_f32 v12, v13, v9, v12
    v_mul_f32 v14, v133, v9
    v_fma_f32 v15, -v14, v8, v133
    v_fma_f32 v14, v15, v9, v14
    v_cvt_pk_bf16_f32 v38, v12, v14
    v_sub_f32 v134, v134, v6
    v_sub_f32 v135, v135, v6
    v_cvt_pk_bf16_f32 v12, v134, v135
    v_lshlrev_b32 v134, 16, v12
    v_and_b32 v135, 0xffff0000, v12
    v_mul_f32 v12, v134, v9
    v_fma_f32 v13, -v12, v8, v134
    v_fma_f32 v12, v13, v9, v12
    v_mul_f32 v14, v135, v9
    v_fma_f32 v15, -v14, v8, v135
    v_fma_f32 v14, v15, v9, v14
    v_cvt_pk_bf16_f32 v39, v12, v14
    v_sub_f32 v136, v136, v6
    s_mov_b32 s6, 4980736
    buffer_load_dwordx4 v[172:175], v200, s[36:39], s6 offen
    v_sub_f32 v137, v137, v6
    v_cvt_pk_bf16_f32 v12, v136, v137
    v_lshlrev_b32 v136, 16, v12
    v_and_b32 v137, 0xffff0000, v12
    v_mul_f32 v12, v136, v9
    v_fma_f32 v13, -v12, v8, v136
    v_fma_f32 v12, v13, v9, v12
    v_mul_f32 v14, v137, v9
    v_fma_f32 v15, -v14, v8, v137
    v_fma_f32 v14, v15, v9, v14
    v_cvt_pk_bf16_f32 v40, v12, v14
    v_sub_f32 v138, v138, v6
    v_sub_f32 v139, v139, v6
    v_cvt_pk_bf16_f32 v12, v138, v139
    v_lshlrev_b32 v138, 16, v12
    v_and_b32 v139, 0xffff0000, v12
    v_mul_f32 v12, v138, v9
    v_fma_f32 v13, -v12, v8, v138
    v_fma_f32 v12, v13, v9, v12
    v_mul_f32 v14, v139, v9
    v_fma_f32 v15, -v14, v8, v139
    v_fma_f32 v14, v15, v9, v14
    v_cvt_pk_bf16_f32 v41, v12, v14
    v_sub_f32 v140, v140, v6
    s_mov_b32 s6, 5242880
    buffer_load_dwordx4 v[176:179], v200, s[36:39], s6 offen
    v_sub_f32 v141, v141, v6
    v_cvt_pk_bf16_f32 v12, v140, v141
    v_lshlrev_b32 v140, 16, v12
    v_and_b32 v141, 0xffff0000, v12
    v_mul_f32 v12, v140, v9
    v_fma_f32 v13, -v12, v8, v140
    v_fma_f32 v12, v13, v9, v12
    v_mul_f32 v14, v141, v9
    v_fma_f32 v15, -v14, v8, v141
    v_fma_f32 v14, v15, v9, v14
    v_cvt_pk_bf16_f32 v42, v12, v14
    v_sub_f32 v142, v142, v6
    v_sub_f32 v143, v143, v6
    v_cvt_pk_bf16_f32 v12, v142, v143
    v_lshlrev_b32 v142, 16, v12
    v_and_b32 v143, 0xffff0000, v12
    v_mul_f32 v12, v142, v9
    v_fma_f32 v13, -v12, v8, v142
    v_fma_f32 v12, v13, v9, v12
    v_mul_f32 v14, v143, v9
    v_fma_f32 v15, -v14, v8, v143
    v_fma_f32 v14, v15, v9, v14
    v_cvt_pk_bf16_f32 v43, v12, v14
    v_sub_f32 v144, v144, v6
    s_mov_b32 s6, 0
    buffer_load_dwordx4 v[160:163], v200, s[40:43], s6 offen
    v_sub_f32 v145, v145, v6
    v_cvt_pk_bf16_f32 v12, v144, v145
    v_lshlrev_b32 v144, 16, v12
    v_and_b32 v145, 0xffff0000, v12
    v_mul_f32 v12, v144, v9
    v_fma_f32 v13, -v12, v8, v144
    v_fma_f32 v12, v13, v9, v12
    v_mul_f32 v14, v145, v9
    v_fma_f32 v15, -v14, v8, v145
    v_fma_f32 v14, v15, v9, v14
    v_cvt_pk_bf16_f32 v44, v12, v14
    v_sub_f32 v146, v146, v6
    v_sub_f32 v147, v147, v6
    v_cvt_pk_bf16_f32 v12, v146, v147
    v_lshlrev_b32 v146, 16, v12
    v_and_b32 v147, 0xffff0000, v12
    v_mul_f32 v12, v146, v9
    v_fma_f32 v13, -v12, v8, v146
    v_fma_f32 v12, v13, v9, v12
    v_mul_f32 v14, v147, v9
    v_fma_f32 v15, -v14, v8, v147
    v_fma_f32 v14, v15, v9, v14
    v_cvt_pk_bf16_f32 v45, v12, v14
    v_sub_f32 v148, v148, v6
    s_mov_b32 s6, 262144
    buffer_load_dwordx4 v[164:167], v200, s[40:43], s6 offen
    v_sub_f32 v149, v149, v6
    v_cvt_pk_bf16_f32 v12, v148, v149
    v_lshlrev_b32 v148, 16, v12
    v_and_b32 v149, 0xffff0000, v12
    v_mul_f32 v12, v148, v9
    v_fma_f32 v13, -v12, v8, v148
    v_fma_f32 v12, v13, v9, v12
    v_mul_f32 v14, v149, v9
    v_fma_f32 v15, -v14, v8, v149
    v_fma_f32 v14, v15, v9, v14
    v_cvt_pk_bf16_f32 v46, v12, v14
    v_sub_f32 v150, v150, v6
    v_sub_f32 v151, v151, v6
    v_cvt_pk_bf16_f32 v12, v150, v151
    v_lshlrev_b32 v150, 16, v12
    v_and_b32 v151, 0xffff0000, v12
    v_mul_f32 v12, v150, v9
    v_fma_f32 v13, -v12, v8, v150
    v_fma_f32 v12, v13, v9, v12
    v_mul_f32 v14, v151, v9
    v_fma_f32 v15, -v14, v8, v151
    v_fma_f32 v14, v15, v9, v14
    v_cvt_pk_bf16_f32 v47, v12, v14
    v_sub_f32 v152, v152, v6
    s_mov_b32 s6, 524288
    buffer_load_dwordx4 v[168:171], v200, s[40:43], s6 offen
    v_sub_f32 v153, v153, v6
    v_cvt_pk_bf16_f32 v12, v152, v153
    v_lshlrev_b32 v152, 16, v12
    v_and_b32 v153, 0xffff0000, v12
    v_mul_f32 v12, v152, v9
    v_fma_f32 v13, -v12, v8, v152
    v_fma_f32 v12, v13, v9, v12
    v_mul_f32 v14, v153, v9
    v_fma_f32 v15, -v14, v8, v153
    v_fma_f32 v14, v15, v9, v14
    v_cvt_pk_bf16_f32 v48, v12, v14
    v_sub_f32 v154, v154, v6
    v_sub_f32 v155, v155, v6
    v_cvt_pk_bf16_f32 v12, v154, v155
    v_lshlrev_b32 v154, 16, v12
    v_and_b32 v155, 0xffff0000, v12
    v_mul_f32 v12, v154, v9
    v_fma_f32 v13, -v12, v8, v154
    v_fma_f32 v12, v13, v9, v12
    v_mul_f32 v14, v155, v9
    v_fma_f32 v15, -v14, v8, v155
    v_fma_f32 v14, v15, v9, v14
    v_cvt_pk_bf16_f32 v49, v12, v14
    v_sub_f32 v156, v156, v6
    v_sub_f32 v157, v157, v6
    v_cvt_pk_bf16_f32 v12, v156, v157
    v_lshlrev_b32 v156, 16, v12
    v_and_b32 v157, 0xffff0000, v12
    v_mul_f32 v12, v156, v9
    v_fma_f32 v13, -v12, v8, v156
    v_fma_f32 v12, v13, v9, v12
    v_mul_f32 v14, v157, v9
    v_fma_f32 v15, -v14, v8, v157
    v_fma_f32 v14, v15, v9, v14
    v_cvt_pk_bf16_f32 v50, v12, v14
    v_sub_f32 v158, v158, v6
    v_sub_f32 v159, v159, v6
    v_cvt_pk_bf16_f32 v12, v158, v159
    v_lshlrev_b32 v158, 16, v12
    v_and_b32 v159, 0xffff0000, v12
    v_mul_f32 v12, v158, v9
    v_fma_f32 v13, -v12, v8, v158
    v_fma_f32 v12, v13, v9, v12
    v_mul_f32 v14, v159, v9
    v_fma_f32 v15, -v14, v8, v159
    v_fma_f32 v14, v15, v9, v14
    v_cvt_pk_bf16_f32 v51, v12, v14
    v_lshrrev_b32 v5, 4, v2
    v_mul_u32_u24 v5, 18432, v5
    v_lshrrev_b32 v4, 2, v3
    v_lshlrev_b32 v4, 10, v4
    v_add_u32 v5, v5, v4
    v_and_b32 v4, 3, v3
    v_lshlrev_b32 v4, 8, v4
    v_add_u32 v5, v5, v4
    v_and_b32 v4, 15, v2
    v_lshlrev_b32 v4, 4, v4
    v_add_u32 v5, v5, v4
    s_mov_b32 s28, 0
    buffer_store_dwordx4 v[16:19], v5, s[16:19], s28 offen offset:0 sc1
    s_mov_b32 s28, 0
    buffer_store_dwordx4 v[20:23], v5, s[16:19], s28 offen offset:2048 sc1
    s_mov_b32 s28, 4096
    buffer_store_dwordx4 v[24:27], v5, s[16:19], s28 offen offset:0 sc1
    s_mov_b32 s28, 4096
    buffer_store_dwordx4 v[28:31], v5, s[16:19], s28 offen offset:2048 sc1
    s_mov_b32 s28, 8192
    buffer_store_dwordx4 v[32:35], v5, s[16:19], s28 offen offset:0 sc1
    s_mov_b32 s28, 8192
    buffer_store_dwordx4 v[36:39], v5, s[16:19], s28 offen offset:2048 sc1
    s_mov_b32 s28, 12288
    buffer_store_dwordx4 v[40:43], v5, s[16:19], s28 offen offset:0 sc1
    s_mov_b32 s28, 12288
    buffer_store_dwordx4 v[44:47], v5, s[16:19], s28 offen offset:2048 sc1
    s_mov_b32 s28, 16384
    buffer_store_dwordx4 v[48:51], v5, s[16:19], s28 offen offset:0 sc1
    s_endpgm
k1_q:
    s_lshr_b32 s4, s3, 4
    s_and_b32 s3, s3, 15
    s_mov_b32 s8, s64
    s_mov_b32 s9, s65
    s_mov_b32 s10, 0x240000
    s_mov_b32 s11, 0x00020000
    s_mov_b32 s12, s66
    s_mov_b32 s13, s67
    s_mov_b32 s14, 0x1e6000
    s_mov_b32 s15, 0x00020000
    s_mul_i32 s25, s4, 288
    s_mov_b32 s26, 0
    s_lshl_b32 s28, s3, 2
    s_add_u32 s33, s28, s27
    s_lshl_b32 s28, s33, 5
    v_and_b32 v2, 15, v1
    v_add_u32 v2, s28, v2
    v_mul_u32_u24 v2, 1152, v2
    v_lshrrev_b32 v3, 4, v1
    v_lshlrev_b32 v3, 4, v3
    v_add_u32 v124, v2, v3
    v_add_u32 v125, 18432, v124
    s_mul_i32 s24, s27, 5120
    s_mul_i32 s28, s27, 320
    s_add_u32 s29, s28, 0
    v_add_u32 v2, s29, v1
    v_mul_u32_u24 v3, 3641, v2
    v_lshrrev_b32 v3, 16, v3
    v_mul_u32_u24 v4, 18, v3
    v_sub_u32 v4, v2, v4
    v_and_b32 v5, 0x33, v3
    v_and_b32 v6, 4, v3
    v_lshlrev_b32 v6, 1, v6
    v_and_b32 v7, 8, v3
    v_lshrrev_b32 v7, 1, v7
    v_or3_b32 v3, v5, v6, v7
    v_lshlrev_b32 v4, 4, v4
    v_mul_u32_u24 v3, 3456, v3
    v_add_u32 v3, v3, v4
    v_mov_b32 v126, v3
    s_add_u32 s29, s28, 64
    v_add_u32 v2, s29, v1
    v_mul_u32_u24 v3, 3641, v2
    v_lshrrev_b32 v3, 16, v3
    v_mul_u32_u24 v4, 18, v3
    v_sub_u32 v4, v2, v4
    v_and_b32 v5, 0x33, v3
    v_and_b32 v6, 4, v3
    v_lshlrev_b32 v6, 1, v6
    v_and_b32 v7, 8, v3
    v_lshrrev_b32 v7, 1, v7
    v_or3_b32 v3, v5, v6, v7
    v_lshlrev_b32 v4, 4, v4
    v_mul_u32_u24 v3, 3456, v3
    v_add_u32 v3, v3, v4
    v_subrev_u32 v127, 1024, v3
    s_add_u32 s29, s28, 128
    v_add_u32 v2, s29, v1
    v_mul_u32_u24 v3, 3641, v2
    v_lshrrev_b32 v3, 16, v3
    v_mul_u32_u24 v4, 18, v3
    v_sub_u32 v4, v2, v4
    v_and_b32 v5, 0x33, v3
    v_and_b32 v6, 4, v3
    v_lshlrev_b32 v6, 1, v6
    v_and_b32 v7, 8, v3
    v_lshrrev_b32 v7, 1, v7
    v_or3_b32 v3, v5, v6, v7
    v_lshlrev_b32 v4, 4, v4
    v_mul_u32_u24 v3, 3456, v3
    v_add_u32 v3, v3, v4
    v_subrev_u32 v128, 2048, v3
    s_add_u32 s29, s28, 192
    s_cmp_ge_u32 s29, 1152
    s_cselect_b32 s30, 128, 0
    s_sub_u32 s29, s29, s30
    v_add_u32 v2, s29, v1
    v_mul_u32_u24 v3, 3641, v2
    v_lshrrev_b32 v3, 16, v3
    v_mul_u32_u24 v4, 18, v3
    v_sub_u32 v4, v2, v4
    v_and_b32 v5, 0x33, v3
    v_and_b32 v6, 4, v3
    v_lshlrev_b32 v6, 1, v6
    v_and_b32 v7, 8, v3
    v_lshrrev_b32 v7, 1, v7
    v_or3_b32 v3, v5, v6, v7
    v_lshlrev_b32 v4, 4, v4
    v_mul_u32_u24 v3, 3456, v3
    v_add_u32 v3, v3, v4
    v_subrev_u32 v129, 3072, v3
    s_add_u32 s29, s28, 256
    s_cmp_ge_u32 s29, 1152
    s_cselect_b32 s30, 128, 0
    s_sub_u32 s29, s29, s30
    v_add_u32 v2, s29, v1
    v_mul_u32_u24 v3, 3641, v2
    v_lshrrev_b32 v3, 16, v3
    v_mul_u32_u24 v4, 18, v3
    v_sub_u32 v4, v2, v4
    v_and_b32 v5, 0x33, v3
    v_and_b32 v6, 4, v3
    v_lshlrev_b32 v6, 1, v6
    v_and_b32 v7, 8, v3
    v_lshrrev_b32 v7, 1, v7
    v_or3_b32 v3, v5, v6, v7
    v_lshlrev_b32 v4, 4, v4
    v_mul_u32_u24 v3, 3456, v3
    v_add_u32 v3, v3, v4
    v_mov_b32 v130, v3
    v_lshrrev_b32 v2, 4, v1
    v_and_b32 v3, 15, v1
    v_lshrrev_b32 v4, 2, v3
    v_lshrrev_b32 v5, 1, v2
    v_lshlrev_b32 v5, 4, v5
    v_and_b32 v6, 1, v2
    v_lshlrev_b32 v6, 2, v6
    v_add3_u32 v4, v4, v5, v6
    v_mul_u32_u24 v4, 288, v4
    v_and_b32 v3, 3, v3
    v_lshlrev_b32 v3, 3, v3
    v_add_u32 v131, v4, v3
    s_add_u32 m0, s24, 0
    s_nop 0
    buffer_load_dwordx4 v126, s[12:15], s25 offen offset:0 lds
    s_add_u32 m0, s24, 0
    s_nop 0
    buffer_load_dwordx4 v127, s[12:15], s25 offen offset:1024 lds
    s_add_u32 m0, s24, 0
    s_nop 0
    buffer_load_dwordx4 v128, s[12:15], s25 offen offset:2048 lds
    s_add_u32 m0, s24, 0
    s_nop 0
    buffer_load_dwordx4 v129, s[12:15], s25 offen offset:3072 lds
    s_add_u32 m0, s24, 4096
    s_nop 0
    buffer_load_dwordx4 v130, s[12:15], s25 offen offset:0 lds
    s_add_u32 s25, s25, 221184
    buffer_load_dwordx4 v[88:91], v124, s[8:11], s26 offen offset:0
    buffer_load_dwordx4 v[92:95], v125, s[8:11], s26 offen offset:0
    s_add_u32 m0, s24, 20480
    s_nop 0
    buffer_load_dwordx4 v126, s[12:15], s25 offen offset:0 lds
    s_add_u32 m0, s24, 20480
    s_nop 0
    buffer_load_dwordx4 v127, s[12:15], s25 offen offset:1024 lds
    s_add_u32 m0, s24, 20480
    s_nop 0
    buffer_load_dwordx4 v128, s[12:15], s25 offen offset:2048 lds
    s_add_u32 m0, s24, 20480
    s_nop 0
    buffer_load_dwordx4 v129, s[12:15], s25 offen offset:3072 lds
    s_add_u32 m0, s24, 24576
    s_nop 0
    buffer_load_dwordx4 v130, s[12:15], s25 offen offset:0 lds
    s_add_u32 s25, s25, 221184
    buffer_load_dwordx4 v[96:99], v124, s[8:11], s26 offen offset:64
    buffer_load_dwordx4 v[100:103], v125, s[8:11], s26 offen offset:64
    s_add_u32 m0, s24, 40960
    s_nop 0
    buffer_load_dwordx4 v126, s[12:15], s25 offen offset:0 lds
    s_add_u32 m0, s24, 40960
    s_nop 0
    buffer_load_dwordx4 v127, s[12:15], s25 offen offset:1024 lds
    s_add_u32 m0, s24, 40960
    s_nop 0
    buffer_load_dwordx4 v128, s[12:15], s25 offen offset:2048 lds
    s_add_u32 m0, s24, 40960
    s_nop 0
    buffer_load_dwordx4 v129, s[12:15], s25 offen offset:3072 lds
    s_add_u32 m0, s24, 45056
    s_nop 0
    buffer_load_dwordx4 v130, s[12:15], s25 offen offset:0 lds
    s_add_u32 s25, s25, 221184
    s_lshr_b32 s5, s4, 2
    s_cmp_eq_u32 s5, 2
    s_mov_b32 s34, 1024
    s_cmov_b32 s34, 32
    s_mov_b32 s35, 512
    s_cmov_b32 s35, 16
    s_mov_b32 s37, 16
    s_cmov_b32 s37, 64
    s_lshl_b32 s28, s27, 14
    v_and_b32 v2, 15, v1
    v_mul_lo_u32 v10, v2, s37
    v_add_u32 v10, s28, v10
    s_lshl_b32 s29, s37, 4
    v_lshrrev_b32 v3, 4, v1
    v_lshlrev_b32 v3, 2, v3
    v_add_u32 v4, 0, v3
    v_mul_u32_u24 v5, 3641, v4
    v_lshrrev_b32 v5, 16, v5
    v_mul_u32_u24 v6, 18, v5
    v_sub_u32 v6, v4, v6
    v_lshlrev_b32 v5, 11, v5
    v_lshrrev_b32 v7, 4, v6
    v_mul_lo_u32 v7, v7, s34
    v_add_u32 v5, v5, v7
    v_bfe_u32 v7, v6, 3, 1
    v_mul_lo_u32 v7, v7, s35
    v_add_u32 v5, v5, v7
    v_and_b32 v7, 7, v6
    v_lshlrev_b32 v7, 1, v7
    v_add3_u32 v132, v5, v7, v10
    v_add_u32 v133, s29, v132
    v_add_u32 v4, 2, v3
    v_mul_u32_u24 v5, 3641, v4
    v_lshrrev_b32 v5, 16, v5
    v_mul_u32_u24 v6, 18, v5
    v_sub_u32 v6, v4, v6
    v_lshlrev_b32 v5, 11, v5
    v_lshrrev_b32 v7, 4, v6
    v_mul_lo_u32 v7, v7, s34
    v_add_u32 v5, v5, v7
    v_bfe_u32 v7, v6, 3, 1
    v_mul_lo_u32 v7, v7, s35
    v_add_u32 v5, v5, v7
    v_and_b32 v7, 7, v6
    v_lshlrev_b32 v7, 1, v7
    v_add3_u32 v134, v5, v7, v10
    v_add_u32 v135, s29, v134
    v_add_u32 v4, 16, v3
    v_mul_u32_u24 v5, 3641, v4
    v_lshrrev_b32 v5, 16, v5
    v_mul_u32_u24 v6, 18, v5
    v_sub_u32 v6, v4, v6
    v_lshlrev_b32 v5, 11, v5
    v_lshrrev_b32 v7, 4, v6
    v_mul_lo_u32 v7, v7, s34
    v_add_u32 v5, v5, v7
    v_bfe_u32 v7, v6, 3, 1
    v_mul_lo_u32 v7, v7, s35
    v_add_u32 v5, v5, v7
    v_and_b32 v7, 7, v6
    v_lshlrev_b32 v7, 1, v7
    v_add3_u32 v136, v5, v7, v10
    v_add_u32 v137, s29, v136
    v_add_u32 v4, 18, v3
    v_mul_u32_u24 v5, 3641, v4
    v_lshrrev_b32 v5, 16, v5
    v_mul_u32_u24 v6, 18, v5
    v_sub_u32 v6, v4, v6
    v_lshlrev_b32 v5, 11, v5
    v_lshrrev_b32 v7, 4, v6
    v_mul_lo_u32 v7, v7, s34
    v_add_u32 v5, v5, v7
    v_bfe_u32 v7, v6, 3, 1
    v_mul_lo_u32 v7, v7, s35
    v_add_u32 v5, v5, v7
    v_and_b32 v7, 7, v6
    v_lshlrev_b32 v7, 1, v7
    v_add3_u32 v138, v5, v7, v10
    v_add_u32 v139, s29, v138
    v_add_u32 v4, 32, v3
    v_mul_u32_u24 v5, 3641, v4
    v_lshrrev_b32 v5, 16, v5
    v_mul_u32_u24 v6, 18, v5
    v_sub_u32 v6, v4, v6
    v_lshlrev_b32 v5, 11, v5
    v_lshrrev_b32 v7, 4, v6
    v_mul_lo_u32 v7, v7, s34
    v_add_u32 v5, v5, v7
    v_bfe_u32 v7, v6, 3, 1
    v_mul_lo_u32 v7, v7, s35
    v_add_u32 v5, v5, v7
    v_and_b32 v7, 7, v6
    v_lshlrev_b32 v7, 1, v7
    v_add3_u32 v140, v5, v7, v10
    v_add_u32 v141, s29, v140
    v_add_u32 v4, 34, v3
    v_mul_u32_u24 v5, 3641, v4
    v_lshrrev_b32 v5, 16, v5
    v_mul_u32_u24 v6, 18, v5
    v_sub_u32 v6, v4, v6
    v_lshlrev_b32 v5, 11, v5
    v_lshrrev_b32 v7, 4, v6
    v_mul_lo_u32 v7, v7, s34
    v_add_u32 v5, v5, v7
    v_bfe_u32 v7, v6, 3, 1
    v_mul_lo_u32 v7, v7, s35
    v_add_u32 v5, v5, v7
    v_and_b32 v7, 7, v6
    v_lshlrev_b32 v7, 1, v7
    v_add3_u32 v142, v5, v7, v10
    v_add_u32 v143, s29, v142
    v_add_u32 v4, 48, v3
    v_mul_u32_u24 v5, 3641, v4
    v_lshrrev_b32 v5, 16, v5
    v_mul_u32_u24 v6, 18, v5
    v_sub_u32 v6, v4, v6
    v_lshlrev_b32 v5, 11, v5
    v_lshrrev_b32 v7, 4, v6
    v_mul_lo_u32 v7, v7, s34
    v_add_u32 v5, v5, v7
    v_bfe_u32 v7, v6, 3, 1
    v_mul_lo_u32 v7, v7, s35
    v_add_u32 v5, v5, v7
    v_and_b32 v7, 7, v6
    v_lshlrev_b32 v7, 1, v7
    v_add3_u32 v144, v5, v7, v10
    v_add_u32 v145, s29, v144
    v_add_u32 v4, 50, v3
    v_mul_u32_u24 v5, 3641, v4
    v_lshrrev_b32 v5, 16, v5
    v_mul_u32_u24 v6, 18, v5
    v_sub_u32 v6, v4, v6
    v_lshlrev_b32 v5, 11, v5
    v_lshrrev_b32 v7, 4, v6
    v_mul_lo_u32 v7, v7, s34
    v_add_u32 v5, v5, v7
    v_bfe_u32 v7, v6, 3, 1
    v_mul_lo_u32 v7, v7, s35
    v_add_u32 v5, v5, v7
    v_and_b32 v7, 7, v6
    v_lshlrev_b32 v7, 1, v7
    v_add3_u32 v146, v5, v7, v10
    v_add_u32 v147, s29, v146
    v_add_u32 v4, 64, v3
    v_mul_u32_u24 v5, 3641, v4
    v_lshrrev_b32 v5, 16, v5
    v_mul_u32_u24 v6, 18, v5
    v_sub_u32 v6, v4, v6
    v_lshlrev_b32 v5, 11, v5
    v_lshrrev_b32 v7, 4, v6
    v_mul_lo_u32 v7, v7, s34
    v_add_u32 v5, v5, v7
    v_bfe_u32 v7, v6, 3, 1
    v_mul_lo_u32 v7, v7, s35
    v_add_u32 v5, v5, v7
    v_and_b32 v7, 7, v6
    v_lshlrev_b32 v7, 1, v7
    v_add3_u32 v148, v5, v7, v10
    v_add_u32 v149, s29, v148
    v_add_u32 v4, 66, v3
    v_mul_u32_u24 v5, 3641, v4
    v_lshrrev_b32 v5, 16, v5
    v_mul_u32_u24 v6, 18, v5
    v_sub_u32 v6, v4, v6
    v_lshlrev_b32 v5, 11, v5
    v_lshrrev_b32 v7, 4, v6
    v_mul_lo_u32 v7, v7, s34
    v_add_u32 v5, v5, v7
    v_bfe_u32 v7, v6, 3, 1
    v_mul_lo_u32 v7, v7, s35
    v_add_u32 v5, v5, v7
    v_and_b32 v7, 7, v6
    v_lshlrev_b32 v7, 1, v7
    v_add3_u32 v150, v5, v7, v10
    v_add_u32 v151, s29, v150
    v_add_u32 v4, 80, v3
    v_mul_u32_u24 v5, 3641, v4
    v_lshrrev_b32 v5, 16, v5
    v_mul_u32_u24 v6, 18, v5
    v_sub_u32 v6, v4, v6
    v_lshlrev_b32 v5, 11, v5
    v_lshrrev_b32 v7, 4, v6
    v_mul_lo_u32 v7, v7, s34
    v_add_u32 v5, v5, v7
    v_bfe_u32 v7, v6, 3, 1
    v_mul_lo_u32 v7, v7, s35
    v_add_u32 v5, v5, v7
    v_and_b32 v7, 7, v6
    v_lshlrev_b32 v7, 1, v7
    v_add3_u32 v152, v5, v7, v10
    v_add_u32 v153, s29, v152
    v_add_u32 v4, 82, v3
    v_mul_u32_u24 v5, 3641, v4
    v_lshrrev_b32 v5, 16, v5
    v_mul_u32_u24 v6, 18, v5
    v_sub_u32 v6, v4, v6
    v_lshlrev_b32 v5, 11, v5
    v_lshrrev_b32 v7, 4, v6
    v_mul_lo_u32 v7, v7, s34
    v_add_u32 v5, v5, v7
    v_bfe_u32 v7, v6, 3, 1
    v_mul_lo_u32 v7, v7, s35
    v_add_u32 v5, v5, v7
    v_and_b32 v7, 7, v6
    v_lshlrev_b32 v7, 1, v7
    v_add3_u32 v154, v5, v7, v10
    v_add_u32 v155, s29, v154
    v_add_u32 v4, 96, v3
    v_mul_u32_u24 v5, 3641, v4
    v_lshrrev_b32 v5, 16, v5
    v_mul_u32_u24 v6, 18, v5
    v_sub_u32 v6, v4, v6
    v_lshlrev_b32 v5, 11, v5
    v_lshrrev_b32 v7, 4, v6
    v_mul_lo_u32 v7, v7, s34
    v_add_u32 v5, v5, v7
    v_bfe_u32 v7, v6, 3, 1
    v_mul_lo_u32 v7, v7, s35
    v_add_u32 v5, v5, v7
    v_and_b32 v7, 7, v6
    v_lshlrev_b32 v7, 1, v7
    v_add3_u32 v156, v5, v7, v10
    v_add_u32 v157, s29, v156
    v_add_u32 v4, 98, v3
    v_mul_u32_u24 v5, 3641, v4
    v_lshrrev_b32 v5, 16, v5
    v_mul_u32_u24 v6, 18, v5
    v_sub_u32 v6, v4, v6
    v_lshlrev_b32 v5, 11, v5
    v_lshrrev_b32 v7, 4, v6
    v_mul_lo_u32 v7, v7, s34
    v_add_u32 v5, v5, v7
    v_bfe_u32 v7, v6, 3, 1
    v_mul_lo_u32 v7, v7, s35
    v_add_u32 v5, v5, v7
    v_and_b32 v7, 7, v6
    v_lshlrev_b32 v7, 1, v7
    v_add3_u32 v158, v5, v7, v10
    v_add_u32 v159, s29, v158
    v_add_u32 v4, 112, v3
    v_mul_u32_u24 v5, 3641, v4
    v_lshrrev_b32 v5, 16, v5
    v_mul_u32_u24 v6, 18, v5
    v_sub_u32 v6, v4, v6
    v_lshlrev_b32 v5, 11, v5
    v_lshrrev_b32 v7, 4, v6
    v_mul_lo_u32 v7, v7, s34
    v_add_u32 v5, v5, v7
    v_bfe_u32 v7, v6, 3, 1
    v_mul_lo_u32 v7, v7, s35
    v_add_u32 v5, v5, v7
    v_and_b32 v7, 7, v6
    v_lshlrev_b32 v7, 1, v7
    v_add3_u32 v160, v5, v7, v10
    v_add_u32 v161, s29, v160
    v_add_u32 v4, 114, v3
    v_mul_u32_u24 v5, 3641, v4
    v_lshrrev_b32 v5, 16, v5
    v_mul_u32_u24 v6, 18, v5
    v_sub_u32 v6, v4, v6
    v_lshlrev_b32 v5, 11, v5
    v_lshrrev_b32 v7, 4, v6
    v_mul_lo_u32 v7, v7, s34
    v_add_u32 v5, v5, v7
    v_bfe_u32 v7, v6, 3, 1
    v_mul_lo_u32 v7, v7, s35
    v_add_u32 v5, v5, v7
    v_and_b32 v7, 7, v6
    v_lshlrev_b32 v7, 1, v7
    v_add3_u32 v162, v5, v7, v10
    v_add_u32 v163, s29, v162
    v_add_u32 v4, 128, v3
    v_mul_u32_u24 v5, 3641, v4
    v_lshrrev_b32 v5, 16, v5
    v_mul_u32_u24 v6, 18, v5
    v_sub_u32 v6, v4, v6
    v_lshlrev_b32 v5, 11, v5
    v_lshrrev_b32 v7, 4, v6
    v_mul_lo_u32 v7, v7, s34
    v_add_u32 v5, v5, v7
    v_bfe_u32 v7, v6, 3, 1
    v_mul_lo_u32 v7, v7, s35
    v_add_u32 v5, v5, v7
    v_and_b32 v7, 7, v6
    v_lshlrev_b32 v7, 1, v7
    v_add3_u32 v164, v5, v7, v10
    v_add_u32 v165, s29, v164
    v_add_u32 v4, 130, v3
    v_mul_u32_u24 v5, 3641, v4
    v_lshrrev_b32 v5, 16, v5
    v_mul_u32_u24 v6, 18, v5
    v_sub_u32 v6, v4, v6
    v_lshlrev_b32 v5, 11, v5
    v_lshrrev_b32 v7, 4, v6
    v_mul_lo_u32 v7, v7, s34
    v_add_u32 v5, v5, v7
    v_bfe_u32 v7, v6, 3, 1
    v_mul_lo_u32 v7, v7, s35
    v_add_u32 v5, v5, v7
    v_and_b32 v7, 7, v6
    v_lshlrev_b32 v7, 1, v7
    v_add3_u32 v166, v5, v7, v10
    v_add_u32 v167, s29, v166
    v_and_b32 v2, 31, v1
    v_mul_lo_u32 v2, v2, s37
    v_lshrrev_b32 v3, 5, v1
    v_lshlrev_b32 v3, 11, v3
    s_add_u32 s29, s28, s34
    v_add3_u32 v168, v2, v3, s29
    v_add_u32 v169, s35, v168
    v_lshlrev_b32 v2, 4, v1
    v_add_u32 v170, s28, v2
    v_mov_b32 v16, 0
    v_mov_b32 v17, 0
    v_mov_b32 v18, 0
    v_mov_b32 v19, 0
    v_mov_b32 v20, 0
    v_mov_b32 v21, 0
    v_mov_b32 v22, 0
    v_mov_b32 v23, 0
    v_mov_b32 v24, 0
    v_mov_b32 v25, 0
    v_mov_b32 v26, 0
    v_mov_b32 v27, 0
    v_mov_b32 v28, 0
    v_mov_b32 v29, 0
    v_mov_b32 v30, 0
    v_mov_b32 v31, 0
    v_mov_b32 v32, 0
    v_mov_b32 v33, 0
    v_mov_b32 v34, 0
    v_mov_b32 v35, 0
    v_mov_b32 v36, 0
    v_mov_b32 v37, 0
    v_mov_b32 v38, 0
    v_mov_b32 v39, 0
    v_mov_b32 v40, 0
    v_mov_b32 v41, 0
    v_mov_b32 v42, 0
    v_mov_b32 v43, 0
    v_mov_b32 v44, 0
    v_mov_b32 v45, 0
    v_mov_b32 v46, 0
    v_mov_b32 v47, 0
    v_mov_b32 v48, 0
    v_mov_b32 v49, 0
    v_mov_b32 v50, 0
    v_mov_b32 v51, 0
    v_mov_b32 v52, 0
    v_mov_b32 v53, 0
    v_mov_b32 v54, 0
    v_mov_b32 v55, 0
    v_mov_b32 v56, 0
    v_mov_b32 v57, 0
    v_mov_b32 v58, 0
    v_mov_b32 v59, 0
    v_mov_b32 v60, 0
    v_mov_b32 v61, 0
    v_mov_b32 v62, 0
    v_mov_b32 v63, 0
    v_mov_b32 v64, 0
    v_mov_b32 v65, 0
    v_mov_b32 v66, 0
    v_mov_b32 v67, 0
    v_mov_b32 v68, 0
    v_mov_b32 v69, 0
    v_mov_b32 v70, 0
    v_mov_b32 v71, 0
    v_mov_b32 v72, 0
    v_mov_b32 v73, 0
    v_mov_b32 v74, 0
    v_mov_b32 v75, 0
    v_mov_b32 v76, 0
    v_mov_b32 v77, 0
    v_mov_b32 v78, 0
    v_mov_b32 v79, 0
    v_mov_b32 v80, 0
    v_mov_b32 v81, 0
    v_mov_b32 v82, 0
    v_mov_b32 v83, 0
    v_mov_b32 v84, 0
    v_mov_b32 v85, 0
    v_mov_b32 v86, 0
    v_mov_b32 v87, 0
    s_waitcnt vmcnt(14)
    s_barrier
    ds_read_b64_tr_b16 v[112:113], v131 offset:0
    ds_read_b64_tr_b16 v[114:115], v131 offset:2304
    ds_read_b64_tr_b16 v[116:117], v131 offset:32
    ds_read_b64_tr_b16 v[118:119], v131 offset:2336
    ds_read_b64_tr_b16 v[120:121], v131 offset:64
    ds_read_b64_tr_b16 v[122:123], v131 offset:2368
    buffer_load_dwordx4 v[104:107], v124, s[8:11], s26 offen offset:128
    s_waitcnt vmcnt(13) lgkmcnt(4)
    v_mfma_f32_16x16x32_bf16 v[16:19], v[112:115], v[88:91], v[16:19]
    v_mfma_f32_16x16x32_bf16 v[52:55], v[112:115], v[92:95], v[52:55]
    ds_read_b64_tr_b16 v[112:113], v131 offset:96
    ds_read_b64_tr_b16 v[114:115], v131 offset:2400
    buffer_load_dwordx4 v[108:111], v125, s[8:11], s26 offen offset:128
    s_waitcnt lgkmcnt(4)
    v_mfma_f32_16x16x32_bf16 v[20:23], v[116:119], v[88:91], v[20:23]
    v_mfma_f32_16x16x32_bf16 v[56:59], v[116:119], v[92:95], v[56:59]
    ds_read_b64_tr_b16 v[116:117], v131 offset:128
    ds_read_b64_tr_b16 v[118:119], v131 offset:2432
    s_waitcnt lgkmcnt(4)
    v_mfma_f32_16x16x32_bf16 v[24:27], v[120:123], v[88:91], v[24:27]
    v_mfma_f32_16x16x32_bf16 v[60:63], v[120:123], v[92:95], v[60:63]
    ds_read_b64_tr_b16 v[120:121], v131 offset:160
    ds_read_b64_tr_b16 v[122:123], v131 offset:2464
    s_waitcnt lgkmcnt(4)
    v_mfma_f32_16x16x32_bf16 v[28:31], v[112:115], v[88:91], v[28:31]
    v_mfma_f32_16x16x32_bf16 v[64:67], v[112:115], v[92:95], v[64:67]
    ds_read_b64_tr_b16 v[112:113], v131 offset:192
    ds_read_b64_tr_b16 v[114:115], v131 offset:2496
    s_waitcnt lgkmcnt(4)
    v_mfma_f32_16x16x32_bf16 v[32:35], v[116:119], v[88:91], v[32:35]
    v_mfma_f32_16x16x32_bf16 v[68:71], v[116:119], v[92:95], v[68:71]
    ds_read_b64_tr_b16 v[116:117], v131 offset:224
    ds_read_b64_tr_b16 v[118:119], v131 offset:2528
    s_waitcnt lgkmcnt(4)
    v_mfma_f32_16x16x32_bf16 v[36:39], v[120:123], v[88:91], v[36:39]
    v_mfma_f32_16x16x32_bf16 v[72:75], v[120:123], v[92:95], v[72:75]
    ds_read_b64_tr_b16 v[120:121], v131 offset:256
    ds_read_b64_tr_b16 v[122:123], v131 offset:2560
    s_waitcnt lgkmcnt(4)
    v_mfma_f32_16x16x32_bf16 v[40:43], v[112:115], v[88:91], v[40:43]
    v_mfma_f32_16x16x32_bf16 v[76:79], v[112:115], v[92:95], v[76:79]
    ds_read_b64_tr_b16 v[112:113], v131 offset:9216
    ds_read_b64_tr_b16 v[114:115], v131 offset:11520
    s_waitcnt lgkmcnt(4)
    v_mfma_f32_16x16x32_bf16 v[44:47], v[116:119], v[88:91], v[44:47]
    v_mfma_f32_16x16x32_bf16 v[80:83], v[116:119], v[92:95], v[80:83]
    ds_read_b64_tr_b16 v[116:117], v131 offset:9248
    ds_read_b64_tr_b16 v[118:119], v131 offset:11552
    s_waitcnt lgkmcnt(4)
    v_mfma_f32_16x16x32_bf16 v[48:51], v[120:123], v[88:91], v[48:51]
    v_mfma_f32_16x16x32_bf16 v[84:87], v[120:123], v[92:95], v[84:87]
    ds_read_b64_tr_b16 v[120:121], v131 offset:9280
    ds_read_b64_tr_b16 v[122:123], v131 offset:11584
    buffer_load_dwordx4 v[88:91], v124, s[8:11], s26 offen offset:192
    s_waitcnt vmcnt(8) lgkmcnt(4)
    v_mfma_f32_16x16x32_bf16 v[16:19], v[112:115], v[96:99], v[16:19]
    v_mfma_f32_16x16x32_bf16 v[52:55], v[112:115], v[100:103], v[52:55]
    ds_read_b64_tr_b16 v[112:113], v131 offset:9312
    ds_read_b64_tr_b16 v[114:115], v131 offset:11616
    buffer_load_dwordx4 v[92:95], v125, s[8:11], s26 offen offset:192
    s_waitcnt lgkmcnt(4)
    v_mfma_f32_16x16x32_bf16 v[20:23], v[116:119], v[96:99], v[20:23]
    v_mfma_f32_16x16x32_bf16 v[56:59], v[116:119], v[100:103], v[56:59]
    ds_read_b64_tr_b16 v[116:117], v131 offset:9344
    ds_read_b64_tr_b16 v[118:119], v131 offset:11648
    s_waitcnt lgkmcnt(4)
    v_mfma_f32_16x16x32_bf16 v[24:27], v[120:123], v[96:99], v[24:27]
    v_mfma_f32_16x16x32_bf16 v[60:63], v[120:123], v[100:103], v[60:63]
    ds_read_b64_tr_b16 v[120:121], v131 offset:9376
    ds_read_b64_tr_b16 v[122:123], v131 offset:11680
    s_waitcnt lgkmcnt(4)
    v_mfma_f32_16x16x32_bf16 v[28:31], v[112:115], v[96:99], v[28:31]
    v_mfma_f32_16x16x32_bf16 v[64:67], v[112:115], v[100:103], v[64:67]
    ds_read_b64_tr_b16 v[112:113], v131 offset:9408
    ds_read_b64_tr_b16 v[114:115], v131 offset:11712
    s_waitcnt lgkmcnt(4)
    v_mfma_f32_16x16x32_bf16 v[32:35], v[116:119], v[96:99], v[32:35]
    v_mfma_f32_16x16x32_bf16 v[68:71], v[116:119], v[100:103], v[68:71]
    ds_read_b64_tr_b16 v[116:117], v131 offset:9440
    ds_read_b64_tr_b16 v[118:119], v131 offset:11744
    s_waitcnt lgkmcnt(4)
    v_mfma_f32_16x16x32_bf16 v[36:39], v[120:123], v[96:99], v[36:39]
    v_mfma_f32_16x16x32_bf16 v[72:75], v[120:123], v[100:103], v[72:75]
    ds_read_b64_tr_b16 v[120:121], v131 offset:9472
    ds_read_b64_tr_b16 v[122:123], v131 offset:11776
    s_waitcnt lgkmcnt(4)
    v_mfma_f32_16x16x32_bf16 v[40:43], v[112:115], v[96:99], v[40:43]
    v_mfma_f32_16x16x32_bf16 v[76:79], v[112:115], v[100:103], v[76:79]
    s_waitcnt lgkmcnt(0)
    s_barrier
    ds_read_b64_tr_b16 v[112:113], v131 offset:20480
    ds_read_b64_tr_b16 v[114:115], v131 offset:22784
    s_add_u32 m0, s24, 0
    s_nop 0
    buffer_load_dwordx4 v126, s[12:15], s25 offen offset:0 lds
    v_mfma_f32_16x16x32_bf16 v[44:47], v[116:119], v[96:99], v[44:47]
    v_mfma_f32_16x16x32_bf16 v[80:83], v[116:119], v[100:103], v[80:83]
    ds_read_b64_tr_b16 v[116:117], v131 offset:20512
    ds_read_b64_tr_b16 v[118:119], v131 offset:22816
    s_add_u32 m0, s24, 0
    s_nop 0
    buffer_load_dwordx4 v127, s[12:15], s25 offen offset:1024 lds
    v_mfma_f32_16x16x32_bf16 v[48:51], v[120:123], v[96:99], v[48:51]
    v_mfma_f32_16x16x32_bf16 v[84:87], v[120:123], v[100:103], v[84:87]
    ds_read_b64_tr_b16 v[120:121], v131 offset:20544
    ds_read_b64_tr_b16 v[122:123], v131 offset:22848
    buffer_load_dwordx4 v[96:99], v124, s[8:11], s26 offen offset:256
    s_waitcnt vmcnt(5) lgkmcnt(4)
    v_mfma_f32_16x16x32_bf16 v[16:19], v[112:115], v[104:107], v[16:19]
    v_mfma_f32_16x16x32_bf16 v[52:55], v[112:115], v[108:111], v[52:55]
    ds_read_b64_tr_b16 v[112:113], v131 offset:20576
    ds_read_b64_tr_b16 v[114:115], v131 offset:22880
    buffer_load_dwordx4 v[100:103], v125, s[8:11], s26 offen offset:256
    s_waitcnt lgkmcnt(4)
    v_mfma_f32_16x16x32_bf16 v[20:23], v[116:119], v[104:107], v[20:23]
    v_mfma_f32_16x16x32_bf16 v[56:59], v[116:119], v[108:111], v[56:59]
    ds_read_b64_tr_b16 v[116:117], v131 offset:20608
    ds_read_b64_tr_b16 v[118:119], v131 offset:22912
    s_add_u32 m0, s24, 0
    s_nop 0
    buffer_load_dwordx4 v128, s[12:15], s25 offen offset:2048 lds
    s_waitcnt lgkmcnt(4)
    v_mfma_f32_16x16x32_bf16 v[24:27], v[120:123], v[104:107], v[24:27]
    v_mfma_f32_16x16x32_bf16 v[60:63], v[120:123], v[108:111], v[60:63]
    ds_read_b64_tr_b16 v[120:121], v131 offset:20640
    ds_read_b64_tr_b16 v[122:123], v131 offset:22944
    s_add_u32 m0, s24, 0
    s_nop 0
    buffer_load_dwordx4 v129, s[12:15], s25 offen offset:3072 lds
    s_waitcnt lgkmcnt(4)
    v_mfma_f32_16x16x32_bf16 v[28:31], v[112:115], v[104:107], v[28:31]
    v_mfma_f32_16x16x32_bf16 v[64:67], v[112:115], v[108:111], v[64:67]
    ds_read_b64_tr_b16 v[112:113], v131 offset:20672
    ds_read_b64_tr_b16 v[114:115], v131 offset:22976
    s_add_u32 m0, s24, 4096
    s_nop 0
    buffer_load_dwordx4 v130, s[12:15], s25 offen offset:0 lds
    s_add_u32 s25, s25, 221184
    s_waitcnt lgkmcnt(4)
    v_mfma_f32_16x16x32_bf16 v[32:35], v[116:119], v[104:107], v[32:35]
    v_mfma_f32_16x16x32_bf16 v[68:71], v[116:119], v[108:111], v[68:71]
    ds_read_b64_tr_b16 v[116:117], v131 offset:20704
    ds_read_b64_tr_b16 v[118:119], v131 offset:23008
    s_waitcnt lgkmcnt(4)
    v_mfma_f32_16x16x32_bf16 v[36:39], v[120:123], v[104:107], v[36:39]
    v_mfma_f32_16x16x32_bf16 v[72:75], v[120:123], v[108:111], v[72:75]
    ds_read_b64_tr_b16 v[120:121], v131 offset:20736
    ds_read_b64_tr_b16 v[122:123], v131 offset:23040
    s_waitcnt lgkmcnt(4)
    v_mfma_f32_16x16x32_bf16 v[40:43], v[112:115], v[104:107], v[40:43]
    v_mfma_f32_16x16x32_bf16 v[76:79], v[112:115], v[108:111], v[76:79]
    ds_read_b64_tr_b16 v[112:113], v131 offset:29696
    ds_read_b64_tr_b16 v[114:115], v131 offset:32000
    s_waitcnt lgkmcnt(4)
    v_mfma_f32_16x16x32_bf16 v[44:47], v[116:119], v[104:107], v[44:47]
    v_mfma_f32_16x16x32_bf16 v[80:83], v[116:119], v[108:111], v[80:83]
    ds_read_b64_tr_b16 v[116:117], v131 offset:29728
    ds_read_b64_tr_b16 v[118:119], v131 offset:32032
    s_waitcnt lgkmcnt(4)
    v_mfma_f32_16x16x32_bf16 v[48:51], v[120:123], v[104:107], v[48:51]
    v_mfma_f32_16x16x32_bf16 v[84:87], v[120:123], v[108:111], v[84:87]
    ds_read_b64_tr_b16 v[120:121], v131 offset:29760
    ds_read_b64_tr_b16 v[122:123], v131 offset:32064
    buffer_load_dwordx4 v[104:107], v124, s[8:11], s26 offen offset:320
    s_waitcnt vmcnt(8) lgkmcnt(4)
    v_mfma_f32_16x16x32_bf16 v[16:19], v[112:115], v[88:91], v[16:19]
    v_mfma_f32_16x16x32_bf16 v[52:55], v[112:115], v[92:95], v[52:55]
    ds_read_b64_tr_b16 v[112:113], v131 offset:29792
    ds_read_b64_tr_b16 v[114:115], v131 offset:32096
    buffer_load_dwordx4 v[108:111], v125, s[8:11], s26 offen offset:320
    s_waitcnt lgkmcnt(4)
    v_mfma_f32_16x16x32_bf16 v[20:23], v[116:119], v[88:91], v[20:23]
    v_mfma_f32_16x16x32_bf16 v[56:59], v[116:119], v[92:95], v[56:59]
    ds_read_b64_tr_b16 v[116:117], v131 offset:29824
    ds_read_b64_tr_b16 v[118:119], v131 offset:32128
    s_waitcnt lgkmcnt(4)
    v_mfma_f32_16x16x32_bf16 v[24:27], v[120:123], v[88:91], v[24:27]
    v_mfma_f32_16x16x32_bf16 v[60:63], v[120:123], v[92:95], v[60:63]
    ds_read_b64_tr_b16 v[120:121], v131 offset:29856
    ds_read_b64_tr_b16 v[122:123], v131 offset:32160
    s_waitcnt lgkmcnt(4)
    v_mfma_f32_16x16x32_bf16 v[28:31], v[112:115], v[88:91], v[28:31]
    v_mfma_f32_16x16x32_bf16 v[64:67], v[112:115], v[92:95], v[64:67]
    ds_read_b64_tr_b16 v[112:113], v131 offset:29888
    ds_read_b64_tr_b16 v[114:115], v131 offset:32192
    s_waitcnt lgkmcnt(4)
    v_mfma_f32_16x16x32_bf16 v[32:35], v[116:119], v[88:91], v[32:35]
    v_mfma_f32_16x16x32_bf16 v[68:71], v[116:119], v[92:95], v[68:71]
    ds_read_b64_tr_b16 v[116:117], v131 offset:29920
    ds_read_b64_tr_b16 v[118:119], v131 offset:32224
    s_waitcnt lgkmcnt(4)
    v_mfma_f32_16x16x32_bf16 v[36:39], v[120:123], v[88:91], v[36:39]
    v_mfma_f32_16x16x32_bf16 v[72:75], v[120:123], v[92:95], v[72:75]
    ds_read_b64_tr_b16 v[120:121], v131 offset:29952
    ds_read_b64_tr_b16 v[122:123], v131 offset:32256
    s_waitcnt lgkmcnt(4)
    v_mfma_f32_16x16x32_bf16 v[40:43], v[112:115], v[88:91], v[40:43]
    v_mfma_f32_16x16x32_bf16 v[76:79], v[112:115], v[92:95], v[76:79]
    s_waitcnt lgkmcnt(0)
    s_barrier
    ds_read_b64_tr_b16 v[112:113], v131 offset:40960
    ds_read_b64_tr_b16 v[114:115], v131 offset:43264
    s_add_u32 m0, s24, 20480
    s_nop 0
    buffer_load_dwordx4 v126, s[12:15], s25 offen offset:0 lds
    v_mfma_f32_16x16x32_bf16 v[44:47], v[116:119], v[88:91], v[44:47]
    v_mfma_f32_16x16x32_bf16 v[80:83], v[116:119], v[92:95], v[80:83]
    ds_read_b64_tr_b16 v[116:117], v131 offset:40992
    ds_read_b64_tr_b16 v[118:119], v131 offset:43296
    s_add_u32 m0, s24, 20480
    s_nop 0
    buffer_load_dwordx4 v127, s[12:15], s25 offen offset:1024 lds
    v_mfma_f32_16x16x32_bf16 v[48:51], v[120:123], v[88:91], v[48:51]
    v_mfma_f32_16x16x32_bf16 v[84:87], v[120:123], v[92:95], v[84:87]
    ds_read_b64_tr_b16 v[120:121], v131 offset:41024
    ds_read_b64_tr_b16 v[122:123], v131 offset:43328
    buffer_load_dwordx4 v[88:91], v124, s[8:11], s26 offen offset:384
    s_waitcnt vmcnt(8) lgkmcnt(4)
    v_mfma_f32_16x16x32_bf16 v[16:19], v[112:115], v[96:99], v[16:19]
    v_mfma_f32_16x16x32_bf16 v[52:55], v[112:115], v[100:103], v[52:55]
    ds_read_b64_tr_b16 v[112:113], v131 offset:41056
    ds_read_b64_tr_b16 v[114:115], v131 offset:43360
    buffer_load_dwordx4 v[92:95], v125, s[8:11], s26 offen offset:384
    s_waitcnt lgkmcnt(4)
    v_mfma_f32_16x16x32_bf16 v[20:23], v[116:119], v[96:99], v[20:23]
    v_mfma_f32_16x16x32_bf16 v[56:59], v[116:119], v[100:103], v[56:59]
    ds_read_b64_tr_b16 v[116:117], v131 offset:41088
    ds_read_b64_tr_b16 v[118:119], v131 offset:43392
    s_add_u32 m0, s24, 20480
    s_nop 0
    buffer_load_dwordx4 v128, s[12:15], s25 offen offset:2048 lds
    s_waitcnt lgkmcnt(4)
    v_mfma_f32_16x16x32_bf16 v[24:27], v[120:123], v[96:99], v[24:27]
    v_mfma_f32_16x16x32_bf16 v[60:63], v[120:123], v[100:103], v[60:63]
    ds_read_b64_tr_b16 v[120:121], v131 offset:41120
    ds_read_b64_tr_b16 v[122:123], v131 offset:43424
    s_add_u32 m0, s24, 20480
    s_nop 0
    buffer_load_dwordx4 v129, s[12:15], s25 offen offset:3072 lds
    s_waitcnt lgkmcnt(4)
    v_mfma_f32_16x16x32_bf16 v[28:31], v[112:115], v[96:99], v[28:31]
    v_mfma_f32_16x16x32_bf16 v[64:67], v[112:115], v[100:103], v[64:67]
    ds_read_b64_tr_b16 v[112:113], v131 offset:41152
    ds_read_b64_tr_b16 v[114:115], v131 offset:43456
    s_add_u32 m0, s24, 24576
    s_nop 0
    buffer_load_dwordx4 v130, s[12:15], s25 offen offset:0 lds
    s_add_u32 s25, s25, 221184
    s_waitcnt lgkmcnt(4)
    v_mfma_f32_16x16x32_bf16 v[32:35], v[116:119], v[96:99], v[32:35]
    v_mfma_f32_16x16x32_bf16 v[68:71], v[116:119], v[100:103], v[68:71]
    ds_read_b64_tr_b16 v[116:117], v131 offset:41184
    ds_read_b64_tr_b16 v[118:119], v131 offset:43488
    s_waitcnt lgkmcnt(4)
    v_mfma_f32_16x16x32_bf16 v[36:39], v[120:123], v[96:99], v[36:39]
    v_mfma_f32_16x16x32_bf16 v[72:75], v[120:123], v[100:103], v[72:75]
    ds_read_b64_tr_b16 v[120:121], v131 offset:41216
    ds_read_b64_tr_b16 v[122:123], v131 offset:43520
    s_waitcnt lgkmcnt(4)
    v_mfma_f32_16x16x32_bf16 v[40:43], v[112:115], v[96:99], v[40:43]
    v_mfma_f32_16x16x32_bf16 v[76:79], v[112:115], v[100:103], v[76:79]
    ds_read_b64_tr_b16 v[112:113], v131 offset:50176
    ds_read_b64_tr_b16 v[114:115], v131 offset:52480
    s_waitcnt lgkmcnt(4)
    v_mfma_f32_16x16x32_bf16 v[44:47], v[116:119], v[96:99], v[44:47]
    v_mfma_f32_16x16x32_bf16 v[80:83], v[116:119], v[100:103], v[80:83]
    ds_read_b64_tr_b16 v[116:117], v131 offset:50208
    ds_read_b64_tr_b16 v[118:119], v131 offset:52512
    s_waitcnt lgkmcnt(4)
    v_mfma_f32_16x16x32_bf16 v[48:51], v[120:123], v[96:99], v[48:51]
    v_mfma_f32_16x16x32_bf16 v[84:87], v[120:123], v[100:103], v[84:87]
    ds_read_b64_tr_b16 v[120:121], v131 offset:50240
    ds_read_b64_tr_b16 v[122:123], v131 offset:52544
    buffer_load_dwordx4 v[96:99], v124, s[8:11], s26 offen offset:448
    s_waitcnt vmcnt(8) lgkmcnt(4)
    v_mfma_f32_16x16x32_bf16 v[16:19], v[112:115], v[104:107], v[16:19]
    v_mfma_f32_16x16x32_bf16 v[52:55], v[112:115], v[108:111], v[52:55]
    ds_read_b64_tr_b16 v[112:113], v131 offset:50272
    ds_read_b64_tr_b16 v[114:115], v131 offset:52576
    buffer_load_dwordx4 v[100:103], v125, s[8:11], s26 offen offset:448
    s_waitcnt lgkmcnt(4)
    v_mfma_f32_16x16x32_bf16 v[20:23], v[116:119], v[104:107], v[20:23]
    v_mfma_f32_16x16x32_bf16 v[56:59], v[116:119], v[108:111], v[56:59]
    ds_read_b64_tr_b16 v[116:117], v131 offset:50304
    ds_read_b64_tr_b16 v[118:119], v131 offset:52608
    s_waitcnt lgkmcnt(4)
    v_mfma_f32_16x16x32_bf16 v[24:27], v[120:123], v[104:107], v[24:27]
    v_mfma_f32_16x16x32_bf16 v[60:63], v[120:123], v[108:111], v[60:63]
    ds_read_b64_tr_b16 v[120:121], v131 offset:50336
    ds_read_b64_tr_b16 v[122:123], v131 offset:52640
    s_waitcnt lgkmcnt(4)
    v_mfma_f32_16x16x32_bf16 v[28:31], v[112:115], v[104:107], v[28:31]
    v_mfma_f32_16x16x32_bf16 v[64:67], v[112:115], v[108:111], v[64:67]
    ds_read_b64_tr_b16 v[112:113], v131 offset:50368
    ds_read_b64_tr_b16 v[114:115], v131 offset:52672
    s_waitcnt lgkmcnt(4)
    v_mfma_f32_16x16x32_bf16 v[32:35], v[116:119], v[104:107], v[32:35]
    v_mfma_f32_16x16x32_bf16 v[68:71], v[116:119], v[108:111], v[68:71]
    ds_read_b64_tr_b16 v[116:117], v131 offset:50400
    ds_read_b64_tr_b16 v[118:119], v131 offset:52704
    s_waitcnt lgkmcnt(4)
    v_mfma_f32_16x16x32_bf16 v[36:39], v[120:123], v[104:107], v[36:39]
    v_mfma_f32_16x16x32_bf16 v[72:75], v[120:123], v[108:111], v[72:75]
    ds_read_b64_tr_b16 v[120:121], v131 offset:50432
    ds_read_b64_tr_b16 v[122:123], v131 offset:52736
    s_waitcnt lgkmcnt(4)
    v_mfma_f32_16x16x32_bf16 v[40:43], v[112:115], v[104:107], v[40:43]
    v_mfma_f32_16x16x32_bf16 v[76:79], v[112:115], v[108:111], v[76:79]
    s_waitcnt lgkmcnt(0)
    s_barrier
    ds_read_b64_tr_b16 v[112:113], v131 offset:0
    ds_read_b64_tr_b16 v[114:115], v131 offset:2304
    s_add_u32 m0, s24, 40960
    s_nop 0
    buffer_load_dwordx4 v126, s[12:15], s25 offen offset:0 lds
    v_mfma_f32_16x16x32_bf16 v[44:47], v[116:119], v[104:107], v[44:47]
    v_mfma_f32_16x16x32_bf16 v[80:83], v[116:119], v[108:111], v[80:83]
    ds_read_b64_tr_b16 v[116:117], v131 offset:32
    ds_read_b64_tr_b16 v[118:119], v131 offset:2336
    s_add_u32 m0, s24, 40960
    s_nop 0
    buffer_load_dwordx4 v127, s[12:15], s25 offen offset:1024 lds
    v_mfma_f32_16x16x32_bf16 v[48:51], v[120:123], v[104:107], v[48:51]
    v_mfma_f32_16x16x32_bf16 v[84:87], v[120:123], v[108:111], v[84:87]
    ds_read_b64_tr_b16 v[120:121], v131 offset:64
    ds_read_b64_tr_b16 v[122:123], v131 offset:2368
    buffer_load_dwordx4 v[104:107], v124, s[8:11], s26 offen offset:512
    s_waitcnt vmcnt(8) lgkmcnt(4)
    v_mfma_f32_16x16x32_bf16 v[16:19], v[112:115], v[88:91], v[16:19]
    v_mfma_f32_16x16x32_bf16 v[52:55], v[112:115], v[92:95], v[52:55]
    ds_read_b64_tr_b16 v[112:113], v131 offset:96
    ds_read_b64_tr_b16 v[114:115], v131 offset:2400
    buffer_load_dwordx4 v[108:111], v125, s[8:11], s26 offen offset:512
    s_waitcnt lgkmcnt(4)
    v_mfma_f32_16x16x32_bf16 v[20:23], v[116:119], v[88:91], v[20:23]
    v_mfma_f32_16x16x32_bf16 v[56:59], v[116:119], v[92:95], v[56:59]
    ds_read_b64_tr_b16 v[116:117], v131 offset:128
    ds_read_b64_tr_b16 v[118:119], v131 offset:2432
    s_add_u32 m0, s24, 40960
    s_nop 0
    buffer_load_dwordx4 v128, s[12:15], s25 offen offset:2048 lds
    s_waitcnt lgkmcnt(4)
    v_mfma_f32_16x16x32_bf16 v[24:27], v[120:123], v[88:91], v[24:27]
    v_mfma_f32_16x16x32_bf16 v[60:63], v[120:123], v[92:95], v[60:63]
    ds_read_b64_tr_b16 v[120:121], v131 offset:160
    ds_read_b64_tr_b16 v[122:123], v131 offset:2464
    s_add_u32 m0, s24, 40960
    s_nop 0
    buffer_load_dwordx4 v129, s[12:15], s25 offen offset:3072 lds
    s_waitcnt lgkmcnt(4)
    v_mfma_f32_16x16x32_bf16 v[28:31], v[112:115], v[88:91], v[28:31]
    v_mfma_f32_16x16x32_bf16 v[64:67], v[112:115], v[92:95], v[64:67]
    ds_read_b64_tr_b16 v[112:113], v131 offset:192
    ds_read_b64_tr_b16 v[114:115], v131 offset:2496
    s_add_u32 m0, s24, 45056
    s_nop 0
    buffer_load_dwordx4 v130, s[12:15], s25 offen offset:0 lds
    s_add_u32 s25, s25, 221184
    s_waitcnt lgkmcnt(4)
    v_mfma_f32_16x16x32_bf16 v[32:35], v[116:119], v[88:91], v[32:35]
    v_mfma_f32_16x16x32_bf16 v[68:71], v[116:119], v[92:95], v[68:71]
    ds_read_b64_tr_b16 v[116:117], v131 offset:224
    ds_read_b64_tr_b16 v[118:119], v131 offset:2528
    s_waitcnt lgkmcnt(4)
    v_mfma_f32_16x16x32_bf16 v[36:39], v[120:123], v[88:91], v[36:39]
    v_mfma_f32_16x16x32_bf16 v[72:75], v[120:123], v[92:95], v[72:75]
    ds_read_b64_tr_b16 v[120:121], v131 offset:256
    ds_read_b64_tr_b16 v[122:123], v131 offset:2560
    s_waitcnt lgkmcnt(4)
    v_mfma_f32_16x16x32_bf16 v[40:43], v[112:115], v[88:91], v[40:43]
    v_mfma_f32_16x16x32_bf16 v[76:79], v[112:115], v[92:95], v[76:79]
    ds_read_b64_tr_b16 v[112:113], v131 offset:9216
    ds_read_b64_tr_b16 v[114:115], v131 offset:11520
    s_waitcnt lgkmcnt(4)
    v_mfma_f32_16x16x32_bf16 v[44:47], v[116:119], v[88:91], v[44:47]
    v_mfma_f32_16x16x32_bf16 v[80:83], v[116:119], v[92:95], v[80:83]
    ds_read_b64_tr_b16 v[116:117], v131 offset:9248
    ds_read_b64_tr_b16 v[118:119], v131 offset:11552
    s_waitcnt lgkmcnt(4)
    v_mfma_f32_16x16x32_bf16 v[48:51], v[120:123], v[88:91], v[48:51]
    v_mfma_f32_16x16x32_bf16 v[84:87], v[120:123], v[92:95], v[84:87]
    ds_read_b64_tr_b16 v[120:121], v131 offset:9280
    ds_read_b64_tr_b16 v[122:123], v131 offset:11584
    buffer_load_dwordx4 v[88:91], v124, s[8:11], s26 offen offset:576
    s_waitcnt vmcnt(8) lgkmcnt(4)
    v_mfma_f32_16x16x32_bf16 v[16:19], v[112:115], v[96:99], v[16:19]
    v_mfma_f32_16x16x32_bf16 v[52:55], v[112:115], v[100:103], v[52:55]
    ds_read_b64_tr_b16 v[112:113], v131 offset:9312
    ds_read_b64_tr_b16 v[114:115], v131 offset:11616
    buffer_load_dwordx4 v[92:95], v125, s[8:11], s26 offen offset:576
    s_waitcnt lgkmcnt(4)
    v_mfma_f32_16x16x32_bf16 v[20:23], v[116:119], v[96:99], v[20:23]
    v_mfma_f32_16x16x32_bf16 v[56:59], v[116:119], v[100:103], v[56:59]
    ds_read_b64_tr_b16 v[116:117], v131 offset:9344
    ds_read_b64_tr_b16 v[118:119], v131 offset:11648
    s_waitcnt lgkmcnt(4)
    v_mfma_f32_16x16x32_bf16 v[24:27], v[120:123], v[96:99], v[24:27]
    v_mfma_f32_16x16x32_bf16 v[60:63], v[120:123], v[100:103], v[60:63]
    ds_read_b64_tr_b16 v[120:121], v131 offset:9376
    ds_read_b64_tr_b16 v[122:123], v131 offset:11680
    s_waitcnt lgkmcnt(4)
    v_mfma_f32_16x16x32_bf16 v[28:31], v[112:115], v[96:99], v[28:31]
    v_mfma_f32_16x16x32_bf16 v[64:67], v[112:115], v[100:103], v[64:67]
    ds_read_b64_tr_b16 v[112:113], v131 offset:9408
    ds_read_b64_tr_b16 v[114:115], v131 offset:11712
    s_waitcnt lgkmcnt(4)
    v_mfma_f32_16x16x32_bf16 v[32:35], v[116:119], v[96:99], v[32:35]
    v_mfma_f32_16x16x32_bf16 v[68:71], v[116:119], v[100:103], v[68:71]
    ds_read_b64_tr_b16 v[116:117], v131 offset:9440
    ds_read_b64_tr_b16 v[118:119], v131 offset:11744
    s_waitcnt lgkmcnt(4)
    v_mfma_f32_16x16x32_bf16 v[36:39], v[120:123], v[96:99], v[36:39]
    v_mfma_f32_16x16x32_bf16 v[72:75], v[120:123], v[100:103], v[72:75]
    ds_read_b64_tr_b16 v[120:121], v131 offset:9472
    ds_read_b64_tr_b16 v[122:123], v131 offset:11776
    s_waitcnt lgkmcnt(4)
    v_mfma_f32_16x16x32_bf16 v[40:43], v[112:115], v[96:99], v[40:43]
    v_mfma_f32_16x16x32_bf16 v[76:79], v[112:115], v[100:103], v[76:79]
    s_waitcnt lgkmcnt(0)
    s_barrier
    ds_read_b64_tr_b16 v[112:113], v131 offset:20480
    ds_read_b64_tr_b16 v[114:115], v131 offset:22784
    s_add_u32 m0, s24, 0
    s_nop 0
    buffer_load_dwordx4 v126, s[12:15], s25 offen offset:0 lds
    v_mfma_f32_16x16x32_bf16 v[44:47], v[116:119], v[96:99], v[44:47]
    v_mfma_f32_16x16x32_bf16 v[80:83], v[116:119], v[100:103], v[80:83]
    ds_read_b64_tr_b16 v[116:117], v131 offset:20512
    ds_read_b64_tr_b16 v[118:119], v131 offset:22816
    s_add_u32 m0, s24, 0
    s_nop 0
    buffer_load_dwordx4 v127, s[12:15], s25 offen offset:1024 lds
    v_mfma_f32_16x16x32_bf16 v[48:51], v[120:123], v[96:99], v[48:51]
    v_mfma_f32_16x16x32_bf16 v[84:87], v[120:123], v[100:103], v[84:87]
    ds_read_b64_tr_b16 v[120:121], v131 offset:20544
    ds_read_b64_tr_b16 v[122:123], v131 offset:22848
    buffer_load_dwordx4 v[96:99], v124, s[8:11], s26 offen offset:640
    s_waitcnt vmcnt(8) lgkmcnt(4)
    v_mfma_f32_16x16x32_bf16 v[16:19], v[112:115], v[104:107], v[16:19]
    v_mfma_f32_16x16x32_bf16 v[52:55], v[112:115], v[108:111], v[52:55]
    ds_read_b64_tr_b16 v[112:113], v131 offset:20576
    ds_read_b64_tr_b16 v[114:115], v131 offset:22880
    buffer_load_dwordx4 v[100:103], v125, s[8:11], s26 offen offset:640
    s_waitcnt lgkmcnt(4)
    v_mfma_f32_16x16x32_bf16 v[20:23], v[116:119], v[104:107], v[20:23]
    v_mfma_f32_16x16x32_bf16 v[56:59], v[116:119], v[108:111], v[56:59]
    ds_read_b64_tr_b16 v[116:117], v131 offset:20608
    ds_read_b64_tr_b16 v[118:119], v131 offset:22912
    s_add_u32 m0, s24, 0
    s_nop 0
    buffer_load_dwordx4 v128, s[12:15], s25 offen offset:2048 lds
    s_waitcnt lgkmcnt(4)
    v_mfma_f32_16x16x32_bf16 v[24:27], v[120:123], v[104:107], v[24:27]
    v_mfma_f32_16x16x32_bf16 v[60:63], v[120:123], v[108:111], v[60:63]
    ds_read_b64_tr_b16 v[120:121], v131 offset:20640
    ds_read_b64_tr_b16 v[122:123], v131 offset:22944
    s_add_u32 m0, s24, 0
    s_nop 0
    buffer_load_dwordx4 v129, s[12:15], s25 offen offset:3072 lds
    s_waitcnt lgkmcnt(4)
    v_mfma_f32_16x16x32_bf16 v[28:31], v[112:115], v[104:107], v[28:31]
    v_mfma_f32_16x16x32_bf16 v[64:67], v[112:115], v[108:111], v[64:67]
    ds_read_b64_tr_b16 v[112:113], v131 offset:20672
    ds_read_b64_tr_b16 v[114:115], v131 offset:22976
    s_add_u32 m0, s24, 4096
    s_nop 0
    buffer_load_dwordx4 v130, s[12:15], s25 offen offset:0 lds
    s_add_u32 s25, s25, 221184
    s_waitcnt lgkmcnt(4)
    v_mfma_f32_16x16x32_bf16 v[32:35], v[116:119], v[104:107], v[32:35]
    v_mfma_f32_16x16x32_bf16 v[68:71], v[116:119], v[108:111], v[68:71]
    ds_read_b64_tr_b16 v[116:117], v131 offset:20704
    ds_read_b64_tr_b16 v[118:119], v131 offset:23008
    s_waitcnt lgkmcnt(4)
    v_mfma_f32_16x16x32_bf16 v[36:39], v[120:123], v[104:107], v[36:39]
    v_mfma_f32_16x16x32_bf16 v[72:75], v[120:123], v[108:111], v[72:75]
    ds_read_b64_tr_b16 v[120:121], v131 offset:20736
    ds_read_b64_tr_b16 v[122:123], v131 offset:23040
    s_waitcnt lgkmcnt(4)
    v_mfma_f32_16x16x32_bf16 v[40:43], v[112:115], v[104:107], v[40:43]
    v_mfma_f32_16x16x32_bf16 v[76:79], v[112:115], v[108:111], v[76:79]
    ds_read_b64_tr_b16 v[112:113], v131 offset:29696
    ds_read_b64_tr_b16 v[114:115], v131 offset:32000
    s_waitcnt lgkmcnt(4)
    v_mfma_f32_16x16x32_bf16 v[44:47], v[116:119], v[104:107], v[44:47]
    v_mfma_f32_16x16x32_bf16 v[80:83], v[116:119], v[108:111], v[80:83]
    ds_read_b64_tr_b16 v[116:117], v131 offset:29728
    ds_read_b64_tr_b16 v[118:119], v131 offset:32032
    s_waitcnt lgkmcnt(4)
    v_mfma_f32_16x16x32_bf16 v[48:51], v[120:123], v[104:107], v[48:51]
    v_mfma_f32_16x16x32_bf16 v[84:87], v[120:123], v[108:111], v[84:87]
    ds_read_b64_tr_b16 v[120:121], v131 offset:29760
    ds_read_b64_tr_b16 v[122:123], v131 offset:32064
    buffer_load_dwordx4 v[104:107], v124, s[8:11], s26 offen offset:704
    s_waitcnt vmcnt(8) lgkmcnt(4)
    v_mfma_f32_16x16x32_bf16 v[16:19], v[112:115], v[88:91], v[16:19]
    v_mfma_f32_16x16x32_bf16 v[52:55], v[112:115], v[92:95], v[52:55]
    ds_read_b64_tr_b16 v[112:113], v131 offset:29792
    ds_read_b64_tr_b16 v[114:115], v131 offset:32096
    buffer_load_dwordx4 v[108:111], v125, s[8:11], s26 offen offset:704
    s_waitcnt lgkmcnt(4)
    v_mfma_f32_16x16x32_bf16 v[20:23], v[116:119], v[88:91], v[20:23]
    v_mfma_f32_16x16x32_bf16 v[56:59], v[116:119], v[92:95], v[56:59]
    ds_read_b64_tr_b16 v[116:117], v131 offset:29824
    ds_read_b64_tr_b16 v[118:119], v131 offset:32128
    s_waitcnt lgkmcnt(4)
    v_mfma_f32_16x16x32_bf16 v[24:27], v[120:123], v[88:91], v[24:27]
    v_mfma_f32_16x16x32_bf16 v[60:63], v[120:123], v[92:95], v[60:63]
    ds_read_b64_tr_b16 v[120:121], v131 offset:29856
    ds_read_b64_tr_b16 v[122:123], v131 offset:32160
    s_waitcnt lgkmcnt(4)
    v_mfma_f32_16x16x32_bf16 v[28:31], v[112:115], v[88:91], v[28:31]
    v_mfma_f32_16x16x32_bf16 v[64:67], v[112:115], v[92:95], v[64:67]
    ds_read_b64_tr_b16 v[112:113], v131 offset:29888
    ds_read_b64_tr_b16 v[114:115], v131 offset:32192
    s_waitcnt lgkmcnt(4)
    v_mfma_f32_16x16x32_bf16 v[32:35], v[116:119], v[88:91], v[32:35]
    v_mfma_f32_16x16x32_bf16 v[68:71], v[116:119], v[92:95], v[68:71]
    ds_read_b64_tr_b16 v[116:117], v131 offset:29920
    ds_read_b64_tr_b16 v[118:119], v131 offset:32224
    s_waitcnt lgkmcnt(4)
    v_mfma_f32_16x16x32_bf16 v[36:39], v[120:123], v[88:91], v[36:39]
    v_mfma_f32_16x16x32_bf16 v[72:75], v[120:123], v[92:95], v[72:75]
    ds_read_b64_tr_b16 v[120:121], v131 offset:29952
    ds_read_b64_tr_b16 v[122:123], v131 offset:32256
    s_waitcnt lgkmcnt(4)
    v_mfma_f32_16x16x32_bf16 v[40:43], v[112:115], v[88:91], v[40:43]
    v_mfma_f32_16x16x32_bf16 v[76:79], v[112:115], v[92:95], v[76:79]
    s_waitcnt lgkmcnt(0)
    s_barrier
    ds_read_b64_tr_b16 v[112:113], v131 offset:40960
    ds_read_b64_tr_b16 v[114:115], v131 offset:43264
    s_add_u32 m0, s24, 20480
    s_nop 0
    buffer_load_dwordx4 v126, s[12:15], s25 offen offset:0 lds
    v_mfma_f32_16x16x32_bf16 v[44:47], v[116:119], v[88:91], v[44:47]
    v_mfma_f32_16x16x32_bf16 v[80:83], v[116:119], v[92:95], v[80:83]
    ds_read_b64_tr_b16 v[116:117], v131 offset:40992
    ds_read_b64_tr_b16 v[118:119], v131 offset:43296
    s_add_u32 m0, s24, 20480
    s_nop 0
    buffer_load_dwordx4 v127, s[12:15], s25 offen offset:1024 lds
    v_mfma_f32_16x16x32_bf16 v[48:51], v[120:123], v[88:91], v[48:51]
    v_mfma_f32_16x16x32_bf16 v[84:87], v[120:123], v[92:95], v[84:87]
    ds_read_b64_tr_b16 v[120:121], v131 offset:41024
    ds_read_b64_tr_b16 v[122:123], v131 offset:43328
    buffer_load_dwordx4 v[88:91], v124, s[8:11], s26 offen offset:768
    s_waitcnt vmcnt(8) lgkmcnt(4)
    v_mfma_f32_16x16x32_bf16 v[16:19], v[112:115], v[96:99], v[16:19]
    v_mfma_f32_16x16x32_bf16 v[52:55], v[112:115], v[100:103], v[52:55]
    ds_read_b64_tr_b16 v[112:113], v131 offset:41056
    ds_read_b64_tr_b16 v[114:115], v131 offset:43360
    buffer_load_dwordx4 v[92:95], v125, s[8:11], s26 offen offset:768
    s_waitcnt lgkmcnt(4)
    v_mfma_f32_16x16x32_bf16 v[20:23], v[116:119], v[96:99], v[20:23]
    v_mfma_f32_16x16x32_bf16 v[56:59], v[116:119], v[100:103], v[56:59]
    ds_read_b64_tr_b16 v[116:117], v131 offset:41088
    ds_read_b64_tr_b16 v[118:119], v131 offset:43392
    s_add_u32 m0, s24, 20480
    s_nop 0
    buffer_load_dwordx4 v128, s[12:15], s25 offen offset:2048 lds
    s_waitcnt lgkmcnt(4)
    v_mfma_f32_16x16x32_bf16 v[24:27], v[120:123], v[96:99], v[24:27]
    v_mfma_f32_16x16x32_bf16 v[60:63], v[120:123], v[100:103], v[60:63]
    ds_read_b64_tr_b16 v[120:121], v131 offset:41120
    ds_read_b64_tr_b16 v[122:123], v131 offset:43424
    s_add_u32 m0, s24, 20480
    s_nop 0
    buffer_load_dwordx4 v129, s[12:15], s25 offen offset:3072 lds
    s_waitcnt lgkmcnt(4)
    v_mfma_f32_16x16x32_bf16 v[28:31], v[112:115], v[96:99], v[28:31]
    v_mfma_f32_16x16x32_bf16 v[64:67], v[112:115], v[100:103], v[64:67]
    ds_read_b64_tr_b16 v[112:113], v131 offset:41152
    ds_read_b64_tr_b16 v[114:115], v131 offset:43456
    s_add_u32 m0, s24, 24576
    s_nop 0
    buffer_load_dwordx4 v130, s[12:15], s25 offen offset:0 lds
    s_add_u32 s25, s25, 221184
    s_waitcnt lgkmcnt(4)
    v_mfma_f32_16x16x32_bf16 v[32:35], v[116:119], v[96:99], v[32:35]
    v_mfma_f32_16x16x32_bf16 v[68:71], v[116:119], v[100:103], v[68:71]
    ds_read_b64_tr_b16 v[116:117], v131 offset:41184
    ds_read_b64_tr_b16 v[118:119], v131 offset:43488
    s_waitcnt lgkmcnt(4)
    v_mfma_f32_16x16x32_bf16 v[36:39], v[120:123], v[96:99], v[36:39]
    v_mfma_f32_16x16x32_bf16 v[72:75], v[120:123], v[100:103], v[72:75]
    ds_read_b64_tr_b16 v[120:121], v131 offset:41216
    ds_read_b64_tr_b16 v[122:123], v131 offset:43520
    s_waitcnt lgkmcnt(4)
    v_mfma_f32_16x16x32_bf16 v[40:43], v[112:115], v[96:99], v[40:43]
    v_mfma_f32_16x16x32_bf16 v[76:79], v[112:115], v[100:103], v[76:79]
    ds_read_b64_tr_b16 v[112:113], v131 offset:50176
    ds_read_b64_tr_b16 v[114:115], v131 offset:52480
    s_waitcnt lgkmcnt(4)
    v_mfma_f32_16x16x32_bf16 v[44:47], v[116:119], v[96:99], v[44:47]
    v_mfma_f32_16x16x32_bf16 v[80:83], v[116:119], v[100:103], v[80:83]
    ds_read_b64_tr_b16 v[116:117], v131 offset:50208
    ds_read_b64_tr_b16 v[118:119], v131 offset:52512
    s_waitcnt lgkmcnt(4)
    v_mfma_f32_16x16x32_bf16 v[48:51], v[120:123], v[96:99], v[48:51]
    v_mfma_f32_16x16x32_bf16 v[84:87], v[120:123], v[100:103], v[84:87]
    ds_read_b64_tr_b16 v[120:121], v131 offset:50240
    ds_read_b64_tr_b16 v[122:123], v131 offset:52544
    buffer_load_dwordx4 v[96:99], v124, s[8:11], s26 offen offset:832
    s_waitcnt vmcnt(8) lgkmcnt(4)
    v_mfma_f32_16x16x32_bf16 v[16:19], v[112:115], v[104:107], v[16:19]
    v_mfma_f32_16x16x32_bf16 v[52:55], v[112:115], v[108:111], v[52:55]
    ds_read_b64_tr_b16 v[112:113], v131 offset:50272
    ds_read_b64_tr_b16 v[114:115], v131 offset:52576
    buffer_load_dwordx4 v[100:103], v125, s[8:11], s26 offen offset:832
    s_waitcnt lgkmcnt(4)
    v_mfma_f32_16x16x32_bf16 v[20:23], v[116:119], v[104:107], v[20:23]
    v_mfma_f32_16x16x32_bf16 v[56:59], v[116:119], v[108:111], v[56:59]
    ds_read_b64_tr_b16 v[116:117], v131 offset:50304
    ds_read_b64_tr_b16 v[118:119], v131 offset:52608
    s_waitcnt lgkmcnt(4)
    v_mfma_f32_16x16x32_bf16 v[24:27], v[120:123], v[104:107], v[24:27]
    v_mfma_f32_16x16x32_bf16 v[60:63], v[120:123], v[108:111], v[60:63]
    ds_read_b64_tr_b16 v[120:121], v131 offset:50336
    ds_read_b64_tr_b16 v[122:123], v131 offset:52640
    s_waitcnt lgkmcnt(4)
    v_mfma_f32_16x16x32_bf16 v[28:31], v[112:115], v[104:107], v[28:31]
    v_mfma_f32_16x16x32_bf16 v[64:67], v[112:115], v[108:111], v[64:67]
    ds_read_b64_tr_b16 v[112:113], v131 offset:50368
    ds_read_b64_tr_b16 v[114:115], v131 offset:52672
    s_waitcnt lgkmcnt(4)
    v_mfma_f32_16x16x32_bf16 v[32:35], v[116:119], v[104:107], v[32:35]
    v_mfma_f32_16x16x32_bf16 v[68:71], v[116:119], v[108:111], v[68:71]
    ds_read_b64_tr_b16 v[116:117], v131 offset:50400
    ds_read_b64_tr_b16 v[118:119], v131 offset:52704
    s_waitcnt lgkmcnt(4)
    v_mfma_f32_16x16x32_bf16 v[36:39], v[120:123], v[104:107], v[36:39]
    v_mfma_f32_16x16x32_bf16 v[72:75], v[120:123], v[108:111], v[72:75]
    ds_read_b64_tr_b16 v[120:121], v131 offset:50432
    ds_read_b64_tr_b16 v[122:123], v131 offset:52736
    s_waitcnt lgkmcnt(4)
    v_mfma_f32_16x16x32_bf16 v[40:43], v[112:115], v[104:107], v[40:43]
    v_mfma_f32_16x16x32_bf16 v[76:79], v[112:115], v[108:111], v[76:79]
    s_waitcnt lgkmcnt(0)
    s_barrier
    ds_read_b64_tr_b16 v[112:113], v131 offset:0
    ds_read_b64_tr_b16 v[114:115], v131 offset:2304
    s_add_u32 m0, s24, 40960
    s_nop 0
    buffer_load_dwordx4 v126, s[12:15], s25 offen offset:0 lds
    v_mfma_f32_16x16x32_bf16 v[44:47], v[116:119], v[104:107], v[44:47]
    v_mfma_f32_16x16x32_bf16 v[80:83], v[116:119], v[108:111], v[80:83]
    ds_read_b64_tr_b16 v[116:117], v131 offset:32
    ds_read_b64_tr_b16 v[118:119], v131 offset:2336
    s_add_u32 m0, s24, 40960
    s_nop 0
    buffer_load_dwordx4 v127, s[12:15], s25 offen offset:1024 lds
    v_mfma_f32_16x16x32_bf16 v[48:51], v[120:123], v[104:107], v[48:51]
    v_mfma_f32_16x16x32_bf16 v[84:87], v[120:123], v[108:111], v[84:87]
    ds_read_b64_tr_b16 v[120:121], v131 offset:64
    ds_read_b64_tr_b16 v[122:123], v131 offset:2368
    buffer_load_dwordx4 v[104:107], v124, s[8:11], s26 offen offset:896
    s_waitcnt vmcnt(8) lgkmcnt(4)
    v_mfma_f32_16x16x32_bf16 v[16:19], v[112:115], v[88:91], v[16:19]
    v_mfma_f32_16x16x32_bf16 v[52:55], v[112:115], v[92:95], v[52:55]
    ds_read_b64_tr_b16 v[112:113], v131 offset:96
    ds_read_b64_tr_b16 v[114:115], v131 offset:2400
    buffer_load_dwordx4 v[108:111], v125, s[8:11], s26 offen offset:896
    s_waitcnt lgkmcnt(4)
    v_mfma_f32_16x16x32_bf16 v[20:23], v[116:119], v[88:91], v[20:23]
    v_mfma_f32_16x16x32_bf16 v[56:59], v[116:119], v[92:95], v[56:59]
    ds_read_b64_tr_b16 v[116:117], v131 offset:128
    ds_read_b64_tr_b16 v[118:119], v131 offset:2432
    s_add_u32 m0, s24, 40960
    s_nop 0
    buffer_load_dwordx4 v128, s[12:15], s25 offen offset:2048 lds
    s_waitcnt lgkmcnt(4)
    v_mfma_f32_16x16x32_bf16 v[24:27], v[120:123], v[88:91], v[24:27]
    v_mfma_f32_16x16x32_bf16 v[60:63], v[120:123], v[92:95], v[60:63]
    ds_read_b64_tr_b16 v[120:121], v131 offset:160
    ds_read_b64_tr_b16 v[122:123], v131 offset:2464
    s_add_u32 m0, s24, 40960
    s_nop 0
    buffer_load_dwordx4 v129, s[12:15], s25 offen offset:3072 lds
    s_waitcnt lgkmcnt(4)
    v_mfma_f32_16x16x32_bf16 v[28:31], v[112:115], v[88:91], v[28:31]
    v_mfma_f32_16x16x32_bf16 v[64:67], v[112:115], v[92:95], v[64:67]
    ds_read_b64_tr_b16 v[112:113], v131 offset:192
    ds_read_b64_tr_b16 v[114:115], v131 offset:2496
    s_add_u32 m0, s24, 45056
    s_nop 0
    buffer_load_dwordx4 v130, s[12:15], s25 offen offset:0 lds
    s_add_u32 s25, s25, 221184
    s_waitcnt lgkmcnt(4)
    v_mfma_f32_16x16x32_bf16 v[32:35], v[116:119], v[88:91], v[32:35]
    v_mfma_f32_16x16x32_bf16 v[68:71], v[116:119], v[92:95], v[68:71]
    ds_read_b64_tr_b16 v[116:117], v131 offset:224
    ds_read_b64_tr_b16 v[118:119], v131 offset:2528
    s_waitcnt lgkmcnt(4)
    v_mfma_f32_16x16x32_bf16 v[36:39], v[120:123], v[88:91], v[36:39]
    v_mfma_f32_16x16x32_bf16 v[72:75], v[120:123], v[92:95], v[72:75]
    ds_read_b64_tr_b16 v[120:121], v131 offset:256
    ds_read_b64_tr_b16 v[122:123], v131 offset:2560
    s_waitcnt lgkmcnt(4)
    v_mfma_f32_16x16x32_bf16 v[40:43], v[112:115], v[88:91], v[40:43]
    v_mfma_f32_16x16x32_bf16 v[76:79], v[112:115], v[92:95], v[76:79]
    ds_read_b64_tr_b16 v[112:113], v131 offset:9216
    ds_read_b64_tr_b16 v[114:115], v131 offset:11520
    s_waitcnt lgkmcnt(4)
    v_mfma_f32_16x16x32_bf16 v[44:47], v[116:119], v[88:91], v[44:47]
    v_mfma_f32_16x16x32_bf16 v[80:83], v[116:119], v[92:95], v[80:83]
    ds_read_b64_tr_b16 v[116:117], v131 offset:9248
    ds_read_b64_tr_b16 v[118:119], v131 offset:11552
    s_waitcnt lgkmcnt(4)
    v_mfma_f32_16x16x32_bf16 v[48:51], v[120:123], v[88:91], v[48:51]
    v_mfma_f32_16x16x32_bf16 v[84:87], v[120:123], v[92:95], v[84:87]
    ds_read_b64_tr_b16 v[120:121], v131 offset:9280
    ds_read_b64_tr_b16 v[122:123], v131 offset:11584
    buffer_load_dwordx4 v[88:91], v124, s[8:11], s26 offen offset:960
    s_waitcnt vmcnt(8) lgkmcnt(4)
    v_mfma_f32_16x16x32_bf16 v[16:19], v[112:115], v[96:99], v[16:19]
    v_mfma_f32_16x16x32_bf16 v[52:55], v[112:115], v[100:103], v[52:55]
    ds_read_b64_tr_b16 v[112:113], v131 offset:9312
    ds_read_b64_tr_b16 v[114:115], v131 offset:11616
    buffer_load_dwordx4 v[92:95], v125, s[8:11], s26 offen offset:960
    s_waitcnt lgkmcnt(4)
    v_mfma_f32_16x16x32_bf16 v[20:23], v[116:119], v[96:99], v[20:23]
    v_mfma_f32_16x16x32_bf16 v[56:59], v[116:119], v[100:103], v[56:59]
    ds_read_b64_tr_b16 v[116:117], v131 offset:9344
    ds_read_b64_tr_b16 v[118:119], v131 offset:11648
    s_waitcnt lgkmcnt(4)
    v_mfma_f32_16x16x32_bf16 v[24:27], v[120:123], v[96:99], v[24:27]
    v_mfma_f32_16x16x32_bf16 v[60:63], v[120:123], v[100:103], v[60:63]
    ds_read_b64_tr_b16 v[120:121], v131 offset:9376
    ds_read_b64_tr_b16 v[122:123], v131 offset:11680
    s_waitcnt lgkmcnt(4)
    v_mfma_f32_16x16x32_bf16 v[28:31], v[112:115], v[96:99], v[28:31]
    v_mfma_f32_16x16x32_bf16 v[64:67], v[112:115], v[100:103], v[64:67]
    ds_read_b64_tr_b16 v[112:113], v131 offset:9408
    ds_read_b64_tr_b16 v[114:115], v131 offset:11712
    s_waitcnt lgkmcnt(4)
    v_mfma_f32_16x16x32_bf16 v[32:35], v[116:119], v[96:99], v[32:35]
    v_mfma_f32_16x16x32_bf16 v[68:71], v[116:119], v[100:103], v[68:71]
    ds_read_b64_tr_b16 v[116:117], v131 offset:9440
    ds_read_b64_tr_b16 v[118:119], v131 offset:11744
    s_waitcnt lgkmcnt(4)
    v_mfma_f32_16x16x32_bf16 v[36:39], v[120:123], v[96:99], v[36:39]
    v_mfma_f32_16x16x32_bf16 v[72:75], v[120:123], v[100:103], v[72:75]
    ds_read_b64_tr_b16 v[120:121], v131 offset:9472
    ds_read_b64_tr_b16 v[122:123], v131 offset:11776
    s_waitcnt lgkmcnt(4)
    v_mfma_f32_16x16x32_bf16 v[40:43], v[112:115], v[96:99], v[40:43]
    v_mfma_f32_16x16x32_bf16 v[76:79], v[112:115], v[100:103], v[76:79]
    s_waitcnt lgkmcnt(0)
    s_barrier
    ds_read_b64_tr_b16 v[112:113], v131 offset:20480
    ds_read_b64_tr_b16 v[114:115], v131 offset:22784
    v_mfma_f32_16x16x32_bf16 v[44:47], v[116:119], v[96:99], v[44:47]
    v_mfma_f32_16x16x32_bf16 v[80:83], v[116:119], v[100:103], v[80:83]
    ds_read_b64_tr_b16 v[116:117], v131 offset:20512
    ds_read_b64_tr_b16 v[118:119], v131 offset:22816
    v_mfma_f32_16x16x32_bf16 v[48:51], v[120:123], v[96:99], v[48:51]
    v_mfma_f32_16x16x32_bf16 v[84:87], v[120:123], v[100:103], v[84:87]
    ds_read_b64_tr_b16 v[120:121], v131 offset:20544
    ds_read_b64_tr_b16 v[122:123], v131 offset:22848
    buffer_load_dwordx4 v[96:99], v124, s[8:11], s26 offen offset:1024
    s_waitcnt vmcnt(6) lgkmcnt(4)
    v_mfma_f32_16x16x32_bf16 v[16:19], v[112:115], v[104:107], v[16:19]
    v_mfma_f32_16x16x32_bf16 v[52:55], v[112:115], v[108:111], v[52:55]
    ds_read_b64_tr_b16 v[112:113], v131 offset:20576
    ds_read_b64_tr_b16 v[114:115], v131 offset:22880
    buffer_load_dwordx4 v[100:103], v125, s[8:11], s26 offen offset:1024
    s_waitcnt lgkmcnt(4)
    v_mfma_f32_16x16x32_bf16 v[20:23], v[116:119], v[104:107], v[20:23]
    v_mfma_f32_16x16x32_bf16 v[56:59], v[116:119], v[108:111], v[56:59]
    ds_read_b64_tr_b16 v[116:117], v131 offset:20608
    ds_read_b64_tr_b16 v[118:119], v131 offset:22912
    s_waitcnt lgkmcnt(4)
    v_mfma_f32_16x16x32_bf16 v[24:27], v[120:123], v[104:107], v[24:27]
    v_mfma_f32_16x16x32_bf16 v[60:63], v[120:123], v[108:111], v[60:63]
    ds_read_b64_tr_b16 v[120:121], v131 offset:20640
    ds_read_b64_tr_b16 v[122:123], v131 offset:22944
    s_waitcnt lgkmcnt(4)
    v_mfma_f32_16x16x32_bf16 v[28:31], v[112:115], v[104:107], v[28:31]
    v_mfma_f32_16x16x32_bf16 v[64:67], v[112:115], v[108:111], v[64:67]
    ds_read_b64_tr_b16 v[112:113], v131 offset:20672
    ds_read_b64_tr_b16 v[114:115], v131 offset:22976
    s_waitcnt lgkmcnt(4)
    v_mfma_f32_16x16x32_bf16 v[32:35], v[116:119], v[104:107], v[32:35]
    v_mfma_f32_16x16x32_bf16 v[68:71], v[116:119], v[108:111], v[68:71]
    ds_read_b64_tr_b16 v[116:117], v131 offset:20704
    ds_read_b64_tr_b16 v[118:119], v131 offset:23008
    s_waitcnt lgkmcnt(4)
    v_mfma_f32_16x16x32_bf16 v[36:39], v[120:123], v[104:107], v[36:39]
    v_mfma_f32_16x16x32_bf16 v[72:75], v[120:123], v[108:111], v[72:75]
    ds_read_b64_tr_b16 v[120:121], v131 offset:20736
    ds_read_b64_tr_b16 v[122:123], v131 offset:23040
    s_waitcnt lgkmcnt(4)
    v_mfma_f32_16x16x32_bf16 v[40:43], v[112:115], v[104:107], v[40:43]
    v_mfma_f32_16x16x32_bf16 v[76:79], v[112:115], v[108:111], v[76:79]
    ds_read_b64_tr_b16 v[112:113], v131 offset:29696
    ds_read_b64_tr_b16 v[114:115], v131 offset:32000
    s_waitcnt lgkmcnt(4)
    v_mfma_f32_16x16x32_bf16 v[44:47], v[116:119], v[104:107], v[44:47]
    v_mfma_f32_16x16x32_bf16 v[80:83], v[116:119], v[108:111], v[80:83]
    ds_read_b64_tr_b16 v[116:117], v131 offset:29728
    ds_read_b64_tr_b16 v[118:119], v131 offset:32032
    s_waitcnt lgkmcnt(4)
    v_mfma_f32_16x16x32_bf16 v[48:51], v[120:123], v[104:107], v[48:51]
    v_mfma_f32_16x16x32_bf16 v[84:87], v[120:123], v[108:111], v[84:87]
    ds_read_b64_tr_b16 v[120:121], v131 offset:29760
    ds_read_b64_tr_b16 v[122:123], v131 offset:32064
    buffer_load_dwordx4 v[104:107], v124, s[8:11], s26 offen offset:1088
    s_waitcnt vmcnt(3) lgkmcnt(4)
    v_mfma_f32_16x16x32_bf16 v[16:19], v[112:115], v[88:91], v[16:19]
    v_mfma_f32_16x16x32_bf16 v[52:55], v[112:115], v[92:95], v[52:55]
    ds_read_b64_tr_b16 v[112:113], v131 offset:29792
    ds_read_b64_tr_b16 v[114:115], v131 offset:32096
    buffer_load_dwordx4 v[108:111], v125, s[8:11], s26 offen offset:1088
    s_waitcnt lgkmcnt(4)
    v_mfma_f32_16x16x32_bf16 v[20:23], v[116:119], v[88:91], v[20:23]
    v_mfma_f32_16x16x32_bf16 v[56:59], v[116:119], v[92:95], v[56:59]
    ds_read_b64_tr_b16 v[116:117], v131 offset:29824
    ds_read_b64_tr_b16 v[118:119], v131 offset:32128
    s_waitcnt lgkmcnt(4)
    v_mfma_f32_16x16x32_bf16 v[24:27], v[120:123], v[88:91], v[24:27]
    v_mfma_f32_16x16x32_bf16 v[60:63], v[120:123], v[92:95], v[60:63]
    ds_read_b64_tr_b16 v[120:121], v131 offset:29856
    ds_read_b64_tr_b16 v[122:123], v131 offset:32160
    s_waitcnt lgkmcnt(4)
    v_mfma_f32_16x16x32_bf16 v[28:31], v[112:115], v[88:91], v[28:31]
    v_mfma_f32_16x16x32_bf16 v[64:67], v[112:115], v[92:95], v[64:67]
    ds_read_b64_tr_b16 v[112:113], v131 offset:29888
    ds_read_b64_tr_b16 v[114:115], v131 offset:32192
    s_waitcnt lgkmcnt(4)
    v_mfma_f32_16x16x32_bf16 v[32:35], v[116:119], v[88:91], v[32:35]
    v_mfma_f32_16x16x32_bf16 v[68:71], v[116:119], v[92:95], v[68:71]
    ds_read_b64_tr_b16 v[116:117], v131 offset:29920
    ds_read_b64_tr_b16 v[118:119], v131 offset:32224
    s_waitcnt lgkmcnt(4)
    v_mfma_f32_16x16x32_bf16 v[36:39], v[120:123], v[88:91], v[36:39]
    v_mfma_f32_16x16x32_bf16 v[72:75], v[120:123], v[92:95], v[72:75]
    ds_read_b64_tr_b16 v[120:121], v131 offset:29952
    ds_read_b64_tr_b16 v[122:123], v131 offset:32256
    s_waitcnt lgkmcnt(4)
    v_mfma_f32_16x16x32_bf16 v[40:43], v[112:115], v[88:91], v[40:43]
    v_mfma_f32_16x16x32_bf16 v[76:79], v[112:115], v[92:95], v[76:79]
    s_waitcnt lgkmcnt(0)
    s_barrier
    ds_read_b64_tr_b16 v[112:113], v131 offset:40960
    ds_read_b64_tr_b16 v[114:115], v131 offset:43264
    v_mfma_f32_16x16x32_bf16 v[44:47], v[116:119], v[88:91], v[44:47]
    v_mfma_f32_16x16x32_bf16 v[80:83], v[116:119], v[92:95], v[80:83]
    ds_read_b64_tr_b16 v[116:117], v131 offset:40992
    ds_read_b64_tr_b16 v[118:119], v131 offset:43296
    v_mfma_f32_16x16x32_bf16 v[48:51], v[120:123], v[88:91], v[48:51]
    v_mfma_f32_16x16x32_bf16 v[84:87], v[120:123], v[92:95], v[84:87]
    ds_read_b64_tr_b16 v[120:121], v131 offset:41024
    ds_read_b64_tr_b16 v[122:123], v131 offset:43328
    s_waitcnt vmcnt(2) lgkmcnt(4)
    v_mfma_f32_16x16x32_bf16 v[16:19], v[112:115], v[96:99], v[16:19]
    v_mfma_f32_16x16x32_bf16 v[52:55], v[112:115], v[100:103], v[52:55]
    ds_read_b64_tr_b16 v[112:113], v131 offset:41056
    ds_read_b64_tr_b16 v[114:115], v131 offset:43360
    s_waitcnt lgkmcnt(4)
    v_mfma_f32_16x16x32_bf16 v[20:23], v[116:119], v[96:99], v[20:23]
    v_mfma_f32_16x16x32_bf16 v[56:59], v[116:119], v[100:103], v[56:59]
    ds_read_b64_tr_b16 v[116:117], v131 offset:41088
    ds_read_b64_tr_b16 v[118:119], v131 offset:43392
    s_waitcnt lgkmcnt(4)
    v_mfma_f32_16x16x32_bf16 v[24:27], v[120:123], v[96:99], v[24:27]
    v_mfma_f32_16x16x32_bf16 v[60:63], v[120:123], v[100:103], v[60:63]
    ds_read_b64_tr_b16 v[120:121], v131 offset:41120
    ds_read_b64_tr_b16 v[122:123], v131 offset:43424
    s_waitcnt lgkmcnt(4)
    v_mfma_f32_16x16x32_bf16 v[28:31], v[112:115], v[96:99], v[28:31]
    v_mfma_f32_16x16x32_bf16 v[64:67], v[112:115], v[100:103], v[64:67]
    ds_read_b64_tr_b16 v[112:113], v131 offset:41152
    ds_read_b64_tr_b16 v[114:115], v131 offset:43456
    s_waitcnt lgkmcnt(4)
    v_mfma_f32_16x16x32_bf16 v[32:35], v[116:119], v[96:99], v[32:35]
    v_mfma_f32_16x16x32_bf16 v[68:71], v[116:119], v[100:103], v[68:71]
    ds_read_b64_tr_b16 v[116:117], v131 offset:41184
    ds_read_b64_tr_b16 v[118:119], v131 offset:43488
    s_waitcnt lgkmcnt(4)
    v_mfma_f32_16x16x32_bf16 v[36:39], v[120:123], v[96:99], v[36:39]
    v_mfma_f32_16x16x32_bf16 v[72:75], v[120:123], v[100:103], v[72:75]
    ds_read_b64_tr_b16 v[120:121], v131 offset:41216
    ds_read_b64_tr_b16 v[122:123], v131 offset:43520
    s_waitcnt lgkmcnt(4)
    v_mfma_f32_16x16x32_bf16 v[40:43], v[112:115], v[96:99], v[40:43]
    v_mfma_f32_16x16x32_bf16 v[76:79], v[112:115], v[100:103], v[76:79]
    ds_read_b64_tr_b16 v[112:113], v131 offset:50176
    ds_read_b64_tr_b16 v[114:115], v131 offset:52480
    s_waitcnt lgkmcnt(4)
    v_mfma_f32_16x16x32_bf16 v[44:47], v[116:119], v[96:99], v[44:47]
    v_mfma_f32_16x16x32_bf16 v[80:83], v[116:119], v[100:103], v[80:83]
    ds_read_b64_tr_b16 v[116:117], v131 offset:50208
    ds_read_b64_tr_b16 v[118:119], v131 offset:52512
    s_waitcnt lgkmcnt(4)
    v_mfma_f32_16x16x32_bf16 v[48:51], v[120:123], v[96:99], v[48:51]
    v_mfma_f32_16x16x32_bf16 v[84:87], v[120:123], v[100:103], v[84:87]
    ds_read_b64_tr_b16 v[120:121], v131 offset:50240
    ds_read_b64_tr_b16 v[122:123], v131 offset:52544
    s_waitcnt vmcnt(0) lgkmcnt(4)
    v_mfma_f32_16x16x32_bf16 v[16:19], v[112:115], v[104:107], v[16:19]
    v_mfma_f32_16x16x32_bf16 v[52:55], v[112:115], v[108:111], v[52:55]
    ds_read_b64_tr_b16 v[112:113], v131 offset:50272
    ds_read_b64_tr_b16 v[114:115], v131 offset:52576
    s_waitcnt lgkmcnt(4)
    v_mfma_f32_16x16x32_bf16 v[20:23], v[116:119], v[104:107], v[20:23]
    v_mfma_f32_16x16x32_bf16 v[56:59], v[116:119], v[108:111], v[56:59]
    ds_read_b64_tr_b16 v[116:117], v131 offset:50304
    ds_read_b64_tr_b16 v[118:119], v131 offset:52608
    s_waitcnt lgkmcnt(4)
    v_mfma_f32_16x16x32_bf16 v[24:27], v[120:123], v[104:107], v[24:27]
    v_mfma_f32_16x16x32_bf16 v[60:63], v[120:123], v[108:111], v[60:63]
    ds_read_b64_tr_b16 v[120:121], v131 offset:50336
    ds_read_b64_tr_b16 v[122:123], v131 offset:52640
    s_waitcnt lgkmcnt(4)
    v_mfma_f32_16x16x32_bf16 v[28:31], v[112:115], v[104:107], v[28:31]
    v_mfma_f32_16x16x32_bf16 v[64:67], v[112:115], v[108:111], v[64:67]
    ds_read_b64_tr_b16 v[112:113], v131 offset:50368
    ds_read_b64_tr_b16 v[114:115], v131 offset:52672
    s_waitcnt lgkmcnt(4)
    v_mfma_f32_16x16x32_bf16 v[32:35], v[116:119], v[104:107], v[32:35]
    v_mfma_f32_16x16x32_bf16 v[68:71], v[116:119], v[108:111], v[68:71]
    ds_read_b64_tr_b16 v[116:117], v131 offset:50400
    ds_read_b64_tr_b16 v[118:119], v131 offset:52704
    s_waitcnt lgkmcnt(4)
    v_mfma_f32_16x16x32_bf16 v[36:39], v[120:123], v[104:107], v[36:39]
    v_mfma_f32_16x16x32_bf16 v[72:75], v[120:123], v[108:111], v[72:75]
    ds_read_b64_tr_b16 v[120:121], v131 offset:50432
    ds_read_b64_tr_b16 v[122:123], v131 offset:52736
    s_waitcnt lgkmcnt(4)
    v_mfma_f32_16x16x32_bf16 v[40:43], v[112:115], v[104:107], v[40:43]
    v_mfma_f32_16x16x32_bf16 v[76:79], v[112:115], v[108:111], v[76:79]
    s_waitcnt lgkmcnt(2)
    v_mfma_f32_16x16x32_bf16 v[44:47], v[116:119], v[104:107], v[44:47]
    v_mfma_f32_16x16x32_bf16 v[80:83], v[116:119], v[108:111], v[80:83]
    s_waitcnt lgkmcnt(0)
    v_mfma_f32_16x16x32_bf16 v[48:51], v[120:123], v[104:107], v[48:51]
    v_mfma_f32_16x16x32_bf16 v[84:87], v[120:123], v[108:111], v[84:87]
    s_nop 7
    s_nop 7
    s_cmp_eq_u32 s5, 0
    s_mov_b32 s28, 0x800000
    s_cmov_b32 s28, 0x400000
    s_mov_b32 s29, 0x800000
    s_cmov_b32 s29, 0x400000
    s_mov_b32 s32, 262144
    s_cmov_b32 s32, 131072
    s_mov_b32 s31, 4096
    s_cmov_b32 s31, 2048
    s_mov_b32 s38, 1.0
    s_cmov_b32 s38, 0x3eae1a93
    s_add_u32 s16, s86, s28
    s_addc_u32 s17, s87, 0
    s_mov_b32 s18, s29
    s_mov_b32 s19, 0x00020000
    s_mul_i32 s31, s31, s33
    s_and_b32 s28, s4, 3
    s_lshl_b32 s28, s28, 3
    s_mul_i32 s28, s28, s32
    s_add_u32 s31, s31, s28
    s_cmp_eq_u32 s5, 2
    s_mov_b32 s28, 0
    s_cmov_b32 s28, 2048
    s_add_u32 s31, s31, s28
    v_mov_b32 v4, 0x3f803f80
    v_mov_b32 v6, 0
    v_mov_b32 v7, 0
    v_mov_b32 v8, 0
    v_mov_b32 v9, 0
    v_mov_b32 v10, 0
    v_mov_b32 v11, 0
    s_barrier
    ds_write_b32 v168, v4 offset:4
    ds_write_b64 v168, v[6:7] offset:8
    ds_write_b128 v169, v[8:11] offset:0
    ds_write_b32 v168, v4 offset:4100
    ds_write_b64 v168, v[6:7] offset:4104
    ds_write_b128 v169, v[8:11] offset:4096
    ds_write_b32 v168, v4 offset:8196
    ds_write_b64 v168, v[6:7] offset:8200
    ds_write_b128 v169, v[8:11] offset:8192
    ds_write_b32 v168, v4 offset:12292
    ds_write_b64 v168, v[6:7] offset:12296
    ds_write_b128 v169, v[8:11] offset:12288
    v_mul_f32 v16, s38, v16
    v_mul_f32 v17, s38, v17
    v_cvt_pk_bf16_f32 v16, v16, v17
    ds_write_b32 v132, v16
    v_mul_f32 v52, s38, v52
    v_mul_f32 v53, s38, v53
    v_cvt_pk_bf16_f32 v52, v52, v53
    ds_write_b32 v133, v52
    v_mul_f32 v18, s38, v18
    v_mul_f32 v19, s38, v19
    v_cvt_pk_bf16_f32 v18, v18, v19
    ds_write_b32 v134, v18
    v_mul_f32 v54, s38, v54
    v_mul_f32 v55, s38, v55
    v_cvt_pk_bf16_f32 v54, v54, v55
    ds_write_b32 v135, v54
    v_mul_f32 v20, s38, v20
    v_mul_f32 v21, s38, v21
    v_cvt_pk_bf16_f32 v20, v20, v21
    ds_write_b32 v136, v20
    v_mul_f32 v56, s38, v56
    v_mul_f32 v57, s38, v57
    v_cvt_pk_bf16_f32 v56, v56, v57
    ds_write_b32 v137, v56
    v_mul_f32 v22, s38, v22
    v_mul_f32 v23, s38, v23
    v_cvt_pk_bf16_f32 v22, v22, v23
    ds_write_b32 v138, v22
    v_mul_f32 v58, s38, v58
    v_mul_f32 v59, s38, v59
    v_cvt_pk_bf16_f32 v58, v58, v59
    ds_write_b32 v139, v58
    v_mul_f32 v24, s38, v24
    v_mul_f32 v25, s38, v25
    v_cvt_pk_bf16_f32 v24, v24, v25
    ds_write_b32 v140, v24
    v_mul_f32 v60, s38, v60
    v_mul_f32 v61, s38, v61
    v_cvt_pk_bf16_f32 v60, v60, v61
    ds_write_b32 v141, v60
    v_mul_f32 v26, s38, v26
    v_mul_f32 v27, s38, v27
    v_cvt_pk_bf16_f32 v26, v26, v27
    ds_write_b32 v142, v26
    v_mul_f32 v62, s38, v62
    v_mul_f32 v63, s38, v63
    v_cvt_pk_bf16_f32 v62, v62, v63
    ds_write_b32 v143, v62
    v_mul_f32 v28, s38, v28
    v_mul_f32 v29, s38, v29
    v_cvt_pk_bf16_f32 v28, v28, v29
    ds_write_b32 v144, v28
    v_mul_f32 v64, s38, v64
    v_mul_f32 v65, s38, v65
    v_cvt_pk_bf16_f32 v64, v64, v65
    ds_write_b32 v145, v64
    v_mul_f32 v30, s38, v30
    v_mul_f32 v31, s38, v31
    v_cvt_pk_bf16_f32 v30, v30, v31
    ds_write_b32 v146, v30
    v_mul_f32 v66, s38, v66
    v_mul_f32 v67, s38, v67
    v_cvt_pk_bf16_f32 v66, v66, v67
    ds_write_b32 v147, v66
    v_mul_f32 v32, s38, v32
    v_mul_f32 v33, s38, v33
    v_cvt_pk_bf16_f32 v32, v32, v33
    ds_write_b32 v148, v32
    v_mul_f32 v68, s38, v68
    v_mul_f32 v69, s38, v69
    v_cvt_pk_bf16_f32 v68, v68, v69
    ds_write_b32 v149, v68
    v_mul_f32 v34, s38, v34
    v_mul_f32 v35, s38, v35
    v_cvt_pk_bf16_f32 v34, v34, v35
    ds_write_b32 v150, v34
    v_mul_f32 v70, s38, v70
    v_mul_f32 v71, s38, v71
    v_cvt_pk_bf16_f32 v70, v70, v71
    ds_write_b32 v151, v70
    v_mul_f32 v36, s38, v36
    v_mul_f32 v37, s38, v37
    v_cvt_pk_bf16_f32 v36, v36, v37
    ds_write_b32 v152, v36
    v_mul_f32 v72, s38, v72
    v_mul_f32 v73, s38, v73
    v_cvt_pk_bf16_f32 v72, v72, v73
    ds_write_b32 v153, v72
    v_mul_f32 v38, s38, v38
    v_mul_f32 v39, s38, v39
    v_cvt_pk_bf16_f32 v38, v38, v39
    ds_write_b32 v154, v38
    v_mul_f32 v74, s38, v74
    v_mul_f32 v75, s38, v75
    v_cvt_pk_bf16_f32 v74, v74, v75
    ds_write_b32 v155, v74
    v_mul_f32 v40, s38, v40
    v_mul_f32 v41, s38, v41
    v_cvt_pk_bf16_f32 v40, v40, v41
    ds_write_b32 v156, v40
    v_mul_f32 v76, s38, v76
    v_mul_f32 v77, s38, v77
    v_cvt_pk_bf16_f32 v76, v76, v77
    ds_write_b32 v157, v76
    v_mul_f32 v42, s38, v42
    v_mul_f32 v43, s38, v43
    v_cvt_pk_bf16_f32 v42, v42, v43
    ds_write_b32 v158, v42
    v_mul_f32 v78, s38, v78
    v_mul_f32 v79, s38, v79
    v_cvt_pk_bf16_f32 v78, v78, v79
    ds_write_b32 v159, v78
    v_mul_f32 v44, s38, v44
    v_mul_f32 v45, s38, v45
    v_cvt_pk_bf16_f32 v44, v44, v45
    ds_write_b32 v160, v44
    v_mul_f32 v80, s38, v80
    v_mul_f32 v81, s38, v81
    v_cvt_pk_bf16_f32 v80, v80, v81
    ds_write_b32 v161, v80
    v_mul_f32 v46, s38, v46
    v_mul_f32 v47, s38, v47
    v_cvt_pk_bf16_f32 v46, v46, v47
    ds_write_b32 v162, v46
    v_mul_f32 v82, s38, v82
    v_mul_f32 v83, s38, v83
    v_cvt_pk_bf16_f32 v82, v82, v83
    ds_write_b32 v163, v82
    v_mul_f32 v48, s38, v48
    v_mul_f32 v49, s38, v49
    v_cvt_pk_bf16_f32 v48, v48, v49
    ds_write_b32 v164, v48
    v_mul_f32 v84, s38, v84
    v_mul_f32 v85, s38, v85
    v_cvt_pk_bf16_f32 v84, v84, v85
    ds_write_b32 v165, v84
    v_mul_f32 v50, s38, v50
    v_mul_f32 v51, s38, v51
    v_cvt_pk_bf16_f32 v50, v50, v51
    ds_write_b32 v166, v50
    v_mul_f32 v86, s38, v86
    v_mul_f32 v87, s38, v87
    v_cvt_pk_bf16_f32 v86, v86, v87
    ds_write_b32 v167, v86
    s_waitcnt lgkmcnt(0)
    v_lshlrev_b32 v2, 4, v1
    ds_read_b128 v[16:19], v170 offset:0
    ds_read_b128 v[20:23], v170 offset:1024
    ds_read_b128 v[24:27], v170 offset:2048
    ds_read_b128 v[28:31], v170 offset:3072
    ds_read_b128 v[32:35], v170 offset:4096
    ds_read_b128 v[36:39], v170 offset:5120
    ds_read_b128 v[40:43], v170 offset:6144
    ds_read_b128 v[44:47], v170 offset:7168
    s_waitcnt lgkmcnt(7)
    buffer_store_dwordx4 v[16:19], v2, s[16:19], s31 offen offset:0 sc1
    s_waitcnt lgkmcnt(6)
    buffer_store_dwordx4 v[20:23], v2, s[16:19], s31 offen offset:1024 sc1
    s_add_u32 s31, s31, s32
    s_waitcnt lgkmcnt(5)
    buffer_store_dwordx4 v[24:27], v2, s[16:19], s31 offen offset:0 sc1
    s_waitcnt lgkmcnt(4)
    buffer_store_dwordx4 v[28:31], v2, s[16:19], s31 offen offset:1024 sc1
    s_add_u32 s31, s31, s32
    s_waitcnt lgkmcnt(3)
    buffer_store_dwordx4 v[32:35], v2, s[16:19], s31 offen offset:0 sc1
    s_waitcnt lgkmcnt(2)
    buffer_store_dwordx4 v[36:39], v2, s[16:19], s31 offen offset:1024 sc1
    s_add_u32 s31, s31, s32
    s_waitcnt lgkmcnt(1)
    buffer_store_dwordx4 v[40:43], v2, s[16:19], s31 offen offset:0 sc1
    s_waitcnt lgkmcnt(0)
    buffer_store_dwordx4 v[44:47], v2, s[16:19], s31 offen offset:1024 sc1
    s_add_u32 s31, s31, s32
    ds_read_b128 v[48:51], v170 offset:8192
    ds_read_b128 v[52:55], v170 offset:9216
    ds_read_b128 v[56:59], v170 offset:10240
    ds_read_b128 v[60:63], v170 offset:11264
    ds_read_b128 v[64:67], v170 offset:12288
    ds_read_b128 v[68:71], v170 offset:13312
    ds_read_b128 v[72:75], v170 offset:14336
    ds_read_b128 v[76:79], v170 offset:15360
    s_waitcnt lgkmcnt(7)
    buffer_store_dwordx4 v[48:51], v2, s[16:19], s31 offen offset:0 sc1
    s_waitcnt lgkmcnt(6)
    buffer_store_dwordx4 v[52:55], v2, s[16:19], s31 offen offset:1024 sc1
    s_add_u32 s31, s31, s32
    s_waitcnt lgkmcnt(5)
    buffer_store_dwordx4 v[56:59], v2, s[16:19], s31 offen offset:0 sc1
    s_waitcnt lgkmcnt(4)
    buffer_store_dwordx4 v[60:63], v2, s[16:19], s31 offen offset:1024 sc1
    s_add_u32 s31, s31, s32
    s_waitcnt lgkmcnt(3)
    buffer_store_dwordx4 v[64:67], v2, s[16:19], s31 offen offset:0 sc1
    s_waitcnt lgkmcnt(2)
    buffer_store_dwordx4 v[68:71], v2, s[16:19], s31 offen offset:1024 sc1
    s_add_u32 s31, s31, s32
    s_waitcnt lgkmcnt(1)
    buffer_store_dwordx4 v[72:75], v2, s[16:19], s31 offen offset:0 sc1
    s_waitcnt lgkmcnt(0)
    buffer_store_dwordx4 v[76:79], v2, s[16:19], s31 offen offset:1024 sc1
    s_add_u32 s31, s31, s32
k1_exit:
    s_endpgm
.globl k2_kernel
.p2align 8
.type k2_kernel,@function
k2_kernel:
    s_load_dwordx8 s[64:71], s[0:1], 0
    s_load_dwordx8 s[72:79], s[0:1], 32
    s_load_dwordx8 s[80:87], s[0:1], 64
    v_and_b32 v1, 63, v0
    v_lshrrev_b32 v2, 6, v0
    s_nop 0
    v_readfirstlane_b32 s27, v2
    s_cmp_ge_u32 s2, 512
    s_cbranch_scc1 k2_exit
    s_waitcnt lgkmcnt(0)
    s_or_b32 s28, s2, s27
    s_cmp_lg_u32 s28, 0
    s_cbranch_scc1 k2_nw_1
    s_memrealtime s[28:29]
    s_mov_b32 s96, s84
    s_mov_b32 s97, s85
    s_mov_b32 s98, 0x100
    s_mov_b32 s99, 0x00020000
    s_waitcnt lgkmcnt(0)
    s_or_b32 s28, s28, 1
    v_mov_b32 v2, s28
    v_mov_b32 v3, 0
    s_mov_b64 exec, 1
    buffer_store_dword v2, v3, s[96:99], 0 offen sc1
    s_mov_b64 exec, -1
k2_nw_1:
    s_cmp_lt_u32 s2, 256
    s_cbranch_scc1 k2_attn
    s_setprio 3
    s_and_b32 s3, s2, 255
    s_and_b32 s4, s3, 7
    s_lshl_b32 s4, s4, 2
    s_bfe_u32 s5, s3, 0x20003
    s_add_u32 s4, s4, s5
    s_lshr_b32 s3, s3, 5
    s_lshl_b32 s3, s3, 4
    s_mov_b32 s8, s86
    s_mov_b32 s9, s87
    s_mov_b32 s10, 0x240000
    s_mov_b32 s11, 0x00020000
    s_mov_b32 s12, s72
    s_mov_b32 s13, s73
    s_mov_b32 s14, 0x510000
    s_mov_b32 s15, 0x00020000
    s_add_u32 s16, s86, 0x1000000
    s_addc_u32 s17, s87, 0
    s_mov_b32 s18, 0x1200000
    s_mov_b32 s19, 0x00020000
    s_mov_b32 s20, s74
    s_mov_b32 s21, s75
    s_mov_b32 s22, 0x2400
    s_mov_b32 s23, 0x00020000
    s_mul_i32 s25, s4, 288
    s_mov_b32 s26, 0
    v_lshrrev_b32 v2, 4, v1
    v_lshlrev_b32 v2, 3, v2
    buffer_load_dwordx2 v[234:235], v2, s[20:23], s25 offen offset:0
    buffer_load_dwordx2 v[236:237], v2, s[20:23], s25 offen offset:32
    buffer_load_dwordx2 v[238:239], v2, s[20:23], s25 offen offset:64
    buffer_load_dwordx2 v[240:241], v2, s[20:23], s25 offen offset:96
    buffer_load_dwordx2 v[242:243], v2, s[20:23], s25 offen offset:128
    buffer_load_dwordx2 v[244:245], v2, s[20:23], s25 offen offset:160
    buffer_load_dwordx2 v[246:247], v2, s[20:23], s25 offen offset:192
    buffer_load_dwordx2 v[248:249], v2, s[20:23], s25 offen offset:224
    buffer_load_dwordx2 v[250:251], v2, s[20:23], s25 offen offset:256
    s_mul_i32 s28, s27, 4
    s_add_u32 s28, s28, s3
    s_mul_i32 s28, s28, 18432
    v_lshlrev_b32 v2, 4, v1
    v_add_u32 v2, s28, v2
    v_add_u32 v224, 0, v2
    v_add_u32 v225, 18432, v2
    v_add_u32 v226, 36864, v2
    v_add_u32 v227, 55296, v2
    s_mul_i32 s24, s27, 5120
    s_mul_i32 s28, s27, 320
    s_add_u32 s29, s28, 0
    v_add_u32 v2, s29, v1
    v_mul_u32_u24 v3, 3641, v2
    v_lshrrev_b32 v3, 16, v3
    v_mul_u32_u24 v4, 18, v3
    v_sub_u32 v4, v2, v4
    v_and_b32 v5, 0x33, v3
    v_and_b32 v6, 4, v3
    v_lshlrev_b32 v6, 1, v6
    v_and_b32 v7, 8, v3
    v_lshrrev_b32 v7, 1, v7
    v_or3_b32 v3, v5, v6, v7
    v_lshlrev_b32 v4, 4, v4
    v_mul_u32_u24 v3, 9216, v3
    v_add_u32 v3, v3, v4
    v_mov_b32 v228, v3
    s_add_u32 s29, s28, 64
    v_add_u32 v2, s29, v1
    v_mul_u32_u24 v3, 3641, v2
    v_lshrrev_b32 v3, 16, v3
    v_mul_u32_u24 v4, 18, v3
    v_sub_u32 v4, v2, v4
    v_and_b32 v5, 0x33, v3
    v_and_b32 v6, 4, v3
    v_lshlrev_b32 v6, 1, v6
    v_and_b32 v7, 8, v3
    v_lshrrev_b32 v7, 1, v7
    v_or3_b32 v3, v5, v6, v7
    v_lshlrev_b32 v4, 4, v4
    v_mul_u32_u24 v3, 9216, v3
    v_add_u32 v3, v3, v4
    v_subrev_u32 v229, 1024, v3
    s_add_u32 s29, s28, 128
    v_add_u32 v2, s29, v1
    v_mul_u32_u24 v3, 3641, v2
    v_lshrrev_b32 v3, 16, v3
    v_mul_u32_u24 v4, 18, v3
    v_sub_u32 v4, v2, v4
    v_and_b32 v5, 0x33, v3
    v_and_b32 v6, 4, v3
    v_lshlrev_b32 v6, 1, v6
    v_and_b32 v7, 8, v3
    v_lshrrev_b32 v7, 1, v7
    v_or3_b32 v3, v5, v6, v7
    v_lshlrev_b32 v4, 4, v4
    v_mul_u32_u24 v3, 9216, v3
    v_add_u32 v3, v3, v4
    v_subrev_u32 v230, 2048, v3
    s_add_u32 s29, s28, 192
    s_cmp_ge_u32 s29, 1152
    s_cselect_b32 s30, 128, 0
    s_sub_u32 s29, s29, s30
    v_add_u32 v2, s29, v1
    v_mul_u32_u24 v3, 3641, v2
    v_lshrrev_b32 v3, 16, v3
    v_mul_u32_u24 v4, 18, v3
    v_sub_u32 v4, v2, v4
    v_and_b32 v5, 0x33, v3
    v_and_b32 v6, 4, v3
    v_lshlrev_b32 v6, 1, v6
    v_and_b32 v7, 8, v3
    v_lshrrev_b32 v7, 1, v7
    v_or3_b32 v3, v5, v6, v7
    v_lshlrev_b32 v4, 4, v4
    v_mul_u32_u24 v3, 9216, v3
    v_add_u32 v3, v3, v4
    v_subrev_u32 v231, 3072, v3
    s_add_u32 s29, s28, 256
    s_cmp_ge_u32 s29, 1152
    s_cselect_b32 s30, 128, 0
    s_sub_u32 s29, s29, s30
    v_add_u32 v2, s29, v1
    v_mul_u32_u24 v3, 3641, v2
    v_lshrrev_b32 v3, 16, v3
    v_mul_u32_u24 v4, 18, v3
    v_sub_u32 v4, v2, v4
    v_and_b32 v5, 0x33, v3
    v_and_b32 v6, 4, v3
    v_lshlrev_b32 v6, 1, v6
    v_and_b32 v7, 8, v3
    v_lshrrev_b32 v7, 1, v7
    v_or3_b32 v3, v5, v6, v7
    v_lshlrev_b32 v4, 4, v4
    v_mul_u32_u24 v3, 9216, v3
    v_add_u32 v3, v3, v4
    v_mov_b32 v232, v3
    v_lshrrev_b32 v2, 4, v1
    v_and_b32 v3, 15, v1
    v_lshrrev_b32 v4, 2, v3
    v_lshrrev_b32 v5, 1, v2
    v_lshlrev_b32 v5, 4, v5
    v_and_b32 v6, 1, v2
    v_lshlrev_b32 v6, 2, v6
    v_add3_u32 v4, v4, v5, v6
    v_mul_u32_u24 v4, 288, v4
    v_and_b32 v3, 3, v3
    v_lshlrev_b32 v3, 3, v3
    v_add_u32 v233, v4, v3
    s_add_u32 m0, s24, 0
    s_nop 0
    buffer_load_dwordx4 v228, s[12:15], s25 offen offset:0 lds
    s_add_u32 m0, s24, 0
    s_nop 0
    buffer_load_dwordx4 v229, s[12:15], s25 offen offset:1024 lds
    s_add_u32 m0, s24, 0
    s_nop 0
    buffer_load_dwordx4 v230, s[12:15], s25 offen offset:2048 lds
    s_add_u32 m0, s24, 0
    s_nop 0
    buffer_load_dwordx4 v231, s[12:15], s25 offen offset:3072 lds
    s_add_u32 m0, s24, 4096
    s_nop 0
    buffer_load_dwordx4 v232, s[12:15], s25 offen offset:0 lds
    s_add_u32 s25, s25, 589824
    buffer_load_dwordx4 v[160:163], v224, s[8:11], s26 offen
    buffer_load_dwordx4 v[164:167], v225, s[8:11], s26 offen
    buffer_load_dwordx4 v[168:171], v226, s[8:11], s26 offen
    buffer_load_dwordx4 v[172:175], v227, s[8:11], s26 offen
    s_add_u32 s26, s26, 1024
    s_add_u32 m0, s24, 20480
    s_nop 0
    buffer_load_dwordx4 v228, s[12:15], s25 offen offset:0 lds
    s_add_u32 m0, s24, 20480
    s_nop 0
    buffer_load_dwordx4 v229, s[12:15], s25 offen offset:1024 lds
    s_add_u32 m0, s24, 20480
    s_nop 0
    buffer_load_dwordx4 v230, s[12:15], s25 offen offset:2048 lds
    s_add_u32 m0, s24, 20480
    s_nop 0
    buffer_load_dwordx4 v231, s[12:15], s25 offen offset:3072 lds
    s_add_u32 m0, s24, 24576
    s_nop 0
    buffer_load_dwordx4 v232, s[12:15], s25 offen offset:0 lds
    s_add_u32 s25, s25, 589824
    buffer_load_dwordx4 v[176:179], v224, s[8:11], s26 offen
    buffer_load_dwordx4 v[180:183], v225, s[8:11], s26 offen
    buffer_load_dwordx4 v[184:187], v226, s[8:11], s26 offen
    buffer_load_dwordx4 v[188:191], v227, s[8:11], s26 offen
    s_add_u32 s26, s26, 1024
    s_add_u32 m0, s24, 40960
    s_nop 0
    buffer_load_dwordx4 v228, s[12:15], s25 offen offset:0 lds
    s_add_u32 m0, s24, 40960
    s_nop 0
    buffer_load_dwordx4 v229, s[12:15], s25 offen offset:1024 lds
    s_add_u32 m0, s24, 40960
    s_nop 0
    buffer_load_dwordx4 v230, s[12:15], s25 offen offset:2048 lds
    s_add_u32 m0, s24, 40960
    s_nop 0
    buffer_load_dwordx4 v231, s[12:15], s25 offen offset:3072 lds
    s_add_u32 m0, s24, 45056
    s_nop 0
    buffer_load_dwordx4 v232, s[12:15], s25 offen offset:0 lds
    s_add_u32 s25, s25, 589824
    v_mov_b32 v16, 0
    v_mov_b32 v17, 0
    v_mov_b32 v18, 0
    v_mov_b32 v19, 0
    v_mov_b32 v20, 0
    v_mov_b32 v21, 0
    v_mov_b32 v22, 0
    v_mov_b32 v23, 0
    v_mov_b32 v24, 0
    v_mov_b32 v25, 0
    v_mov_b32 v26, 0
    v_mov_b32 v27, 0
    v_mov_b32 v28, 0
    v_mov_b32 v29, 0
    v_mov_b32 v30, 0
    v_mov_b32 v31, 0
    v_mov_b32 v32, 0
    v_mov_b32 v33, 0
    v_mov_b32 v34, 0
    v_mov_b32 v35, 0
    v_mov_b32 v36, 0
    v_mov_b32 v37, 0
    v_mov_b32 v38, 0
    v_mov_b32 v39, 0
    v_mov_b32 v40, 0
    v_mov_b32 v41, 0
    v_mov_b32 v42, 0
    v_mov_b32 v43, 0
    v_mov_b32 v44, 0
    v_mov_b32 v45, 0
    v_mov_b32 v46, 0
    v_mov_b32 v47, 0
    v_mov_b32 v48, 0
    v_mov_b32 v49, 0
    v_mov_b32 v50, 0
    v_mov_b32 v51, 0
    v_mov_b32 v52, 0
    v_mov_b32 v53, 0
    v_mov_b32 v54, 0
    v_mov_b32 v55, 0
    v_mov_b32 v56, 0
    v_mov_b32 v57, 0
    v_mov_b32 v58, 0
    v_mov_b32 v59, 0
    v_mov_b32 v60, 0
    v_mov_b32 v61, 0
    v_mov_b32 v62, 0
    v_mov_b32 v63, 0
    v_mov_b32 v64, 0
    v_mov_b32 v65, 0
    v_mov_b32 v66, 0
    v_mov_b32 v67, 0
    v_mov_b32 v68, 0
    v_mov_b32 v69, 0
    v_mov_b32 v70, 0
    v_mov_b32 v71, 0
    v_mov_b32 v72, 0
    v_mov_b32 v73, 0
    v_mov_b32 v74, 0
    v_mov_b32 v75, 0
    v_mov_b32 v76, 0
    v_mov_b32 v77, 0
    v_mov_b32 v78, 0
    v_mov_b32 v79, 0
    v_mov_b32 v80, 0
    v_mov_b32 v81, 0
    v_mov_b32 v82, 0
    v_mov_b32 v83, 0
    v_mov_b32 v84, 0
    v_mov_b32 v85, 0
    v_mov_b32 v86, 0
    v_mov_b32 v87, 0
    v_mov_b32 v88, 0
    v_mov_b32 v89, 0
    v_mov_b32 v90, 0
    v_mov_b32 v91, 0
    v_mov_b32 v92, 0
    v_mov_b32 v93, 0
    v_mov_b32 v94, 0
    v_mov_b32 v95, 0
    v_mov_b32 v96, 0
    v_mov_b32 v97, 0
    v_mov_b32 v98, 0
    v_mov_b32 v99, 0
    v_mov_b32 v100, 0
    v_mov_b32 v101, 0
    v_mov_b32 v102, 0
    v_mov_b32 v103, 0
    v_mov_b32 v104, 0
    v_mov_b32 v105, 0
    v_mov_b32 v106, 0
    v_mov_b32 v107, 0
    v_mov_b32 v108, 0
    v_mov_b32 v109, 0
    v_mov_b32 v110, 0
    v_mov_b32 v111, 0
    v_mov_b32 v112, 0
    v_mov_b32 v113, 0
    v_mov_b32 v114, 0
    v_mov_b32 v115, 0
    v_mov_b32 v116, 0
    v_mov_b32 v117, 0
    v_mov_b32 v118, 0
    v_mov_b32 v119, 0
    v_mov_b32 v120, 0
    v_mov_b32 v121, 0
    v_mov_b32 v122, 0
    v_mov_b32 v123, 0
    v_mov_b32 v124, 0
    v_mov_b32 v125, 0
    v_mov_b32 v126, 0
    v_mov_b32 v127, 0
    v_mov_b32 v128, 0
    v_mov_b32 v129, 0
    v_mov_b32 v130, 0
    v_mov_b32 v131, 0
    v_mov_b32 v132, 0
    v_mov_b32 v133, 0
    v_mov_b32 v134, 0
    v_mov_b32 v135, 0
    v_mov_b32 v136, 0
    v_mov_b32 v137, 0
    v_mov_b32 v138, 0
    v_mov_b32 v139, 0
    v_mov_b32 v140, 0
    v_mov_b32 v141, 0
    v_mov_b32 v142, 0
    v_mov_b32 v143, 0
    v_mov_b32 v144, 0
    v_mov_b32 v145, 0
    v_mov_b32 v146, 0
    v_mov_b32 v147, 0
    v_mov_b32 v148, 0
    v_mov_b32 v149, 0
    v_mov_b32 v150, 0
    v_mov_b32 v151, 0
    v_mov_b32 v152, 0
    v_mov_b32 v153, 0
    v_mov_b32 v154, 0
    v_mov_b32 v155, 0
    v_mov_b32 v156, 0
    v_mov_b32 v157, 0
    v_mov_b32 v158, 0
    v_mov_b32 v159, 0
    s_waitcnt vmcnt(18)
    s_barrier
    ds_read_b64_tr_b16 v[208:209], v233 offset:0
    ds_read_b64_tr_b16 v[210:211], v233 offset:2304
    ds_read_b64_tr_b16 v[212:213], v233 offset:32
    ds_read_b64_tr_b16 v[214:215], v233 offset:2336
    ds_read_b64_tr_b16 v[216:217], v233 offset:64
    ds_read_b64_tr_b16 v[218:219], v233 offset:2368
    ds_read_b64_tr_b16 v[220:221], v233 offset:96
    ds_read_b64_tr_b16 v[222:223], v233 offset:2400
    buffer_load_dwordx4 v[192:195], v224, s[8:11], s26 offen
    s_waitcnt vmcnt(15) lgkmcnt(6)
    v_mfma_f32_16x16x32_bf16 v[16:19], v[208:211], v[160:163], v[16:19]
    v_mfma_f32_16x16x32_bf16 v[52:55], v[208:211], v[164:167], v[52:55]
    v_mfma_f32_16x16x32_bf16 v[88:91], v[208:211], v[168:171], v[88:91]
    v_mfma_f32_16x16x32_bf16 v[124:127], v[208:211], v[172:175], v[124:127]
    ds_read_b64_tr_b16 v[208:209], v233 offset:128
    ds_read_b64_tr_b16 v[210:211], v233 offset:2432
    buffer_load_dwordx4 v[196:199], v225, s[8:11], s26 offen
    s_waitcnt lgkmcnt(6)
    v_mfma_f32_16x16x32_bf16 v[20:23], v[212:215], v[160:163], v[20:23]
    v_mfma_f32_16x16x32_bf16 v[56:59], v[212:215], v[164:167], v[56:59]
    v_mfma_f32_16x16x32_bf16 v[92:95], v[212:215], v[168:171], v[92:95]
    v_mfma_f32_16x16x32_bf16 v[128:131], v[212:215], v[172:175], v[128:131]
    ds_read_b64_tr_b16 v[212:213], v233 offset:160
    ds_read_b64_tr_b16 v[214:215], v233 offset:2464
    buffer_load_dwordx4 v[200:203], v226, s[8:11], s26 offen
    s_waitcnt lgkmcnt(6)
    v_mfma_f32_16x16x32_bf16 v[24:27], v[216:219], v[160:163], v[24:27]
    v_mfma_f32_16x16x32_bf16 v[60:63], v[216:219], v[164:167], v[60:63]
    v_mfma_f32_16x16x32_bf16 v[96:99], v[216:219], v[168:171], v[96:99]
    v_mfma_f32_16x16x32_bf16 v[132:135], v[216:219], v[172:175], v[132:135]
    ds_read_b64_tr_b16 v[216:217], v233 offset:192
    ds_read_b64_tr_b16 v[218:219], v233 offset:2496
    buffer_load_dwordx4 v[204:207], v227, s[8:11], s26 offen
    s_add_u32 s26, s26, 1024
    s_waitcnt lgkmcnt(6)
    v_mfma_f32_16x16x32_bf16 v[28:31], v[220:223], v[160:163], v[28:31]
    v_mfma_f32_16x16x32_bf16 v[64:67], v[220:223], v[164:167], v[64:67]
    v_mfma_f32_16x16x32_bf16 v[100:103], v[220:223], v[168:171], v[100:103]
    v_mfma_f32_16x16x32_bf16 v[136:139], v[220:223], v[172:175], v[136:139]
    ds_read_b64_tr_b16 v[220:221], v233 offset:224
    ds_read_b64_tr_b16 v[222:223], v233 offset:2528
    s_waitcnt lgkmcnt(6)
    v_mfma_f32_16x16x32_bf16 v[32:35], v[208:211], v[160:163], v[32:35]
    v_mfma_f32_16x16x32_bf16 v[68:71], v[208:211], v[164:167], v[68:71]
    v_mfma_f32_16x16x32_bf16 v[104:107], v[208:211], v[168:171], v[104:107]
    v_mfma_f32_16x16x32_bf16 v[140:143], v[208:211], v[172:175], v[140:143]
    ds_read_b64_tr_b16 v[208:209], v233 offset:256
    ds_read_b64_tr_b16 v[210:211], v233 offset:2560
    s_waitcnt lgkmcnt(6)
    v_mfma_f32_16x16x32_bf16 v[36:39], v[212:215], v[160:163], v[36:39]
    v_mfma_f32_16x16x32_bf16 v[72:75], v[212:215], v[164:167], v[72:75]
    v_mfma_f32_16x16x32_bf16 v[108:111], v[212:215], v[168:171], v[108:111]
    v_mfma_f32_16x16x32_bf16 v[144:147], v[212:215], v[172:175], v[144:147]
    ds_read_b64_tr_b16 v[212:213], v233 offset:9216
    ds_read_b64_tr_b16 v[214:215], v233 offset:11520
    s_waitcnt lgkmcnt(6)
    v_mfma_f32_16x16x32_bf16 v[40:43], v[216:219], v[160:163], v[40:43]
    v_mfma_f32_16x16x32_bf16 v[76:79], v[216:219], v[164:167], v[76:79]
    v_mfma_f32_16x16x32_bf16 v[112:115], v[216:219], v[168:171], v[112:115]
    v_mfma_f32_16x16x32_bf16 v[148:151], v[216:219], v[172:175], v[148:151]
    ds_read_b64_tr_b16 v[216:217], v233 offset:9248
    ds_read_b64_tr_b16 v[218:219], v233 offset:11552
    s_waitcnt lgkmcnt(6)
    v_mfma_f32_16x16x32_bf16 v[44:47], v[220:223], v[160:163], v[44:47]
    v_mfma_f32_16x16x32_bf16 v[80:83], v[220:223], v[164:167], v[80:83]
    v_mfma_f32_16x16x32_bf16 v[116:119], v[220:223], v[168:171], v[116:119]
    v_mfma_f32_16x16x32_bf16 v[152:155], v[220:223], v[172:175], v[152:155]
    ds_read_b64_tr_b16 v[220:221], v233 offset:9280
    ds_read_b64_tr_b16 v[222:223], v233 offset:11584
    s_waitcnt lgkmcnt(6)
    v_mfma_f32_16x16x32_bf16 v[48:51], v[208:211], v[160:163], v[48:51]
    v_mfma_f32_16x16x32_bf16 v[84:87], v[208:211], v[164:167], v[84:87]
    v_mfma_f32_16x16x32_bf16 v[120:123], v[208:211], v[168:171], v[120:123]
    v_mfma_f32_16x16x32_bf16 v[156:159], v[208:211], v[172:175], v[156:159]
    ds_read_b64_tr_b16 v[208:209], v233 offset:9312
    ds_read_b64_tr_b16 v[210:211], v233 offset:11616
    buffer_load_dwordx4 v[160:163], v224, s[8:11], s26 offen
    s_waitcnt vmcnt(10) lgkmcnt(6)
    v_mfma_f32_16x16x32_bf16 v[16:19], v[212:215], v[176:179], v[16:19]
    v_mfma_f32_16x16x32_bf16 v[52:55], v[212:215], v[180:183], v[52:55]
    v_mfma_f32_16x16x32_bf16 v[88:91], v[212:215], v[184:187], v[88:91]
    v_mfma_f32_16x16x32_bf16 v[124:127], v[212:215], v[188:191], v[124:127]
    ds_read_b64_tr_b16 v[212:213], v233 offset:9344
    ds_read_b64_tr_b16 v[214:215], v233 offset:11648
    buffer_load_dwordx4 v[164:167], v225, s[8:11], s26 offen
    s_waitcnt lgkmcnt(6)
    v_mfma_f32_16x16x32_bf16 v[20:23], v[216:219], v[176:179], v[20:23]
    v_mfma_f32_16x16x32_bf16 v[56:59], v[216:219], v[180:183], v[56:59]
    v_mfma_f32_16x16x32_bf16 v[92:95], v[216:219], v[184:187], v[92:95]
    v_mfma_f32_16x16x32_bf16 v[128:131], v[216:219], v[188:191], v[128:131]
    ds_read_b64_tr_b16 v[216:217], v233 offset:9376
    ds_read_b64_tr_b16 v[218:219], v233 offset:11680
    buffer_load_dwordx4 v[168:171], v226, s[8:11], s26 offen
    s_waitcnt lgkmcnt(6)
    v_mfma_f32_16x16x32_bf16 v[24:27], v[220:223], v[176:179], v[24:27]
    v_mfma_f32_16x16x32_bf16 v[60:63], v[220:223], v[180:183], v[60:63]
    v_mfma_f32_16x16x32_bf16 v[96:99], v[220:223], v[184:187], v[96:99]
    v_mfma_f32_16x16x32_bf16 v[132:135], v[220:223], v[188:191], v[132:135]
    ds_read_b64_tr_b16 v[220:221], v233 offset:9408
    ds_read_b64_tr_b16 v[222:223], v233 offset:11712
    buffer_load_dwordx4 v[172:175], v227, s[8:11], s26 offen
    s_add_u32 s26, s26, 1024
    s_waitcnt lgkmcnt(6)
    v_mfma_f32_16x16x32_bf16 v[28:31], v[208:211], v[176:179], v[28:31]
    v_mfma_f32_16x16x32_bf16 v[64:67], v[208:211], v[180:183], v[64:67]
    v_mfma_f32_16x16x32_bf16 v[100:103], v[208:211], v[184:187], v[100:103]
    v_mfma_f32_16x16x32_bf16 v[136:139], v[208:211], v[188:191], v[136:139]
    ds_read_b64_tr_b16 v[208:209], v233 offset:9440
    ds_read_b64_tr_b16 v[210:211], v233 offset:11744
    s_waitcnt lgkmcnt(6)
    v_mfma_f32_16x16x32_bf16 v[32:35], v[212:215], v[176:179], v[32:35]
    v_mfma_f32_16x16x32_bf16 v[68:71], v[212:215], v[180:183], v[68:71]
    v_mfma_f32_16x16x32_bf16 v[104:107], v[212:215], v[184:187], v[104:107]
    v_mfma_f32_16x16x32_bf16 v[140:143], v[212:215], v[188:191], v[140:143]
    ds_read_b64_tr_b16 v[212:213], v233 offset:9472
    ds_read_b64_tr_b16 v[214:215], v233 offset:11776
    s_waitcnt lgkmcnt(6)
    v_mfma_f32_16x16x32_bf16 v[36:39], v[216:219], v[176:179], v[36:39]
    v_mfma_f32_16x16x32_bf16 v[72:75], v[216:219], v[180:183], v[72:75]
    v_mfma_f32_16x16x32_bf16 v[108:111], v[216:219], v[184:187], v[108:111]
    v_mfma_f32_16x16x32_bf16 v[144:147], v[216:219], v[188:191], v[144:147]
    s_waitcnt lgkmcnt(0)
    s_barrier
    ds_read_b64_tr_b16 v[216:217], v233 offset:20480
    ds_read_b64_tr_b16 v[218:219], v233 offset:22784
    s_add_u32 m0, s24, 0
    s_nop 0
    buffer_load_dwordx4 v228, s[12:15], s25 offen offset:0 lds
    v_mfma_f32_16x16x32_bf16 v[40:43], v[220:223], v[176:179], v[40:43]
    v_mfma_f32_16x16x32_bf16 v[76:79], v[220:223], v[180:183], v[76:79]
    v_mfma_f32_16x16x32_bf16 v[112:115], v[220:223], v[184:187], v[112:115]
    v_mfma_f32_16x16x32_bf16 v[148:151], v[220:223], v[188:191], v[148:151]
    ds_read_b64_tr_b16 v[220:221], v233 offset:20512
    ds_read_b64_tr_b16 v[222:223], v233 offset:22816
    s_add_u32 m0, s24, 0
    s_nop 0
    buffer_load_dwordx4 v229, s[12:15], s25 offen offset:1024 lds
    v_mfma_f32_16x16x32_bf16 v[44:47], v[208:211], v[176:179], v[44:47]
    v_mfma_f32_16x16x32_bf16 v[80:83], v[208:211], v[180:183], v[80:83]
    v_mfma_f32_16x16x32_bf16 v[116:119], v[208:211], v[184:187], v[116:119]
    v_mfma_f32_16x16x32_bf16 v[152:155], v[208:211], v[188:191], v[152:155]
    ds_read_b64_tr_b16 v[208:209], v233 offset:20544
    ds_read_b64_tr_b16 v[210:211], v233 offset:22848
    s_add_u32 m0, s24, 0
    s_nop 0
    buffer_load_dwordx4 v230, s[12:15], s25 offen offset:2048 lds
    v_mfma_f32_16x16x32_bf16 v[48:51], v[212:215], v[176:179], v[48:51]
    v_mfma_f32_16x16x32_bf16 v[84:87], v[212:215], v[180:183], v[84:87]
    v_mfma_f32_16x16x32_bf16 v[120:123], v[212:215], v[184:187], v[120:123]
    v_mfma_f32_16x16x32_bf16 v[156:159], v[212:215], v[188:191], v[156:159]
    ds_read_b64_tr_b16 v[212:213], v233 offset:20576
    ds_read_b64_tr_b16 v[214:215], v233 offset:22880
    buffer_load_dwordx4 v[176:179], v224, s[8:11], s26 offen
    s_waitcnt vmcnt(8) lgkmcnt(6)
    v_mfma_f32_16x16x32_bf16 v[16:19], v[216:219], v[192:195], v[16:19]
    v_mfma_f32_16x16x32_bf16 v[52:55], v[216:219], v[196:199], v[52:55]
    v_mfma_f32_16x16x32_bf16 v[88:91], v[216:219], v[200:203], v[88:91]
    v_mfma_f32_16x16x32_bf16 v[124:127], v[216:219], v[204:207], v[124:127]
    ds_read_b64_tr_b16 v[216:217], v233 offset:20608
    ds_read_b64_tr_b16 v[218:219], v233 offset:22912
    buffer_load_dwordx4 v[180:183], v225, s[8:11], s26 offen
    s_waitcnt lgkmcnt(6)
    v_mfma_f32_16x16x32_bf16 v[20:23], v[220:223], v[192:195], v[20:23]
    v_mfma_f32_16x16x32_bf16 v[56:59], v[220:223], v[196:199], v[56:59]
    v_mfma_f32_16x16x32_bf16 v[92:95], v[220:223], v[200:203], v[92:95]
    v_mfma_f32_16x16x32_bf16 v[128:131], v[220:223], v[204:207], v[128:131]
    ds_read_b64_tr_b16 v[220:221], v233 offset:20640
    ds_read_b64_tr_b16 v[222:223], v233 offset:22944
    buffer_load_dwordx4 v[184:187], v226, s[8:11], s26 offen
    s_waitcnt lgkmcnt(6)
    v_mfma_f32_16x16x32_bf16 v[24:27], v[208:211], v[192:195], v[24:27]
    v_mfma_f32_16x16x32_bf16 v[60:63], v[208:211], v[196:199], v[60:63]
    v_mfma_f32_16x16x32_bf16 v[96:99], v[208:211], v[200:203], v[96:99]
    v_mfma_f32_16x16x32_bf16 v[132:135], v[208:211], v[204:207], v[132:135]
    ds_read_b64_tr_b16 v[208:209], v233 offset:20672
    ds_read_b64_tr_b16 v[210:211], v233 offset:22976
    buffer_load_dwordx4 v[188:191], v227, s[8:11], s26 offen
    s_add_u32 s26, s26, 1024
    s_waitcnt lgkmcnt(6)
    v_mfma_f32_16x16x32_bf16 v[28:31], v[212:215], v[192:195], v[28:31]
    v_mfma_f32_16x16x32_bf16 v[64:67], v[212:215], v[196:199], v[64:67]
    v_mfma_f32_16x16x32_bf16 v[100:103], v[212:215], v[200:203], v[100:103]
    v_mfma_f32_16x16x32_bf16 v[136:139], v[212:215], v[204:207], v[136:139]
    ds_read_b64_tr_b16 v[212:213], v233 offset:20704
    ds_read_b64_tr_b16 v[214:215], v233 offset:23008
    s_add_u32 m0, s24, 0
    s_nop 0
    buffer_load_dwordx4 v231, s[12:15], s25 offen offset:3072 lds
    s_waitcnt lgkmcnt(6)
    v_mfma_f32_16x16x32_bf16 v[32:35], v[216:219], v[192:195], v[32:35]
    v_mfma_f32_16x16x32_bf16 v[68:71], v[216:219], v[196:199], v[68:71]
    v_mfma_f32_16x16x32_bf16 v[104:107], v[216:219], v[200:203], v[104:107]
    v_mfma_f32_16x16x32_bf16 v[140:143], v[216:219], v[204:207], v[140:143]
    ds_read_b64_tr_b16 v[216:217], v233 offset:20736
    ds_read_b64_tr_b16 v[218:219], v233 offset:23040
    s_add_u32 m0, s24, 4096
    s_nop 0
    buffer_load_dwordx4 v232, s[12:15], s25 offen offset:0 lds
    s_add_u32 s25, s25, 589824
    s_waitcnt lgkmcnt(6)
    v_mfma_f32_16x16x32_bf16 v[36:39], v[220:223], v[192:195], v[36:39]
    v_mfma_f32_16x16x32_bf16 v[72:75], v[220:223], v[196:199], v[72:75]
    v_mfma_f32_16x16x32_bf16 v[108:111], v[220:223], v[200:203], v[108:111]
    v_mfma_f32_16x16x32_bf16 v[144:147], v[220:223], v[204:207], v[144:147]
    ds_read_b64_tr_b16 v[220:221], v233 offset:29696
    ds_read_b64_tr_b16 v[222:223], v233 offset:32000
    s_waitcnt lgkmcnt(6)
    v_mfma_f32_16x16x32_bf16 v[40:43], v[208:211], v[192:195], v[40:43]
    v_mfma_f32_16x16x32_bf16 v[76:79], v[208:211], v[196:199], v[76:79]
    v_mfma_f32_16x16x32_bf16 v[112:115], v[208:211], v[200:203], v[112:115]
    v_mfma_f32_16x16x32_bf16 v[148:151], v[208:211], v[204:207], v[148:151]
    ds_read_b64_tr_b16 v[208:209], v233 offset:29728
    ds_read_b64_tr_b16 v[210:211], v233 offset:32032
    s_waitcnt lgkmcnt(6)
    v_mfma_f32_16x16x32_bf16 v[44:47], v[212:215], v[192:195], v[44:47]
    v_mfma_f32_16x16x32_bf16 v[80:83], v[212:215], v[196:199], v[80:83]
    v_mfma_f32_16x16x32_bf16 v[116:119], v[212:215], v[200:203], v[116:119]
    v_mfma_f32_16x16x32_bf16 v[152:155], v[212:215], v[204:207], v[152:155]
    ds_read_b64_tr_b16 v[212:213], v233 offset:29760
    ds_read_b64_tr_b16 v[214:215], v233 offset:32064
    s_waitcnt lgkmcnt(6)
    v_mfma_f32_16x16x32_bf16 v[48:51], v[216:219], v[192:195], v[48:51]
    v_mfma_f32_16x16x32_bf16 v[84:87], v[216:219], v[196:199], v[84:87]
    v_mfma_f32_16x16x32_bf16 v[120:123], v[216:219], v[200:203], v[120:123]
    v_mfma_f32_16x16x32_bf16 v[156:159], v[216:219], v[204:207], v[156:159]
    ds_read_b64_tr_b16 v[216:217], v233 offset:29792
    ds_read_b64_tr_b16 v[218:219], v233 offset:32096
    buffer_load_dwordx4 v[192:195], v224, s[8:11], s26 offen
    s_waitcnt vmcnt(10) lgkmcnt(6)
    v_mfma_f32_16x16x32_bf16 v[16:19], v[220:223], v[160:163], v[16:19]
    v_mfma_f32_16x16x32_bf16 v[52:55], v[220:223], v[164:167], v[52:55]
    v_mfma_f32_16x16x32_bf16 v[88:91], v[220:223], v[168:171], v[88:91]
    v_mfma_f32_16x16x32_bf16 v[124:127], v[220:223], v[172:175], v[124:127]
    ds_read_b64_tr_b16 v[220:221], v233 offset:29824
    ds_read_b64_tr_b16 v[222:223], v233 offset:32128
    buffer_load_dwordx4 v[196:199], v225, s[8:11], s26 offen
    s_waitcnt lgkmcnt(6)
    v_mfma_f32_16x16x32_bf16 v[20:23], v[208:211], v[160:163], v[20:23]
    v_mfma_f32_16x16x32_bf16 v[56:59], v[208:211], v[164:167], v[56:59]
    v_mfma_f32_16x16x32_bf16 v[92:95], v[208:211], v[168:171], v[92:95]
    v_mfma_f32_16x16x32_bf16 v[128:131], v[208:211], v[172:175], v[128:131]
    ds_read_b64_tr_b16 v[208:209], v233 offset:29856
    ds_read_b64_tr_b16 v[210:211], v233 offset:32160
    buffer_load_dwordx4 v[200:203], v226, s[8:11], s26 offen
    s_waitcnt lgkmcnt(6)
    v_mfma_f32_16x16x32_bf16 v[24:27], v[212:215], v[160:163], v[24:27]
    v_mfma_f32_16x16x32_bf16 v[60:63], v[212:215], v[164:167], v[60:63]
    v_mfma_f32_16x16x32_bf16 v[96:99], v[212:215], v[168:171], v[96:99]
    v_mfma_f32_16x16x32_bf16 v[132:135], v[212:215], v[172:175], v[132:135]
    ds_read_b64_tr_b16 v[212:213], v233 offset:29888
    ds_read_b64_tr_b16 v[214:215], v233 offset:32192
    buffer_load_dwordx4 v[204:207], v227, s[8:11], s26 offen
    s_add_u32 s26, s26, 1024
    s_waitcnt lgkmcnt(6)
    v_mfma_f32_16x16x32_bf16 v[28:31], v[216:219], v[160:163], v[28:31]
    v_mfma_f32_16x16x32_bf16 v[64:67], v[216:219], v[164:167], v[64:67]
    v_mfma_f32_16x16x32_bf16 v[100:103], v[216:219], v[168:171], v[100:103]
    v_mfma_f32_16x16x32_bf16 v[136:139], v[216:219], v[172:175], v[136:139]
    ds_read_b64_tr_b16 v[216:217], v233 offset:29920
    ds_read_b64_tr_b16 v[218:219], v233 offset:32224
    s_waitcnt lgkmcnt(6)
    v_mfma_f32_16x16x32_bf16 v[32:35], v[220:223], v[160:163], v[32:35]
    v_mfma_f32_16x16x32_bf16 v[68:71], v[220:223], v[164:167], v[68:71]
    v_mfma_f32_16x16x32_bf16 v[104:107], v[220:223], v[168:171], v[104:107]
    v_mfma_f32_16x16x32_bf16 v[140:143], v[220:223], v[172:175], v[140:143]
    ds_read_b64_tr_b16 v[220:221], v233 offset:29952
    ds_read_b64_tr_b16 v[222:223], v233 offset:32256
    s_waitcnt lgkmcnt(6)
    v_mfma_f32_16x16x32_bf16 v[36:39], v[208:211], v[160:163], v[36:39]
    v_mfma_f32_16x16x32_bf16 v[72:75], v[208:211], v[164:167], v[72:75]
    v_mfma_f32_16x16x32_bf16 v[108:111], v[208:211], v[168:171], v[108:111]
    v_mfma_f32_16x16x32_bf16 v[144:147], v[208:211], v[172:175], v[144:147]
    s_waitcnt lgkmcnt(0)
    s_barrier
    ds_read_b64_tr_b16 v[208:209], v233 offset:40960
    ds_read_b64_tr_b16 v[210:211], v233 offset:43264
    s_add_u32 m0, s24, 20480
    s_nop 0
    buffer_load_dwordx4 v228, s[12:15], s25 offen offset:0 lds
    v_mfma_f32_16x16x32_bf16 v[40:43], v[212:215], v[160:163], v[40:43]
    v_mfma_f32_16x16x32_bf16 v[76:79], v[212:215], v[164:167], v[76:79]
    v_mfma_f32_16x16x32_bf16 v[112:115], v[212:215], v[168:171], v[112:115]
    v_mfma_f32_16x16x32_bf16 v[148:151], v[212:215], v[172:175], v[148:151]
    ds_read_b64_tr_b16 v[212:213], v233 offset:40992
    ds_read_b64_tr_b16 v[214:215], v233 offset:43296
    s_add_u32 m0, s24, 20480
    s_nop 0
    buffer_load_dwordx4 v229, s[12:15], s25 offen offset:1024 lds
    v_mfma_f32_16x16x32_bf16 v[44:47], v[216:219], v[160:163], v[44:47]
    v_mfma_f32_16x16x32_bf16 v[80:83], v[216:219], v[164:167], v[80:83]
    v_mfma_f32_16x16x32_bf16 v[116:119], v[216:219], v[168:171], v[116:119]
    v_mfma_f32_16x16x32_bf16 v[152:155], v[216:219], v[172:175], v[152:155]
    ds_read_b64_tr_b16 v[216:217], v233 offset:41024
    ds_read_b64_tr_b16 v[218:219], v233 offset:43328
    s_add_u32 m0, s24, 20480
    s_nop 0
    buffer_load_dwordx4 v230, s[12:15], s25 offen offset:2048 lds
    v_mfma_f32_16x16x32_bf16 v[48:51], v[220:223], v[160:163], v[48:51]
    v_mfma_f32_16x16x32_bf16 v[84:87], v[220:223], v[164:167], v[84:87]
    v_mfma_f32_16x16x32_bf16 v[120:123], v[220:223], v[168:171], v[120:123]
    v_mfma_f32_16x16x32_bf16 v[156:159], v[220:223], v[172:175], v[156:159]
    ds_read_b64_tr_b16 v[220:221], v233 offset:41056
    ds_read_b64_tr_b16 v[222:223], v233 offset:43360
    buffer_load_dwordx4 v[160:163], v224, s[8:11], s26 offen
    s_waitcnt vmcnt(10) lgkmcnt(6)
    v_mfma_f32_16x16x32_bf16 v[16:19], v[208:211], v[176:179], v[16:19]
    v_mfma_f32_16x16x32_bf16 v[52:55], v[208:211], v[180:183], v[52:55]
    v_mfma_f32_16x16x32_bf16 v[88:91], v[208:211], v[184:187], v[88:91]
    v_mfma_f32_16x16x32_bf16 v[124:127], v[208:211], v[188:191], v[124:127]
    ds_read_b64_tr_b16 v[208:209], v233 offset:41088
    ds_read_b64_tr_b16 v[210:211], v233 offset:43392
    buffer_load_dwordx4 v[164:167], v225, s[8:11], s26 offen
    s_waitcnt lgkmcnt(6)
    v_mfma_f32_16x16x32_bf16 v[20:23], v[212:215], v[176:179], v[20:23]
    v_mfma_f32_16x16x32_bf16 v[56:59], v[212:215], v[180:183], v[56:59]
    v_mfma_f32_16x16x32_bf16 v[92:95], v[212:215], v[184:187], v[92:95]
    v_mfma_f32_16x16x32_bf16 v[128:131], v[212:215], v[188:191], v[128:131]
    ds_read_b64_tr_b16 v[212:213], v233 offset:41120
    ds_read_b64_tr_b16 v[214:215], v233 offset:43424
    buffer_load_dwordx4 v[168:171], v226, s[8:11], s26 offen
    s_waitcnt lgkmcnt(6)
    v_mfma_f32_16x16x32_bf16 v[24:27], v[216:219], v[176:179], v[24:27]
    v_mfma_f32_16x16x32_bf16 v[60:63], v[216:219], v[180:183], v[60:63]
    v_mfma_f32_16x16x32_bf16 v[96:99], v[216:219], v[184:187], v[96:99]
    v_mfma_f32_16x16x32_bf16 v[132:135], v[216:219], v[188:191], v[132:135]
    ds_read_b64_tr_b16 v[216:217], v233 offset:41152
    ds_read_b64_tr_b16 v[218:219], v233 offset:43456
    buffer_load_dwordx4 v[172:175], v227, s[8:11], s26 offen
    s_add_u32 s26, s26, 1024
    s_waitcnt lgkmcnt(6)
    v_mfma_f32_16x16x32_bf16 v[28:31], v[220:223], v[176:179], v[28:31]
    v_mfma_f32_16x16x32_bf16 v[64:67], v[220:223], v[180:183], v[64:67]
    v_mfma_f32_16x16x32_bf16 v[100:103], v[220:223], v[184:187], v[100:103]
    v_mfma_f32_16x16x32_bf16 v[136:139], v[220:223], v[188:191], v[136:139]
    ds_read_b64_tr_b16 v[220:221], v233 offset:41184
    ds_read_b64_tr_b16 v[222:223], v233 offset:43488
    s_add_u32 m0, s24, 20480
    s_nop 0
    buffer_load_dwordx4 v231, s[12:15], s25 offen offset:3072 lds
    s_waitcnt lgkmcnt(6)
    v_mfma_f32_16x16x32_bf16 v[32:35], v[208:211], v[176:179], v[32:35]
    v_mfma_f32_16x16x32_bf16 v[68:71], v[208:211], v[180:183], v[68:71]
    v_mfma_f32_16x16x32_bf16 v[104:107], v[208:211], v[184:187], v[104:107]
    v_mfma_f32_16x16x32_bf16 v[140:143], v[208:211], v[188:191], v[140:143]
    ds_read_b64_tr_b16 v[208:209], v233 offset:41216
    ds_read_b64_tr_b16 v[210:211], v233 offset:43520
    s_add_u32 m0, s24, 24576
    s_nop 0
    buffer_load_dwordx4 v232, s[12:15], s25 offen offset:0 lds
    s_add_u32 s25, s25, 589824
    s_waitcnt lgkmcnt(6)
    v_mfma_f32_16x16x32_bf16 v[36:39], v[212:215], v[176:179], v[36:39]
    v_mfma_f32_16x16x32_bf16 v[72:75], v[212:215], v[180:183], v[72:75]
    v_mfma_f32_16x16x32_bf16 v[108:111], v[212:215], v[184:187], v[108:111]
    v_mfma_f32_16x16x32_bf16 v[144:147], v[212:215], v[188:191], v[144:147]
    ds_read_b64_tr_b16 v[212:213], v233 offset:50176
    ds_read_b64_tr_b16 v[214:215], v233 offset:52480
    s_waitcnt lgkmcnt(6)
    v_mfma_f32_16x16x32_bf16 v[40:43], v[216:219], v[176:179], v[40:43]
    v_mfma_f32_16x16x32_bf16 v[76:79], v[216:219], v[180:183], v[76:79]
    v_mfma_f32_16x16x32_bf16 v[112:115], v[216:219], v[184:187], v[112:115]
    v_mfma_f32_16x16x32_bf16 v[148:151], v[216:219], v[188:191], v[148:151]
    ds_read_b64_tr_b16 v[216:217], v233 offset:50208
    ds_read_b64_tr_b16 v[218:219], v233 offset:52512
    s_waitcnt lgkmcnt(6)
    v_mfma_f32_16x16x32_bf16 v[44:47], v[220:223], v[176:179], v[44:47]
    v_mfma_f32_16x16x32_bf16 v[80:83], v[220:223], v[180:183], v[80:83]
    v_mfma_f32_16x16x32_bf16 v[116:119], v[220:223], v[184:187], v[116:119]
    v_mfma_f32_16x16x32_bf16 v[152:155], v[220:223], v[188:191], v[152:155]
    ds_read_b64_tr_b16 v[220:221], v233 offset:50240
    ds_read_b64_tr_b16 v[222:223], v233 offset:52544
    s_waitcnt lgkmcnt(6)
    v_mfma_f32_16x16x32_bf16 v[48:51], v[208:211], v[176:179], v[48:51]
    v_mfma_f32_16x16x32_bf16 v[84:87], v[208:211], v[180:183], v[84:87]
    v_mfma_f32_16x16x32_bf16 v[120:123], v[208:211], v[184:187], v[120:123]
    v_mfma_f32_16x16x32_bf16 v[156:159], v[208:211], v[188:191], v[156:159]
    ds_read_b64_tr_b16 v[208:209], v233 offset:50272
    ds_read_b64_tr_b16 v[210:211], v233 offset:52576
    buffer_load_dwordx4 v[176:179], v224, s[8:11], s26 offen
    s_waitcnt vmcnt(10) lgkmcnt(6)
    v_mfma_f32_16x16x32_bf16 v[16:19], v[212:215], v[192:195], v[16:19]
    v_mfma_f32_16x16x32_bf16 v[52:55], v[212:215], v[196:199], v[52:55]
    v_mfma_f32_16x16x32_bf16 v[88:91], v[212:215], v[200:203], v[88:91]
    v_mfma_f32_16x16x32_bf16 v[124:127], v[212:215], v[204:207], v[124:127]
    ds_read_b64_tr_b16 v[212:213], v233 offset:50304
    ds_read_b64_tr_b16 v[214:215], v233 offset:52608
    buffer_load_dwordx4 v[180:183], v225, s[8:11], s26 offen
    s_waitcnt lgkmcnt(6)
    v_mfma_f32_16x16x32_bf16 v[20:23], v[216:219], v[192:195], v[20:23]
    v_mfma_f32_16x16x32_bf16 v[56:59], v[216:219], v[196:199], v[56:59]
    v_mfma_f32_16x16x32_bf16 v[92:95], v[216:219], v[200:203], v[92:95]
    v_mfma_f32_16x16x32_bf16 v[128:131], v[216:219], v[204:207], v[128:131]
    ds_read_b64_tr_b16 v[216:217], v233 offset:50336
    ds_read_b64_tr_b16 v[218:219], v233 offset:52640
    buffer_load_dwordx4 v[184:187], v226, s[8:11], s26 offen
    s_waitcnt lgkmcnt(6)
    v_mfma_f32_16x16x32_bf16 v[24:27], v[220:223], v[192:195], v[24:27]
    v_mfma_f32_16x16x32_bf16 v[60:63], v[220:223], v[196:199], v[60:63]
    v_mfma_f32_16x16x32_bf16 v[96:99], v[220:223], v[200:203], v[96:99]
    v_mfma_f32_16x16x32_bf16 v[132:135], v[220:223], v[204:207], v[132:135]
    ds_read_b64_tr_b16 v[220:221], v233 offset:50368
    ds_read_b64_tr_b16 v[222:223], v233 offset:52672
    buffer_load_dwordx4 v[188:191], v227, s[8:11], s26 offen
    s_add_u32 s26, s26, 1024
    s_waitcnt lgkmcnt(6)
    v_mfma_f32_16x16x32_bf16 v[28:31], v[208:211], v[192:195], v[28:31]
    v_mfma_f32_16x16x32_bf16 v[64:67], v[208:211], v[196:199], v[64:67]
    v_mfma_f32_16x16x32_bf16 v[100:103], v[208:211], v[200:203], v[100:103]
    v_mfma_f32_16x16x32_bf16 v[136:139], v[208:211], v[204:207], v[136:139]
    ds_read_b64_tr_b16 v[208:209], v233 offset:50400
    ds_read_b64_tr_b16 v[210:211], v233 offset:52704
    s_waitcnt lgkmcnt(6)
    v_mfma_f32_16x16x32_bf16 v[32:35], v[212:215], v[192:195], v[32:35]
    v_mfma_f32_16x16x32_bf16 v[68:71], v[212:215], v[196:199], v[68:71]
    v_mfma_f32_16x16x32_bf16 v[104:107], v[212:215], v[200:203], v[104:107]
    v_mfma_f32_16x16x32_bf16 v[140:143], v[212:215], v[204:207], v[140:143]
    ds_read_b64_tr_b16 v[212:213], v233 offset:50432
    ds_read_b64_tr_b16 v[214:215], v233 offset:52736
    s_waitcnt lgkmcnt(6)
    v_mfma_f32_16x16x32_bf16 v[36:39], v[216:219], v[192:195], v[36:39]
    v_mfma_f32_16x16x32_bf16 v[72:75], v[216:219], v[196:199], v[72:75]
    v_mfma_f32_16x16x32_bf16 v[108:111], v[216:219], v[200:203], v[108:111]
    v_mfma_f32_16x16x32_bf16 v[144:147], v[216:219], v[204:207], v[144:147]
    s_waitcnt lgkmcnt(0)
    s_barrier
    ds_read_b64_tr_b16 v[216:217], v233 offset:0
    ds_read_b64_tr_b16 v[218:219], v233 offset:2304
    s_add_u32 m0, s24, 40960
    s_nop 0
    buffer_load_dwordx4 v228, s[12:15], s25 offen offset:0 lds
    v_mfma_f32_16x16x32_bf16 v[40:43], v[220:223], v[192:195], v[40:43]
    v_mfma_f32_16x16x32_bf16 v[76:79], v[220:223], v[196:199], v[76:79]
    v_mfma_f32_16x16x32_bf16 v[112:115], v[220:223], v[200:203], v[112:115]
    v_mfma_f32_16x16x32_bf16 v[148:151], v[220:223], v[204:207], v[148:151]
    ds_read_b64_tr_b16 v[220:221], v233 offset:32
    ds_read_b64_tr_b16 v[222:223], v233 offset:2336
    s_add_u32 m0, s24, 40960
    s_nop 0
    buffer_load_dwordx4 v229, s[12:15], s25 offen offset:1024 lds
    v_mfma_f32_16x16x32_bf16 v[44:47], v[208:211], v[192:195], v[44:47]
    v_mfma_f32_16x16x32_bf16 v[80:83], v[208:211], v[196:199], v[80:83]
    v_mfma_f32_16x16x32_bf16 v[116:119], v[208:211], v[200:203], v[116:119]
    v_mfma_f32_16x16x32_bf16 v[152:155], v[208:211], v[204:207], v[152:155]
    ds_read_b64_tr_b16 v[208:209], v233 offset:64
    ds_read_b64_tr_b16 v[210:211], v233 offset:2368
    s_add_u32 m0, s24, 40960
    s_nop 0
    buffer_load_dwordx4 v230, s[12:15], s25 offen offset:2048 lds
    v_mfma_f32_16x16x32_bf16 v[48:51], v[212:215], v[192:195], v[48:51]
    v_mfma_f32_16x16x32_bf16 v[84:87], v[212:215], v[196:199], v[84:87]
    v_mfma_f32_16x16x32_bf16 v[120:123], v[212:215], v[200:203], v[120:123]
    v_mfma_f32_16x16x32_bf16 v[156:159], v[212:215], v[204:207], v[156:159]
    ds_read_b64_tr_b16 v[212:213], v233 offset:96
    ds_read_b64_tr_b16 v[214:215], v233 offset:2400
    buffer_load_dwordx4 v[192:195], v224, s[8:11], s26 offen
    s_waitcnt vmcnt(10) lgkmcnt(6)
    v_mfma_f32_16x16x32_bf16 v[16:19], v[216:219], v[160:163], v[16:19]
    v_mfma_f32_16x16x32_bf16 v[52:55], v[216:219], v[164:167], v[52:55]
    v_mfma_f32_16x16x32_bf16 v[88:91], v[216:219], v[168:171], v[88:91]
    v_mfma_f32_16x16x32_bf16 v[124:127], v[216:219], v[172:175], v[124:127]
    ds_read_b64_tr_b16 v[216:217], v233 offset:128
    ds_read_b64_tr_b16 v[218:219], v233 offset:2432
    buffer_load_dwordx4 v[196:199], v225, s[8:11], s26 offen
    s_waitcnt lgkmcnt(6)
    v_mfma_f32_16x16x32_bf16 v[20:23], v[220:223], v[160:163], v[20:23]
    v_mfma_f32_16x16x32_bf16 v[56:59], v[220:223], v[164:167], v[56:59]
    v_mfma_f32_16x16x32_bf16 v[92:95], v[220:223], v[168:171], v[92:95]
    v_mfma_f32_16x16x32_bf16 v[128:131], v[220:223], v[172:175], v[128:131]
    ds_read_b64_tr_b16 v[220:221], v233 offset:160
    ds_read_b64_tr_b16 v[222:223], v233 offset:2464
    buffer_load_dwordx4 v[200:203], v226, s[8:11], s26 offen
    s_waitcnt lgkmcnt(6)
    v_mfma_f32_16x16x32_bf16 v[24:27], v[208:211], v[160:163], v[24:27]
    v_mfma_f32_16x16x32_bf16 v[60:63], v[208:211], v[164:167], v[60:63]
    v_mfma_f32_16x16x32_bf16 v[96:99], v[208:211], v[168:171], v[96:99]
    v_mfma_f32_16x16x32_bf16 v[132:135], v[208:211], v[172:175], v[132:135]
    ds_read_b64_tr_b16 v[208:209], v233 offset:192
    ds_read_b64_tr_b16 v[210:211], v233 offset:2496
    buffer_load_dwordx4 v[204:207], v227, s[8:11], s26 offen
    s_add_u32 s26, s26, 1024
    s_waitcnt lgkmcnt(6)
    v_mfma_f32_16x16x32_bf16 v[28:31], v[212:215], v[160:163], v[28:31]
    v_mfma_f32_16x16x32_bf16 v[64:67], v[212:215], v[164:167], v[64:67]
    v_mfma_f32_16x16x32_bf16 v[100:103], v[212:215], v[168:171], v[100:103]
    v_mfma_f32_16x16x32_bf16 v[136:139], v[212:215], v[172:175], v[136:139]
    ds_read_b64_tr_b16 v[212:213], v233 offset:224
    ds_read_b64_tr_b16 v[214:215], v233 offset:2528
    s_add_u32 m0, s24, 40960
    s_nop 0
    buffer_load_dwordx4 v231, s[12:15], s25 offen offset:3072 lds
    s_waitcnt lgkmcnt(6)
    v_mfma_f32_16x16x32_bf16 v[32:35], v[216:219], v[160:163], v[32:35]
    v_mfma_f32_16x16x32_bf16 v[68:71], v[216:219], v[164:167], v[68:71]
    v_mfma_f32_16x16x32_bf16 v[104:107], v[216:219], v[168:171], v[104:107]
    v_mfma_f32_16x16x32_bf16 v[140:143], v[216:219], v[172:175], v[140:143]
    ds_read_b64_tr_b16 v[216:217], v233 offset:256
    ds_read_b64_tr_b16 v[218:219], v233 offset:2560
    s_add_u32 m0, s24, 45056
    s_nop 0
    buffer_load_dwordx4 v232, s[12:15], s25 offen offset:0 lds
    s_add_u32 s25, s25, 589824
    s_waitcnt lgkmcnt(6)
    v_mfma_f32_16x16x32_bf16 v[36:39], v[220:223], v[160:163], v[36:39]
    v_mfma_f32_16x16x32_bf16 v[72:75], v[220:223], v[164:167], v[72:75]
    v_mfma_f32_16x16x32_bf16 v[108:111], v[220:223], v[168:171], v[108:111]
    v_mfma_f32_16x16x32_bf16 v[144:147], v[220:223], v[172:175], v[144:147]
    ds_read_b64_tr_b16 v[220:221], v233 offset:9216
    ds_read_b64_tr_b16 v[222:223], v233 offset:11520
    s_waitcnt lgkmcnt(6)
    v_mfma_f32_16x16x32_bf16 v[40:43], v[208:211], v[160:163], v[40:43]
    v_mfma_f32_16x16x32_bf16 v[76:79], v[208:211], v[164:167], v[76:79]
    v_mfma_f32_16x16x32_bf16 v[112:115], v[208:211], v[168:171], v[112:115]
    v_mfma_f32_16x16x32_bf16 v[148:151], v[208:211], v[172:175], v[148:151]
    ds_read_b64_tr_b16 v[208:209], v233 offset:9248
    ds_read_b64_tr_b16 v[210:211], v233 offset:11552
    s_waitcnt lgkmcnt(6)
    v_mfma_f32_16x16x32_bf16 v[44:47], v[212:215], v[160:163], v[44:47]
    v_mfma_f32_16x16x32_bf16 v[80:83], v[212:215], v[164:167], v[80:83]
    v_mfma_f32_16x16x32_bf16 v[116:119], v[212:215], v[168:171], v[116:119]
    v_mfma_f32_16x16x32_bf16 v[152:155], v[212:215], v[172:175], v[152:155]
    ds_read_b64_tr_b16 v[212:213], v233 offset:9280
    ds_read_b64_tr_b16 v[214:215], v233 offset:11584
    s_waitcnt lgkmcnt(6)
    v_mfma_f32_16x16x32_bf16 v[48:51], v[216:219], v[160:163], v[48:51]
    v_mfma_f32_16x16x32_bf16 v[84:87], v[216:219], v[164:167], v[84:87]
    v_mfma_f32_16x16x32_bf16 v[120:123], v[216:219], v[168:171], v[120:123]
    v_mfma_f32_16x16x32_bf16 v[156:159], v[216:219], v[172:175], v[156:159]
    ds_read_b64_tr_b16 v[216:217], v233 offset:9312
    ds_read_b64_tr_b16 v[218:219], v233 offset:11616
    buffer_load_dwordx4 v[160:163], v224, s[8:11], s26 offen
    s_waitcnt vmcnt(10) lgkmcnt(6)
    v_mfma_f32_16x16x32_bf16 v[16:19], v[220:223], v[176:179], v[16:19]
    v_mfma_f32_16x16x32_bf16 v[52:55], v[220:223], v[180:183], v[52:55]
    v_mfma_f32_16x16x32_bf16 v[88:91], v[220:223], v[184:187], v[88:91]
    v_mfma_f32_16x16x32_bf16 v[124:127], v[220:223], v[188:191], v[124:127]
    ds_read_b64_tr_b16 v[220:221], v233 offset:9344
    ds_read_b64_tr_b16 v[222:223], v233 offset:11648
    buffer_load_dwordx4 v[164:167], v225, s[8:11], s26 offen
    s_waitcnt lgkmcnt(6)
    v_mfma_f32_16x16x32_bf16 v[20:23], v[208:211], v[176:179], v[20:23]
    v_mfma_f32_16x16x32_bf16 v[56:59], v[208:211], v[180:183], v[56:59]
    v_mfma_f32_16x16x32_bf16 v[92:95], v[208:211], v[184:187], v[92:95]
    v_mfma_f32_16x16x32_bf16 v[128:131], v[208:211], v[188:191], v[128:131]
    ds_read_b64_tr_b16 v[208:209], v233 offset:9376
    ds_read_b64_tr_b16 v[210:211], v233 offset:11680
    buffer_load_dwordx4 v[168:171], v226, s[8:11], s26 offen
    s_waitcnt lgkmcnt(6)
    v_mfma_f32_16x16x32_bf16 v[24:27], v[212:215], v[176:179], v[24:27]
    v_mfma_f32_16x16x32_bf16 v[60:63], v[212:215], v[180:183], v[60:63]
    v_mfma_f32_16x16x32_bf16 v[96:99], v[212:215], v[184:187], v[96:99]
    v_mfma_f32_16x16x32_bf16 v[132:135], v[212:215], v[188:191], v[132:135]
    ds_read_b64_tr_b16 v[212:213], v233 offset:9408
    ds_read_b64_tr_b16 v[214:215], v233 offset:11712
    buffer_load_dwordx4 v[172:175], v227, s[8:11], s26 offen
    s_add_u32 s26, s26, 1024
    s_waitcnt lgkmcnt(6)
    v_mfma_f32_16x16x32_bf16 v[28:31], v[216:219], v[176:179], v[28:31]
    v_mfma_f32_16x16x32_bf16 v[64:67], v[216:219], v[180:183], v[64:67]
    v_mfma_f32_16x16x32_bf16 v[100:103], v[216:219], v[184:187], v[100:103]
    v_mfma_f32_16x16x32_bf16 v[136:139], v[216:219], v[188:191], v[136:139]
    ds_read_b64_tr_b16 v[216:217], v233 offset:9440
    ds_read_b64_tr_b16 v[218:219], v233 offset:11744
    s_waitcnt lgkmcnt(6)
    v_mfma_f32_16x16x32_bf16 v[32:35], v[220:223], v[176:179], v[32:35]
    v_mfma_f32_16x16x32_bf16 v[68:71], v[220:223], v[180:183], v[68:71]
    v_mfma_f32_16x16x32_bf16 v[104:107], v[220:223], v[184:187], v[104:107]
    v_mfma_f32_16x16x32_bf16 v[140:143], v[220:223], v[188:191], v[140:143]
    ds_read_b64_tr_b16 v[220:221], v233 offset:9472
    ds_read_b64_tr_b16 v[222:223], v233 offset:11776
    s_waitcnt lgkmcnt(6)
    v_mfma_f32_16x16x32_bf16 v[36:39], v[208:211], v[176:179], v[36:39]
    v_mfma_f32_16x16x32_bf16 v[72:75], v[208:211], v[180:183], v[72:75]
    v_mfma_f32_16x16x32_bf16 v[108:111], v[208:211], v[184:187], v[108:111]
    v_mfma_f32_16x16x32_bf16 v[144:147], v[208:211], v[188:191], v[144:147]
    s_waitcnt lgkmcnt(0)
    s_barrier
    ds_read_b64_tr_b16 v[208:209], v233 offset:20480
    ds_read_b64_tr_b16 v[210:211], v233 offset:22784
    s_add_u32 m0, s24, 0
    s_nop 0
    buffer_load_dwordx4 v228, s[12:15], s25 offen offset:0 lds
    v_mfma_f32_16x16x32_bf16 v[40:43], v[212:215], v[176:179], v[40:43]
    v_mfma_f32_16x16x32_bf16 v[76:79], v[212:215], v[180:183], v[76:79]
    v_mfma_f32_16x16x32_bf16 v[112:115], v[212:215], v[184:187], v[112:115]
    v_mfma_f32_16x16x32_bf16 v[148:151], v[212:215], v[188:191], v[148:151]
    ds_read_b64_tr_b16 v[212:213], v233 offset:20512
    ds_read_b64_tr_b16 v[214:215], v233 offset:22816
    s_add_u32 m0, s24, 0
    s_nop 0
    buffer_load_dwordx4 v229, s[12:15], s25 offen offset:1024 lds
    v_mfma_f32_16x16x32_bf16 v[44:47], v[216:219], v[176:179], v[44:47]
    v_mfma_f32_16x16x32_bf16 v[80:83], v[216:219], v[180:183], v[80:83]
    v_mfma_f32_16x16x32_bf16 v[116:119], v[216:219], v[184:187], v[116:119]
    v_mfma_f32_16x16x32_bf16 v[152:155], v[216:219], v[188:191], v[152:155]
    ds_read_b64_tr_b16 v[216:217], v233 offset:20544
    ds_read_b64_tr_b16 v[218:219], v233 offset:22848
    s_add_u32 m0, s24, 0
    s_nop 0
    buffer_load_dwordx4 v230, s[12:15], s25 offen offset:2048 lds
    v_mfma_f32_16x16x32_bf16 v[48:51], v[220:223], v[176:179], v[48:51]
    v_mfma_f32_16x16x32_bf16 v[84:87], v[220:223], v[180:183], v[84:87]
    v_mfma_f32_16x16x32_bf16 v[120:123], v[220:223], v[184:187], v[120:123]
    v_mfma_f32_16x16x32_bf16 v[156:159], v[220:223], v[188:191], v[156:159]
    ds_read_b64_tr_b16 v[220:221], v233 offset:20576
    ds_read_b64_tr_b16 v[222:223], v233 offset:22880
    buffer_load_dwordx4 v[176:179], v224, s[8:11], s26 offen
    s_waitcnt vmcnt(10) lgkmcnt(6)
    v_mfma_f32_16x16x32_bf16 v[16:19], v[208:211], v[192:195], v[16:19]
    v_mfma_f32_16x16x32_bf16 v[52:55], v[208:211], v[196:199], v[52:55]
    v_mfma_f32_16x16x32_bf16 v[88:91], v[208:211], v[200:203], v[88:91]
    v_mfma_f32_16x16x32_bf16 v[124:127], v[208:211], v[204:207], v[124:127]
    ds_read_b64_tr_b16 v[208:209], v233 offset:20608
    ds_read_b64_tr_b16 v[210:211], v233 offset:22912
    buffer_load_dwordx4 v[180:183], v225, s[8:11], s26 offen
    s_waitcnt lgkmcnt(6)
    v_mfma_f32_16x16x32_bf16 v[20:23], v[212:215], v[192:195], v[20:23]
    v_mfma_f32_16x16x32_bf16 v[56:59], v[212:215], v[196:199], v[56:59]
    v_mfma_f32_16x16x32_bf16 v[92:95], v[212:215], v[200:203], v[92:95]
    v_mfma_f32_16x16x32_bf16 v[128:131], v[212:215], v[204:207], v[128:131]
    ds_read_b64_tr_b16 v[212:213], v233 offset:20640
    ds_read_b64_tr_b16 v[214:215], v233 offset:22944
    buffer_load_dwordx4 v[184:187], v226, s[8:11], s26 offen
    s_waitcnt lgkmcnt(6)
    v_mfma_f32_16x16x32_bf16 v[24:27], v[216:219], v[192:195], v[24:27]
    v_mfma_f32_16x16x32_bf16 v[60:63], v[216:219], v[196:199], v[60:63]
    v_mfma_f32_16x16x32_bf16 v[96:99], v[216:219], v[200:203], v[96:99]
    v_mfma_f32_16x16x32_bf16 v[132:135], v[216:219], v[204:207], v[132:135]
    ds_read_b64_tr_b16 v[216:217], v233 offset:20672
    ds_read_b64_tr_b16 v[218:219], v233 offset:22976
    buffer_load_dwordx4 v[188:191], v227, s[8:11], s26 offen
    s_add_u32 s26, s26, 1024
    s_waitcnt lgkmcnt(6)
    v_mfma_f32_16x16x32_bf16 v[28:31], v[220:223], v[192:195], v[28:31]
    v_mfma_f32_16x16x32_bf16 v[64:67], v[220:223], v[196:199], v[64:67]
    v_mfma_f32_16x16x32_bf16 v[100:103], v[220:223], v[200:203], v[100:103]
    v_mfma_f32_16x16x32_bf16 v[136:139], v[220:223], v[204:207], v[136:139]
    ds_read_b64_tr_b16 v[220:221], v233 offset:20704
    ds_read_b64_tr_b16 v[222:223], v233 offset:23008
    s_add_u32 m0, s24, 0
    s_nop 0
    buffer_load_dwordx4 v231, s[12:15], s25 offen offset:3072 lds
    s_waitcnt lgkmcnt(6)
    v_mfma_f32_16x16x32_bf16 v[32:35], v[208:211], v[192:195], v[32:35]
    v_mfma_f32_16x16x32_bf16 v[68:71], v[208:211], v[196:199], v[68:71]
    v_mfma_f32_16x16x32_bf16 v[104:107], v[208:211], v[200:203], v[104:107]
    v_mfma_f32_16x16x32_bf16 v[140:143], v[208:211], v[204:207], v[140:143]
    ds_read_b64_tr_b16 v[208:209], v233 offset:20736
    ds_read_b64_tr_b16 v[210:211], v233 offset:23040
    s_add_u32 m0, s24, 4096
    s_nop 0
    buffer_load_dwordx4 v232, s[12:15], s25 offen offset:0 lds
    s_add_u32 s25, s25, 589824
    s_waitcnt lgkmcnt(6)
    v_mfma_f32_16x16x32_bf16 v[36:39], v[212:215], v[192:195], v[36:39]
    v_mfma_f32_16x16x32_bf16 v[72:75], v[212:215], v[196:199], v[72:75]
    v_mfma_f32_16x16x32_bf16 v[108:111], v[212:215], v[200:203], v[108:111]
    v_mfma_f32_16x16x32_bf16 v[144:147], v[212:215], v[204:207], v[144:147]
    ds_read_b64_tr_b16 v[212:213], v233 offset:29696
    ds_read_b64_tr_b16 v[214:215], v233 offset:32000
    s_waitcnt lgkmcnt(6)
    v_mfma_f32_16x16x32_bf16 v[40:43], v[216:219], v[192:195], v[40:43]
    v_mfma_f32_16x16x32_bf16 v[76:79], v[216:219], v[196:199], v[76:79]
    v_mfma_f32_16x16x32_bf16 v[112:115], v[216:219], v[200:203], v[112:115]
    v_mfma_f32_16x16x32_bf16 v[148:151], v[216:219], v[204:207], v[148:151]
    ds_read_b64_tr_b16 v[216:217], v233 offset:29728
    ds_read_b64_tr_b16 v[218:219], v233 offset:32032
    s_waitcnt lgkmcnt(6)
    v_mfma_f32_16x16x32_bf16 v[44:47], v[220:223], v[192:195], v[44:47]
    v_mfma_f32_16x16x32_bf16 v[80:83], v[220:223], v[196:199], v[80:83]
    v_mfma_f32_16x16x32_bf16 v[116:119], v[220:223], v[200:203], v[116:119]
    v_mfma_f32_16x16x32_bf16 v[152:155], v[220:223], v[204:207], v[152:155]
    ds_read_b64_tr_b16 v[220:221], v233 offset:29760
    ds_read_b64_tr_b16 v[222:223], v233 offset:32064
    s_waitcnt lgkmcnt(6)
    v_mfma_f32_16x16x32_bf16 v[48:51], v[208:211], v[192:195], v[48:51]
    v_mfma_f32_16x16x32_bf16 v[84:87], v[208:211], v[196:199], v[84:87]
    v_mfma_f32_16x16x32_bf16 v[120:123], v[208:211], v[200:203], v[120:123]
    v_mfma_f32_16x16x32_bf16 v[156:159], v[208:211], v[204:207], v[156:159]
    ds_read_b64_tr_b16 v[208:209], v233 offset:29792
    ds_read_b64_tr_b16 v[210:211], v233 offset:32096
    buffer_load_dwordx4 v[192:195], v224, s[8:11], s26 offen
    s_waitcnt vmcnt(10) lgkmcnt(6)
    v_mfma_f32_16x16x32_bf16 v[16:19], v[212:215], v[160:163], v[16:19]
    v_mfma_f32_16x16x32_bf16 v[52:55], v[212:215], v[164:167], v[52:55]
    v_mfma_f32_16x16x32_bf16 v[88:91], v[212:215], v[168:171], v[88:91]
    v_mfma_f32_16x16x32_bf16 v[124:127], v[212:215], v[172:175], v[124:127]
    ds_read_b64_tr_b16 v[212:213], v233 offset:29824
    ds_read_b64_tr_b16 v[214:215], v233 offset:32128
    buffer_load_dwordx4 v[196:199], v225, s[8:11], s26 offen
    s_waitcnt lgkmcnt(6)
    v_mfma_f32_16x16x32_bf16 v[20:23], v[216:219], v[160:163], v[20:23]
    v_mfma_f32_16x16x32_bf16 v[56:59], v[216:219], v[164:167], v[56:59]
    v_mfma_f32_16x16x32_bf16 v[92:95], v[216:219], v[168:171], v[92:95]
    v_mfma_f32_16x16x32_bf16 v[128:131], v[216:219], v[172:175], v[128:131]
    ds_read_b64_tr_b16 v[216:217], v233 offset:29856
    ds_read_b64_tr_b16 v[218:219], v233 offset:32160
    buffer_load_dwordx4 v[200:203], v226, s[8:11], s26 offen
    s_waitcnt lgkmcnt(6)
    v_mfma_f32_16x16x32_bf16 v[24:27], v[220:223], v[160:163], v[24:27]
    v_mfma_f32_16x16x32_bf16 v[60:63], v[220:223], v[164:167], v[60:63]
    v_mfma_f32_16x16x32_bf16 v[96:99], v[220:223], v[168:171], v[96:99]
    v_mfma_f32_16x16x32_bf16 v[132:135], v[220:223], v[172:175], v[132:135]
    ds_read_b64_tr_b16 v[220:221], v233 offset:29888
    ds_read_b64_tr_b16 v[222:223], v233 offset:32192
    buffer_load_dwordx4 v[204:207], v227, s[8:11], s26 offen
    s_add_u32 s26, s26, 1024
    s_waitcnt lgkmcnt(6)
    v_mfma_f32_16x16x32_bf16 v[28:31], v[208:211], v[160:163], v[28:31]
    v_mfma_f32_16x16x32_bf16 v[64:67], v[208:211], v[164:167], v[64:67]
    v_mfma_f32_16x16x32_bf16 v[100:103], v[208:211], v[168:171], v[100:103]
    v_mfma_f32_16x16x32_bf16 v[136:139], v[208:211], v[172:175], v[136:139]
    ds_read_b64_tr_b16 v[208:209], v233 offset:29920
    ds_read_b64_tr_b16 v[210:211], v233 offset:32224
    s_waitcnt lgkmcnt(6)
    v_mfma_f32_16x16x32_bf16 v[32:35], v[212:215], v[160:163], v[32:35]
    v_mfma_f32_16x16x32_bf16 v[68:71], v[212:215], v[164:167], v[68:71]
    v_mfma_f32_16x16x32_bf16 v[104:107], v[212:215], v[168:171], v[104:107]
    v_mfma_f32_16x16x32_bf16 v[140:143], v[212:215], v[172:175], v[140:143]
    ds_read_b64_tr_b16 v[212:213], v233 offset:29952
    ds_read_b64_tr_b16 v[214:215], v233 offset:32256
    s_waitcnt lgkmcnt(6)
    v_mfma_f32_16x16x32_bf16 v[36:39], v[216:219], v[160:163], v[36:39]
    v_mfma_f32_16x16x32_bf16 v[72:75], v[216:219], v[164:167], v[72:75]
    v_mfma_f32_16x16x32_bf16 v[108:111], v[216:219], v[168:171], v[108:111]
    v_mfma_f32_16x16x32_bf16 v[144:147], v[216:219], v[172:175], v[144:147]
    s_waitcnt lgkmcnt(0)
    s_barrier
    ds_read_b64_tr_b16 v[216:217], v233 offset:40960
    ds_read_b64_tr_b16 v[218:219], v233 offset:43264
    s_add_u32 m0, s24, 20480
    s_nop 0
    buffer_load_dwordx4 v228, s[12:15], s25 offen offset:0 lds
    v_mfma_f32_16x16x32_bf16 v[40:43], v[220:223], v[160:163], v[40:43]
    v_mfma_f32_16x16x32_bf16 v[76:79], v[220:223], v[164:167], v[76:79]
    v_mfma_f32_16x16x32_bf16 v[112:115], v[220:223], v[168:171], v[112:115]
    v_mfma_f32_16x16x32_bf16 v[148:151], v[220:223], v[172:175], v[148:151]
    ds_read_b64_tr_b16 v[220:221], v233 offset:40992
    ds_read_b64_tr_b16 v[222:223], v233 offset:43296
    s_add_u32 m0, s24, 20480
    s_nop 0
    buffer_load_dwordx4 v229, s[12:15], s25 offen offset:1024 lds
    v_mfma_f32_16x16x32_bf16 v[44:47], v[208:211], v[160:163], v[44:47]
    v_mfma_f32_16x16x32_bf16 v[80:83], v[208:211], v[164:167], v[80:83]
    v_mfma_f32_16x16x32_bf16 v[116:119], v[208:211], v[168:171], v[116:119]
    v_mfma_f32_16x16x32_bf16 v[152:155], v[208:211], v[172:175], v[152:155]
    ds_read_b64_tr_b16 v[208:209], v233 offset:41024
    ds_read_b64_tr_b16 v[210:211], v233 offset:43328
    s_add_u32 m0, s24, 20480
    s_nop 0
    buffer_load_dwordx4 v230, s[12:15], s25 offen offset:2048 lds
    v_mfma_f32_16x16x32_bf16 v[48:51], v[212:215], v[160:163], v[48:51]
    v_mfma_f32_16x16x32_bf16 v[84:87], v[212:215], v[164:167], v[84:87]
    v_mfma_f32_16x16x32_bf16 v[120:123], v[212:215], v[168:171], v[120:123]
    v_mfma_f32_16x16x32_bf16 v[156:159], v[212:215], v[172:175], v[156:159]
    ds_read_b64_tr_b16 v[212:213], v233 offset:41056
    ds_read_b64_tr_b16 v[214:215], v233 offset:43360
    buffer_load_dwordx4 v[160:163], v224, s[8:11], s26 offen
    s_waitcnt vmcnt(10) lgkmcnt(6)
    v_mfma_f32_16x16x32_bf16 v[16:19], v[216:219], v[176:179], v[16:19]
    v_mfma_f32_16x16x32_bf16 v[52:55], v[216:219], v[180:183], v[52:55]
    v_mfma_f32_16x16x32_bf16 v[88:91], v[216:219], v[184:187], v[88:91]
    v_mfma_f32_16x16x32_bf16 v[124:127], v[216:219], v[188:191], v[124:127]
    ds_read_b64_tr_b16 v[216:217], v233 offset:41088
    ds_read_b64_tr_b16 v[218:219], v233 offset:43392
    buffer_load_dwordx4 v[164:167], v225, s[8:11], s26 offen
    s_waitcnt lgkmcnt(6)
    v_mfma_f32_16x16x32_bf16 v[20:23], v[220:223], v[176:179], v[20:23]
    v_mfma_f32_16x16x32_bf16 v[56:59], v[220:223], v[180:183], v[56:59]
    v_mfma_f32_16x16x32_bf16 v[92:95], v[220:223], v[184:187], v[92:95]
    v_mfma_f32_16x16x32_bf16 v[128:131], v[220:223], v[188:191], v[128:131]
    ds_read_b64_tr_b16 v[220:221], v233 offset:41120
    ds_read_b64_tr_b16 v[222:223], v233 offset:43424
    buffer_load_dwordx4 v[168:171], v226, s[8:11], s26 offen
    s_waitcnt lgkmcnt(6)
    v_mfma_f32_16x16x32_bf16 v[24:27], v[208:211], v[176:179], v[24:27]
    v_mfma_f32_16x16x32_bf16 v[60:63], v[208:211], v[180:183], v[60:63]
    v_mfma_f32_16x16x32_bf16 v[96:99], v[208:211], v[184:187], v[96:99]
    v_mfma_f32_16x16x32_bf16 v[132:135], v[208:211], v[188:191], v[132:135]
    ds_read_b64_tr_b16 v[208:209], v233 offset:41152
    ds_read_b64_tr_b16 v[210:211], v233 offset:43456
    buffer_load_dwordx4 v[172:175], v227, s[8:11], s26 offen
    s_add_u32 s26, s26, 1024
    s_waitcnt lgkmcnt(6)
    v_mfma_f32_16x16x32_bf16 v[28:31], v[212:215], v[176:179], v[28:31]
    v_mfma_f32_16x16x32_bf16 v[64:67], v[212:215], v[180:183], v[64:67]
    v_mfma_f32_16x16x32_bf16 v[100:103], v[212:215], v[184:187], v[100:103]
    v_mfma_f32_16x16x32_bf16 v[136:139], v[212:215], v[188:191], v[136:139]
    ds_read_b64_tr_b16 v[212:213], v233 offset:41184
    ds_read_b64_tr_b16 v[214:215], v233 offset:43488
    s_add_u32 m0, s24, 20480
    s_nop 0
    buffer_load_dwordx4 v231, s[12:15], s25 offen offset:3072 lds
    s_waitcnt lgkmcnt(6)
    v_mfma_f32_16x16x32_bf16 v[32:35], v[216:219], v[176:179], v[32:35]
    v_mfma_f32_16x16x32_bf16 v[68:71], v[216:219], v[180:183], v[68:71]
    v_mfma_f32_16x16x32_bf16 v[104:107], v[216:219], v[184:187], v[104:107]
    v_mfma_f32_16x16x32_bf16 v[140:143], v[216:219], v[188:191], v[140:143]
    ds_read_b64_tr_b16 v[216:217], v233 offset:41216
    ds_read_b64_tr_b16 v[218:219], v233 offset:43520
    s_add_u32 m0, s24, 24576
    s_nop 0
    buffer_load_dwordx4 v232, s[12:15], s25 offen offset:0 lds
    s_add_u32 s25, s25, 589824
    s_waitcnt lgkmcnt(6)
    v_mfma_f32_16x16x32_bf16 v[36:39], v[220:223], v[176:179], v[36:39]
    v_mfma_f32_16x16x32_bf16 v[72:75], v[220:223], v[180:183], v[72:75]
    v_mfma_f32_16x16x32_bf16 v[108:111], v[220:223], v[184:187], v[108:111]
    v_mfma_f32_16x16x32_bf16 v[144:147], v[220:223], v[188:191], v[144:147]
    ds_read_b64_tr_b16 v[220:221], v233 offset:50176
    ds_read_b64_tr_b16 v[222:223], v233 offset:52480
    s_waitcnt lgkmcnt(6)
    v_mfma_f32_16x16x32_bf16 v[40:43], v[208:211], v[176:179], v[40:43]
    v_mfma_f32_16x16x32_bf16 v[76:79], v[208:211], v[180:183], v[76:79]
    v_mfma_f32_16x16x32_bf16 v[112:115], v[208:211], v[184:187], v[112:115]
    v_mfma_f32_16x16x32_bf16 v[148:151], v[208:211], v[188:191], v[148:151]
    ds_read_b64_tr_b16 v[208:209], v233 offset:50208
    ds_read_b64_tr_b16 v[210:211], v233 offset:52512
    s_waitcnt lgkmcnt(6)
    v_mfma_f32_16x16x32_bf16 v[44:47], v[212:215], v[176:179], v[44:47]
    v_mfma_f32_16x16x32_bf16 v[80:83], v[212:215], v[180:183], v[80:83]
    v_mfma_f32_16x16x32_bf16 v[116:119], v[212:215], v[184:187], v[116:119]
    v_mfma_f32_16x16x32_bf16 v[152:155], v[212:215], v[188:191], v[152:155]
    ds_read_b64_tr_b16 v[212:213], v233 offset:50240
    ds_read_b64_tr_b16 v[214:215], v233 offset:52544
    s_waitcnt lgkmcnt(6)
    v_mfma_f32_16x16x32_bf16 v[48:51], v[216:219], v[176:179], v[48:51]
    v_mfma_f32_16x16x32_bf16 v[84:87], v[216:219], v[180:183], v[84:87]
    v_mfma_f32_16x16x32_bf16 v[120:123], v[216:219], v[184:187], v[120:123]
    v_mfma_f32_16x16x32_bf16 v[156:159], v[216:219], v[188:191], v[156:159]
    ds_read_b64_tr_b16 v[216:217], v233 offset:50272
    ds_read_b64_tr_b16 v[218:219], v233 offset:52576
    buffer_load_dwordx4 v[176:179], v224, s[8:11], s26 offen
    s_waitcnt vmcnt(10) lgkmcnt(6)
    v_mfma_f32_16x16x32_bf16 v[16:19], v[220:223], v[192:195], v[16:19]
    v_mfma_f32_16x16x32_bf16 v[52:55], v[220:223], v[196:199], v[52:55]
    v_mfma_f32_16x16x32_bf16 v[88:91], v[220:223], v[200:203], v[88:91]
    v_mfma_f32_16x16x32_bf16 v[124:127], v[220:223], v[204:207], v[124:127]
    ds_read_b64_tr_b16 v[220:221], v233 offset:50304
    ds_read_b64_tr_b16 v[222:223], v233 offset:52608
    buffer_load_dwordx4 v[180:183], v225, s[8:11], s26 offen
    s_waitcnt lgkmcnt(6)
    v_mfma_f32_16x16x32_bf16 v[20:23], v[208:211], v[192:195], v[20:23]
    v_mfma_f32_16x16x32_bf16 v[56:59], v[208:211], v[196:199], v[56:59]
    v_mfma_f32_16x16x32_bf16 v[92:95], v[208:211], v[200:203], v[92:95]
    v_mfma_f32_16x16x32_bf16 v[128:131], v[208:211], v[204:207], v[128:131]
    ds_read_b64_tr_b16 v[208:209], v233 offset:50336
    ds_read_b64_tr_b16 v[210:211], v233 offset:52640
    buffer_load_dwordx4 v[184:187], v226, s[8:11], s26 offen
    s_waitcnt lgkmcnt(6)
    v_mfma_f32_16x16x32_bf16 v[24:27], v[212:215], v[192:195], v[24:27]
    v_mfma_f32_16x16x32_bf16 v[60:63], v[212:215], v[196:199], v[60:63]
    v_mfma_f32_16x16x32_bf16 v[96:99], v[212:215], v[200:203], v[96:99]
    v_mfma_f32_16x16x32_bf16 v[132:135], v[212:215], v[204:207], v[132:135]
    ds_read_b64_tr_b16 v[212:213], v233 offset:50368
    ds_read_b64_tr_b16 v[214:215], v233 offset:52672
    buffer_load_dwordx4 v[188:191], v227, s[8:11], s26 offen
    s_add_u32 s26, s26, 1024
    s_waitcnt lgkmcnt(6)
    v_mfma_f32_16x16x32_bf16 v[28:31], v[216:219], v[192:195], v[28:31]
    v_mfma_f32_16x16x32_bf16 v[64:67], v[216:219], v[196:199], v[64:67]
    v_mfma_f32_16x16x32_bf16 v[100:103], v[216:219], v[200:203], v[100:103]
    v_mfma_f32_16x16x32_bf16 v[136:139], v[216:219], v[204:207], v[136:139]
    ds_read_b64_tr_b16 v[216:217], v233 offset:50400
    ds_read_b64_tr_b16 v[218:219], v233 offset:52704
    s_waitcnt lgkmcnt(6)
    v_mfma_f32_16x16x32_bf16 v[32:35], v[220:223], v[192:195], v[32:35]
    v_mfma_f32_16x16x32_bf16 v[68:71], v[220:223], v[196:199], v[68:71]
    v_mfma_f32_16x16x32_bf16 v[104:107], v[220:223], v[200:203], v[104:107]
    v_mfma_f32_16x16x32_bf16 v[140:143], v[220:223], v[204:207], v[140:143]
    ds_read_b64_tr_b16 v[220:221], v233 offset:50432
    ds_read_b64_tr_b16 v[222:223], v233 offset:52736
    s_waitcnt lgkmcnt(6)
    v_mfma_f32_16x16x32_bf16 v[36:39], v[208:211], v[192:195], v[36:39]
    v_mfma_f32_16x16x32_bf16 v[72:75], v[208:211], v[196:199], v[72:75]
    v_mfma_f32_16x16x32_bf16 v[108:111], v[208:211], v[200:203], v[108:111]
    v_mfma_f32_16x16x32_bf16 v[144:147], v[208:211], v[204:207], v[144:147]
    s_waitcnt lgkmcnt(0)
    s_barrier
    ds_read_b64_tr_b16 v[208:209], v233 offset:0
    ds_read_b64_tr_b16 v[210:211], v233 offset:2304
    s_add_u32 m0, s24, 40960
    s_nop 0
    buffer_load_dwordx4 v228, s[12:15], s25 offen offset:0 lds
    v_mfma_f32_16x16x32_bf16 v[40:43], v[212:215], v[192:195], v[40:43]
    v_mfma_f32_16x16x32_bf16 v[76:79], v[212:215], v[196:199], v[76:79]
    v_mfma_f32_16x16x32_bf16 v[112:115], v[212:215], v[200:203], v[112:115]
    v_mfma_f32_16x16x32_bf16 v[148:151], v[212:215], v[204:207], v[148:151]
    ds_read_b64_tr_b16 v[212:213], v233 offset:32
    ds_read_b64_tr_b16 v[214:215], v233 offset:2336
    s_add_u32 m0, s24, 40960
    s_nop 0
    buffer_load_dwordx4 v229, s[12:15], s25 offen offset:1024 lds
    v_mfma_f32_16x16x32_bf16 v[44:47], v[216:219], v[192:195], v[44:47]
    v_mfma_f32_16x16x32_bf16 v[80:83], v[216:219], v[196:199], v[80:83]
    v_mfma_f32_16x16x32_bf16 v[116:119], v[216:219], v[200:203], v[116:119]
    v_mfma_f32_16x16x32_bf16 v[152:155], v[216:219], v[204:207], v[152:155]
    ds_read_b64_tr_b16 v[216:217], v233 offset:64
    ds_read_b64_tr_b16 v[218:219], v233 offset:2368
    s_add_u32 m0, s24, 40960
    s_nop 0
    buffer_load_dwordx4 v230, s[12:15], s25 offen offset:2048 lds
    v_mfma_f32_16x16x32_bf16 v[48:51], v[220:223], v[192:195], v[48:51]
    v_mfma_f32_16x16x32_bf16 v[84:87], v[220:223], v[196:199], v[84:87]
    v_mfma_f32_16x16x32_bf16 v[120:123], v[220:223], v[200:203], v[120:123]
    v_mfma_f32_16x16x32_bf16 v[156:159], v[220:223], v[204:207], v[156:159]
    ds_read_b64_tr_b16 v[220:221], v233 offset:96
    ds_read_b64_tr_b16 v[222:223], v233 offset:2400
    buffer_load_dwordx4 v[192:195], v224, s[8:11], s26 offen
    s_waitcnt vmcnt(10) lgkmcnt(6)
    v_mfma_f32_16x16x32_bf16 v[16:19], v[208:211], v[160:163], v[16:19]
    v_mfma_f32_16x16x32_bf16 v[52:55], v[208:211], v[164:167], v[52:55]
    v_mfma_f32_16x16x32_bf16 v[88:91], v[208:211], v[168:171], v[88:91]
    v_mfma_f32_16x16x32_bf16 v[124:127], v[208:211], v[172:175], v[124:127]
    ds_read_b64_tr_b16 v[208:209], v233 offset:128
    ds_read_b64_tr_b16 v[210:211], v233 offset:2432
    buffer_load_dwordx4 v[196:199], v225, s[8:11], s26 offen
    s_waitcnt lgkmcnt(6)
    v_mfma_f32_16x16x32_bf16 v[20:23], v[212:215], v[160:163], v[20:23]
    v_mfma_f32_16x16x32_bf16 v[56:59], v[212:215], v[164:167], v[56:59]
    v_mfma_f32_16x16x32_bf16 v[92:95], v[212:215], v[168:171], v[92:95]
    v_mfma_f32_16x16x32_bf16 v[128:131], v[212:215], v[172:175], v[128:131]
    ds_read_b64_tr_b16 v[212:213], v233 offset:160
    ds_read_b64_tr_b16 v[214:215], v233 offset:2464
    buffer_load_dwordx4 v[200:203], v226, s[8:11], s26 offen
    s_waitcnt lgkmcnt(6)
    v_mfma_f32_16x16x32_bf16 v[24:27], v[216:219], v[160:163], v[24:27]
    v_mfma_f32_16x16x32_bf16 v[60:63], v[216:219], v[164:167], v[60:63]
    v_mfma_f32_16x16x32_bf16 v[96:99], v[216:219], v[168:171], v[96:99]
    v_mfma_f32_16x16x32_bf16 v[132:135], v[216:219], v[172:175], v[132:135]
    ds_read_b64_tr_b16 v[216:217], v233 offset:192
    ds_read_b64_tr_b16 v[218:219], v233 offset:2496
    buffer_load_dwordx4 v[204:207], v227, s[8:11], s26 offen
    s_add_u32 s26, s26, 1024
    s_waitcnt lgkmcnt(6)
    v_mfma_f32_16x16x32_bf16 v[28:31], v[220:223], v[160:163], v[28:31]
    v_mfma_f32_16x16x32_bf16 v[64:67], v[220:223], v[164:167], v[64:67]
    v_mfma_f32_16x16x32_bf16 v[100:103], v[220:223], v[168:171], v[100:103]
    v_mfma_f32_16x16x32_bf16 v[136:139], v[220:223], v[172:175], v[136:139]
    ds_read_b64_tr_b16 v[220:221], v233 offset:224
    ds_read_b64_tr_b16 v[222:223], v233 offset:2528
    s_add_u32 m0, s24, 40960
    s_nop 0
    buffer_load_dwordx4 v231, s[12:15], s25 offen offset:3072 lds
    s_waitcnt lgkmcnt(6)
    v_mfma_f32_16x16x32_bf16 v[32:35], v[208:211], v[160:163], v[32:35]
    v_mfma_f32_16x16x32_bf16 v[68:71], v[208:211], v[164:167], v[68:71]
    v_mfma_f32_16x16x32_bf16 v[104:107], v[208:211], v[168:171], v[104:107]
    v_mfma_f32_16x16x32_bf16 v[140:143], v[208:211], v[172:175], v[140:143]
    ds_read_b64_tr_b16 v[208:209], v233 offset:256
    ds_read_b64_tr_b16 v[210:211], v233 offset:2560
    s_add_u32 m0, s24, 45056
    s_nop 0
    buffer_load_dwordx4 v232, s[12:15], s25 offen offset:0 lds
    s_add_u32 s25, s25, 589824
    s_waitcnt lgkmcnt(6)
    v_mfma_f32_16x16x32_bf16 v[36:39], v[212:215], v[160:163], v[36:39]
    v_mfma_f32_16x16x32_bf16 v[72:75], v[212:215], v[164:167], v[72:75]
    v_mfma_f32_16x16x32_bf16 v[108:111], v[212:215], v[168:171], v[108:111]
    v_mfma_f32_16x16x32_bf16 v[144:147], v[212:215], v[172:175], v[144:147]
    ds_read_b64_tr_b16 v[212:213], v233 offset:9216
    ds_read_b64_tr_b16 v[214:215], v233 offset:11520
    s_waitcnt lgkmcnt(6)
    v_mfma_f32_16x16x32_bf16 v[40:43], v[216:219], v[160:163], v[40:43]
    v_mfma_f32_16x16x32_bf16 v[76:79], v[216:219], v[164:167], v[76:79]
    v_mfma_f32_16x16x32_bf16 v[112:115], v[216:219], v[168:171], v[112:115]
    v_mfma_f32_16x16x32_bf16 v[148:151], v[216:219], v[172:175], v[148:151]
    ds_read_b64_tr_b16 v[216:217], v233 offset:9248
    ds_read_b64_tr_b16 v[218:219], v233 offset:11552
    s_waitcnt lgkmcnt(6)
    v_mfma_f32_16x16x32_bf16 v[44:47], v[220:223], v[160:163], v[44:47]
    v_mfma_f32_16x16x32_bf16 v[80:83], v[220:223], v[164:167], v[80:83]
    v_mfma_f32_16x16x32_bf16 v[116:119], v[220:223], v[168:171], v[116:119]
    v_mfma_f32_16x16x32_bf16 v[152:155], v[220:223], v[172:175], v[152:155]
    ds_read_b64_tr_b16 v[220:221], v233 offset:9280
    ds_read_b64_tr_b16 v[222:223], v233 offset:11584
    s_waitcnt lgkmcnt(6)
    v_mfma_f32_16x16x32_bf16 v[48:51], v[208:211], v[160:163], v[48:51]
    v_mfma_f32_16x16x32_bf16 v[84:87], v[208:211], v[164:167], v[84:87]
    v_mfma_f32_16x16x32_bf16 v[120:123], v[208:211], v[168:171], v[120:123]
    v_mfma_f32_16x16x32_bf16 v[156:159], v[208:211], v[172:175], v[156:159]
    ds_read_b64_tr_b16 v[208:209], v233 offset:9312
    ds_read_b64_tr_b16 v[210:211], v233 offset:11616
    buffer_load_dwordx4 v[160:163], v224, s[8:11], s26 offen
    s_waitcnt vmcnt(10) lgkmcnt(6)
    v_mfma_f32_16x16x32_bf16 v[16:19], v[212:215], v[176:179], v[16:19]
    v_mfma_f32_16x16x32_bf16 v[52:55], v[212:215], v[180:183], v[52:55]
    v_mfma_f32_16x16x32_bf16 v[88:91], v[212:215], v[184:187], v[88:91]
    v_mfma_f32_16x16x32_bf16 v[124:127], v[212:215], v[188:191], v[124:127]
    ds_read_b64_tr_b16 v[212:213], v233 offset:9344
    ds_read_b64_tr_b16 v[214:215], v233 offset:11648
    buffer_load_dwordx4 v[164:167], v225, s[8:11], s26 offen
    s_waitcnt lgkmcnt(6)
    v_mfma_f32_16x16x32_bf16 v[20:23], v[216:219], v[176:179], v[20:23]
    v_mfma_f32_16x16x32_bf16 v[56:59], v[216:219], v[180:183], v[56:59]
    v_mfma_f32_16x16x32_bf16 v[92:95], v[216:219], v[184:187], v[92:95]
    v_mfma_f32_16x16x32_bf16 v[128:131], v[216:219], v[188:191], v[128:131]
    ds_read_b64_tr_b16 v[216:217], v233 offset:9376
    ds_read_b64_tr_b16 v[218:219], v233 offset:11680
    buffer_load_dwordx4 v[168:171], v226, s[8:11], s26 offen
    s_waitcnt lgkmcnt(6)
    v_mfma_f32_16x16x32_bf16 v[24:27], v[220:223], v[176:179], v[24:27]
    v_mfma_f32_16x16x32_bf16 v[60:63], v[220:223], v[180:183], v[60:63]
    v_mfma_f32_16x16x32_bf16 v[96:99], v[220:223], v[184:187], v[96:99]
    v_mfma_f32_16x16x32_bf16 v[132:135], v[220:223], v[188:191], v[132:135]
    ds_read_b64_tr_b16 v[220:221], v233 offset:9408
    ds_read_b64_tr_b16 v[222:223], v233 offset:11712
    buffer_load_dwordx4 v[172:175], v227, s[8:11], s26 offen
    s_add_u32 s26, s26, 1024
    s_waitcnt lgkmcnt(6)
    v_mfma_f32_16x16x32_bf16 v[28:31], v[208:211], v[176:179], v[28:31]
    v_mfma_f32_16x16x32_bf16 v[64:67], v[208:211], v[180:183], v[64:67]
    v_mfma_f32_16x16x32_bf16 v[100:103], v[208:211], v[184:187], v[100:103]
    v_mfma_f32_16x16x32_bf16 v[136:139], v[208:211], v[188:191], v[136:139]
    ds_read_b64_tr_b16 v[208:209], v233 offset:9440
    ds_read_b64_tr_b16 v[210:211], v233 offset:11744
    s_waitcnt lgkmcnt(6)
    v_mfma_f32_16x16x32_bf16 v[32:35], v[212:215], v[176:179], v[32:35]
    v_mfma_f32_16x16x32_bf16 v[68:71], v[212:215], v[180:183], v[68:71]
    v_mfma_f32_16x16x32_bf16 v[104:107], v[212:215], v[184:187], v[104:107]
    v_mfma_f32_16x16x32_bf16 v[140:143], v[212:215], v[188:191], v[140:143]
    ds_read_b64_tr_b16 v[212:213], v233 offset:9472
    ds_read_b64_tr_b16 v[214:215], v233 offset:11776
    s_waitcnt lgkmcnt(6)
    v_mfma_f32_16x16x32_bf16 v[36:39], v[216:219], v[176:179], v[36:39]
    v_mfma_f32_16x16x32_bf16 v[72:75], v[216:219], v[180:183], v[72:75]
    v_mfma_f32_16x16x32_bf16 v[108:111], v[216:219], v[184:187], v[108:111]
    v_mfma_f32_16x16x32_bf16 v[144:147], v[216:219], v[188:191], v[144:147]
    s_waitcnt lgkmcnt(0)
    s_barrier
    ds_read_b64_tr_b16 v[216:217], v233 offset:20480
    ds_read_b64_tr_b16 v[218:219], v233 offset:22784
    v_mfma_f32_16x16x32_bf16 v[40:43], v[220:223], v[176:179], v[40:43]
    v_mfma_f32_16x16x32_bf16 v[76:79], v[220:223], v[180:183], v[76:79]
    v_mfma_f32_16x16x32_bf16 v[112:115], v[220:223], v[184:187], v[112:115]
    v_mfma_f32_16x16x32_bf16 v[148:151], v[220:223], v[188:191], v[148:151]
    ds_read_b64_tr_b16 v[220:221], v233 offset:20512
    ds_read_b64_tr_b16 v[222:223], v233 offset:22816
    v_mfma_f32_16x16x32_bf16 v[44:47], v[208:211], v[176:179], v[44:47]
    v_mfma_f32_16x16x32_bf16 v[80:83], v[208:211], v[180:183], v[80:83]
    v_mfma_f32_16x16x32_bf16 v[116:119], v[208:211], v[184:187], v[116:119]
    v_mfma_f32_16x16x32_bf16 v[152:155], v[208:211], v[188:191], v[152:155]
    ds_read_b64_tr_b16 v[208:209], v233 offset:20544
    ds_read_b64_tr_b16 v[210:211], v233 offset:22848
    v_mfma_f32_16x16x32_bf16 v[48:51], v[212:215], v[176:179], v[48:51]
    v_mfma_f32_16x16x32_bf16 v[84:87], v[212:215], v[180:183], v[84:87]
    v_mfma_f32_16x16x32_bf16 v[120:123], v[212:215], v[184:187], v[120:123]
    v_mfma_f32_16x16x32_bf16 v[156:159], v[212:215], v[188:191], v[156:159]
    ds_read_b64_tr_b16 v[212:213], v233 offset:20576
    ds_read_b64_tr_b16 v[214:215], v233 offset:22880
    buffer_load_dwordx4 v[176:179], v224, s[8:11], s26 offen
    s_waitcnt vmcnt(7) lgkmcnt(6)
    v_mfma_f32_16x16x32_bf16 v[16:19], v[216:219], v[192:195], v[16:19]
    v_mfma_f32_16x16x32_bf16 v[52:55], v[216:219], v[196:199], v[52:55]
    v_mfma_f32_16x16x32_bf16 v[88:91], v[216:219], v[200:203], v[88:91]
    v_mfma_f32_16x16x32_bf16 v[124:127], v[216:219], v[204:207], v[124:127]
    ds_read_b64_tr_b16 v[216:217], v233 offset:20608
    ds_read_b64_tr_b16 v[218:219], v233 offset:22912
    buffer_load_dwordx4 v[180:183], v225, s[8:11], s26 offen
    s_waitcnt lgkmcnt(6)
    v_mfma_f32_16x16x32_bf16 v[20:23], v[220:223], v[192:195], v[20:23]
    v_mfma_f32_16x16x32_bf16 v[56:59], v[220:223], v[196:199], v[56:59]
    v_mfma_f32_16x16x32_bf16 v[92:95], v[220:223], v[200:203], v[92:95]
    v_mfma_f32_16x16x32_bf16 v[128:131], v[220:223], v[204:207], v[128:131]
    ds_read_b64_tr_b16 v[220:221], v233 offset:20640
    ds_read_b64_tr_b16 v[222:223], v233 offset:22944
    buffer_load_dwordx4 v[184:187], v226, s[8:11], s26 offen
    s_waitcnt lgkmcnt(6)
    v_mfma_f32_16x16x32_bf16 v[24:27], v[208:211], v[192:195], v[24:27]
    v_mfma_f32_16x16x32_bf16 v[60:63], v[208:211], v[196:199], v[60:63]
    v_mfma_f32_16x16x32_bf16 v[96:99], v[208:211], v[200:203], v[96:99]
    v_mfma_f32_16x16x32_bf16 v[132:135], v[208:211], v[204:207], v[132:135]
    ds_read_b64_tr_b16 v[208:209], v233 offset:20672
    ds_read_b64_tr_b16 v[210:211], v233 offset:22976
    buffer_load_dwordx4 v[188:191], v227, s[8:11], s26 offen
    s_add_u32 s26, s26, 1024
    s_waitcnt lgkmcnt(6)
    v_mfma_f32_16x16x32_bf16 v[28:31], v[212:215], v[192:195], v[28:31]
    v_mfma_f32_16x16x32_bf16 v[64:67], v[212:215], v[196:199], v[64:67]
    v_mfma_f32_16x16x32_bf16 v[100:103], v[212:215], v[200:203], v[100:103]
    v_mfma_f32_16x16x32_bf16 v[136:139], v[212:215], v[204:207], v[136:139]
    ds_read_b64_tr_b16 v[212:213], v233 offset:20704
    ds_read_b64_tr_b16 v[214:215], v233 offset:23008
    s_waitcnt lgkmcnt(6)
    v_mfma_f32_16x16x32_bf16 v[32:35], v[216:219], v[192:195], v[32:35]
    v_mfma_f32_16x16x32_bf16 v[68:71], v[216:219], v[196:199], v[68:71]
    v_mfma_f32_16x16x32_bf16 v[104:107], v[216:219], v[200:203], v[104:107]
    v_mfma_f32_16x16x32_bf16 v[140:143], v[216:219], v[204:207], v[140:143]
    ds_read_b64_tr_b16 v[216:217], v233 offset:20736
    ds_read_b64_tr_b16 v[218:219], v233 offset:23040
    s_waitcnt lgkmcnt(6)
    v_mfma_f32_16x16x32_bf16 v[36:39], v[220:223], v[192:195], v[36:39]
    v_mfma_f32_16x16x32_bf16 v[72:75], v[220:223], v[196:199], v[72:75]
    v_mfma_f32_16x16x32_bf16 v[108:111], v[220:223], v[200:203], v[108:111]
    v_mfma_f32_16x16x32_bf16 v[144:147], v[220:223], v[204:207], v[144:147]
    ds_read_b64_tr_b16 v[220:221], v233 offset:29696
    ds_read_b64_tr_b16 v[222:223], v233 offset:32000
    s_waitcnt lgkmcnt(6)
    v_mfma_f32_16x16x32_bf16 v[40:43], v[208:211], v[192:195], v[40:43]
    v_mfma_f32_16x16x32_bf16 v[76:79], v[208:211], v[196:199], v[76:79]
    v_mfma_f32_16x16x32_bf16 v[112:115], v[208:211], v[200:203], v[112:115]
    v_mfma_f32_16x16x32_bf16 v[148:151], v[208:211], v[204:207], v[148:151]
    ds_read_b64_tr_b16 v[208:209], v233 offset:29728
    ds_read_b64_tr_b16 v[210:211], v233 offset:32032
    s_waitcnt lgkmcnt(6)
    v_mfma_f32_16x16x32_bf16 v[44:47], v[212:215], v[192:195], v[44:47]
    v_mfma_f32_16x16x32_bf16 v[80:83], v[212:215], v[196:199], v[80:83]
    v_mfma_f32_16x16x32_bf16 v[116:119], v[212:215], v[200:203], v[116:119]
    v_mfma_f32_16x16x32_bf16 v[152:155], v[212:215], v[204:207], v[152:155]
    ds_read_b64_tr_b16 v[212:213], v233 offset:29760
    ds_read_b64_tr_b16 v[214:215], v233 offset:32064
    s_waitcnt lgkmcnt(6)
    v_mfma_f32_16x16x32_bf16 v[48:51], v[216:219], v[192:195], v[48:51]
    v_mfma_f32_16x16x32_bf16 v[84:87], v[216:219], v[196:199], v[84:87]
    v_mfma_f32_16x16x32_bf16 v[120:123], v[216:219], v[200:203], v[120:123]
    v_mfma_f32_16x16x32_bf16 v[156:159], v[216:219], v[204:207], v[156:159]
    ds_read_b64_tr_b16 v[216:217], v233 offset:29792
    ds_read_b64_tr_b16 v[218:219], v233 offset:32096
    buffer_load_dwordx4 v[192:195], v224, s[8:11], s26 offen
    s_waitcnt vmcnt(5) lgkmcnt(6)
    v_mfma_f32_16x16x32_bf16 v[16:19], v[220:223], v[160:163], v[16:19]
    v_mfma_f32_16x16x32_bf16 v[52:55], v[220:223], v[164:167], v[52:55]
    v_mfma_f32_16x16x32_bf16 v[88:91], v[220:223], v[168:171], v[88:91]
    v_mfma_f32_16x16x32_bf16 v[124:127], v[220:223], v[172:175], v[124:127]
    ds_read_b64_tr_b16 v[220:221], v233 offset:29824
    ds_read_b64_tr_b16 v[222:223], v233 offset:32128
    buffer_load_dwordx4 v[196:199], v225, s[8:11], s26 offen
    s_waitcnt lgkmcnt(6)
    v_mfma_f32_16x16x32_bf16 v[20:23], v[208:211], v[160:163], v[20:23]
    v_mfma_f32_16x16x32_bf16 v[56:59], v[208:211], v[164:167], v[56:59]
    v_mfma_f32_16x16x32_bf16 v[92:95], v[208:211], v[168:171], v[92:95]
    v_mfma_f32_16x16x32_bf16 v[128:131], v[208:211], v[172:175], v[128:131]
    ds_read_b64_tr_b16 v[208:209], v233 offset:29856
    ds_read_b64_tr_b16 v[210:211], v233 offset:32160
    buffer_load_dwordx4 v[200:203], v226, s[8:11], s26 offen
    s_waitcnt lgkmcnt(6)
    v_mfma_f32_16x16x32_bf16 v[24:27], v[212:215], v[160:163], v[24:27]
    v_mfma_f32_16x16x32_bf16 v[60:63], v[212:215], v[164:167], v[60:63]
    v_mfma_f32_16x16x32_bf16 v[96:99], v[212:215], v[168:171], v[96:99]
    v_mfma_f32_16x16x32_bf16 v[132:135], v[212:215], v[172:175], v[132:135]
    ds_read_b64_tr_b16 v[212:213], v233 offset:29888
    ds_read_b64_tr_b16 v[214:215], v233 offset:32192
    buffer_load_dwordx4 v[204:207], v227, s[8:11], s26 offen
    s_add_u32 s26, s26, 1024
    s_waitcnt lgkmcnt(6)
    v_mfma_f32_16x16x32_bf16 v[28:31], v[216:219], v[160:163], v[28:31]
    v_mfma_f32_16x16x32_bf16 v[64:67], v[216:219], v[164:167], v[64:67]
    v_mfma_f32_16x16x32_bf16 v[100:103], v[216:219], v[168:171], v[100:103]
    v_mfma_f32_16x16x32_bf16 v[136:139], v[216:219], v[172:175], v[136:139]
    ds_read_b64_tr_b16 v[216:217], v233 offset:29920
    ds_read_b64_tr_b16 v[218:219], v233 offset:32224
    s_waitcnt lgkmcnt(6)
    v_mfma_f32_16x16x32_bf16 v[32:35], v[220:223], v[160:163], v[32:35]
    v_mfma_f32_16x16x32_bf16 v[68:71], v[220:223], v[164:167], v[68:71]
    v_mfma_f32_16x16x32_bf16 v[104:107], v[220:223], v[168:171], v[104:107]
    v_mfma_f32_16x16x32_bf16 v[140:143], v[220:223], v[172:175], v[140:143]
    ds_read_b64_tr_b16 v[220:221], v233 offset:29952
    ds_read_b64_tr_b16 v[222:223], v233 offset:32256
    s_waitcnt lgkmcnt(6)
    v_mfma_f32_16x16x32_bf16 v[36:39], v[208:211], v[160:163], v[36:39]
    v_mfma_f32_16x16x32_bf16 v[72:75], v[208:211], v[164:167], v[72:75]
    v_mfma_f32_16x16x32_bf16 v[108:111], v[208:211], v[168:171], v[108:111]
    v_mfma_f32_16x16x32_bf16 v[144:147], v[208:211], v[172:175], v[144:147]
    s_waitcnt lgkmcnt(0)
    s_barrier
    ds_read_b64_tr_b16 v[208:209], v233 offset:40960
    ds_read_b64_tr_b16 v[210:211], v233 offset:43264
    v_mfma_f32_16x16x32_bf16 v[40:43], v[212:215], v[160:163], v[40:43]
    v_mfma_f32_16x16x32_bf16 v[76:79], v[212:215], v[164:167], v[76:79]
    v_mfma_f32_16x16x32_bf16 v[112:115], v[212:215], v[168:171], v[112:115]
    v_mfma_f32_16x16x32_bf16 v[148:151], v[212:215], v[172:175], v[148:151]
    ds_read_b64_tr_b16 v[212:213], v233 offset:40992
    ds_read_b64_tr_b16 v[214:215], v233 offset:43296
    v_mfma_f32_16x16x32_bf16 v[44:47], v[216:219], v[160:163], v[44:47]
    v_mfma_f32_16x16x32_bf16 v[80:83], v[216:219], v[164:167], v[80:83]
    v_mfma_f32_16x16x32_bf16 v[116:119], v[216:219], v[168:171], v[116:119]
    v_mfma_f32_16x16x32_bf16 v[152:155], v[216:219], v[172:175], v[152:155]
    ds_read_b64_tr_b16 v[216:217], v233 offset:41024
    ds_read_b64_tr_b16 v[218:219], v233 offset:43328
    v_mfma_f32_16x16x32_bf16 v[48:51], v[220:223], v[160:163], v[48:51]
    v_mfma_f32_16x16x32_bf16 v[84:87], v[220:223], v[164:167], v[84:87]
    v_mfma_f32_16x16x32_bf16 v[120:123], v[220:223], v[168:171], v[120:123]
    v_mfma_f32_16x16x32_bf16 v[156:159], v[220:223], v[172:175], v[156:159]
    ds_read_b64_tr_b16 v[220:221], v233 offset:41056
    ds_read_b64_tr_b16 v[222:223], v233 offset:43360
    s_waitcnt vmcnt(4) lgkmcnt(6)
    v_mfma_f32_16x16x32_bf16 v[16:19], v[208:211], v[176:179], v[16:19]
    v_mfma_f32_16x16x32_bf16 v[52:55], v[208:211], v[180:183], v[52:55]
    v_mfma_f32_16x16x32_bf16 v[88:91], v[208:211], v[184:187], v[88:91]
    v_mfma_f32_16x16x32_bf16 v[124:127], v[208:211], v[188:191], v[124:127]
    ds_read_b64_tr_b16 v[208:209], v233 offset:41088
    ds_read_b64_tr_b16 v[210:211], v233 offset:43392
    s_waitcnt lgkmcnt(6)
    v_mfma_f32_16x16x32_bf16 v[20:23], v[212:215], v[176:179], v[20:23]
    v_mfma_f32_16x16x32_bf16 v[56:59], v[212:215], v[180:183], v[56:59]
    v_mfma_f32_16x16x32_bf16 v[92:95], v[212:215], v[184:187], v[92:95]
    v_mfma_f32_16x16x32_bf16 v[128:131], v[212:215], v[188:191], v[128:131]
    ds_read_b64_tr_b16 v[212:213], v233 offset:41120
    ds_read_b64_tr_b16 v[214:215], v233 offset:43424
    s_waitcnt lgkmcnt(6)
    v_mfma_f32_16x16x32_bf16 v[24:27], v[216:219], v[176:179], v[24:27]
    v_mfma_f32_16x16x32_bf16 v[60:63], v[216:219], v[180:183], v[60:63]
    v_mfma_f32_16x16x32_bf16 v[96:99], v[216:219], v[184:187], v[96:99]
    v_mfma_f32_16x16x32_bf16 v[132:135], v[216:219], v[188:191], v[132:135]
    ds_read_b64_tr_b16 v[216:217], v233 offset:41152
    ds_read_b64_tr_b16 v[218:219], v233 offset:43456
    s_waitcnt lgkmcnt(6)
    v_mfma_f32_16x16x32_bf16 v[28:31], v[220:223], v[176:179], v[28:31]
    v_mfma_f32_16x16x32_bf16 v[64:67], v[220:223], v[180:183], v[64:67]
    v_mfma_f32_16x16x32_bf16 v[100:103], v[220:223], v[184:187], v[100:103]
    v_mfma_f32_16x16x32_bf16 v[136:139], v[220:223], v[188:191], v[136:139]
    ds_read_b64_tr_b16 v[220:221], v233 offset:41184
    ds_read_b64_tr_b16 v[222:223], v233 offset:43488
    s_waitcnt lgkmcnt(6)
    v_mfma_f32_16x16x32_bf16 v[32:35], v[208:211], v[176:179], v[32:35]
    v_mfma_f32_16x16x32_bf16 v[68:71], v[208:211], v[180:183], v[68:71]
    v_mfma_f32_16x16x32_bf16 v[104:107], v[208:211], v[184:187], v[104:107]
    v_mfma_f32_16x16x32_bf16 v[140:143], v[208:211], v[188:191], v[140:143]
    ds_read_b64_tr_b16 v[208:209], v233 offset:41216
    ds_read_b64_tr_b16 v[210:211], v233 offset:43520
    s_waitcnt lgkmcnt(6)
    v_mfma_f32_16x16x32_bf16 v[36:39], v[212:215], v[176:179], v[36:39]
    v_mfma_f32_16x16x32_bf16 v[72:75], v[212:215], v[180:183], v[72:75]
    v_mfma_f32_16x16x32_bf16 v[108:111], v[212:215], v[184:187], v[108:111]
    v_mfma_f32_16x16x32_bf16 v[144:147], v[212:215], v[188:191], v[144:147]
    ds_read_b64_tr_b16 v[212:213], v233 offset:50176
    ds_read_b64_tr_b16 v[214:215], v233 offset:52480
    s_waitcnt lgkmcnt(6)
    v_mfma_f32_16x16x32_bf16 v[40:43], v[216:219], v[176:179], v[40:43]
    v_mfma_f32_16x16x32_bf16 v[76:79], v[216:219], v[180:183], v[76:79]
    v_mfma_f32_16x16x32_bf16 v[112:115], v[216:219], v[184:187], v[112:115]
    v_mfma_f32_16x16x32_bf16 v[148:151], v[216:219], v[188:191], v[148:151]
    ds_read_b64_tr_b16 v[216:217], v233 offset:50208
    ds_read_b64_tr_b16 v[218:219], v233 offset:52512
    s_waitcnt lgkmcnt(6)
    v_mfma_f32_16x16x32_bf16 v[44:47], v[220:223], v[176:179], v[44:47]
    v_mfma_f32_16x16x32_bf16 v[80:83], v[220:223], v[180:183], v[80:83]
    v_mfma_f32_16x16x32_bf16 v[116:119], v[220:223], v[184:187], v[116:119]
    v_mfma_f32_16x16x32_bf16 v[152:155], v[220:223], v[188:191], v[152:155]
    ds_read_b64_tr_b16 v[220:221], v233 offset:50240
    ds_read_b64_tr_b16 v[222:223], v233 offset:52544
    s_waitcnt lgkmcnt(6)
    v_mfma_f32_16x16x32_bf16 v[48:51], v[208:211], v[176:179], v[48:51]
    v_mfma_f32_16x16x32_bf16 v[84:87], v[208:211], v[180:183], v[84:87]
    v_mfma_f32_16x16x32_bf16 v[120:123], v[208:211], v[184:187], v[120:123]
    v_mfma_f32_16x16x32_bf16 v[156:159], v[208:211], v[188:191], v[156:159]
    ds_read_b64_tr_b16 v[208:209], v233 offset:50272
    ds_read_b64_tr_b16 v[210:211], v233 offset:52576
    s_waitcnt vmcnt(0) lgkmcnt(6)
    v_mfma_f32_16x16x32_bf16 v[16:19], v[212:215], v[192:195], v[16:19]
    v_mfma_f32_16x16x32_bf16 v[52:55], v[212:215], v[196:199], v[52:55]
    v_mfma_f32_16x16x32_bf16 v[88:91], v[212:215], v[200:203], v[88:91]
    v_mfma_f32_16x16x32_bf16 v[124:127], v[212:215], v[204:207], v[124:127]
    ds_read_b64_tr_b16 v[212:213], v233 offset:50304
    ds_read_b64_tr_b16 v[214:215], v233 offset:52608
    s_waitcnt lgkmcnt(6)
    v_mfma_f32_16x16x32_bf16 v[20:23], v[216:219], v[192:195], v[20:23]
    v_mfma_f32_16x16x32_bf16 v[56:59], v[216:219], v[196:199], v[56:59]
    v_mfma_f32_16x16x32_bf16 v[92:95], v[216:219], v[200:203], v[92:95]
    v_mfma_f32_16x16x32_bf16 v[128:131], v[216:219], v[204:207], v[128:131]
    ds_read_b64_tr_b16 v[216:217], v233 offset:50336
    ds_read_b64_tr_b16 v[218:219], v233 offset:52640
    s_waitcnt lgkmcnt(6)
    v_mfma_f32_16x16x32_bf16 v[24:27], v[220:223], v[192:195], v[24:27]
    v_mfma_f32_16x16x32_bf16 v[60:63], v[220:223], v[196:199], v[60:63]
    v_mfma_f32_16x16x32_bf16 v[96:99], v[220:223], v[200:203], v[96:99]
    v_mfma_f32_16x16x32_bf16 v[132:135], v[220:223], v[204:207], v[132:135]
    ds_read_b64_tr_b16 v[220:221], v233 offset:50368
    ds_read_b64_tr_b16 v[222:223], v233 offset:52672
    s_waitcnt lgkmcnt(6)
    v_mfma_f32_16x16x32_bf16 v[28:31], v[208:211], v[192:195], v[28:31]
    v_mfma_f32_16x16x32_bf16 v[64:67], v[208:211], v[196:199], v[64:67]
    v_mfma_f32_16x16x32_bf16 v[100:103], v[208:211], v[200:203], v[100:103]
    v_mfma_f32_16x16x32_bf16 v[136:139], v[208:211], v[204:207], v[136:139]
    ds_read_b64_tr_b16 v[208:209], v233 offset:50400
    ds_read_b64_tr_b16 v[210:211], v233 offset:52704
    s_waitcnt lgkmcnt(6)
    v_mfma_f32_16x16x32_bf16 v[32:35], v[212:215], v[192:195], v[32:35]
    v_mfma_f32_16x16x32_bf16 v[68:71], v[212:215], v[196:199], v[68:71]
    v_mfma_f32_16x16x32_bf16 v[104:107], v[212:215], v[200:203], v[104:107]
    v_mfma_f32_16x16x32_bf16 v[140:143], v[212:215], v[204:207], v[140:143]
    ds_read_b64_tr_b16 v[212:213], v233 offset:50432
    ds_read_b64_tr_b16 v[214:215], v233 offset:52736
    s_waitcnt lgkmcnt(6)
    v_mfma_f32_16x16x32_bf16 v[36:39], v[216:219], v[192:195], v[36:39]
    v_mfma_f32_16x16x32_bf16 v[72:75], v[216:219], v[196:199], v[72:75]
    v_mfma_f32_16x16x32_bf16 v[108:111], v[216:219], v[200:203], v[108:111]
    v_mfma_f32_16x16x32_bf16 v[144:147], v[216:219], v[204:207], v[144:147]
    s_waitcnt lgkmcnt(4)
    v_mfma_f32_16x16x32_bf16 v[40:43], v[220:223], v[192:195], v[40:43]
    v_mfma_f32_16x16x32_bf16 v[76:79], v[220:223], v[196:199], v[76:79]
    v_mfma_f32_16x16x32_bf16 v[112:115], v[220:223], v[200:203], v[112:115]
    v_mfma_f32_16x16x32_bf16 v[148:151], v[220:223], v[204:207], v[148:151]
    s_waitcnt lgkmcnt(2)
    v_mfma_f32_16x16x32_bf16 v[44:47], v[208:211], v[192:195], v[44:47]
    v_mfma_f32_16x16x32_bf16 v[80:83], v[208:211], v[196:199], v[80:83]
    v_mfma_f32_16x16x32_bf16 v[116:119], v[208:211], v[200:203], v[116:119]
    v_mfma_f32_16x16x32_bf16 v[152:155], v[208:211], v[204:207], v[152:155]
    s_waitcnt lgkmcnt(0)
    v_mfma_f32_16x16x32_bf16 v[48:51], v[212:215], v[192:195], v[48:51]
    v_mfma_f32_16x16x32_bf16 v[84:87], v[212:215], v[196:199], v[84:87]
    v_mfma_f32_16x16x32_bf16 v[120:123], v[212:215], v[200:203], v[120:123]
    v_mfma_f32_16x16x32_bf16 v[156:159], v[212:215], v[204:207], v[156:159]
    s_nop 7
    s_nop 7
    s_mov_b32 s12, s76
    s_mov_b32 s13, s77
    s_mov_b32 s14, 0x510000
    s_mov_b32 s15, 0x00020000
    s_and_b32 s28, s2, 3
    s_mul_i32 s28, s28, 1327104
    s_bfe_u32 s29, s2, 0x50003
    s_lshl_b32 s29, s29, 2
    s_add_u32 s29, s29, s27
    s_lshl_b32 s29, s29, 10
    s_add_u32 s28, s28, s29
    v_lshlrev_b32 v228, 4, v1
    buffer_load_dwordx4 v[208:211], v228, s[12:15], s28 offen
    s_add_u32 s28, s28, 131072
    buffer_load_dwordx4 v[208:211], v228, s[12:15], s28 offen
    s_add_u32 s28, s28, 131072
    buffer_load_dwordx4 v[208:211], v228, s[12:15], s28 offen
    s_add_u32 s28, s28, 131072
    buffer_load_dwordx4 v[208:211], v228, s[12:15], s28 offen
    s_add_u32 s28, s28, 131072
    buffer_load_dwordx4 v[208:211], v228, s[12:15], s28 offen
    s_add_u32 s28, s28, 131072
    buffer_load_dwordx4 v[208:211], v228, s[12:15], s28 offen
    s_add_u32 s28, s28, 131072
    buffer_load_dwordx4 v[208:211], v228, s[12:15], s28 offen
    s_add_u32 s28, s28, 131072
    buffer_load_dwordx4 v[208:211], v228, s[12:15], s28 offen
    s_add_u32 s28, s28, 131072
    buffer_load_dwordx4 v[208:211], v228, s[12:15], s28 offen
    s_add_u32 s28, s28, 131072
    buffer_load_dwordx4 v[208:211], v228, s[12:15], s28 offen
    s_add_u32 s28, s28, 131072
    buffer_load_dwordx4 v[208:211], v228, s[12:15], s28 offen
    v_mov_b32 v8, 0xbdd2d3e8
    v_mov_b32 v9, 0xbdd2d3e8
    v_mov_b32 v10, 0xc0135761
    v_mov_b32 v11, 0xc0135761
    v_mov_b32 v12, 0x3f800000
    v_mov_b32 v13, 0x3f800000
    s_lshl_b32 s29, s27, 2
    s_add_u32 s28, s3, s29
    s_mul_i32 s28, s28, 147456
    v_lshlrev_b32 v2, 4, v1
    v_add_u32 v2, s28, v2
    v_add_u32 v224, 0, v2
    v_add_u32 v225, 147456, v2
    v_add_u32 v226, 294912, v2
    v_add_u32 v227, 442368, v2
    s_mul_i32 s30, s4, 9
    s_and_b32 s31, s4, 1
    s_cmp_lg_u32 s31, 0
    s_cbranch_scc1 k2_gelu1
    s_add_u32 s31, s30, 0
    s_lshr_b32 s32, s31, 1
    s_lshl_b32 s32, s32, 10
    v_lshlrev_b32 v4, 16, v234
    v_and_b32 v5, 0xffff0000, v234
    v_lshlrev_b32 v6, 16, v235
    v_and_b32 v7, 0xffff0000, v235
    v_lshlrev_b32 v14, 16, v236
    v_and_b32 v15, 0xffff0000, v236
    v_lshlrev_b32 v2, 16, v237
    v_and_b32 v3, 0xffff0000, v237
    v_pk_add_f32 v[16:17], v[16:17], v[4:5]
    v_pk_add_f32 v[18:19], v[18:19], v[6:7]
    v_pk_add_f32 v[20:21], v[20:21], v[14:15]
    v_pk_add_f32 v[22:23], v[22:23], v[2:3]
    v_pk_add_f32 v[52:53], v[52:53], v[4:5]
    v_pk_add_f32 v[54:55], v[54:55], v[6:7]
    v_pk_add_f32 v[56:57], v[56:57], v[14:15]
    v_pk_add_f32 v[58:59], v[58:59], v[2:3]
    v_pk_mul_f32 v[160:161], v[16:17], v[16:17]
    v_pk_mul_f32 v[162:163], v[18:19], v[18:19]
    v_pk_mul_f32 v[164:165], v[20:21], v[20:21]
    v_pk_mul_f32 v[166:167], v[22:23], v[22:23]
    v_pk_mul_f32 v[172:173], v[52:53], v[52:53]
    v_pk_mul_f32 v[174:175], v[54:55], v[54:55]
    v_pk_mul_f32 v[176:177], v[56:57], v[56:57]
    v_pk_mul_f32 v[178:179], v[58:59], v[58:59]
    v_pk_fma_f32 v[160:161], v[160:161], v[8:9], v[10:11]
    v_pk_fma_f32 v[162:163], v[162:163], v[8:9], v[10:11]
    v_pk_fma_f32 v[164:165], v[164:165], v[8:9], v[10:11]
    v_pk_fma_f32 v[166:167], v[166:167], v[8:9], v[10:11]
    v_pk_fma_f32 v[172:173], v[172:173], v[8:9], v[10:11]
    v_pk_fma_f32 v[174:175], v[174:175], v[8:9], v[10:11]
    v_pk_fma_f32 v[176:177], v[176:177], v[8:9], v[10:11]
    v_pk_fma_f32 v[178:179], v[178:179], v[8:9], v[10:11]
    v_pk_mul_f32 v[160:161], v[160:161], v[16:17]
    v_pk_mul_f32 v[162:163], v[162:163], v[18:19]
    v_pk_mul_f32 v[164:165], v[164:165], v[20:21]
    v_pk_mul_f32 v[166:167], v[166:167], v[22:23]
    v_pk_mul_f32 v[172:173], v[172:173], v[52:53]
    v_pk_mul_f32 v[174:175], v[174:175], v[54:55]
    v_pk_mul_f32 v[176:177], v[176:177], v[56:57]
    v_pk_mul_f32 v[178:179], v[178:179], v[58:59]
    v_exp_f32 v160, v160
    v_exp_f32 v161, v161
    v_exp_f32 v162, v162
    v_exp_f32 v163, v163
    v_exp_f32 v164, v164
    v_exp_f32 v165, v165
    v_exp_f32 v166, v166
    v_exp_f32 v167, v167
    v_exp_f32 v172, v172
    v_exp_f32 v173, v173
    v_exp_f32 v174, v174
    v_exp_f32 v175, v175
    v_exp_f32 v176, v176
    v_exp_f32 v177, v177
    v_exp_f32 v178, v178
    v_exp_f32 v179, v179
    v_pk_add_f32 v[160:161], v[160:161], v[12:13]
    v_pk_add_f32 v[162:163], v[162:163], v[12:13]
    v_pk_add_f32 v[164:165], v[164:165], v[12:13]
    v_pk_add_f32 v[166:167], v[166:167], v[12:13]
    v_pk_add_f32 v[172:173], v[172:173], v[12:13]
    v_pk_add_f32 v[174:175], v[174:175], v[12:13]
    v_pk_add_f32 v[176:177], v[176:177], v[12:13]
    v_pk_add_f32 v[178:179], v[178:179], v[12:13]
    v_rcp_f32 v160, v160
    v_rcp_f32 v161, v161
    v_rcp_f32 v162, v162
    v_rcp_f32 v163, v163
    v_rcp_f32 v164, v164
    v_rcp_f32 v165, v165
    v_rcp_f32 v166, v166
    v_rcp_f32 v167, v167
    v_rcp_f32 v172, v172
    v_rcp_f32 v173, v173
    v_rcp_f32 v174, v174
    v_rcp_f32 v175, v175
    v_rcp_f32 v176, v176
    v_rcp_f32 v177, v177
    v_rcp_f32 v178, v178
    v_rcp_f32 v179, v179
    v_pk_mul_f32 v[160:161], v[160:161], v[16:17]
    v_pk_mul_f32 v[162:163], v[162:163], v[18:19]
    v_pk_mul_f32 v[164:165], v[164:165], v[20:21]
    v_pk_mul_f32 v[166:167], v[166:167], v[22:23]
    v_pk_mul_f32 v[172:173], v[172:173], v[52:53]
    v_pk_mul_f32 v[174:175], v[174:175], v[54:55]
    v_pk_mul_f32 v[176:177], v[176:177], v[56:57]
    v_pk_mul_f32 v[178:179], v[178:179], v[58:59]
    v_cvt_pk_bf16_f32 v168, v160, v161
    v_cvt_pk_bf16_f32 v169, v162, v163
    v_cvt_pk_bf16_f32 v170, v164, v165
    v_cvt_pk_bf16_f32 v171, v166, v167
    buffer_store_dwordx4 v[168:171], v224, s[16:19], s32 offen sc1
    v_cvt_pk_bf16_f32 v180, v172, v173
    v_cvt_pk_bf16_f32 v181, v174, v175
    v_cvt_pk_bf16_f32 v182, v176, v177
    v_cvt_pk_bf16_f32 v183, v178, v179
    buffer_store_dwordx4 v[180:183], v225, s[16:19], s32 offen sc1
    v_pk_add_f32 v[88:89], v[88:89], v[4:5]
    v_pk_add_f32 v[90:91], v[90:91], v[6:7]
    v_pk_add_f32 v[92:93], v[92:93], v[14:15]
    v_pk_add_f32 v[94:95], v[94:95], v[2:3]
    v_pk_add_f32 v[124:125], v[124:125], v[4:5]
    v_pk_add_f32 v[126:127], v[126:127], v[6:7]
    v_pk_add_f32 v[128:129], v[128:129], v[14:15]
    v_pk_add_f32 v[130:131], v[130:131], v[2:3]
    v_pk_mul_f32 v[184:185], v[88:89], v[88:89]
    v_pk_mul_f32 v[186:187], v[90:91], v[90:91]
    v_pk_mul_f32 v[188:189], v[92:93], v[92:93]
    v_pk_mul_f32 v[190:191], v[94:95], v[94:95]
    v_pk_mul_f32 v[196:197], v[124:125], v[124:125]
    v_pk_mul_f32 v[198:199], v[126:127], v[126:127]
    v_pk_mul_f32 v[200:201], v[128:129], v[128:129]
    v_pk_mul_f32 v[202:203], v[130:131], v[130:131]
    v_pk_fma_f32 v[184:185], v[184:185], v[8:9], v[10:11]
    v_pk_fma_f32 v[186:187], v[186:187], v[8:9], v[10:11]
    v_pk_fma_f32 v[188:189], v[188:189], v[8:9], v[10:11]
    v_pk_fma_f32 v[190:191], v[190:191], v[8:9], v[10:11]
    v_pk_fma_f32 v[196:197], v[196:197], v[8:9], v[10:11]
    v_pk_fma_f32 v[198:199], v[198:199], v[8:9], v[10:11]
    v_pk_fma_f32 v[200:201], v[200:201], v[8:9], v[10:11]
    v_pk_fma_f32 v[202:203], v[202:203], v[8:9], v[10:11]
    v_pk_mul_f32 v[184:185], v[184:185], v[88:89]
    v_pk_mul_f32 v[186:187], v[186:187], v[90:91]
    v_pk_mul_f32 v[188:189], v[188:189], v[92:93]
    v_pk_mul_f32 v[190:191], v[190:191], v[94:95]
    v_pk_mul_f32 v[196:197], v[196:197], v[124:125]
    v_pk_mul_f32 v[198:199], v[198:199], v[126:127]
    v_pk_mul_f32 v[200:201], v[200:201], v[128:129]
    v_pk_mul_f32 v[202:203], v[202:203], v[130:131]
    v_exp_f32 v184, v184
    v_exp_f32 v185, v185
    v_exp_f32 v186, v186
    v_exp_f32 v187, v187
    v_exp_f32 v188, v188
    v_exp_f32 v189, v189
    v_exp_f32 v190, v190
    v_exp_f32 v191, v191
    v_exp_f32 v196, v196
    v_exp_f32 v197, v197
    v_exp_f32 v198, v198
    v_exp_f32 v199, v199
    v_exp_f32 v200, v200
    v_exp_f32 v201, v201
    v_exp_f32 v202, v202
    v_exp_f32 v203, v203
    v_pk_add_f32 v[184:185], v[184:185], v[12:13]
    v_pk_add_f32 v[186:187], v[186:187], v[12:13]
    v_pk_add_f32 v[188:189], v[188:189], v[12:13]
    v_pk_add_f32 v[190:191], v[190:191], v[12:13]
    v_pk_add_f32 v[196:197], v[196:197], v[12:13]
    v_pk_add_f32 v[198:199], v[198:199], v[12:13]
    v_pk_add_f32 v[200:201], v[200:201], v[12:13]
    v_pk_add_f32 v[202:203], v[202:203], v[12:13]
    v_rcp_f32 v184, v184
    v_rcp_f32 v185, v185
    v_rcp_f32 v186, v186
    v_rcp_f32 v187, v187
    v_rcp_f32 v188, v188
    v_rcp_f32 v189, v189
    v_rcp_f32 v190, v190
    v_rcp_f32 v191, v191
    v_rcp_f32 v196, v196
    v_rcp_f32 v197, v197
    v_rcp_f32 v198, v198
    v_rcp_f32 v199, v199
    v_rcp_f32 v200, v200
    v_rcp_f32 v201, v201
    v_rcp_f32 v202, v202
    v_rcp_f32 v203, v203
    v_pk_mul_f32 v[184:185], v[184:185], v[88:89]
    v_pk_mul_f32 v[186:187], v[186:187], v[90:91]
    v_pk_mul_f32 v[188:189], v[188:189], v[92:93]
    v_pk_mul_f32 v[190:191], v[190:191], v[94:95]
    v_pk_mul_f32 v[196:197], v[196:197], v[124:125]
    v_pk_mul_f32 v[198:199], v[198:199], v[126:127]
    v_pk_mul_f32 v[200:201], v[200:201], v[128:129]
    v_pk_mul_f32 v[202:203], v[202:203], v[130:131]
    v_cvt_pk_bf16_f32 v192, v184, v185
    v_cvt_pk_bf16_f32 v193, v186, v187
    v_cvt_pk_bf16_f32 v194, v188, v189
    v_cvt_pk_bf16_f32 v195, v190, v191
    buffer_store_dwordx4 v[192:195], v226, s[16:19], s32 offen sc1
    v_cvt_pk_bf16_f32 v204, v196, v197
    v_cvt_pk_bf16_f32 v205, v198, v199
    v_cvt_pk_bf16_f32 v206, v200, v201
    v_cvt_pk_bf16_f32 v207, v202, v203
    buffer_store_dwordx4 v[204:207], v227, s[16:19], s32 offen sc1
    s_add_u32 s31, s30, 2
    s_lshr_b32 s32, s31, 1
    s_lshl_b32 s32, s32, 10
    v_lshlrev_b32 v4, 16, v238
    v_and_b32 v5, 0xffff0000, v238
    v_lshlrev_b32 v6, 16, v239
    v_and_b32 v7, 0xffff0000, v239
    v_lshlrev_b32 v14, 16, v240
    v_and_b32 v15, 0xffff0000, v240
    v_lshlrev_b32 v2, 16, v241
    v_and_b32 v3, 0xffff0000, v241
    v_pk_add_f32 v[24:25], v[24:25], v[4:5]
    v_pk_add_f32 v[26:27], v[26:27], v[6:7]
    v_pk_add_f32 v[28:29], v[28:29], v[14:15]
    v_pk_add_f32 v[30:31], v[30:31], v[2:3]
    v_pk_add_f32 v[60:61], v[60:61], v[4:5]
    v_pk_add_f32 v[62:63], v[62:63], v[6:7]
    v_pk_add_f32 v[64:65], v[64:65], v[14:15]
    v_pk_add_f32 v[66:67], v[66:67], v[2:3]
    v_pk_mul_f32 v[160:161], v[24:25], v[24:25]
    v_pk_mul_f32 v[162:163], v[26:27], v[26:27]
    v_pk_mul_f32 v[164:165], v[28:29], v[28:29]
    v_pk_mul_f32 v[166:167], v[30:31], v[30:31]
    v_pk_mul_f32 v[172:173], v[60:61], v[60:61]
    v_pk_mul_f32 v[174:175], v[62:63], v[62:63]
    v_pk_mul_f32 v[176:177], v[64:65], v[64:65]
    v_pk_mul_f32 v[178:179], v[66:67], v[66:67]
    v_pk_fma_f32 v[160:161], v[160:161], v[8:9], v[10:11]
    v_pk_fma_f32 v[162:163], v[162:163], v[8:9], v[10:11]
    v_pk_fma_f32 v[164:165], v[164:165], v[8:9], v[10:11]
    v_pk_fma_f32 v[166:167], v[166:167], v[8:9], v[10:11]
    v_pk_fma_f32 v[172:173], v[172:173], v[8:9], v[10:11]
    v_pk_fma_f32 v[174:175], v[174:175], v[8:9], v[10:11]
    v_pk_fma_f32 v[176:177], v[176:177], v[8:9], v[10:11]
    v_pk_fma_f32 v[178:179], v[178:179], v[8:9], v[10:11]
    v_pk_mul_f32 v[160:161], v[160:161], v[24:25]
    v_pk_mul_f32 v[162:163], v[162:163], v[26:27]
    v_pk_mul_f32 v[164:165], v[164:165], v[28:29]
    v_pk_mul_f32 v[166:167], v[166:167], v[30:31]
    v_pk_mul_f32 v[172:173], v[172:173], v[60:61]
    v_pk_mul_f32 v[174:175], v[174:175], v[62:63]
    v_pk_mul_f32 v[176:177], v[176:177], v[64:65]
    v_pk_mul_f32 v[178:179], v[178:179], v[66:67]
    v_exp_f32 v160, v160
    v_exp_f32 v161, v161
    v_exp_f32 v162, v162
    v_exp_f32 v163, v163
    v_exp_f32 v164, v164
    v_exp_f32 v165, v165
    v_exp_f32 v166, v166
    v_exp_f32 v167, v167
    v_exp_f32 v172, v172
    v_exp_f32 v173, v173
    v_exp_f32 v174, v174
    v_exp_f32 v175, v175
    v_exp_f32 v176, v176
    v_exp_f32 v177, v177
    v_exp_f32 v178, v178
    v_exp_f32 v179, v179
    v_pk_add_f32 v[160:161], v[160:161], v[12:13]
    v_pk_add_f32 v[162:163], v[162:163], v[12:13]
    v_pk_add_f32 v[164:165], v[164:165], v[12:13]
    v_pk_add_f32 v[166:167], v[166:167], v[12:13]
    v_pk_add_f32 v[172:173], v[172:173], v[12:13]
    v_pk_add_f32 v[174:175], v[174:175], v[12:13]
    v_pk_add_f32 v[176:177], v[176:177], v[12:13]
    v_pk_add_f32 v[178:179], v[178:179], v[12:13]
    v_rcp_f32 v160, v160
    v_rcp_f32 v161, v161
    v_rcp_f32 v162, v162
    v_rcp_f32 v163, v163
    v_rcp_f32 v164, v164
    v_rcp_f32 v165, v165
    v_rcp_f32 v166, v166
    v_rcp_f32 v167, v167
    v_rcp_f32 v172, v172
    v_rcp_f32 v173, v173
    v_rcp_f32 v174, v174
    v_rcp_f32 v175, v175
    v_rcp_f32 v176, v176
    v_rcp_f32 v177, v177
    v_rcp_f32 v178, v178
    v_rcp_f32 v179, v179
    v_pk_mul_f32 v[160:161], v[160:161], v[24:25]
    v_pk_mul_f32 v[162:163], v[162:163], v[26:27]
    v_pk_mul_f32 v[164:165], v[164:165], v[28:29]
    v_pk_mul_f32 v[166:167], v[166:167], v[30:31]
    v_pk_mul_f32 v[172:173], v[172:173], v[60:61]
    v_pk_mul_f32 v[174:175], v[174:175], v[62:63]
    v_pk_mul_f32 v[176:177], v[176:177], v[64:65]
    v_pk_mul_f32 v[178:179], v[178:179], v[66:67]
    v_cvt_pk_bf16_f32 v168, v160, v161
    v_cvt_pk_bf16_f32 v169, v162, v163
    v_cvt_pk_bf16_f32 v170, v164, v165
    v_cvt_pk_bf16_f32 v171, v166, v167
    buffer_store_dwordx4 v[168:171], v224, s[16:19], s32 offen sc1
    v_cvt_pk_bf16_f32 v180, v172, v173
    v_cvt_pk_bf16_f32 v181, v174, v175
    v_cvt_pk_bf16_f32 v182, v176, v177
    v_cvt_pk_bf16_f32 v183, v178, v179
    buffer_store_dwordx4 v[180:183], v225, s[16:19], s32 offen sc1
    v_pk_add_f32 v[96:97], v[96:97], v[4:5]
    v_pk_add_f32 v[98:99], v[98:99], v[6:7]
    v_pk_add_f32 v[100:101], v[100:101], v[14:15]
    v_pk_add_f32 v[102:103], v[102:103], v[2:3]
    v_pk_add_f32 v[132:133], v[132:133], v[4:5]
    v_pk_add_f32 v[134:135], v[134:135], v[6:7]
    v_pk_add_f32 v[136:137], v[136:137], v[14:15]
    v_pk_add_f32 v[138:139], v[138:139], v[2:3]
    v_pk_mul_f32 v[184:185], v[96:97], v[96:97]
    v_pk_mul_f32 v[186:187], v[98:99], v[98:99]
    v_pk_mul_f32 v[188:189], v[100:101], v[100:101]
    v_pk_mul_f32 v[190:191], v[102:103], v[102:103]
    v_pk_mul_f32 v[196:197], v[132:133], v[132:133]
    v_pk_mul_f32 v[198:199], v[134:135], v[134:135]
    v_pk_mul_f32 v[200:201], v[136:137], v[136:137]
    v_pk_mul_f32 v[202:203], v[138:139], v[138:139]
    v_pk_fma_f32 v[184:185], v[184:185], v[8:9], v[10:11]
    v_pk_fma_f32 v[186:187], v[186:187], v[8:9], v[10:11]
    v_pk_fma_f32 v[188:189], v[188:189], v[8:9], v[10:11]
    v_pk_fma_f32 v[190:191], v[190:191], v[8:9], v[10:11]
    v_pk_fma_f32 v[196:197], v[196:197], v[8:9], v[10:11]
    v_pk_fma_f32 v[198:199], v[198:199], v[8:9], v[10:11]
    v_pk_fma_f32 v[200:201], v[200:201], v[8:9], v[10:11]
    v_pk_fma_f32 v[202:203], v[202:203], v[8:9], v[10:11]
    v_pk_mul_f32 v[184:185], v[184:185], v[96:97]
    v_pk_mul_f32 v[186:187], v[186:187], v[98:99]
    v_pk_mul_f32 v[188:189], v[188:189], v[100:101]
    v_pk_mul_f32 v[190:191], v[190:191], v[102:103]
    v_pk_mul_f32 v[196:197], v[196:197], v[132:133]
    v_pk_mul_f32 v[198:199], v[198:199], v[134:135]
    v_pk_mul_f32 v[200:201], v[200:201], v[136:137]
    v_pk_mul_f32 v[202:203], v[202:203], v[138:139]
    v_exp_f32 v184, v184
    v_exp_f32 v185, v185
    v_exp_f32 v186, v186
    v_exp_f32 v187, v187
    v_exp_f32 v188, v188
    v_exp_f32 v189, v189
    v_exp_f32 v190, v190
    v_exp_f32 v191, v191
    v_exp_f32 v196, v196
    v_exp_f32 v197, v197
    v_exp_f32 v198, v198
    v_exp_f32 v199, v199
    v_exp_f32 v200, v200
    v_exp_f32 v201, v201
    v_exp_f32 v202, v202
    v_exp_f32 v203, v203
    v_pk_add_f32 v[184:185], v[184:185], v[12:13]
    v_pk_add_f32 v[186:187], v[186:187], v[12:13]
    v_pk_add_f32 v[188:189], v[188:189], v[12:13]
    v_pk_add_f32 v[190:191], v[190:191], v[12:13]
    v_pk_add_f32 v[196:197], v[196:197], v[12:13]
    v_pk_add_f32 v[198:199], v[198:199], v[12:13]
    v_pk_add_f32 v[200:201], v[200:201], v[12:13]
    v_pk_add_f32 v[202:203], v[202:203], v[12:13]
    v_rcp_f32 v184, v184
    v_rcp_f32 v185, v185
    v_rcp_f32 v186, v186
    v_rcp_f32 v187, v187
    v_rcp_f32 v188, v188
    v_rcp_f32 v189, v189
    v_rcp_f32 v190, v190
    v_rcp_f32 v191, v191
    v_rcp_f32 v196, v196
    v_rcp_f32 v197, v197
    v_rcp_f32 v198, v198
    v_rcp_f32 v199, v199
    v_rcp_f32 v200, v200
    v_rcp_f32 v201, v201
    v_rcp_f32 v202, v202
    v_rcp_f32 v203, v203
    v_pk_mul_f32 v[184:185], v[184:185], v[96:97]
    v_pk_mul_f32 v[186:187], v[186:187], v[98:99]
    v_pk_mul_f32 v[188:189], v[188:189], v[100:101]
    v_pk_mul_f32 v[190:191], v[190:191], v[102:103]
    v_pk_mul_f32 v[196:197], v[196:197], v[132:133]
    v_pk_mul_f32 v[198:199], v[198:199], v[134:135]
    v_pk_mul_f32 v[200:201], v[200:201], v[136:137]
    v_pk_mul_f32 v[202:203], v[202:203], v[138:139]
    v_cvt_pk_bf16_f32 v192, v184, v185
    v_cvt_pk_bf16_f32 v193, v186, v187
    v_cvt_pk_bf16_f32 v194, v188, v189
    v_cvt_pk_bf16_f32 v195, v190, v191
    buffer_store_dwordx4 v[192:195], v226, s[16:19], s32 offen sc1
    v_cvt_pk_bf16_f32 v204, v196, v197
    v_cvt_pk_bf16_f32 v205, v198, v199
    v_cvt_pk_bf16_f32 v206, v200, v201
    v_cvt_pk_bf16_f32 v207, v202, v203
    buffer_store_dwordx4 v[204:207], v227, s[16:19], s32 offen sc1
    s_add_u32 s31, s30, 4
    s_lshr_b32 s32, s31, 1
    s_lshl_b32 s32, s32, 10
    v_lshlrev_b32 v4, 16, v242
    v_and_b32 v5, 0xffff0000, v242
    v_lshlrev_b32 v6, 16, v243
    v_and_b32 v7, 0xffff0000, v243
    v_lshlrev_b32 v14, 16, v244
    v_and_b32 v15, 0xffff0000, v244
    v_lshlrev_b32 v2, 16, v245
    v_and_b32 v3, 0xffff0000, v245
    v_pk_add_f32 v[32:33], v[32:33], v[4:5]
    v_pk_add_f32 v[34:35], v[34:35], v[6:7]
    v_pk_add_f32 v[36:37], v[36:37], v[14:15]
    v_pk_add_f32 v[38:39], v[38:39], v[2:3]
    v_pk_add_f32 v[68:69], v[68:69], v[4:5]
    v_pk_add_f32 v[70:71], v[70:71], v[6:7]
    v_pk_add_f32 v[72:73], v[72:73], v[14:15]
    v_pk_add_f32 v[74:75], v[74:75], v[2:3]
    v_pk_mul_f32 v[160:161], v[32:33], v[32:33]
    v_pk_mul_f32 v[162:163], v[34:35], v[34:35]
    v_pk_mul_f32 v[164:165], v[36:37], v[36:37]
    v_pk_mul_f32 v[166:167], v[38:39], v[38:39]
    v_pk_mul_f32 v[172:173], v[68:69], v[68:69]
    v_pk_mul_f32 v[174:175], v[70:71], v[70:71]
    v_pk_mul_f32 v[176:177], v[72:73], v[72:73]
    v_pk_mul_f32 v[178:179], v[74:75], v[74:75]
    v_pk_fma_f32 v[160:161], v[160:161], v[8:9], v[10:11]
    v_pk_fma_f32 v[162:163], v[162:163], v[8:9], v[10:11]
    v_pk_fma_f32 v[164:165], v[164:165], v[8:9], v[10:11]
    v_pk_fma_f32 v[166:167], v[166:167], v[8:9], v[10:11]
    v_pk_fma_f32 v[172:173], v[172:173], v[8:9], v[10:11]
    v_pk_fma_f32 v[174:175], v[174:175], v[8:9], v[10:11]
    v_pk_fma_f32 v[176:177], v[176:177], v[8:9], v[10:11]
    v_pk_fma_f32 v[178:179], v[178:179], v[8:9], v[10:11]
    v_pk_mul_f32 v[160:161], v[160:161], v[32:33]
    v_pk_mul_f32 v[162:163], v[162:163], v[34:35]
    v_pk_mul_f32 v[164:165], v[164:165], v[36:37]
    v_pk_mul_f32 v[166:167], v[166:167], v[38:39]
    v_pk_mul_f32 v[172:173], v[172:173], v[68:69]
    v_pk_mul_f32 v[174:175], v[174:175], v[70:71]
    v_pk_mul_f32 v[176:177], v[176:177], v[72:73]
    v_pk_mul_f32 v[178:179], v[178:179], v[74:75]
    v_exp_f32 v160, v160
    v_exp_f32 v161, v161
    v_exp_f32 v162, v162
    v_exp_f32 v163, v163
    v_exp_f32 v164, v164
    v_exp_f32 v165, v165
    v_exp_f32 v166, v166
    v_exp_f32 v167, v167
    v_exp_f32 v172, v172
    v_exp_f32 v173, v173
    v_exp_f32 v174, v174
    v_exp_f32 v175, v175
    v_exp_f32 v176, v176
    v_exp_f32 v177, v177
    v_exp_f32 v178, v178
    v_exp_f32 v179, v179
    v_pk_add_f32 v[160:161], v[160:161], v[12:13]
    v_pk_add_f32 v[162:163], v[162:163], v[12:13]
    v_pk_add_f32 v[164:165], v[164:165], v[12:13]
    v_pk_add_f32 v[166:167], v[166:167], v[12:13]
    v_pk_add_f32 v[172:173], v[172:173], v[12:13]
    v_pk_add_f32 v[174:175], v[174:175], v[12:13]
    v_pk_add_f32 v[176:177], v[176:177], v[12:13]
    v_pk_add_f32 v[178:179], v[178:179], v[12:13]
    v_rcp_f32 v160, v160
    v_rcp_f32 v161, v161
    v_rcp_f32 v162, v162
    v_rcp_f32 v163, v163
    v_rcp_f32 v164, v164
    v_rcp_f32 v165, v165
    v_rcp_f32 v166, v166
    v_rcp_f32 v167, v167
    v_rcp_f32 v172, v172
    v_rcp_f32 v173, v173
    v_rcp_f32 v174, v174
    v_rcp_f32 v175, v175
    v_rcp_f32 v176, v176
    v_rcp_f32 v177, v177
    v_rcp_f32 v178, v178
    v_rcp_f32 v179, v179
    v_pk_mul_f32 v[160:161], v[160:161], v[32:33]
    v_pk_mul_f32 v[162:163], v[162:163], v[34:35]
    v_pk_mul_f32 v[164:165], v[164:165], v[36:37]
    v_pk_mul_f32 v[166:167], v[166:167], v[38:39]
    v_pk_mul_f32 v[172:173], v[172:173], v[68:69]
    v_pk_mul_f32 v[174:175], v[174:175], v[70:71]
    v_pk_mul_f32 v[176:177], v[176:177], v[72:73]
    v_pk_mul_f32 v[178:179], v[178:179], v[74:75]
    v_cvt_pk_bf16_f32 v168, v160, v161
    v_cvt_pk_bf16_f32 v169, v162, v163
    v_cvt_pk_bf16_f32 v170, v164, v165
    v_cvt_pk_bf16_f32 v171, v166, v167
    buffer_store_dwordx4 v[168:171], v224, s[16:19], s32 offen sc1
    v_cvt_pk_bf16_f32 v180, v172, v173
    v_cvt_pk_bf16_f32 v181, v174, v175
    v_cvt_pk_bf16_f32 v182, v176, v177
    v_cvt_pk_bf16_f32 v183, v178, v179
    buffer_store_dwordx4 v[180:183], v225, s[16:19], s32 offen sc1
    v_pk_add_f32 v[104:105], v[104:105], v[4:5]
    v_pk_add_f32 v[106:107], v[106:107], v[6:7]
    v_pk_add_f32 v[108:109], v[108:109], v[14:15]
    v_pk_add_f32 v[110:111], v[110:111], v[2:3]
    v_pk_add_f32 v[140:141], v[140:141], v[4:5]
    v_pk_add_f32 v[142:143], v[142:143], v[6:7]
    v_pk_add_f32 v[144:145], v[144:145], v[14:15]
    v_pk_add_f32 v[146:147], v[146:147], v[2:3]
    v_pk_mul_f32 v[184:185], v[104:105], v[104:105]
    v_pk_mul_f32 v[186:187], v[106:107], v[106:107]
    v_pk_mul_f32 v[188:189], v[108:109], v[108:109]
    v_pk_mul_f32 v[190:191], v[110:111], v[110:111]
    v_pk_mul_f32 v[196:197], v[140:141], v[140:141]
    v_pk_mul_f32 v[198:199], v[142:143], v[142:143]
    v_pk_mul_f32 v[200:201], v[144:145], v[144:145]
    v_pk_mul_f32 v[202:203], v[146:147], v[146:147]
    v_pk_fma_f32 v[184:185], v[184:185], v[8:9], v[10:11]
    v_pk_fma_f32 v[186:187], v[186:187], v[8:9], v[10:11]
    v_pk_fma_f32 v[188:189], v[188:189], v[8:9], v[10:11]
    v_pk_fma_f32 v[190:191], v[190:191], v[8:9], v[10:11]
    v_pk_fma_f32 v[196:197], v[196:197], v[8:9], v[10:11]
    v_pk_fma_f32 v[198:199], v[198:199], v[8:9], v[10:11]
    v_pk_fma_f32 v[200:201], v[200:201], v[8:9], v[10:11]
    v_pk_fma_f32 v[202:203], v[202:203], v[8:9], v[10:11]
    v_pk_mul_f32 v[184:185], v[184:185], v[104:105]
    v_pk_mul_f32 v[186:187], v[186:187], v[106:107]
    v_pk_mul_f32 v[188:189], v[188:189], v[108:109]
    v_pk_mul_f32 v[190:191], v[190:191], v[110:111]
    v_pk_mul_f32 v[196:197], v[196:197], v[140:141]
    v_pk_mul_f32 v[198:199], v[198:199], v[142:143]
    v_pk_mul_f32 v[200:201], v[200:201], v[144:145]
    v_pk_mul_f32 v[202:203], v[202:203], v[146:147]
    v_exp_f32 v184, v184
    v_exp_f32 v185, v185
    v_exp_f32 v186, v186
    v_exp_f32 v187, v187
    v_exp_f32 v188, v188
    v_exp_f32 v189, v189
    v_exp_f32 v190, v190
    v_exp_f32 v191, v191
    v_exp_f32 v196, v196
    v_exp_f32 v197, v197
    v_exp_f32 v198, v198
    v_exp_f32 v199, v199
    v_exp_f32 v200, v200
    v_exp_f32 v201, v201
    v_exp_f32 v202, v202
    v_exp_f32 v203, v203
    v_pk_add_f32 v[184:185], v[184:185], v[12:13]
    v_pk_add_f32 v[186:187], v[186:187], v[12:13]
    v_pk_add_f32 v[188:189], v[188:189], v[12:13]
    v_pk_add_f32 v[190:191], v[190:191], v[12:13]
    v_pk_add_f32 v[196:197], v[196:197], v[12:13]
    v_pk_add_f32 v[198:199], v[198:199], v[12:13]
    v_pk_add_f32 v[200:201], v[200:201], v[12:13]
    v_pk_add_f32 v[202:203], v[202:203], v[12:13]
    v_rcp_f32 v184, v184
    v_rcp_f32 v185, v185
    v_rcp_f32 v186, v186
    v_rcp_f32 v187, v187
    v_rcp_f32 v188, v188
    v_rcp_f32 v189, v189
    v_rcp_f32 v190, v190
    v_rcp_f32 v191, v191
    v_rcp_f32 v196, v196
    v_rcp_f32 v197, v197
    v_rcp_f32 v198, v198
    v_rcp_f32 v199, v199
    v_rcp_f32 v200, v200
    v_rcp_f32 v201, v201
    v_rcp_f32 v202, v202
    v_rcp_f32 v203, v203
    v_pk_mul_f32 v[184:185], v[184:185], v[104:105]
    v_pk_mul_f32 v[186:187], v[186:187], v[106:107]
    v_pk_mul_f32 v[188:189], v[188:189], v[108:109]
    v_pk_mul_f32 v[190:191], v[190:191], v[110:111]
    v_pk_mul_f32 v[196:197], v[196:197], v[140:141]
    v_pk_mul_f32 v[198:199], v[198:199], v[142:143]
    v_pk_mul_f32 v[200:201], v[200:201], v[144:145]
    v_pk_mul_f32 v[202:203], v[202:203], v[146:147]
    v_cvt_pk_bf16_f32 v192, v184, v185
    v_cvt_pk_bf16_f32 v193, v186, v187
    v_cvt_pk_bf16_f32 v194, v188, v189
    v_cvt_pk_bf16_f32 v195, v190, v191
    buffer_store_dwordx4 v[192:195], v226, s[16:19], s32 offen sc1
    v_cvt_pk_bf16_f32 v204, v196, v197
    v_cvt_pk_bf16_f32 v205, v198, v199
    v_cvt_pk_bf16_f32 v206, v200, v201
    v_cvt_pk_bf16_f32 v207, v202, v203
    buffer_store_dwordx4 v[204:207], v227, s[16:19], s32 offen sc1
    s_add_u32 s31, s30, 6
    s_lshr_b32 s32, s31, 1
    s_lshl_b32 s32, s32, 10
    v_lshlrev_b32 v4, 16, v246
    v_and_b32 v5, 0xffff0000, v246
    v_lshlrev_b32 v6, 16, v247
    v_and_b32 v7, 0xffff0000, v247
    v_lshlrev_b32 v14, 16, v248
    v_and_b32 v15, 0xffff0000, v248
    v_lshlrev_b32 v2, 16, v249
    v_and_b32 v3, 0xffff0000, v249
    v_pk_add_f32 v[40:41], v[40:41], v[4:5]
    v_pk_add_f32 v[42:43], v[42:43], v[6:7]
    v_pk_add_f32 v[44:45], v[44:45], v[14:15]
    v_pk_add_f32 v[46:47], v[46:47], v[2:3]
    v_pk_add_f32 v[76:77], v[76:77], v[4:5]
    v_pk_add_f32 v[78:79], v[78:79], v[6:7]
    v_pk_add_f32 v[80:81], v[80:81], v[14:15]
    v_pk_add_f32 v[82:83], v[82:83], v[2:3]
    v_pk_mul_f32 v[160:161], v[40:41], v[40:41]
    v_pk_mul_f32 v[162:163], v[42:43], v[42:43]
    v_pk_mul_f32 v[164:165], v[44:45], v[44:45]
    v_pk_mul_f32 v[166:167], v[46:47], v[46:47]
    v_pk_mul_f32 v[172:173], v[76:77], v[76:77]
    v_pk_mul_f32 v[174:175], v[78:79], v[78:79]
    v_pk_mul_f32 v[176:177], v[80:81], v[80:81]
    v_pk_mul_f32 v[178:179], v[82:83], v[82:83]
    v_pk_fma_f32 v[160:161], v[160:161], v[8:9], v[10:11]
    v_pk_fma_f32 v[162:163], v[162:163], v[8:9], v[10:11]
    v_pk_fma_f32 v[164:165], v[164:165], v[8:9], v[10:11]
    v_pk_fma_f32 v[166:167], v[166:167], v[8:9], v[10:11]
    v_pk_fma_f32 v[172:173], v[172:173], v[8:9], v[10:11]
    v_pk_fma_f32 v[174:175], v[174:175], v[8:9], v[10:11]
    v_pk_fma_f32 v[176:177], v[176:177], v[8:9], v[10:11]
    v_pk_fma_f32 v[178:179], v[178:179], v[8:9], v[10:11]
    v_pk_mul_f32 v[160:161], v[160:161], v[40:41]
    v_pk_mul_f32 v[162:163], v[162:163], v[42:43]
    v_pk_mul_f32 v[164:165], v[164:165], v[44:45]
    v_pk_mul_f32 v[166:167], v[166:167], v[46:47]
    v_pk_mul_f32 v[172:173], v[172:173], v[76:77]
    v_pk_mul_f32 v[174:175], v[174:175], v[78:79]
    v_pk_mul_f32 v[176:177], v[176:177], v[80:81]
    v_pk_mul_f32 v[178:179], v[178:179], v[82:83]
    v_exp_f32 v160, v160
    v_exp_f32 v161, v161
    v_exp_f32 v162, v162
    v_exp_f32 v163, v163
    v_exp_f32 v164, v164
    v_exp_f32 v165, v165
    v_exp_f32 v166, v166
    v_exp_f32 v167, v167
    v_exp_f32 v172, v172
    v_exp_f32 v173, v173
    v_exp_f32 v174, v174
    v_exp_f32 v175, v175
    v_exp_f32 v176, v176
    v_exp_f32 v177, v177
    v_exp_f32 v178, v178
    v_exp_f32 v179, v179
    v_pk_add_f32 v[160:161], v[160:161], v[12:13]
    v_pk_add_f32 v[162:163], v[162:163], v[12:13]
    v_pk_add_f32 v[164:165], v[164:165], v[12:13]
    v_pk_add_f32 v[166:167], v[166:167], v[12:13]
    v_pk_add_f32 v[172:173], v[172:173], v[12:13]
    v_pk_add_f32 v[174:175], v[174:175], v[12:13]
    v_pk_add_f32 v[176:177], v[176:177], v[12:13]
    v_pk_add_f32 v[178:179], v[178:179], v[12:13]
    v_rcp_f32 v160, v160
    v_rcp_f32 v161, v161
    v_rcp_f32 v162, v162
    v_rcp_f32 v163, v163
    v_rcp_f32 v164, v164
    v_rcp_f32 v165, v165
    v_rcp_f32 v166, v166
    v_rcp_f32 v167, v167
    v_rcp_f32 v172, v172
    v_rcp_f32 v173, v173
    v_rcp_f32 v174, v174
    v_rcp_f32 v175, v175
    v_rcp_f32 v176, v176
    v_rcp_f32 v177, v177
    v_rcp_f32 v178, v178
    v_rcp_f32 v179, v179
    v_pk_mul_f32 v[160:161], v[160:161], v[40:41]
    v_pk_mul_f32 v[162:163], v[162:163], v[42:43]
    v_pk_mul_f32 v[164:165], v[164:165], v[44:45]
    v_pk_mul_f32 v[166:167], v[166:167], v[46:47]
    v_pk_mul_f32 v[172:173], v[172:173], v[76:77]
    v_pk_mul_f32 v[174:175], v[174:175], v[78:79]
    v_pk_mul_f32 v[176:177], v[176:177], v[80:81]
    v_pk_mul_f32 v[178:179], v[178:179], v[82:83]
    v_cvt_pk_bf16_f32 v168, v160, v161
    v_cvt_pk_bf16_f32 v169, v162, v163
    v_cvt_pk_bf16_f32 v170, v164, v165
    v_cvt_pk_bf16_f32 v171, v166, v167
    buffer_store_dwordx4 v[168:171], v224, s[16:19], s32 offen sc1
    v_cvt_pk_bf16_f32 v180, v172, v173
    v_cvt_pk_bf16_f32 v181, v174, v175
    v_cvt_pk_bf16_f32 v182, v176, v177
    v_cvt_pk_bf16_f32 v183, v178, v179
    buffer_store_dwordx4 v[180:183], v225, s[16:19], s32 offen sc1
    v_pk_add_f32 v[112:113], v[112:113], v[4:5]
    v_pk_add_f32 v[114:115], v[114:115], v[6:7]
    v_pk_add_f32 v[116:117], v[116:117], v[14:15]
    v_pk_add_f32 v[118:119], v[118:119], v[2:3]
    v_pk_add_f32 v[148:149], v[148:149], v[4:5]
    v_pk_add_f32 v[150:151], v[150:151], v[6:7]
    v_pk_add_f32 v[152:153], v[152:153], v[14:15]
    v_pk_add_f32 v[154:155], v[154:155], v[2:3]
    v_pk_mul_f32 v[184:185], v[112:113], v[112:113]
    v_pk_mul_f32 v[186:187], v[114:115], v[114:115]
    v_pk_mul_f32 v[188:189], v[116:117], v[116:117]
    v_pk_mul_f32 v[190:191], v[118:119], v[118:119]
    v_pk_mul_f32 v[196:197], v[148:149], v[148:149]
    v_pk_mul_f32 v[198:199], v[150:151], v[150:151]
    v_pk_mul_f32 v[200:201], v[152:153], v[152:153]
    v_pk_mul_f32 v[202:203], v[154:155], v[154:155]
    v_pk_fma_f32 v[184:185], v[184:185], v[8:9], v[10:11]
    v_pk_fma_f32 v[186:187], v[186:187], v[8:9], v[10:11]
    v_pk_fma_f32 v[188:189], v[188:189], v[8:9], v[10:11]
    v_pk_fma_f32 v[190:191], v[190:191], v[8:9], v[10:11]
    v_pk_fma_f32 v[196:197], v[196:197], v[8:9], v[10:11]
    v_pk_fma_f32 v[198:199], v[198:199], v[8:9], v[10:11]
    v_pk_fma_f32 v[200:201], v[200:201], v[8:9], v[10:11]
    v_pk_fma_f32 v[202:203], v[202:203], v[8:9], v[10:11]
    v_pk_mul_f32 v[184:185], v[184:185], v[112:113]
    v_pk_mul_f32 v[186:187], v[186:187], v[114:115]
    v_pk_mul_f32 v[188:189], v[188:189], v[116:117]
    v_pk_mul_f32 v[190:191], v[190:191], v[118:119]
    v_pk_mul_f32 v[196:197], v[196:197], v[148:149]
    v_pk_mul_f32 v[198:199], v[198:199], v[150:151]
    v_pk_mul_f32 v[200:201], v[200:201], v[152:153]
    v_pk_mul_f32 v[202:203], v[202:203], v[154:155]
    v_exp_f32 v184, v184
    v_exp_f32 v185, v185
    v_exp_f32 v186, v186
    v_exp_f32 v187, v187
    v_exp_f32 v188, v188
    v_exp_f32 v189, v189
    v_exp_f32 v190, v190
    v_exp_f32 v191, v191
    v_exp_f32 v196, v196
    v_exp_f32 v197, v197
    v_exp_f32 v198, v198
    v_exp_f32 v199, v199
    v_exp_f32 v200, v200
    v_exp_f32 v201, v201
    v_exp_f32 v202, v202
    v_exp_f32 v203, v203
    v_pk_add_f32 v[184:185], v[184:185], v[12:13]
    v_pk_add_f32 v[186:187], v[186:187], v[12:13]
    v_pk_add_f32 v[188:189], v[188:189], v[12:13]
    v_pk_add_f32 v[190:191], v[190:191], v[12:13]
    v_pk_add_f32 v[196:197], v[196:197], v[12:13]
    v_pk_add_f32 v[198:199], v[198:199], v[12:13]
    v_pk_add_f32 v[200:201], v[200:201], v[12:13]
    v_pk_add_f32 v[202:203], v[202:203], v[12:13]
    v_rcp_f32 v184, v184
    v_rcp_f32 v185, v185
    v_rcp_f32 v186, v186
    v_rcp_f32 v187, v187
    v_rcp_f32 v188, v188
    v_rcp_f32 v189, v189
    v_rcp_f32 v190, v190
    v_rcp_f32 v191, v191
    v_rcp_f32 v196, v196
    v_rcp_f32 v197, v197
    v_rcp_f32 v198, v198
    v_rcp_f32 v199, v199
    v_rcp_f32 v200, v200
    v_rcp_f32 v201, v201
    v_rcp_f32 v202, v202
    v_rcp_f32 v203, v203
    v_pk_mul_f32 v[184:185], v[184:185], v[112:113]
    v_pk_mul_f32 v[186:187], v[186:187], v[114:115]
    v_pk_mul_f32 v[188:189], v[188:189], v[116:117]
    v_pk_mul_f32 v[190:191], v[190:191], v[118:119]
    v_pk_mul_f32 v[196:197], v[196:197], v[148:149]
    v_pk_mul_f32 v[198:199], v[198:199], v[150:151]
    v_pk_mul_f32 v[200:201], v[200:201], v[152:153]
    v_pk_mul_f32 v[202:203], v[202:203], v[154:155]
    v_cvt_pk_bf16_f32 v192, v184, v185
    v_cvt_pk_bf16_f32 v193, v186, v187
    v_cvt_pk_bf16_f32 v194, v188, v189
    v_cvt_pk_bf16_f32 v195, v190, v191
    buffer_store_dwordx4 v[192:195], v226, s[16:19], s32 offen sc1
    v_cvt_pk_bf16_f32 v204, v196, v197
    v_cvt_pk_bf16_f32 v205, v198, v199
    v_cvt_pk_bf16_f32 v206, v200, v201
    v_cvt_pk_bf16_f32 v207, v202, v203
    buffer_store_dwordx4 v[204:207], v227, s[16:19], s32 offen sc1
    s_add_u32 s31, s30, 8
    s_lshr_b32 s32, s31, 1
    s_lshl_b32 s32, s32, 10
    v_lshlrev_b32 v4, 16, v250
    v_and_b32 v5, 0xffff0000, v250
    v_lshlrev_b32 v6, 16, v251
    v_and_b32 v7, 0xffff0000, v251
    v_pk_add_f32 v[48:49], v[48:49], v[4:5]
    v_pk_add_f32 v[50:51], v[50:51], v[6:7]
    v_pk_add_f32 v[84:85], v[84:85], v[4:5]
    v_pk_add_f32 v[86:87], v[86:87], v[6:7]
    v_pk_mul_f32 v[160:161], v[48:49], v[48:49]
    v_pk_mul_f32 v[162:163], v[50:51], v[50:51]
    v_pk_mul_f32 v[172:173], v[84:85], v[84:85]
    v_pk_mul_f32 v[174:175], v[86:87], v[86:87]
    v_pk_fma_f32 v[160:161], v[160:161], v[8:9], v[10:11]
    v_pk_fma_f32 v[162:163], v[162:163], v[8:9], v[10:11]
    v_pk_fma_f32 v[172:173], v[172:173], v[8:9], v[10:11]
    v_pk_fma_f32 v[174:175], v[174:175], v[8:9], v[10:11]
    v_pk_mul_f32 v[160:161], v[160:161], v[48:49]
    v_pk_mul_f32 v[162:163], v[162:163], v[50:51]
    v_pk_mul_f32 v[172:173], v[172:173], v[84:85]
    v_pk_mul_f32 v[174:175], v[174:175], v[86:87]
    v_exp_f32 v160, v160
    v_exp_f32 v161, v161
    v_exp_f32 v162, v162
    v_exp_f32 v163, v163
    v_exp_f32 v172, v172
    v_exp_f32 v173, v173
    v_exp_f32 v174, v174
    v_exp_f32 v175, v175
    v_pk_add_f32 v[160:161], v[160:161], v[12:13]
    v_pk_add_f32 v[162:163], v[162:163], v[12:13]
    v_pk_add_f32 v[172:173], v[172:173], v[12:13]
    v_pk_add_f32 v[174:175], v[174:175], v[12:13]
    v_rcp_f32 v160, v160
    v_rcp_f32 v161, v161
    v_rcp_f32 v162, v162
    v_rcp_f32 v163, v163
    v_rcp_f32 v172, v172
    v_rcp_f32 v173, v173
    v_rcp_f32 v174, v174
    v_rcp_f32 v175, v175
    v_pk_mul_f32 v[160:161], v[160:161], v[48:49]
    v_pk_mul_f32 v[162:163], v[162:163], v[50:51]
    v_pk_mul_f32 v[172:173], v[172:173], v[84:85]
    v_pk_mul_f32 v[174:175], v[174:175], v[86:87]
    v_cvt_pk_bf16_f32 v168, v160, v161
    v_cvt_pk_bf16_f32 v169, v162, v163
    buffer_store_dwordx2 v[168:169], v224, s[16:19], s32 offen sc1
    v_cvt_pk_bf16_f32 v180, v172, v173
    v_cvt_pk_bf16_f32 v181, v174, v175
    buffer_store_dwordx2 v[180:181], v225, s[16:19], s32 offen sc1
    v_pk_add_f32 v[120:121], v[120:121], v[4:5]
    v_pk_add_f32 v[122:123], v[122:123], v[6:7]
    v_pk_add_f32 v[156:157], v[156:157], v[4:5]
    v_pk_add_f32 v[158:159], v[158:159], v[6:7]
    v_pk_mul_f32 v[184:185], v[120:121], v[120:121]
    v_pk_mul_f32 v[186:187], v[122:123], v[122:123]
    v_pk_mul_f32 v[196:197], v[156:157], v[156:157]
    v_pk_mul_f32 v[198:199], v[158:159], v[158:159]
    v_pk_fma_f32 v[184:185], v[184:185], v[8:9], v[10:11]
    v_pk_fma_f32 v[186:187], v[186:187], v[8:9], v[10:11]
    v_pk_fma_f32 v[196:197], v[196:197], v[8:9], v[10:11]
    v_pk_fma_f32 v[198:199], v[198:199], v[8:9], v[10:11]
    v_pk_mul_f32 v[184:185], v[184:185], v[120:121]
    v_pk_mul_f32 v[186:187], v[186:187], v[122:123]
    v_pk_mul_f32 v[196:197], v[196:197], v[156:157]
    v_pk_mul_f32 v[198:199], v[198:199], v[158:159]
    v_exp_f32 v184, v184
    v_exp_f32 v185, v185
    v_exp_f32 v186, v186
    v_exp_f32 v187, v187
    v_exp_f32 v196, v196
    v_exp_f32 v197, v197
    v_exp_f32 v198, v198
    v_exp_f32 v199, v199
    v_pk_add_f32 v[184:185], v[184:185], v[12:13]
    v_pk_add_f32 v[186:187], v[186:187], v[12:13]
    v_pk_add_f32 v[196:197], v[196:197], v[12:13]
    v_pk_add_f32 v[198:199], v[198:199], v[12:13]
    v_rcp_f32 v184, v184
    v_rcp_f32 v185, v185
    v_rcp_f32 v186, v186
    v_rcp_f32 v187, v187
    v_rcp_f32 v196, v196
    v_rcp_f32 v197, v197
    v_rcp_f32 v198, v198
    v_rcp_f32 v199, v199
    v_pk_mul_f32 v[184:185], v[184:185], v[120:121]
    v_pk_mul_f32 v[186:187], v[186:187], v[122:123]
    v_pk_mul_f32 v[196:197], v[196:197], v[156:157]
    v_pk_mul_f32 v[198:199], v[198:199], v[158:159]
    v_cvt_pk_bf16_f32 v192, v184, v185
    v_cvt_pk_bf16_f32 v193, v186, v187
    buffer_store_dwordx2 v[192:193], v226, s[16:19], s32 offen sc1
    v_cvt_pk_bf16_f32 v204, v196, v197
    v_cvt_pk_bf16_f32 v205, v198, v199
    buffer_store_dwordx2 v[204:205], v227, s[16:19], s32 offen sc1
    s_branch k2_gelu_end
k2_gelu1:
    s_add_u32 s31, s30, 0
    s_lshr_b32 s32, s31, 1
    s_lshl_b32 s32, s32, 10
    s_add_u32 s32, s32, 8
    v_lshlrev_b32 v4, 16, v234
    v_and_b32 v5, 0xffff0000, v234
    v_lshlrev_b32 v6, 16, v235
    v_and_b32 v7, 0xffff0000, v235
    v_pk_add_f32 v[16:17], v[16:17], v[4:5]
    v_pk_add_f32 v[18:19], v[18:19], v[6:7]
    v_pk_add_f32 v[52:53], v[52:53], v[4:5]
    v_pk_add_f32 v[54:55], v[54:55], v[6:7]
    v_pk_mul_f32 v[160:161], v[16:17], v[16:17]
    v_pk_mul_f32 v[162:163], v[18:19], v[18:19]
    v_pk_mul_f32 v[172:173], v[52:53], v[52:53]
    v_pk_mul_f32 v[174:175], v[54:55], v[54:55]
    v_pk_fma_f32 v[160:161], v[160:161], v[8:9], v[10:11]
    v_pk_fma_f32 v[162:163], v[162:163], v[8:9], v[10:11]
    v_pk_fma_f32 v[172:173], v[172:173], v[8:9], v[10:11]
    v_pk_fma_f32 v[174:175], v[174:175], v[8:9], v[10:11]
    v_pk_mul_f32 v[160:161], v[160:161], v[16:17]
    v_pk_mul_f32 v[162:163], v[162:163], v[18:19]
    v_pk_mul_f32 v[172:173], v[172:173], v[52:53]
    v_pk_mul_f32 v[174:175], v[174:175], v[54:55]
    v_exp_f32 v160, v160
    v_exp_f32 v161, v161
    v_exp_f32 v162, v162
    v_exp_f32 v163, v163
    v_exp_f32 v172, v172
    v_exp_f32 v173, v173
    v_exp_f32 v174, v174
    v_exp_f32 v175, v175
    v_pk_add_f32 v[160:161], v[160:161], v[12:13]
    v_pk_add_f32 v[162:163], v[162:163], v[12:13]
    v_pk_add_f32 v[172:173], v[172:173], v[12:13]
    v_pk_add_f32 v[174:175], v[174:175], v[12:13]
    v_rcp_f32 v160, v160
    v_rcp_f32 v161, v161
    v_rcp_f32 v162, v162
    v_rcp_f32 v163, v163
    v_rcp_f32 v172, v172
    v_rcp_f32 v173, v173
    v_rcp_f32 v174, v174
    v_rcp_f32 v175, v175
    v_pk_mul_f32 v[160:161], v[160:161], v[16:17]
    v_pk_mul_f32 v[162:163], v[162:163], v[18:19]
    v_pk_mul_f32 v[172:173], v[172:173], v[52:53]
    v_pk_mul_f32 v[174:175], v[174:175], v[54:55]
    v_cvt_pk_bf16_f32 v168, v160, v161
    v_cvt_pk_bf16_f32 v169, v162, v163
    buffer_store_dwordx2 v[168:169], v224, s[16:19], s32 offen sc1
    v_cvt_pk_bf16_f32 v180, v172, v173
    v_cvt_pk_bf16_f32 v181, v174, v175
    buffer_store_dwordx2 v[180:181], v225, s[16:19], s32 offen sc1
    v_pk_add_f32 v[88:89], v[88:89], v[4:5]
    v_pk_add_f32 v[90:91], v[90:91], v[6:7]
    v_pk_add_f32 v[124:125], v[124:125], v[4:5]
    v_pk_add_f32 v[126:127], v[126:127], v[6:7]
    v_pk_mul_f32 v[184:185], v[88:89], v[88:89]
    v_pk_mul_f32 v[186:187], v[90:91], v[90:91]
    v_pk_mul_f32 v[196:197], v[124:125], v[124:125]
    v_pk_mul_f32 v[198:199], v[126:127], v[126:127]
    v_pk_fma_f32 v[184:185], v[184:185], v[8:9], v[10:11]
    v_pk_fma_f32 v[186:187], v[186:187], v[8:9], v[10:11]
    v_pk_fma_f32 v[196:197], v[196:197], v[8:9], v[10:11]
    v_pk_fma_f32 v[198:199], v[198:199], v[8:9], v[10:11]
    v_pk_mul_f32 v[184:185], v[184:185], v[88:89]
    v_pk_mul_f32 v[186:187], v[186:187], v[90:91]
    v_pk_mul_f32 v[196:197], v[196:197], v[124:125]
    v_pk_mul_f32 v[198:199], v[198:199], v[126:127]
    v_exp_f32 v184, v184
    v_exp_f32 v185, v185
    v_exp_f32 v186, v186
    v_exp_f32 v187, v187
    v_exp_f32 v196, v196
    v_exp_f32 v197, v197
    v_exp_f32 v198, v198
    v_exp_f32 v199, v199
    v_pk_add_f32 v[184:185], v[184:185], v[12:13]
    v_pk_add_f32 v[186:187], v[186:187], v[12:13]
    v_pk_add_f32 v[196:197], v[196:197], v[12:13]
    v_pk_add_f32 v[198:199], v[198:199], v[12:13]
    v_rcp_f32 v184, v184
    v_rcp_f32 v185, v185
    v_rcp_f32 v186, v186
    v_rcp_f32 v187, v187
    v_rcp_f32 v196, v196
    v_rcp_f32 v197, v197
    v_rcp_f32 v198, v198
    v_rcp_f32 v199, v199
    v_pk_mul_f32 v[184:185], v[184:185], v[88:89]
    v_pk_mul_f32 v[186:187], v[186:187], v[90:91]
    v_pk_mul_f32 v[196:197], v[196:197], v[124:125]
    v_pk_mul_f32 v[198:199], v[198:199], v[126:127]
    v_cvt_pk_bf16_f32 v192, v184, v185
    v_cvt_pk_bf16_f32 v193, v186, v187
    buffer_store_dwordx2 v[192:193], v226, s[16:19], s32 offen sc1
    v_cvt_pk_bf16_f32 v204, v196, v197
    v_cvt_pk_bf16_f32 v205, v198, v199
    buffer_store_dwordx2 v[204:205], v227, s[16:19], s32 offen sc1
    s_add_u32 s31, s30, 1
    s_lshr_b32 s32, s31, 1
    s_lshl_b32 s32, s32, 10
    v_lshlrev_b32 v4, 16, v236
    v_and_b32 v5, 0xffff0000, v236
    v_lshlrev_b32 v6, 16, v237
    v_and_b32 v7, 0xffff0000, v237
    v_lshlrev_b32 v14, 16, v238
    v_and_b32 v15, 0xffff0000, v238
    v_lshlrev_b32 v2, 16, v239
    v_and_b32 v3, 0xffff0000, v239
    v_pk_add_f32 v[20:21], v[20:21], v[4:5]
    v_pk_add_f32 v[22:23], v[22:23], v[6:7]
    v_pk_add_f32 v[24:25], v[24:25], v[14:15]
    v_pk_add_f32 v[26:27], v[26:27], v[2:3]
    v_pk_add_f32 v[56:57], v[56:57], v[4:5]
    v_pk_add_f32 v[58:59], v[58:59], v[6:7]
    v_pk_add_f32 v[60:61], v[60:61], v[14:15]
    v_pk_add_f32 v[62:63], v[62:63], v[2:3]
    v_pk_mul_f32 v[160:161], v[20:21], v[20:21]
    v_pk_mul_f32 v[162:163], v[22:23], v[22:23]
    v_pk_mul_f32 v[164:165], v[24:25], v[24:25]
    v_pk_mul_f32 v[166:167], v[26:27], v[26:27]
    v_pk_mul_f32 v[172:173], v[56:57], v[56:57]
    v_pk_mul_f32 v[174:175], v[58:59], v[58:59]
    v_pk_mul_f32 v[176:177], v[60:61], v[60:61]
    v_pk_mul_f32 v[178:179], v[62:63], v[62:63]
    v_pk_fma_f32 v[160:161], v[160:161], v[8:9], v[10:11]
    v_pk_fma_f32 v[162:163], v[162:163], v[8:9], v[10:11]
    v_pk_fma_f32 v[164:165], v[164:165], v[8:9], v[10:11]
    v_pk_fma_f32 v[166:167], v[166:167], v[8:9], v[10:11]
    v_pk_fma_f32 v[172:173], v[172:173], v[8:9], v[10:11]
    v_pk_fma_f32 v[174:175], v[174:175], v[8:9], v[10:11]
    v_pk_fma_f32 v[176:177], v[176:177], v[8:9], v[10:11]
    v_pk_fma_f32 v[178:179], v[178:179], v[8:9], v[10:11]
    v_pk_mul_f32 v[160:161], v[160:161], v[20:21]
    v_pk_mul_f32 v[162:163], v[162:163], v[22:23]
    v_pk_mul_f32 v[164:165], v[164:165], v[24:25]
    v_pk_mul_f32 v[166:167], v[166:167], v[26:27]
    v_pk_mul_f32 v[172:173], v[172:173], v[56:57]
    v_pk_mul_f32 v[174:175], v[174:175], v[58:59]
    v_pk_mul_f32 v[176:177], v[176:177], v[60:61]
    v_pk_mul_f32 v[178:179], v[178:179], v[62:63]
    v_exp_f32 v160, v160
    v_exp_f32 v161, v161
    v_exp_f32 v162, v162
    v_exp_f32 v163, v163
    v_exp_f32 v164, v164
    v_exp_f32 v165, v165
    v_exp_f32 v166, v166
    v_exp_f32 v167, v167
    v_exp_f32 v172, v172
    v_exp_f32 v173, v173
    v_exp_f32 v174, v174
    v_exp_f32 v175, v175
    v_exp_f32 v176, v176
    v_exp_f32 v177, v177
    v_exp_f32 v178, v178
    v_exp_f32 v179, v179
    v_pk_add_f32 v[160:161], v[160:161], v[12:13]
    v_pk_add_f32 v[162:163], v[162:163], v[12:13]
    v_pk_add_f32 v[164:165], v[164:165], v[12:13]
    v_pk_add_f32 v[166:167], v[166:167], v[12:13]
    v_pk_add_f32 v[172:173], v[172:173], v[12:13]
    v_pk_add_f32 v[174:175], v[174:175], v[12:13]
    v_pk_add_f32 v[176:177], v[176:177], v[12:13]
    v_pk_add_f32 v[178:179], v[178:179], v[12:13]
    v_rcp_f32 v160, v160
    v_rcp_f32 v161, v161
    v_rcp_f32 v162, v162
    v_rcp_f32 v163, v163
    v_rcp_f32 v164, v164
    v_rcp_f32 v165, v165
    v_rcp_f32 v166, v166
    v_rcp_f32 v167, v167
    v_rcp_f32 v172, v172
    v_rcp_f32 v173, v173
    v_rcp_f32 v174, v174
    v_rcp_f32 v175, v175
    v_rcp_f32 v176, v176
    v_rcp_f32 v177, v177
    v_rcp_f32 v178, v178
    v_rcp_f32 v179, v179
    v_pk_mul_f32 v[160:161], v[160:161], v[20:21]
    v_pk_mul_f32 v[162:163], v[162:163], v[22:23]
    v_pk_mul_f32 v[164:165], v[164:165], v[24:25]
    v_pk_mul_f32 v[166:167], v[166:167], v[26:27]
    v_pk_mul_f32 v[172:173], v[172:173], v[56:57]
    v_pk_mul_f32 v[174:175], v[174:175], v[58:59]
    v_pk_mul_f32 v[176:177], v[176:177], v[60:61]
    v_pk_mul_f32 v[178:179], v[178:179], v[62:63]
    v_cvt_pk_bf16_f32 v168, v160, v161
    v_cvt_pk_bf16_f32 v169, v162, v163
    v_cvt_pk_bf16_f32 v170, v164, v165
    v_cvt_pk_bf16_f32 v171, v166, v167
    buffer_store_dwordx4 v[168:171], v224, s[16:19], s32 offen sc1
    v_cvt_pk_bf16_f32 v180, v172, v173
    v_cvt_pk_bf16_f32 v181, v174, v175
    v_cvt_pk_bf16_f32 v182, v176, v177
    v_cvt_pk_bf16_f32 v183, v178, v179
    buffer_store_dwordx4 v[180:183], v225, s[16:19], s32 offen sc1
    v_pk_add_f32 v[92:93], v[92:93], v[4:5]
    v_pk_add_f32 v[94:95], v[94:95], v[6:7]
    v_pk_add_f32 v[96:97], v[96:97], v[14:15]
    v_pk_add_f32 v[98:99], v[98:99], v[2:3]
    v_pk_add_f32 v[128:129], v[128:129], v[4:5]
    v_pk_add_f32 v[130:131], v[130:131], v[6:7]
    v_pk_add_f32 v[132:133], v[132:133], v[14:15]
    v_pk_add_f32 v[134:135], v[134:135], v[2:3]
    v_pk_mul_f32 v[184:185], v[92:93], v[92:93]
    v_pk_mul_f32 v[186:187], v[94:95], v[94:95]
    v_pk_mul_f32 v[188:189], v[96:97], v[96:97]
    v_pk_mul_f32 v[190:191], v[98:99], v[98:99]
    v_pk_mul_f32 v[196:197], v[128:129], v[128:129]
    v_pk_mul_f32 v[198:199], v[130:131], v[130:131]
    v_pk_mul_f32 v[200:201], v[132:133], v[132:133]
    v_pk_mul_f32 v[202:203], v[134:135], v[134:135]
    v_pk_fma_f32 v[184:185], v[184:185], v[8:9], v[10:11]
    v_pk_fma_f32 v[186:187], v[186:187], v[8:9], v[10:11]
    v_pk_fma_f32 v[188:189], v[188:189], v[8:9], v[10:11]
    v_pk_fma_f32 v[190:191], v[190:191], v[8:9], v[10:11]
    v_pk_fma_f32 v[196:197], v[196:197], v[8:9], v[10:11]
    v_pk_fma_f32 v[198:199], v[198:199], v[8:9], v[10:11]
    v_pk_fma_f32 v[200:201], v[200:201], v[8:9], v[10:11]
    v_pk_fma_f32 v[202:203], v[202:203], v[8:9], v[10:11]
    v_pk_mul_f32 v[184:185], v[184:185], v[92:93]
    v_pk_mul_f32 v[186:187], v[186:187], v[94:95]
    v_pk_mul_f32 v[188:189], v[188:189], v[96:97]
    v_pk_mul_f32 v[190:191], v[190:191], v[98:99]
    v_pk_mul_f32 v[196:197], v[196:197], v[128:129]
    v_pk_mul_f32 v[198:199], v[198:199], v[130:131]
    v_pk_mul_f32 v[200:201], v[200:201], v[132:133]
    v_pk_mul_f32 v[202:203], v[202:203], v[134:135]
    v_exp_f32 v184, v184
    v_exp_f32 v185, v185
    v_exp_f32 v186, v186
    v_exp_f32 v187, v187
    v_exp_f32 v188, v188
    v_exp_f32 v189, v189
    v_exp_f32 v190, v190
    v_exp_f32 v191, v191
    v_exp_f32 v196, v196
    v_exp_f32 v197, v197
    v_exp_f32 v198, v198
    v_exp_f32 v199, v199
    v_exp_f32 v200, v200
    v_exp_f32 v201, v201
    v_exp_f32 v202, v202
    v_exp_f32 v203, v203
    v_pk_add_f32 v[184:185], v[184:185], v[12:13]
    v_pk_add_f32 v[186:187], v[186:187], v[12:13]
    v_pk_add_f32 v[188:189], v[188:189], v[12:13]
    v_pk_add_f32 v[190:191], v[190:191], v[12:13]
    v_pk_add_f32 v[196:197], v[196:197], v[12:13]
    v_pk_add_f32 v[198:199], v[198:199], v[12:13]
    v_pk_add_f32 v[200:201], v[200:201], v[12:13]
    v_pk_add_f32 v[202:203], v[202:203], v[12:13]
    v_rcp_f32 v184, v184
    v_rcp_f32 v185, v185
    v_rcp_f32 v186, v186
    v_rcp_f32 v187, v187
    v_rcp_f32 v188, v188
    v_rcp_f32 v189, v189
    v_rcp_f32 v190, v190
    v_rcp_f32 v191, v191
    v_rcp_f32 v196, v196
    v_rcp_f32 v197, v197
    v_rcp_f32 v198, v198
    v_rcp_f32 v199, v199
    v_rcp_f32 v200, v200
    v_rcp_f32 v201, v201
    v_rcp_f32 v202, v202
    v_rcp_f32 v203, v203
    v_pk_mul_f32 v[184:185], v[184:185], v[92:93]
    v_pk_mul_f32 v[186:187], v[186:187], v[94:95]
    v_pk_mul_f32 v[188:189], v[188:189], v[96:97]
    v_pk_mul_f32 v[190:191], v[190:191], v[98:99]
    v_pk_mul_f32 v[196:197], v[196:197], v[128:129]
    v_pk_mul_f32 v[198:199], v[198:199], v[130:131]
    v_pk_mul_f32 v[200:201], v[200:201], v[132:133]
    v_pk_mul_f32 v[202:203], v[202:203], v[134:135]
    v_cvt_pk_bf16_f32 v192, v184, v185
    v_cvt_pk_bf16_f32 v193, v186, v187
    v_cvt_pk_bf16_f32 v194, v188, v189
    v_cvt_pk_bf16_f32 v195, v190, v191
    buffer_store_dwordx4 v[192:195], v226, s[16:19], s32 offen sc1
    v_cvt_pk_bf16_f32 v204, v196, v197
    v_cvt_pk_bf16_f32 v205, v198, v199
    v_cvt_pk_bf16_f32 v206, v200, v201
    v_cvt_pk_bf16_f32 v207, v202, v203
    buffer_store_dwordx4 v[204:207], v227, s[16:19], s32 offen sc1
    s_add_u32 s31, s30, 3
    s_lshr_b32 s32, s31, 1
    s_lshl_b32 s32, s32, 10
    v_lshlrev_b32 v4, 16, v240
    v_and_b32 v5, 0xffff0000, v240
    v_lshlrev_b32 v6, 16, v241
    v_and_b32 v7, 0xffff0000, v241
    v_lshlrev_b32 v14, 16, v242
    v_and_b32 v15, 0xffff0000, v242
    v_lshlrev_b32 v2, 16, v243
    v_and_b32 v3, 0xffff0000, v243
    v_pk_add_f32 v[28:29], v[28:29], v[4:5]
    v_pk_add_f32 v[30:31], v[30:31], v[6:7]
    v_pk_add_f32 v[32:33], v[32:33], v[14:15]
    v_pk_add_f32 v[34:35], v[34:35], v[2:3]
    v_pk_add_f32 v[64:65], v[64:65], v[4:5]
    v_pk_add_f32 v[66:67], v[66:67], v[6:7]
    v_pk_add_f32 v[68:69], v[68:69], v[14:15]
    v_pk_add_f32 v[70:71], v[70:71], v[2:3]
    v_pk_mul_f32 v[160:161], v[28:29], v[28:29]
    v_pk_mul_f32 v[162:163], v[30:31], v[30:31]
    v_pk_mul_f32 v[164:165], v[32:33], v[32:33]
    v_pk_mul_f32 v[166:167], v[34:35], v[34:35]
    v_pk_mul_f32 v[172:173], v[64:65], v[64:65]
    v_pk_mul_f32 v[174:175], v[66:67], v[66:67]
    v_pk_mul_f32 v[176:177], v[68:69], v[68:69]
    v_pk_mul_f32 v[178:179], v[70:71], v[70:71]
    v_pk_fma_f32 v[160:161], v[160:161], v[8:9], v[10:11]
    v_pk_fma_f32 v[162:163], v[162:163], v[8:9], v[10:11]
    v_pk_fma_f32 v[164:165], v[164:165], v[8:9], v[10:11]
    v_pk_fma_f32 v[166:167], v[166:167], v[8:9], v[10:11]
    v_pk_fma_f32 v[172:173], v[172:173], v[8:9], v[10:11]
    v_pk_fma_f32 v[174:175], v[174:175], v[8:9], v[10:11]
    v_pk_fma_f32 v[176:177], v[176:177], v[8:9], v[10:11]
    v_pk_fma_f32 v[178:179], v[178:179], v[8:9], v[10:11]
    v_pk_mul_f32 v[160:161], v[160:161], v[28:29]
    v_pk_mul_f32 v[162:163], v[162:163], v[30:31]
    v_pk_mul_f32 v[164:165], v[164:165], v[32:33]
    v_pk_mul_f32 v[166:167], v[166:167], v[34:35]
    v_pk_mul_f32 v[172:173], v[172:173], v[64:65]
    v_pk_mul_f32 v[174:175], v[174:175], v[66:67]
    v_pk_mul_f32 v[176:177], v[176:177], v[68:69]
    v_pk_mul_f32 v[178:179], v[178:179], v[70:71]
    v_exp_f32 v160, v160
    v_exp_f32 v161, v161
    v_exp_f32 v162, v162
    v_exp_f32 v163, v163
    v_exp_f32 v164, v164
    v_exp_f32 v165, v165
    v_exp_f32 v166, v166
    v_exp_f32 v167, v167
    v_exp_f32 v172, v172
    v_exp_f32 v173, v173
    v_exp_f32 v174, v174
    v_exp_f32 v175, v175
    v_exp_f32 v176, v176
    v_exp_f32 v177, v177
    v_exp_f32 v178, v178
    v_exp_f32 v179, v179
    v_pk_add_f32 v[160:161], v[160:161], v[12:13]
    v_pk_add_f32 v[162:163], v[162:163], v[12:13]
    v_pk_add_f32 v[164:165], v[164:165], v[12:13]
    v_pk_add_f32 v[166:167], v[166:167], v[12:13]
    v_pk_add_f32 v[172:173], v[172:173], v[12:13]
    v_pk_add_f32 v[174:175], v[174:175], v[12:13]
    v_pk_add_f32 v[176:177], v[176:177], v[12:13]
    v_pk_add_f32 v[178:179], v[178:179], v[12:13]
    v_rcp_f32 v160, v160
    v_rcp_f32 v161, v161
    v_rcp_f32 v162, v162
    v_rcp_f32 v163, v163
    v_rcp_f32 v164, v164
    v_rcp_f32 v165, v165
    v_rcp_f32 v166, v166
    v_rcp_f32 v167, v167
    v_rcp_f32 v172, v172
    v_rcp_f32 v173, v173
    v_rcp_f32 v174, v174
    v_rcp_f32 v175, v175
    v_rcp_f32 v176, v176
    v_rcp_f32 v177, v177
    v_rcp_f32 v178, v178
    v_rcp_f32 v179, v179
    v_pk_mul_f32 v[160:161], v[160:161], v[28:29]
    v_pk_mul_f32 v[162:163], v[162:163], v[30:31]
    v_pk_mul_f32 v[164:165], v[164:165], v[32:33]
    v_pk_mul_f32 v[166:167], v[166:167], v[34:35]
    v_pk_mul_f32 v[172:173], v[172:173], v[64:65]
    v_pk_mul_f32 v[174:175], v[174:175], v[66:67]
    v_pk_mul_f32 v[176:177], v[176:177], v[68:69]
    v_pk_mul_f32 v[178:179], v[178:179], v[70:71]
    v_cvt_pk_bf16_f32 v168, v160, v161
    v_cvt_pk_bf16_f32 v169, v162, v163
    v_cvt_pk_bf16_f32 v170, v164, v165
    v_cvt_pk_bf16_f32 v171, v166, v167
    buffer_store_dwordx4 v[168:171], v224, s[16:19], s32 offen sc1
    v_cvt_pk_bf16_f32 v180, v172, v173
    v_cvt_pk_bf16_f32 v181, v174, v175
    v_cvt_pk_bf16_f32 v182, v176, v177
    v_cvt_pk_bf16_f32 v183, v178, v179
    buffer_store_dwordx4 v[180:183], v225, s[16:19], s32 offen sc1
    v_pk_add_f32 v[100:101], v[100:101], v[4:5]
    v_pk_add_f32 v[102:103], v[102:103], v[6:7]
    v_pk_add_f32 v[104:105], v[104:105], v[14:15]
    v_pk_add_f32 v[106:107], v[106:107], v[2:3]
    v_pk_add_f32 v[136:137], v[136:137], v[4:5]
    v_pk_add_f32 v[138:139], v[138:139], v[6:7]
    v_pk_add_f32 v[140:141], v[140:141], v[14:15]
    v_pk_add_f32 v[142:143], v[142:143], v[2:3]
    v_pk_mul_f32 v[184:185], v[100:101], v[100:101]
    v_pk_mul_f32 v[186:187], v[102:103], v[102:103]
    v_pk_mul_f32 v[188:189], v[104:105], v[104:105]
    v_pk_mul_f32 v[190:191], v[106:107], v[106:107]
    v_pk_mul_f32 v[196:197], v[136:137], v[136:137]
    v_pk_mul_f32 v[198:199], v[138:139], v[138:139]
    v_pk_mul_f32 v[200:201], v[140:141], v[140:141]
    v_pk_mul_f32 v[202:203], v[142:143], v[142:143]
    v_pk_fma_f32 v[184:185], v[184:185], v[8:9], v[10:11]
    v_pk_fma_f32 v[186:187], v[186:187], v[8:9], v[10:11]
    v_pk_fma_f32 v[188:189], v[188:189], v[8:9], v[10:11]
    v_pk_fma_f32 v[190:191], v[190:191], v[8:9], v[10:11]
    v_pk_fma_f32 v[196:197], v[196:197], v[8:9], v[10:11]
    v_pk_fma_f32 v[198:199], v[198:199], v[8:9], v[10:11]
    v_pk_fma_f32 v[200:201], v[200:201], v[8:9], v[10:11]
    v_pk_fma_f32 v[202:203], v[202:203], v[8:9], v[10:11]
    v_pk_mul_f32 v[184:185], v[184:185], v[100:101]
    v_pk_mul_f32 v[186:187], v[186:187], v[102:103]
    v_pk_mul_f32 v[188:189], v[188:189], v[104:105]
    v_pk_mul_f32 v[190:191], v[190:191], v[106:107]
    v_pk_mul_f32 v[196:197], v[196:197], v[136:137]
    v_pk_mul_f32 v[198:199], v[198:199], v[138:139]
    v_pk_mul_f32 v[200:201], v[200:201], v[140:141]
    v_pk_mul_f32 v[202:203], v[202:203], v[142:143]
    v_exp_f32 v184, v184
    v_exp_f32 v185, v185
    v_exp_f32 v186, v186
    v_exp_f32 v187, v187
    v_exp_f32 v188, v188
    v_exp_f32 v189, v189
    v_exp_f32 v190, v190
    v_exp_f32 v191, v191
    v_exp_f32 v196, v196
    v_exp_f32 v197, v197
    v_exp_f32 v198, v198
    v_exp_f32 v199, v199
    v_exp_f32 v200, v200
    v_exp_f32 v201, v201
    v_exp_f32 v202, v202
    v_exp_f32 v203, v203
    v_pk_add_f32 v[184:185], v[184:185], v[12:13]
    v_pk_add_f32 v[186:187], v[186:187], v[12:13]
    v_pk_add_f32 v[188:189], v[188:189], v[12:13]
    v_pk_add_f32 v[190:191], v[190:191], v[12:13]
    v_pk_add_f32 v[196:197], v[196:197], v[12:13]
    v_pk_add_f32 v[198:199], v[198:199], v[12:13]
    v_pk_add_f32 v[200:201], v[200:201], v[12:13]
    v_pk_add_f32 v[202:203], v[202:203], v[12:13]
    v_rcp_f32 v184, v184
    v_rcp_f32 v185, v185
    v_rcp_f32 v186, v186
    v_rcp_f32 v187, v187
    v_rcp_f32 v188, v188
    v_rcp_f32 v189, v189
    v_rcp_f32 v190, v190
    v_rcp_f32 v191, v191
    v_rcp_f32 v196, v196
    v_rcp_f32 v197, v197
    v_rcp_f32 v198, v198
    v_rcp_f32 v199, v199
    v_rcp_f32 v200, v200
    v_rcp_f32 v201, v201
    v_rcp_f32 v202, v202
    v_rcp_f32 v203, v203
    v_pk_mul_f32 v[184:185], v[184:185], v[100:101]
    v_pk_mul_f32 v[186:187], v[186:187], v[102:103]
    v_pk_mul_f32 v[188:189], v[188:189], v[104:105]
    v_pk_mul_f32 v[190:191], v[190:191], v[106:107]
    v_pk_mul_f32 v[196:197], v[196:197], v[136:137]
    v_pk_mul_f32 v[198:199], v[198:199], v[138:139]
    v_pk_mul_f32 v[200:201], v[200:201], v[140:141]
    v_pk_mul_f32 v[202:203], v[202:203], v[142:143]
    v_cvt_pk_bf16_f32 v192, v184, v185
    v_cvt_pk_bf16_f32 v193, v186, v187
    v_cvt_pk_bf16_f32 v194, v188, v189
    v_cvt_pk_bf16_f32 v195, v190, v191
    buffer_store_dwordx4 v[192:195], v226, s[16:19], s32 offen sc1
    v_cvt_pk_bf16_f32 v204, v196, v197
    v_cvt_pk_bf16_f32 v205, v198, v199
    v_cvt_pk_bf16_f32 v206, v200, v201
    v_cvt_pk_bf16_f32 v207, v202, v203
    buffer_store_dwordx4 v[204:207], v227, s[16:19], s32 offen sc1
    s_add_u32 s31, s30, 5
    s_lshr_b32 s32, s31, 1
    s_lshl_b32 s32, s32, 10
    v_lshlrev_b32 v4, 16, v244
    v_and_b32 v5, 0xffff0000, v244
    v_lshlrev_b32 v6, 16, v245
    v_and_b32 v7, 0xffff0000, v245
    v_lshlrev_b32 v14, 16, v246
    v_and_b32 v15, 0xffff0000, v246
    v_lshlrev_b32 v2, 16, v247
    v_and_b32 v3, 0xffff0000, v247
    v_pk_add_f32 v[36:37], v[36:37], v[4:5]
    v_pk_add_f32 v[38:39], v[38:39], v[6:7]
    v_pk_add_f32 v[40:41], v[40:41], v[14:15]
    v_pk_add_f32 v[42:43], v[42:43], v[2:3]
    v_pk_add_f32 v[72:73], v[72:73], v[4:5]
    v_pk_add_f32 v[74:75], v[74:75], v[6:7]
    v_pk_add_f32 v[76:77], v[76:77], v[14:15]
    v_pk_add_f32 v[78:79], v[78:79], v[2:3]
    v_pk_mul_f32 v[160:161], v[36:37], v[36:37]
    v_pk_mul_f32 v[162:163], v[38:39], v[38:39]
    v_pk_mul_f32 v[164:165], v[40:41], v[40:41]
    v_pk_mul_f32 v[166:167], v[42:43], v[42:43]
    v_pk_mul_f32 v[172:173], v[72:73], v[72:73]
    v_pk_mul_f32 v[174:175], v[74:75], v[74:75]
    v_pk_mul_f32 v[176:177], v[76:77], v[76:77]
    v_pk_mul_f32 v[178:179], v[78:79], v[78:79]
    v_pk_fma_f32 v[160:161], v[160:161], v[8:9], v[10:11]
    v_pk_fma_f32 v[162:163], v[162:163], v[8:9], v[10:11]
    v_pk_fma_f32 v[164:165], v[164:165], v[8:9], v[10:11]
    v_pk_fma_f32 v[166:167], v[166:167], v[8:9], v[10:11]
    v_pk_fma_f32 v[172:173], v[172:173], v[8:9], v[10:11]
    v_pk_fma_f32 v[174:175], v[174:175], v[8:9], v[10:11]
    v_pk_fma_f32 v[176:177], v[176:177], v[8:9], v[10:11]
    v_pk_fma_f32 v[178:179], v[178:179], v[8:9], v[10:11]
    v_pk_mul_f32 v[160:161], v[160:161], v[36:37]
    v_pk_mul_f32 v[162:163], v[162:163], v[38:39]
    v_pk_mul_f32 v[164:165], v[164:165], v[40:41]
    v_pk_mul_f32 v[166:167], v[166:167], v[42:43]
    v_pk_mul_f32 v[172:173], v[172:173], v[72:73]
    v_pk_mul_f32 v[174:175], v[174:175], v[74:75]
    v_pk_mul_f32 v[176:177], v[176:177], v[76:77]
    v_pk_mul_f32 v[178:179], v[178:179], v[78:79]
    v_exp_f32 v160, v160
    v_exp_f32 v161, v161
    v_exp_f32 v162, v162
    v_exp_f32 v163, v163
    v_exp_f32 v164, v164
    v_exp_f32 v165, v165
    v_exp_f32 v166, v166
    v_exp_f32 v167, v167
    v_exp_f32 v172, v172
    v_exp_f32 v173, v173
    v_exp_f32 v174, v174
    v_exp_f32 v175, v175
    v_exp_f32 v176, v176
    v_exp_f32 v177, v177
    v_exp_f32 v178, v178
    v_exp_f32 v179, v179
    v_pk_add_f32 v[160:161], v[160:161], v[12:13]
    v_pk_add_f32 v[162:163], v[162:163], v[12:13]
    v_pk_add_f32 v[164:165], v[164:165], v[12:13]
    v_pk_add_f32 v[166:167], v[166:167], v[12:13]
    v_pk_add_f32 v[172:173], v[172:173], v[12:13]
    v_pk_add_f32 v[174:175], v[174:175], v[12:13]
    v_pk_add_f32 v[176:177], v[176:177], v[12:13]
    v_pk_add_f32 v[178:179], v[178:179], v[12:13]
    v_rcp_f32 v160, v160
    v_rcp_f32 v161, v161
    v_rcp_f32 v162, v162
    v_rcp_f32 v163, v163
    v_rcp_f32 v164, v164
    v_rcp_f32 v165, v165
    v_rcp_f32 v166, v166
    v_rcp_f32 v167, v167
    v_rcp_f32 v172, v172
    v_rcp_f32 v173, v173
    v_rcp_f32 v174, v174
    v_rcp_f32 v175, v175
    v_rcp_f32 v176, v176
    v_rcp_f32 v177, v177
    v_rcp_f32 v178, v178
    v_rcp_f32 v179, v179
    v_pk_mul_f32 v[160:161], v[160:161], v[36:37]
    v_pk_mul_f32 v[162:163], v[162:163], v[38:39]
    v_pk_mul_f32 v[164:165], v[164:165], v[40:41]
    v_pk_mul_f32 v[166:167], v[166:167], v[42:43]
    v_pk_mul_f32 v[172:173], v[172:173], v[72:73]
    v_pk_mul_f32 v[174:175], v[174:175], v[74:75]
    v_pk_mul_f32 v[176:177], v[176:177], v[76:77]
    v_pk_mul_f32 v[178:179], v[178:179], v[78:79]
    v_cvt_pk_bf16_f32 v168, v160, v161
    v_cvt_pk_bf16_f32 v169, v162, v163
    v_cvt_pk_bf16_f32 v170, v164, v165
    v_cvt_pk_bf16_f32 v171, v166, v167
    buffer_store_dwordx4 v[168:171], v224, s[16:19], s32 offen sc1
    v_cvt_pk_bf16_f32 v180, v172, v173
    v_cvt_pk_bf16_f32 v181, v174, v175
    v_cvt_pk_bf16_f32 v182, v176, v177
    v_cvt_pk_bf16_f32 v183, v178, v179
    buffer_store_dwordx4 v[180:183], v225, s[16:19], s32 offen sc1
    v_pk_add_f32 v[108:109], v[108:109], v[4:5]
    v_pk_add_f32 v[110:111], v[110:111], v[6:7]
    v_pk_add_f32 v[112:113], v[112:113], v[14:15]
    v_pk_add_f32 v[114:115], v[114:115], v[2:3]
    v_pk_add_f32 v[144:145], v[144:145], v[4:5]
    v_pk_add_f32 v[146:147], v[146:147], v[6:7]
    v_pk_add_f32 v[148:149], v[148:149], v[14:15]
    v_pk_add_f32 v[150:151], v[150:151], v[2:3]
    v_pk_mul_f32 v[184:185], v[108:109], v[108:109]
    v_pk_mul_f32 v[186:187], v[110:111], v[110:111]
    v_pk_mul_f32 v[188:189], v[112:113], v[112:113]
    v_pk_mul_f32 v[190:191], v[114:115], v[114:115]
    v_pk_mul_f32 v[196:197], v[144:145], v[144:145]
    v_pk_mul_f32 v[198:199], v[146:147], v[146:147]
    v_pk_mul_f32 v[200:201], v[148:149], v[148:149]
    v_pk_mul_f32 v[202:203], v[150:151], v[150:151]
    v_pk_fma_f32 v[184:185], v[184:185], v[8:9], v[10:11]
    v_pk_fma_f32 v[186:187], v[186:187], v[8:9], v[10:11]
    v_pk_fma_f32 v[188:189], v[188:189], v[8:9], v[10:11]
    v_pk_fma_f32 v[190:191], v[190:191], v[8:9], v[10:11]
    v_pk_fma_f32 v[196:197], v[196:197], v[8:9], v[10:11]
    v_pk_fma_f32 v[198:199], v[198:199], v[8:9], v[10:11]
    v_pk_fma_f32 v[200:201], v[200:201], v[8:9], v[10:11]
    v_pk_fma_f32 v[202:203], v[202:203], v[8:9], v[10:11]
    v_pk_mul_f32 v[184:185], v[184:185], v[108:109]
    v_pk_mul_f32 v[186:187], v[186:187], v[110:111]
    v_pk_mul_f32 v[188:189], v[188:189], v[112:113]
    v_pk_mul_f32 v[190:191], v[190:191], v[114:115]
    v_pk_mul_f32 v[196:197], v[196:197], v[144:145]
    v_pk_mul_f32 v[198:199], v[198:199], v[146:147]
    v_pk_mul_f32 v[200:201], v[200:201], v[148:149]
    v_pk_mul_f32 v[202:203], v[202:203], v[150:151]
    v_exp_f32 v184, v184
    v_exp_f32 v185, v185
    v_exp_f32 v186, v186
    v_exp_f32 v187, v187
    v_exp_f32 v188, v188
    v_exp_f32 v189, v189
    v_exp_f32 v190, v190
    v_exp_f32 v191, v191
    v_exp_f32 v196, v196
    v_exp_f32 v197, v197
    v_exp_f32 v198, v198
    v_exp_f32 v199, v199
    v_exp_f32 v200, v200
    v_exp_f32 v201, v201
    v_exp_f32 v202, v202
    v_exp_f32 v203, v203
    v_pk_add_f32 v[184:185], v[184:185], v[12:13]
    v_pk_add_f32 v[186:187], v[186:187], v[12:13]
    v_pk_add_f32 v[188:189], v[188:189], v[12:13]
    v_pk_add_f32 v[190:191], v[190:191], v[12:13]
    v_pk_add_f32 v[196:197], v[196:197], v[12:13]
    v_pk_add_f32 v[198:199], v[198:199], v[12:13]
    v_pk_add_f32 v[200:201], v[200:201], v[12:13]
    v_pk_add_f32 v[202:203], v[202:203], v[12:13]
    v_rcp_f32 v184, v184
    v_rcp_f32 v185, v185
    v_rcp_f32 v186, v186
    v_rcp_f32 v187, v187
    v_rcp_f32 v188, v188
    v_rcp_f32 v189, v189
    v_rcp_f32 v190, v190
    v_rcp_f32 v191, v191
    v_rcp_f32 v196, v196
    v_rcp_f32 v197, v197
    v_rcp_f32 v198, v198
    v_rcp_f32 v199, v199
    v_rcp_f32 v200, v200
    v_rcp_f32 v201, v201
    v_rcp_f32 v202, v202
    v_rcp_f32 v203, v203
    v_pk_mul_f32 v[184:185], v[184:185], v[108:109]
    v_pk_mul_f32 v[186:187], v[186:187], v[110:111]
    v_pk_mul_f32 v[188:189], v[188:189], v[112:113]
    v_pk_mul_f32 v[190:191], v[190:191], v[114:115]
    v_pk_mul_f32 v[196:197], v[196:197], v[144:145]
    v_pk_mul_f32 v[198:199], v[198:199], v[146:147]
    v_pk_mul_f32 v[200:201], v[200:201], v[148:149]
    v_pk_mul_f32 v[202:203], v[202:203], v[150:151]
    v_cvt_pk_bf16_f32 v192, v184, v185
    v_cvt_pk_bf16_f32 v193, v186, v187
    v_cvt_pk_bf16_f32 v194, v188, v189
    v_cvt_pk_bf16_f32 v195, v190, v191
    buffer_store_dwordx4 v[192:195], v226, s[16:19], s32 offen sc1
    v_cvt_pk_bf16_f32 v204, v196, v197
    v_cvt_pk_bf16_f32 v205, v198, v199
    v_cvt_pk_bf16_f32 v206, v200, v201
    v_cvt_pk_bf16_f32 v207, v202, v203
    buffer_store_dwordx4 v[204:207], v227, s[16:19], s32 offen sc1
    s_add_u32 s31, s30, 7
    s_lshr_b32 s32, s31, 1
    s_lshl_b32 s32, s32, 10
    v_lshlrev_b32 v4, 16, v248
    v_and_b32 v5, 0xffff0000, v248
    v_lshlrev_b32 v6, 16, v249
    v_and_b32 v7, 0xffff0000, v249
    v_lshlrev_b32 v14, 16, v250
    v_and_b32 v15, 0xffff0000, v250
    v_lshlrev_b32 v2, 16, v251
    v_and_b32 v3, 0xffff0000, v251
    v_pk_add_f32 v[44:45], v[44:45], v[4:5]
    v_pk_add_f32 v[46:47], v[46:47], v[6:7]
    v_pk_add_f32 v[48:49], v[48:49], v[14:15]
    v_pk_add_f32 v[50:51], v[50:51], v[2:3]
    v_pk_add_f32 v[80:81], v[80:81], v[4:5]
    v_pk_add_f32 v[82:83], v[82:83], v[6:7]
    v_pk_add_f32 v[84:85], v[84:85], v[14:15]
    v_pk_add_f32 v[86:87], v[86:87], v[2:3]
    v_pk_mul_f32 v[160:161], v[44:45], v[44:45]
    v_pk_mul_f32 v[162:163], v[46:47], v[46:47]
    v_pk_mul_f32 v[164:165], v[48:49], v[48:49]
    v_pk_mul_f32 v[166:167], v[50:51], v[50:51]
    v_pk_mul_f32 v[172:173], v[80:81], v[80:81]
    v_pk_mul_f32 v[174:175], v[82:83], v[82:83]
    v_pk_mul_f32 v[176:177], v[84:85], v[84:85]
    v_pk_mul_f32 v[178:179], v[86:87], v[86:87]
    v_pk_fma_f32 v[160:161], v[160:161], v[8:9], v[10:11]
    v_pk_fma_f32 v[162:163], v[162:163], v[8:9], v[10:11]
    v_pk_fma_f32 v[164:165], v[164:165], v[8:9], v[10:11]
    v_pk_fma_f32 v[166:167], v[166:167], v[8:9], v[10:11]
    v_pk_fma_f32 v[172:173], v[172:173], v[8:9], v[10:11]
    v_pk_fma_f32 v[174:175], v[174:175], v[8:9], v[10:11]
    v_pk_fma_f32 v[176:177], v[176:177], v[8:9], v[10:11]
    v_pk_fma_f32 v[178:179], v[178:179], v[8:9], v[10:11]
    v_pk_mul_f32 v[160:161], v[160:161], v[44:45]
    v_pk_mul_f32 v[162:163], v[162:163], v[46:47]
    v_pk_mul_f32 v[164:165], v[164:165], v[48:49]
    v_pk_mul_f32 v[166:167], v[166:167], v[50:51]
    v_pk_mul_f32 v[172:173], v[172:173], v[80:81]
    v_pk_mul_f32 v[174:175], v[174:175], v[82:83]
    v_pk_mul_f32 v[176:177], v[176:177], v[84:85]
    v_pk_mul_f32 v[178:179], v[178:179], v[86:87]
    v_exp_f32 v160, v160
    v_exp_f32 v161, v161
    v_exp_f32 v162, v162
    v_exp_f32 v163, v163
    v_exp_f32 v164, v164
    v_exp_f32 v165, v165
    v_exp_f32 v166, v166
    v_exp_f32 v167, v167
    v_exp_f32 v172, v172
    v_exp_f32 v173, v173
    v_exp_f32 v174, v174
    v_exp_f32 v175, v175
    v_exp_f32 v176, v176
    v_exp_f32 v177, v177
    v_exp_f32 v178, v178
    v_exp_f32 v179, v179
    v_pk_add_f32 v[160:161], v[160:161], v[12:13]
    v_pk_add_f32 v[162:163], v[162:163], v[12:13]
    v_pk_add_f32 v[164:165], v[164:165], v[12:13]
    v_pk_add_f32 v[166:167], v[166:167], v[12:13]
    v_pk_add_f32 v[172:173], v[172:173], v[12:13]
    v_pk_add_f32 v[174:175], v[174:175], v[12:13]
    v_pk_add_f32 v[176:177], v[176:177], v[12:13]
    v_pk_add_f32 v[178:179], v[178:179], v[12:13]
    v_rcp_f32 v160, v160
    v_rcp_f32 v161, v161
    v_rcp_f32 v162, v162
    v_rcp_f32 v163, v163
    v_rcp_f32 v164, v164
    v_rcp_f32 v165, v165
    v_rcp_f32 v166, v166
    v_rcp_f32 v167, v167
    v_rcp_f32 v172, v172
    v_rcp_f32 v173, v173
    v_rcp_f32 v174, v174
    v_rcp_f32 v175, v175
    v_rcp_f32 v176, v176
    v_rcp_f32 v177, v177
    v_rcp_f32 v178, v178
    v_rcp_f32 v179, v179
    v_pk_mul_f32 v[160:161], v[160:161], v[44:45]
    v_pk_mul_f32 v[162:163], v[162:163], v[46:47]
    v_pk_mul_f32 v[164:165], v[164:165], v[48:49]
    v_pk_mul_f32 v[166:167], v[166:167], v[50:51]
    v_pk_mul_f32 v[172:173], v[172:173], v[80:81]
    v_pk_mul_f32 v[174:175], v[174:175], v[82:83]
    v_pk_mul_f32 v[176:177], v[176:177], v[84:85]
    v_pk_mul_f32 v[178:179], v[178:179], v[86:87]
    v_cvt_pk_bf16_f32 v168, v160, v161
    v_cvt_pk_bf16_f32 v169, v162, v163
    v_cvt_pk_bf16_f32 v170, v164, v165
    v_cvt_pk_bf16_f32 v171, v166, v167
    buffer_store_dwordx4 v[168:171], v224, s[16:19], s32 offen sc1
    v_cvt_pk_bf16_f32 v180, v172, v173
    v_cvt_pk_bf16_f32 v181, v174, v175
    v_cvt_pk_bf16_f32 v182, v176, v177
    v_cvt_pk_bf16_f32 v183, v178, v179
    buffer_store_dwordx4 v[180:183], v225, s[16:19], s32 offen sc1
    v_pk_add_f32 v[116:117], v[116:117], v[4:5]
    v_pk_add_f32 v[118:119], v[118:119], v[6:7]
    v_pk_add_f32 v[120:121], v[120:121], v[14:15]
    v_pk_add_f32 v[122:123], v[122:123], v[2:3]
    v_pk_add_f32 v[152:153], v[152:153], v[4:5]
    v_pk_add_f32 v[154:155], v[154:155], v[6:7]
    v_pk_add_f32 v[156:157], v[156:157], v[14:15]
    v_pk_add_f32 v[158:159], v[158:159], v[2:3]
    v_pk_mul_f32 v[184:185], v[116:117], v[116:117]
    v_pk_mul_f32 v[186:187], v[118:119], v[118:119]
    v_pk_mul_f32 v[188:189], v[120:121], v[120:121]
    v_pk_mul_f32 v[190:191], v[122:123], v[122:123]
    v_pk_mul_f32 v[196:197], v[152:153], v[152:153]
    v_pk_mul_f32 v[198:199], v[154:155], v[154:155]
    v_pk_mul_f32 v[200:201], v[156:157], v[156:157]
    v_pk_mul_f32 v[202:203], v[158:159], v[158:159]
    v_pk_fma_f32 v[184:185], v[184:185], v[8:9], v[10:11]
    v_pk_fma_f32 v[186:187], v[186:187], v[8:9], v[10:11]
    v_pk_fma_f32 v[188:189], v[188:189], v[8:9], v[10:11]
    v_pk_fma_f32 v[190:191], v[190:191], v[8:9], v[10:11]
    v_pk_fma_f32 v[196:197], v[196:197], v[8:9], v[10:11]
    v_pk_fma_f32 v[198:199], v[198:199], v[8:9], v[10:11]
    v_pk_fma_f32 v[200:201], v[200:201], v[8:9], v[10:11]
    v_pk_fma_f32 v[202:203], v[202:203], v[8:9], v[10:11]
    v_pk_mul_f32 v[184:185], v[184:185], v[116:117]
    v_pk_mul_f32 v[186:187], v[186:187], v[118:119]
    v_pk_mul_f32 v[188:189], v[188:189], v[120:121]
    v_pk_mul_f32 v[190:191], v[190:191], v[122:123]
    v_pk_mul_f32 v[196:197], v[196:197], v[152:153]
    v_pk_mul_f32 v[198:199], v[198:199], v[154:155]
    v_pk_mul_f32 v[200:201], v[200:201], v[156:157]
    v_pk_mul_f32 v[202:203], v[202:203], v[158:159]
    v_exp_f32 v184, v184
    v_exp_f32 v185, v185
    v_exp_f32 v186, v186
    v_exp_f32 v187, v187
    v_exp_f32 v188, v188
    v_exp_f32 v189, v189
    v_exp_f32 v190, v190
    v_exp_f32 v191, v191
    v_exp_f32 v196, v196
    v_exp_f32 v197, v197
    v_exp_f32 v198, v198
    v_exp_f32 v199, v199
    v_exp_f32 v200, v200
    v_exp_f32 v201, v201
    v_exp_f32 v202, v202
    v_exp_f32 v203, v203
    v_pk_add_f32 v[184:185], v[184:185], v[12:13]
    v_pk_add_f32 v[186:187], v[186:187], v[12:13]
    v_pk_add_f32 v[188:189], v[188:189], v[12:13]
    v_pk_add_f32 v[190:191], v[190:191], v[12:13]
    v_pk_add_f32 v[196:197], v[196:197], v[12:13]
    v_pk_add_f32 v[198:199], v[198:199], v[12:13]
    v_pk_add_f32 v[200:201], v[200:201], v[12:13]
    v_pk_add_f32 v[202:203], v[202:203], v[12:13]
    v_rcp_f32 v184, v184
    v_rcp_f32 v185, v185
    v_rcp_f32 v186, v186
    v_rcp_f32 v187, v187
    v_rcp_f32 v188, v188
    v_rcp_f32 v189, v189
    v_rcp_f32 v190, v190
    v_rcp_f32 v191, v191
    v_rcp_f32 v196, v196
    v_rcp_f32 v197, v197
    v_rcp_f32 v198, v198
    v_rcp_f32 v199, v199
    v_rcp_f32 v200, v200
    v_rcp_f32 v201, v201
    v_rcp_f32 v202, v202
    v_rcp_f32 v203, v203
    v_pk_mul_f32 v[184:185], v[184:185], v[116:117]
    v_pk_mul_f32 v[186:187], v[186:187], v[118:119]
    v_pk_mul_f32 v[188:189], v[188:189], v[120:121]
    v_pk_mul_f32 v[190:191], v[190:191], v[122:123]
    v_pk_mul_f32 v[196:197], v[196:197], v[152:153]
    v_pk_mul_f32 v[198:199], v[198:199], v[154:155]
    v_pk_mul_f32 v[200:201], v[200:201], v[156:157]
    v_pk_mul_f32 v[202:203], v[202:203], v[158:159]
    v_cvt_pk_bf16_f32 v192, v184, v185
    v_cvt_pk_bf16_f32 v193, v186, v187
    v_cvt_pk_bf16_f32 v194, v188, v189
    v_cvt_pk_bf16_f32 v195, v190, v191
    buffer_store_dwordx4 v[192:195], v226, s[16:19], s32 offen sc1
    v_cvt_pk_bf16_f32 v204, v196, v197
    v_cvt_pk_bf16_f32 v205, v198, v199
    v_cvt_pk_bf16_f32 v206, v200, v201
    v_cvt_pk_bf16_f32 v207, v202, v203
    buffer_store_dwordx4 v[204:207], v227, s[16:19], s32 offen sc1
k2_gelu_end:
    s_lshr_b32 s3, s3, 4
    s_lshl_b32 s3, s3, 5
    s_add_u32 s3, s3, s4
    s_waitcnt vmcnt(0)
    s_barrier
    s_cmp_lg_u32 s27, 0
    s_cbranch_scc1 k2_pb_2
    s_mov_b32 s96, s84
    s_mov_b32 s97, s85
    s_mov_b32 s98, 0x100
    s_mov_b32 s99, 0x00020000
    v_mov_b32 v3, 0
    s_mov_b32 s101, 262144
k2_ng_3:
    buffer_load_dword v2, v3, s[96:99], 0 offen sc1
    s_waitcnt vmcnt(0)
    v_readfirstlane_b32 s100, v2
    s_cmp_lg_u32 s100, 0
    s_cbranch_scc1 k2_ngd_4
    s_sub_u32 s101, s101, 1
    s_cbranch_scc1 k2_ngd_4
    s_sleep 1
    s_branch k2_ng_3
k2_ngd_4:
    s_add_u32 s96, s86, 0x300000
    s_addc_u32 s97, s87, 0
    s_mov_b32 s98, 0x10000
    s_mov_b32 s99, 0x00020000
    s_lshl_b32 s28, s3, 2
    s_add_u32 s28, s28, 0
    v_mov_b32 v3, s28
    v_mov_b32 v2, s100
    s_mov_b64 exec, 1
    buffer_store_dword v2, v3, s[96:99], 0 offen sc1
    s_mov_b64 exec, -1
k2_pb_2:
    s_and_b32 s5, s2, 3
    s_bfe_u32 s3, s2, 0x10002
    s_lshl_b32 s3, s3, 3
    s_bfe_u32 s4, s2, 0x30005
    s_add_u32 s3, s3, s4
    s_lshl_b32 s3, s3, 3
    s_bfe_u32 s4, s2, 0x20003
    s_lshr_b32 s6, s27, 1
    s_and_b32 s7, s27, 1
    s_lshl_b32 s28, s5, 1
    s_add_u32 s28, s28, s6
    s_add_u32 s8, s86, 0x1000000
    s_addc_u32 s9, s87, 0
    s_mov_b32 s10, 0x1200000
    s_mov_b32 s11, 0x00020000
    s_mov_b32 s12, s76
    s_mov_b32 s13, s77
    s_mov_b32 s14, 0x510000
    s_mov_b32 s15, 0x00020000
    s_mul_i32 s25, s28, 663552
    s_mul_i32 s29, s4, 288
    s_add_u32 s25, s25, s29
    s_mul_i32 s26, s28, 18432
    s_lshl_b32 s28, s7, 2
    s_add_u32 s3, s3, s28
    s_mul_i32 s28, s3, 147456
    v_lshlrev_b32 v2, 4, v1
    v_add_u32 v2, s28, v2
    v_add_u32 v224, 0, v2
    v_add_u32 v225, 147456, v2
    v_add_u32 v226, 294912, v2
    v_add_u32 v227, 442368, v2
    s_and_b32 s28, s27, 1
    s_lshr_b32 s31, s27, 1
    s_mul_i32 s31, s31, 36864
    s_mul_i32 s24, s28, 4096
    s_add_u32 s24, s24, s31
    s_mul_i32 s28, s28, 256
    s_add_u32 s29, s28, 0
    v_add_u32 v2, s29, v1
    v_mul_u32_u24 v3, 3641, v2
    v_lshrrev_b32 v3, 16, v3
    v_mul_u32_u24 v4, 18, v3
    v_sub_u32 v4, v2, v4
    v_lshlrev_b32 v4, 4, v4
    v_mul_u32_u24 v3, 1152, v3
    v_add_u32 v3, v3, v4
    v_mov_b32 v228, v3
    s_add_u32 s29, s28, 64
    v_add_u32 v2, s29, v1
    v_mul_u32_u24 v3, 3641, v2
    v_lshrrev_b32 v3, 16, v3
    v_mul_u32_u24 v4, 18, v3
    v_sub_u32 v4, v2, v4
    v_lshlrev_b32 v4, 4, v4
    v_mul_u32_u24 v3, 1152, v3
    v_add_u32 v3, v3, v4
    v_subrev_u32 v229, 1024, v3
    s_add_u32 s29, s28, 128
    v_add_u32 v2, s29, v1
    v_mul_u32_u24 v3, 3641, v2
    v_lshrrev_b32 v3, 16, v3
    v_mul_u32_u24 v4, 18, v3
    v_sub_u32 v4, v2, v4
    v_lshlrev_b32 v4, 4, v4
    v_mul_u32_u24 v3, 1152, v3
    v_add_u32 v3, v3, v4
    v_subrev_u32 v230, 2048, v3
    s_add_u32 s29, s28, 192
    v_add_u32 v2, s29, v1
    v_mul_u32_u24 v3, 3641, v2
    v_lshrrev_b32 v3, 16, v3
    v_mul_u32_u24 v4, 18, v3
    v_sub_u32 v4, v2, v4
    v_lshlrev_b32 v4, 4, v4
    v_mul_u32_u24 v3, 1152, v3
    v_add_u32 v3, v3, v4
    v_subrev_u32 v231, 3072, v3
    s_add_u32 s29, s28, 256
    v_add_u32 v2, s29, v1
    v_mul_u32_u24 v3, 3641, v2
    v_lshrrev_b32 v3, 16, v3
    v_mul_u32_u24 v4, 18, v3
    v_sub_u32 v4, v2, v4
    v_lshlrev_b32 v4, 4, v4
    v_mul_u32_u24 v3, 1152, v3
    v_add_u32 v3, v3, v4
    v_mov_b32 v232, v3
    v_lshrrev_b32 v2, 4, v1
    v_and_b32 v3, 15, v1
    v_lshrrev_b32 v4, 2, v3
    v_lshlrev_b32 v5, 2, v2
    v_add_u32 v4, v4, v5
    v_mul_u32_u24 v4, 288, v4
    v_and_b32 v3, 3, v3
    v_lshlrev_b32 v3, 3, v3
    v_add_u32 v233, v4, v3
    v_add_u32 v233, s31, v233
    s_lshr_b32 s39, s3, 4
    s_lshl_b32 s39, s39, 5
    s_lshl_b32 s28, s5, 3
    s_add_u32 s39, s39, s28
    s_add_u32 m0, s24, 0
    s_nop 0
    buffer_load_dwordx4 v228, s[12:15], s25 offen offset:0 lds
    s_add_u32 m0, s24, 0
    s_nop 0
    buffer_load_dwordx4 v229, s[12:15], s25 offen offset:1024 lds
    s_add_u32 m0, s24, 0
    s_nop 0
    buffer_load_dwordx4 v230, s[12:15], s25 offen offset:2048 lds
    s_add_u32 m0, s24, 0
    s_nop 0
    buffer_load_dwordx4 v231, s[12:15], s25 offen offset:3072 lds
    s_add_u32 m0, s24, 4096
    s_nop 0
    buffer_load_dwordx4 v232, s[12:15], s25 offen offset:0 lds
    s_add_u32 s25, s25, 36864
    s_add_u32 m0, s24, 9216
    s_nop 0
    buffer_load_dwordx4 v228, s[12:15], s25 offen offset:0 lds
    s_add_u32 m0, s24, 9216
    s_nop 0
    buffer_load_dwordx4 v229, s[12:15], s25 offen offset:1024 lds
    s_add_u32 m0, s24, 9216
    s_nop 0
    buffer_load_dwordx4 v230, s[12:15], s25 offen offset:2048 lds
    s_add_u32 m0, s24, 9216
    s_nop 0
    buffer_load_dwordx4 v231, s[12:15], s25 offen offset:3072 lds
    s_add_u32 m0, s24, 13312
    s_nop 0
    buffer_load_dwordx4 v232, s[12:15], s25 offen offset:0 lds
    s_add_u32 s25, s25, 36864
    s_add_u32 m0, s24, 18432
    s_nop 0
    buffer_load_dwordx4 v228, s[12:15], s25 offen offset:0 lds
    s_add_u32 m0, s24, 18432
    s_nop 0
    buffer_load_dwordx4 v229, s[12:15], s25 offen offset:1024 lds
    s_add_u32 m0, s24, 18432
    s_nop 0
    buffer_load_dwordx4 v230, s[12:15], s25 offen offset:2048 lds
    s_add_u32 m0, s24, 18432
    s_nop 0
    buffer_load_dwordx4 v231, s[12:15], s25 offen offset:3072 lds
    s_add_u32 m0, s24, 22528
    s_nop 0
    buffer_load_dwordx4 v232, s[12:15], s25 offen offset:0 lds
    s_add_u32 s25, s25, 36864
    s_add_u32 m0, s24, 27648
    s_nop 0
    buffer_load_dwordx4 v228, s[12:15], s25 offen offset:0 lds
    s_add_u32 m0, s24, 27648
    s_nop 0
    buffer_load_dwordx4 v229, s[12:15], s25 offen offset:1024 lds
    s_add_u32 m0, s24, 27648
    s_nop 0
    buffer_load_dwordx4 v230, s[12:15], s25 offen offset:2048 lds
    s_add_u32 m0, s24, 27648
    s_nop 0
    buffer_load_dwordx4 v231, s[12:15], s25 offen offset:3072 lds
    s_add_u32 m0, s24, 31744
    s_nop 0
    buffer_load_dwordx4 v232, s[12:15], s25 offen offset:0 lds
    s_add_u32 s25, s25, 36864
    s_cmp_lg_u32 s27, 0
    s_cbranch_scc1 k2_aw_5
    s_lshl_b32 s28, s39, 2
    s_add_u32 s28, s28, 0
    v_lshlrev_b32 v3, 2, v1
    v_add_u32 v3, s28, v3
    s_mov_b32 s28, 255
    s_mov_b32 s29, 0
    s_mov_b64 exec, s[28:29]
    s_mov_b32 s101, 262144
k2_awl_6:
    buffer_load_dword v2, v3, s[96:99], 0 offen sc1
    s_waitcnt vmcnt(0)
    v_cmp_ne_u32 vcc, s100, v2
    s_cbranch_vccz k2_awd_7
    s_sub_u32 s101, s101, 1
    s_cbranch_scc1 k2_awd_7
    s_sleep 1
    s_branch k2_awl_6
k2_awd_7:
    s_mov_b64 exec, -1
k2_aw_5:
    s_barrier
    buffer_load_dwordx4 v[160:163], v224, s[8:11], s26 offen sc1
    buffer_load_dwordx4 v[164:167], v225, s[8:11], s26 offen sc1
    buffer_load_dwordx4 v[168:171], v226, s[8:11], s26 offen sc1
    buffer_load_dwordx4 v[172:175], v227, s[8:11], s26 offen sc1
    s_add_u32 s26, s26, 1024
    buffer_load_dwordx4 v[176:179], v224, s[8:11], s26 offen sc1
    buffer_load_dwordx4 v[180:183], v225, s[8:11], s26 offen sc1
    buffer_load_dwordx4 v[184:187], v226, s[8:11], s26 offen sc1
    buffer_load_dwordx4 v[188:191], v227, s[8:11], s26 offen sc1
    s_add_u32 s26, s26, 1024
    v_mov_b32 v16, 0
    v_mov_b32 v17, 0
    v_mov_b32 v18, 0
    v_mov_b32 v19, 0
    v_mov_b32 v20, 0
    v_mov_b32 v21, 0
    v_mov_b32 v22, 0
    v_mov_b32 v23, 0
    v_mov_b32 v24, 0
    v_mov_b32 v25, 0
    v_mov_b32 v26, 0
    v_mov_b32 v27, 0
    v_mov_b32 v28, 0
    v_mov_b32 v29, 0
    v_mov_b32 v30, 0
    v_mov_b32 v31, 0
    v_mov_b32 v32, 0
    v_mov_b32 v33, 0
    v_mov_b32 v34, 0
    v_mov_b32 v35, 0
    v_mov_b32 v36, 0
    v_mov_b32 v37, 0
    v_mov_b32 v38, 0
    v_mov_b32 v39, 0
    v_mov_b32 v40, 0
    v_mov_b32 v41, 0
    v_mov_b32 v42, 0
    v_mov_b32 v43, 0
    v_mov_b32 v44, 0
    v_mov_b32 v45, 0
    v_mov_b32 v46, 0
    v_mov_b32 v47, 0
    v_mov_b32 v48, 0
    v_mov_b32 v49, 0
    v_mov_b32 v50, 0
    v_mov_b32 v51, 0
    v_mov_b32 v52, 0
    v_mov_b32 v53, 0
    v_mov_b32 v54, 0
    v_mov_b32 v55, 0
    v_mov_b32 v56, 0
    v_mov_b32 v57, 0
    v_mov_b32 v58, 0
    v_mov_b32 v59, 0
    v_mov_b32 v60, 0
    v_mov_b32 v61, 0
    v_mov_b32 v62, 0
    v_mov_b32 v63, 0
    v_mov_b32 v64, 0
    v_mov_b32 v65, 0
    v_mov_b32 v66, 0
    v_mov_b32 v67, 0
    v_mov_b32 v68, 0
    v_mov_b32 v69, 0
    v_mov_b32 v70, 0
    v_mov_b32 v71, 0
    v_mov_b32 v72, 0
    v_mov_b32 v73, 0
    v_mov_b32 v74, 0
    v_mov_b32 v75, 0
    v_mov_b32 v76, 0
    v_mov_b32 v77, 0
    v_mov_b32 v78, 0
    v_mov_b32 v79, 0
    v_mov_b32 v80, 0
    v_mov_b32 v81, 0
    v_mov_b32 v82, 0
    v_mov_b32 v83, 0
    v_mov_b32 v84, 0
    v_mov_b32 v85, 0
    v_mov_b32 v86, 0
    v_mov_b32 v87, 0
    v_mov_b32 v88, 0
    v_mov_b32 v89, 0
    v_mov_b32 v90, 0
    v_mov_b32 v91, 0
    v_mov_b32 v92, 0
    v_mov_b32 v93, 0
    v_mov_b32 v94, 0
    v_mov_b32 v95, 0
    v_mov_b32 v96, 0
    v_mov_b32 v97, 0
    v_mov_b32 v98, 0
    v_mov_b32 v99, 0
    v_mov_b32 v100, 0
    v_mov_b32 v101, 0
    v_mov_b32 v102, 0
    v_mov_b32 v103, 0
    v_mov_b32 v104, 0
    v_mov_b32 v105, 0
    v_mov_b32 v106, 0
    v_mov_b32 v107, 0
    v_mov_b32 v108, 0
    v_mov_b32 v109, 0
    v_mov_b32 v110, 0
    v_mov_b32 v111, 0
    v_mov_b32 v112, 0
    v_mov_b32 v113, 0
    v_mov_b32 v114, 0
    v_mov_b32 v115, 0
    v_mov_b32 v116, 0
    v_mov_b32 v117, 0
    v_mov_b32 v118, 0
    v_mov_b32 v119, 0
    v_mov_b32 v120, 0
    v_mov_b32 v121, 0
    v_mov_b32 v122, 0
    v_mov_b32 v123, 0
    v_mov_b32 v124, 0
    v_mov_b32 v125, 0
    v_mov_b32 v126, 0
    v_mov_b32 v127, 0
    v_mov_b32 v128, 0
    v_mov_b32 v129, 0
    v_mov_b32 v130, 0
    v_mov_b32 v131, 0
    v_mov_b32 v132, 0
    v_mov_b32 v133, 0
    v_mov_b32 v134, 0
    v_mov_b32 v135, 0
    v_mov_b32 v136, 0
    v_mov_b32 v137, 0
    v_mov_b32 v138, 0
    v_mov_b32 v139, 0
    v_mov_b32 v140, 0
    v_mov_b32 v141, 0
    v_mov_b32 v142, 0
    v_mov_b32 v143, 0
    v_mov_b32 v144, 0
    v_mov_b32 v145, 0
    v_mov_b32 v146, 0
    v_mov_b32 v147, 0
    v_mov_b32 v148, 0
    v_mov_b32 v149, 0
    v_mov_b32 v150, 0
    v_mov_b32 v151, 0
    v_mov_b32 v152, 0
    v_mov_b32 v153, 0
    v_mov_b32 v154, 0
    v_mov_b32 v155, 0
    v_mov_b32 v156, 0
    v_mov_b32 v157, 0
    v_mov_b32 v158, 0
    v_mov_b32 v159, 0
    s_waitcnt vmcnt(23)
    s_barrier
    ds_read_b64_tr_b16 v[208:209], v233 offset:0
    ds_read_b64_tr_b16 v[210:211], v233 offset:4608
    ds_read_b64_tr_b16 v[212:213], v233 offset:32
    ds_read_b64_tr_b16 v[214:215], v233 offset:4640
    ds_read_b64_tr_b16 v[216:217], v233 offset:64
    ds_read_b64_tr_b16 v[218:219], v233 offset:4672
    ds_read_b64_tr_b16 v[220:221], v233 offset:96
    ds_read_b64_tr_b16 v[222:223], v233 offset:4704
    buffer_load_dwordx4 v[192:195], v224, s[8:11], s26 offen sc1
    s_waitcnt vmcnt(5) lgkmcnt(6)
    v_mfma_f32_16x16x32_bf16 v[16:19], v[208:211], v[160:163], v[16:19]
    v_mfma_f32_16x16x32_bf16 v[52:55], v[208:211], v[164:167], v[52:55]
    v_mfma_f32_16x16x32_bf16 v[88:91], v[208:211], v[168:171], v[88:91]
    v_mfma_f32_16x16x32_bf16 v[124:127], v[208:211], v[172:175], v[124:127]
    ds_read_b64_tr_b16 v[208:209], v233 offset:128
    ds_read_b64_tr_b16 v[210:211], v233 offset:4736
    buffer_load_dwordx4 v[196:199], v225, s[8:11], s26 offen sc1
    s_waitcnt lgkmcnt(6)
    v_mfma_f32_16x16x32_bf16 v[20:23], v[212:215], v[160:163], v[20:23]
    v_mfma_f32_16x16x32_bf16 v[56:59], v[212:215], v[164:167], v[56:59]
    v_mfma_f32_16x16x32_bf16 v[92:95], v[212:215], v[168:171], v[92:95]
    v_mfma_f32_16x16x32_bf16 v[128:131], v[212:215], v[172:175], v[128:131]
    ds_read_b64_tr_b16 v[212:213], v233 offset:160
    ds_read_b64_tr_b16 v[214:215], v233 offset:4768
    buffer_load_dwordx4 v[200:203], v226, s[8:11], s26 offen sc1
    s_waitcnt lgkmcnt(6)
    v_mfma_f32_16x16x32_bf16 v[24:27], v[216:219], v[160:163], v[24:27]
    v_mfma_f32_16x16x32_bf16 v[60:63], v[216:219], v[164:167], v[60:63]
    v_mfma_f32_16x16x32_bf16 v[96:99], v[216:219], v[168:171], v[96:99]
    v_mfma_f32_16x16x32_bf16 v[132:135], v[216:219], v[172:175], v[132:135]
    ds_read_b64_tr_b16 v[216:217], v233 offset:192
    ds_read_b64_tr_b16 v[218:219], v233 offset:4800
    buffer_load_dwordx4 v[204:207], v227, s[8:11], s26 offen sc1
    s_add_u32 s26, s26, 1024
    s_waitcnt lgkmcnt(6)
    v_mfma_f32_16x16x32_bf16 v[28:31], v[220:223], v[160:163], v[28:31]
    v_mfma_f32_16x16x32_bf16 v[64:67], v[220:223], v[164:167], v[64:67]
    v_mfma_f32_16x16x32_bf16 v[100:103], v[220:223], v[168:171], v[100:103]
    v_mfma_f32_16x16x32_bf16 v[136:139], v[220:223], v[172:175], v[136:139]
    ds_read_b64_tr_b16 v[220:221], v233 offset:224
    ds_read_b64_tr_b16 v[222:223], v233 offset:4832
    s_waitcnt lgkmcnt(6)
    v_mfma_f32_16x16x32_bf16 v[32:35], v[208:211], v[160:163], v[32:35]
    v_mfma_f32_16x16x32_bf16 v[68:71], v[208:211], v[164:167], v[68:71]
    v_mfma_f32_16x16x32_bf16 v[104:107], v[208:211], v[168:171], v[104:107]
    v_mfma_f32_16x16x32_bf16 v[140:143], v[208:211], v[172:175], v[140:143]
    ds_read_b64_tr_b16 v[208:209], v233 offset:256
    ds_read_b64_tr_b16 v[210:211], v233 offset:4864
    s_waitcnt lgkmcnt(6)
    v_mfma_f32_16x16x32_bf16 v[36:39], v[212:215], v[160:163], v[36:39]
    v_mfma_f32_16x16x32_bf16 v[72:75], v[212:215], v[164:167], v[72:75]
    v_mfma_f32_16x16x32_bf16 v[108:111], v[212:215], v[168:171], v[108:111]
    v_mfma_f32_16x16x32_bf16 v[144:147], v[212:215], v[172:175], v[144:147]
    s_waitcnt lgkmcnt(0)
    s_barrier
    ds_read_b64_tr_b16 v[212:213], v233 offset:9216
    ds_read_b64_tr_b16 v[214:215], v233 offset:13824
    s_add_u32 m0, s24, 0
    s_nop 0
    buffer_load_dwordx4 v228, s[12:15], s25 offen offset:0 lds
    v_mfma_f32_16x16x32_bf16 v[40:43], v[216:219], v[160:163], v[40:43]
    v_mfma_f32_16x16x32_bf16 v[76:79], v[216:219], v[164:167], v[76:79]
    v_mfma_f32_16x16x32_bf16 v[112:115], v[216:219], v[168:171], v[112:115]
    v_mfma_f32_16x16x32_bf16 v[148:151], v[216:219], v[172:175], v[148:151]
    ds_read_b64_tr_b16 v[216:217], v233 offset:9248
    ds_read_b64_tr_b16 v[218:219], v233 offset:13856
    s_add_u32 m0, s24, 0
    s_nop 0
    buffer_load_dwordx4 v229, s[12:15], s25 offen offset:1024 lds
    v_mfma_f32_16x16x32_bf16 v[44:47], v[220:223], v[160:163], v[44:47]
    v_mfma_f32_16x16x32_bf16 v[80:83], v[220:223], v[164:167], v[80:83]
    v_mfma_f32_16x16x32_bf16 v[116:119], v[220:223], v[168:171], v[116:119]
    v_mfma_f32_16x16x32_bf16 v[152:155], v[220:223], v[172:175], v[152:155]
    ds_read_b64_tr_b16 v[220:221], v233 offset:9280
    ds_read_b64_tr_b16 v[222:223], v233 offset:13888
    s_add_u32 m0, s24, 0
    s_nop 0
    buffer_load_dwordx4 v230, s[12:15], s25 offen offset:2048 lds
    v_mfma_f32_16x16x32_bf16 v[48:51], v[208:211], v[160:163], v[48:51]
    v_mfma_f32_16x16x32_bf16 v[84:87], v[208:211], v[164:167], v[84:87]
    v_mfma_f32_16x16x32_bf16 v[120:123], v[208:211], v[168:171], v[120:123]
    v_mfma_f32_16x16x32_bf16 v[156:159], v[208:211], v[172:175], v[156:159]
    ds_read_b64_tr_b16 v[208:209], v233 offset:9312
    ds_read_b64_tr_b16 v[210:211], v233 offset:13920
    buffer_load_dwordx4 v[160:163], v224, s[8:11], s26 offen sc1
    s_waitcnt vmcnt(8) lgkmcnt(6)
    v_mfma_f32_16x16x32_bf16 v[16:19], v[212:215], v[176:179], v[16:19]
    v_mfma_f32_16x16x32_bf16 v[52:55], v[212:215], v[180:183], v[52:55]
    v_mfma_f32_16x16x32_bf16 v[88:91], v[212:215], v[184:187], v[88:91]
    v_mfma_f32_16x16x32_bf16 v[124:127], v[212:215], v[188:191], v[124:127]
    ds_read_b64_tr_b16 v[212:213], v233 offset:9344
    ds_read_b64_tr_b16 v[214:215], v233 offset:13952
    buffer_load_dwordx4 v[164:167], v225, s[8:11], s26 offen sc1
    s_waitcnt lgkmcnt(6)
    v_mfma_f32_16x16x32_bf16 v[20:23], v[216:219], v[176:179], v[20:23]
    v_mfma_f32_16x16x32_bf16 v[56:59], v[216:219], v[180:183], v[56:59]
    v_mfma_f32_16x16x32_bf16 v[92:95], v[216:219], v[184:187], v[92:95]
    v_mfma_f32_16x16x32_bf16 v[128:131], v[216:219], v[188:191], v[128:131]
    ds_read_b64_tr_b16 v[216:217], v233 offset:9376
    ds_read_b64_tr_b16 v[218:219], v233 offset:13984
    buffer_load_dwordx4 v[168:171], v226, s[8:11], s26 offen sc1
    s_waitcnt lgkmcnt(6)
    v_mfma_f32_16x16x32_bf16 v[24:27], v[220:223], v[176:179], v[24:27]
    v_mfma_f32_16x16x32_bf16 v[60:63], v[220:223], v[180:183], v[60:63]
    v_mfma_f32_16x16x32_bf16 v[96:99], v[220:223], v[184:187], v[96:99]
    v_mfma_f32_16x16x32_bf16 v[132:135], v[220:223], v[188:191], v[132:135]
    ds_read_b64_tr_b16 v[220:221], v233 offset:9408
    ds_read_b64_tr_b16 v[222:223], v233 offset:14016
    buffer_load_dwordx4 v[172:175], v227, s[8:11], s26 offen sc1
    s_add_u32 s26, s26, 1024
    s_waitcnt lgkmcnt(6)
    v_mfma_f32_16x16x32_bf16 v[28:31], v[208:211], v[176:179], v[28:31]
    v_mfma_f32_16x16x32_bf16 v[64:67], v[208:211], v[180:183], v[64:67]
    v_mfma_f32_16x16x32_bf16 v[100:103], v[208:211], v[184:187], v[100:103]
    v_mfma_f32_16x16x32_bf16 v[136:139], v[208:211], v[188:191], v[136:139]
    ds_read_b64_tr_b16 v[208:209], v233 offset:9440
    ds_read_b64_tr_b16 v[210:211], v233 offset:14048
    s_add_u32 m0, s24, 0
    s_nop 0
    buffer_load_dwordx4 v231, s[12:15], s25 offen offset:3072 lds
    s_waitcnt lgkmcnt(6)
    v_mfma_f32_16x16x32_bf16 v[32:35], v[212:215], v[176:179], v[32:35]
    v_mfma_f32_16x16x32_bf16 v[68:71], v[212:215], v[180:183], v[68:71]
    v_mfma_f32_16x16x32_bf16 v[104:107], v[212:215], v[184:187], v[104:107]
    v_mfma_f32_16x16x32_bf16 v[140:143], v[212:215], v[188:191], v[140:143]
    ds_read_b64_tr_b16 v[212:213], v233 offset:9472
    ds_read_b64_tr_b16 v[214:215], v233 offset:14080
    s_add_u32 m0, s24, 4096
    s_nop 0
    buffer_load_dwordx4 v232, s[12:15], s25 offen offset:0 lds
    s_add_u32 s25, s25, 36864
    s_waitcnt lgkmcnt(6)
    v_mfma_f32_16x16x32_bf16 v[36:39], v[216:219], v[176:179], v[36:39]
    v_mfma_f32_16x16x32_bf16 v[72:75], v[216:219], v[180:183], v[72:75]
    v_mfma_f32_16x16x32_bf16 v[108:111], v[216:219], v[184:187], v[108:111]
    v_mfma_f32_16x16x32_bf16 v[144:147], v[216:219], v[188:191], v[144:147]
    s_waitcnt lgkmcnt(0)
    s_barrier
    ds_read_b64_tr_b16 v[216:217], v233 offset:18432
    ds_read_b64_tr_b16 v[218:219], v233 offset:23040
    s_add_u32 m0, s24, 9216
    s_nop 0
    buffer_load_dwordx4 v228, s[12:15], s25 offen offset:0 lds
    v_mfma_f32_16x16x32_bf16 v[40:43], v[220:223], v[176:179], v[40:43]
    v_mfma_f32_16x16x32_bf16 v[76:79], v[220:223], v[180:183], v[76:79]
    v_mfma_f32_16x16x32_bf16 v[112:115], v[220:223], v[184:187], v[112:115]
    v_mfma_f32_16x16x32_bf16 v[148:151], v[220:223], v[188:191], v[148:151]
    ds_read_b64_tr_b16 v[220:221], v233 offset:18464
    ds_read_b64_tr_b16 v[222:223], v233 offset:23072
    s_add_u32 m0, s24, 9216
    s_nop 0
    buffer_load_dwordx4 v229, s[12:15], s25 offen offset:1024 lds
    v_mfma_f32_16x16x32_bf16 v[44:47], v[208:211], v[176:179], v[44:47]
    v_mfma_f32_16x16x32_bf16 v[80:83], v[208:211], v[180:183], v[80:83]
    v_mfma_f32_16x16x32_bf16 v[116:119], v[208:211], v[184:187], v[116:119]
    v_mfma_f32_16x16x32_bf16 v[152:155], v[208:211], v[188:191], v[152:155]
    ds_read_b64_tr_b16 v[208:209], v233 offset:18496
    ds_read_b64_tr_b16 v[210:211], v233 offset:23104
    s_add_u32 m0, s24, 9216
    s_nop 0
    buffer_load_dwordx4 v230, s[12:15], s25 offen offset:2048 lds
    v_mfma_f32_16x16x32_bf16 v[48:51], v[212:215], v[176:179], v[48:51]
    v_mfma_f32_16x16x32_bf16 v[84:87], v[212:215], v[180:183], v[84:87]
    v_mfma_f32_16x16x32_bf16 v[120:123], v[212:215], v[184:187], v[120:123]
    v_mfma_f32_16x16x32_bf16 v[156:159], v[212:215], v[188:191], v[156:159]
    ds_read_b64_tr_b16 v[212:213], v233 offset:18528
    ds_read_b64_tr_b16 v[214:215], v233 offset:23136
    buffer_load_dwordx4 v[176:179], v224, s[8:11], s26 offen sc1
    s_waitcnt vmcnt(13) lgkmcnt(6)
    v_mfma_f32_16x16x32_bf16 v[16:19], v[216:219], v[192:195], v[16:19]
    v_mfma_f32_16x16x32_bf16 v[52:55], v[216:219], v[196:199], v[52:55]
    v_mfma_f32_16x16x32_bf16 v[88:91], v[216:219], v[200:203], v[88:91]
    v_mfma_f32_16x16x32_bf16 v[124:127], v[216:219], v[204:207], v[124:127]
    ds_read_b64_tr_b16 v[216:217], v233 offset:18560
    ds_read_b64_tr_b16 v[218:219], v233 offset:23168
    buffer_load_dwordx4 v[180:183], v225, s[8:11], s26 offen sc1
    s_waitcnt lgkmcnt(6)
    v_mfma_f32_16x16x32_bf16 v[20:23], v[220:223], v[192:195], v[20:23]
    v_mfma_f32_16x16x32_bf16 v[56:59], v[220:223], v[196:199], v[56:59]
    v_mfma_f32_16x16x32_bf16 v[92:95], v[220:223], v[200:203], v[92:95]
    v_mfma_f32_16x16x32_bf16 v[128:131], v[220:223], v[204:207], v[128:131]
    ds_read_b64_tr_b16 v[220:221], v233 offset:18592
    ds_read_b64_tr_b16 v[222:223], v233 offset:23200
    buffer_load_dwordx4 v[184:187], v226, s[8:11], s26 offen sc1
    s_waitcnt lgkmcnt(6)
    v_mfma_f32_16x16x32_bf16 v[24:27], v[208:211], v[192:195], v[24:27]
    v_mfma_f32_16x16x32_bf16 v[60:63], v[208:211], v[196:199], v[60:63]
    v_mfma_f32_16x16x32_bf16 v[96:99], v[208:211], v[200:203], v[96:99]
    v_mfma_f32_16x16x32_bf16 v[132:135], v[208:211], v[204:207], v[132:135]
    ds_read_b64_tr_b16 v[208:209], v233 offset:18624
    ds_read_b64_tr_b16 v[210:211], v233 offset:23232
    buffer_load_dwordx4 v[188:191], v227, s[8:11], s26 offen sc1
    s_add_u32 s26, s26, 1024
    s_waitcnt lgkmcnt(6)
    v_mfma_f32_16x16x32_bf16 v[28:31], v[212:215], v[192:195], v[28:31]
    v_mfma_f32_16x16x32_bf16 v[64:67], v[212:215], v[196:199], v[64:67]
    v_mfma_f32_16x16x32_bf16 v[100:103], v[212:215], v[200:203], v[100:103]
    v_mfma_f32_16x16x32_bf16 v[136:139], v[212:215], v[204:207], v[136:139]
    ds_read_b64_tr_b16 v[212:213], v233 offset:18656
    ds_read_b64_tr_b16 v[214:215], v233 offset:23264
    s_add_u32 m0, s24, 9216
    s_nop 0
    buffer_load_dwordx4 v231, s[12:15], s25 offen offset:3072 lds
    s_waitcnt lgkmcnt(6)
    v_mfma_f32_16x16x32_bf16 v[32:35], v[216:219], v[192:195], v[32:35]
    v_mfma_f32_16x16x32_bf16 v[68:71], v[216:219], v[196:199], v[68:71]
    v_mfma_f32_16x16x32_bf16 v[104:107], v[216:219], v[200:203], v[104:107]
    v_mfma_f32_16x16x32_bf16 v[140:143], v[216:219], v[204:207], v[140:143]
    ds_read_b64_tr_b16 v[216:217], v233 offset:18688
    ds_read_b64_tr_b16 v[218:219], v233 offset:23296
    s_add_u32 m0, s24, 13312
    s_nop 0
    buffer_load_dwordx4 v232, s[12:15], s25 offen offset:0 lds
    s_add_u32 s25, s25, 36864
    s_waitcnt lgkmcnt(6)
    v_mfma_f32_16x16x32_bf16 v[36:39], v[220:223], v[192:195], v[36:39]
    v_mfma_f32_16x16x32_bf16 v[72:75], v[220:223], v[196:199], v[72:75]
    v_mfma_f32_16x16x32_bf16 v[108:111], v[220:223], v[200:203], v[108:111]
    v_mfma_f32_16x16x32_bf16 v[144:147], v[220:223], v[204:207], v[144:147]
    s_waitcnt lgkmcnt(0)
    s_barrier
    ds_read_b64_tr_b16 v[220:221], v233 offset:27648
    ds_read_b64_tr_b16 v[222:223], v233 offset:32256
    s_add_u32 m0, s24, 18432
    s_nop 0
    buffer_load_dwordx4 v228, s[12:15], s25 offen offset:0 lds
    v_mfma_f32_16x16x32_bf16 v[40:43], v[208:211], v[192:195], v[40:43]
    v_mfma_f32_16x16x32_bf16 v[76:79], v[208:211], v[196:199], v[76:79]
    v_mfma_f32_16x16x32_bf16 v[112:115], v[208:211], v[200:203], v[112:115]
    v_mfma_f32_16x16x32_bf16 v[148:151], v[208:211], v[204:207], v[148:151]
    ds_read_b64_tr_b16 v[208:209], v233 offset:27680
    ds_read_b64_tr_b16 v[210:211], v233 offset:32288
    s_add_u32 m0, s24, 18432
    s_nop 0
    buffer_load_dwordx4 v229, s[12:15], s25 offen offset:1024 lds
    v_mfma_f32_16x16x32_bf16 v[44:47], v[212:215], v[192:195], v[44:47]
    v_mfma_f32_16x16x32_bf16 v[80:83], v[212:215], v[196:199], v[80:83]
    v_mfma_f32_16x16x32_bf16 v[116:119], v[212:215], v[200:203], v[116:119]
    v_mfma_f32_16x16x32_bf16 v[152:155], v[212:215], v[204:207], v[152:155]
    ds_read_b64_tr_b16 v[212:213], v233 offset:27712
    ds_read_b64_tr_b16 v[214:215], v233 offset:32320
    s_add_u32 m0, s24, 18432
    s_nop 0
    buffer_load_dwordx4 v230, s[12:15], s25 offen offset:2048 lds
    v_mfma_f32_16x16x32_bf16 v[48:51], v[216:219], v[192:195], v[48:51]
    v_mfma_f32_16x16x32_bf16 v[84:87], v[216:219], v[196:199], v[84:87]
    v_mfma_f32_16x16x32_bf16 v[120:123], v[216:219], v[200:203], v[120:123]
    v_mfma_f32_16x16x32_bf16 v[156:159], v[216:219], v[204:207], v[156:159]
    ds_read_b64_tr_b16 v[216:217], v233 offset:27744
    ds_read_b64_tr_b16 v[218:219], v233 offset:32352
    buffer_load_dwordx4 v[192:195], v224, s[8:11], s26 offen sc1
    s_waitcnt vmcnt(15) lgkmcnt(6)
    v_mfma_f32_16x16x32_bf16 v[16:19], v[220:223], v[160:163], v[16:19]
    v_mfma_f32_16x16x32_bf16 v[52:55], v[220:223], v[164:167], v[52:55]
    v_mfma_f32_16x16x32_bf16 v[88:91], v[220:223], v[168:171], v[88:91]
    v_mfma_f32_16x16x32_bf16 v[124:127], v[220:223], v[172:175], v[124:127]
    ds_read_b64_tr_b16 v[220:221], v233 offset:27776
    ds_read_b64_tr_b16 v[222:223], v233 offset:32384
    buffer_load_dwordx4 v[196:199], v225, s[8:11], s26 offen sc1
    s_waitcnt lgkmcnt(6)
    v_mfma_f32_16x16x32_bf16 v[20:23], v[208:211], v[160:163], v[20:23]
    v_mfma_f32_16x16x32_bf16 v[56:59], v[208:211], v[164:167], v[56:59]
    v_mfma_f32_16x16x32_bf16 v[92:95], v[208:211], v[168:171], v[92:95]
    v_mfma_f32_16x16x32_bf16 v[128:131], v[208:211], v[172:175], v[128:131]
    ds_read_b64_tr_b16 v[208:209], v233 offset:27808
    ds_read_b64_tr_b16 v[210:211], v233 offset:32416
    buffer_load_dwordx4 v[200:203], v226, s[8:11], s26 offen sc1
    s_waitcnt lgkmcnt(6)
    v_mfma_f32_16x16x32_bf16 v[24:27], v[212:215], v[160:163], v[24:27]
    v_mfma_f32_16x16x32_bf16 v[60:63], v[212:215], v[164:167], v[60:63]
    v_mfma_f32_16x16x32_bf16 v[96:99], v[212:215], v[168:171], v[96:99]
    v_mfma_f32_16x16x32_bf16 v[132:135], v[212:215], v[172:175], v[132:135]
    ds_read_b64_tr_b16 v[212:213], v233 offset:27840
    ds_read_b64_tr_b16 v[214:215], v233 offset:32448
    buffer_load_dwordx4 v[204:207], v227, s[8:11], s26 offen sc1
    s_add_u32 s26, s26, 1024
    s_waitcnt lgkmcnt(6)
    v_mfma_f32_16x16x32_bf16 v[28:31], v[216:219], v[160:163], v[28:31]
    v_mfma_f32_16x16x32_bf16 v[64:67], v[216:219], v[164:167], v[64:67]
    v_mfma_f32_16x16x32_bf16 v[100:103], v[216:219], v[168:171], v[100:103]
    v_mfma_f32_16x16x32_bf16 v[136:139], v[216:219], v[172:175], v[136:139]
    ds_read_b64_tr_b16 v[216:217], v233 offset:27872
    ds_read_b64_tr_b16 v[218:219], v233 offset:32480
    s_add_u32 m0, s24, 18432
    s_nop 0
    buffer_load_dwordx4 v231, s[12:15], s25 offen offset:3072 lds
    s_waitcnt lgkmcnt(6)
    v_mfma_f32_16x16x32_bf16 v[32:35], v[220:223], v[160:163], v[32:35]
    v_mfma_f32_16x16x32_bf16 v[68:71], v[220:223], v[164:167], v[68:71]
    v_mfma_f32_16x16x32_bf16 v[104:107], v[220:223], v[168:171], v[104:107]
    v_mfma_f32_16x16x32_bf16 v[140:143], v[220:223], v[172:175], v[140:143]
    ds_read_b64_tr_b16 v[220:221], v233 offset:27904
    ds_read_b64_tr_b16 v[222:223], v233 offset:32512
    s_add_u32 m0, s24, 22528
    s_nop 0
    buffer_load_dwordx4 v232, s[12:15], s25 offen offset:0 lds
    s_add_u32 s25, s25, 36864
    s_waitcnt lgkmcnt(6)
    v_mfma_f32_16x16x32_bf16 v[36:39], v[208:211], v[160:163], v[36:39]
    v_mfma_f32_16x16x32_bf16 v[72:75], v[208:211], v[164:167], v[72:75]
    v_mfma_f32_16x16x32_bf16 v[108:111], v[208:211], v[168:171], v[108:111]
    v_mfma_f32_16x16x32_bf16 v[144:147], v[208:211], v[172:175], v[144:147]
    s_waitcnt vmcnt(18) lgkmcnt(0)
    s_barrier
    ds_read_b64_tr_b16 v[208:209], v233 offset:0
    ds_read_b64_tr_b16 v[210:211], v233 offset:4608
    s_add_u32 m0, s24, 27648
    s_nop 0
    buffer_load_dwordx4 v228, s[12:15], s25 offen offset:0 lds
    v_mfma_f32_16x16x32_bf16 v[40:43], v[212:215], v[160:163], v[40:43]
    v_mfma_f32_16x16x32_bf16 v[76:79], v[212:215], v[164:167], v[76:79]
    v_mfma_f32_16x16x32_bf16 v[112:115], v[212:215], v[168:171], v[112:115]
    v_mfma_f32_16x16x32_bf16 v[148:151], v[212:215], v[172:175], v[148:151]
    ds_read_b64_tr_b16 v[212:213], v233 offset:32
    ds_read_b64_tr_b16 v[214:215], v233 offset:4640
    s_add_u32 m0, s24, 27648
    s_nop 0
    buffer_load_dwordx4 v229, s[12:15], s25 offen offset:1024 lds
    v_mfma_f32_16x16x32_bf16 v[44:47], v[216:219], v[160:163], v[44:47]
    v_mfma_f32_16x16x32_bf16 v[80:83], v[216:219], v[164:167], v[80:83]
    v_mfma_f32_16x16x32_bf16 v[116:119], v[216:219], v[168:171], v[116:119]
    v_mfma_f32_16x16x32_bf16 v[152:155], v[216:219], v[172:175], v[152:155]
    ds_read_b64_tr_b16 v[216:217], v233 offset:64
    ds_read_b64_tr_b16 v[218:219], v233 offset:4672
    s_add_u32 m0, s24, 27648
    s_nop 0
    buffer_load_dwordx4 v230, s[12:15], s25 offen offset:2048 lds
    v_mfma_f32_16x16x32_bf16 v[48:51], v[220:223], v[160:163], v[48:51]
    v_mfma_f32_16x16x32_bf16 v[84:87], v[220:223], v[164:167], v[84:87]
    v_mfma_f32_16x16x32_bf16 v[120:123], v[220:223], v[168:171], v[120:123]
    v_mfma_f32_16x16x32_bf16 v[156:159], v[220:223], v[172:175], v[156:159]
    ds_read_b64_tr_b16 v[220:221], v233 offset:96
    ds_read_b64_tr_b16 v[222:223], v233 offset:4704
    buffer_load_dwordx4 v[160:163], v224, s[8:11], s26 offen sc1
    s_waitcnt vmcnt(15) lgkmcnt(6)
    v_mfma_f32_16x16x32_bf16 v[16:19], v[208:211], v[176:179], v[16:19]
    v_mfma_f32_16x16x32_bf16 v[52:55], v[208:211], v[180:183], v[52:55]
    v_mfma_f32_16x16x32_bf16 v[88:91], v[208:211], v[184:187], v[88:91]
    v_mfma_f32_16x16x32_bf16 v[124:127], v[208:211], v[188:191], v[124:127]
    ds_read_b64_tr_b16 v[208:209], v233 offset:128
    ds_read_b64_tr_b16 v[210:211], v233 offset:4736
    buffer_load_dwordx4 v[164:167], v225, s[8:11], s26 offen sc1
    s_waitcnt lgkmcnt(6)
    v_mfma_f32_16x16x32_bf16 v[20:23], v[212:215], v[176:179], v[20:23]
    v_mfma_f32_16x16x32_bf16 v[56:59], v[212:215], v[180:183], v[56:59]
    v_mfma_f32_16x16x32_bf16 v[92:95], v[212:215], v[184:187], v[92:95]
    v_mfma_f32_16x16x32_bf16 v[128:131], v[212:215], v[188:191], v[128:131]
    ds_read_b64_tr_b16 v[212:213], v233 offset:160
    ds_read_b64_tr_b16 v[214:215], v233 offset:4768
    buffer_load_dwordx4 v[168:171], v226, s[8:11], s26 offen sc1
    s_waitcnt lgkmcnt(6)
    v_mfma_f32_16x16x32_bf16 v[24:27], v[216:219], v[176:179], v[24:27]
    v_mfma_f32_16x16x32_bf16 v[60:63], v[216:219], v[180:183], v[60:63]
    v_mfma_f32_16x16x32_bf16 v[96:99], v[216:219], v[184:187], v[96:99]
    v_mfma_f32_16x16x32_bf16 v[132:135], v[216:219], v[188:191], v[132:135]
    ds_read_b64_tr_b16 v[216:217], v233 offset:192
    ds_read_b64_tr_b16 v[218:219], v233 offset:4800
    buffer_load_dwordx4 v[172:175], v227, s[8:11], s26 offen sc1
    s_add_u32 s26, s26, 1024
    s_waitcnt lgkmcnt(6)
    v_mfma_f32_16x16x32_bf16 v[28:31], v[220:223], v[176:179], v[28:31]
    v_mfma_f32_16x16x32_bf16 v[64:67], v[220:223], v[180:183], v[64:67]
    v_mfma_f32_16x16x32_bf16 v[100:103], v[220:223], v[184:187], v[100:103]
    v_mfma_f32_16x16x32_bf16 v[136:139], v[220:223], v[188:191], v[136:139]
    ds_read_b64_tr_b16 v[220:221], v233 offset:224
    ds_read_b64_tr_b16 v[222:223], v233 offset:4832
    s_add_u32 m0, s24, 27648
    s_nop 0
    buffer_load_dwordx4 v231, s[12:15], s25 offen offset:3072 lds
    s_waitcnt lgkmcnt(6)
    v_mfma_f32_16x16x32_bf16 v[32:35], v[208:211], v[176:179], v[32:35]
    v_mfma_f32_16x16x32_bf16 v[68:71], v[208:211], v[180:183], v[68:71]
    v_mfma_f32_16x16x32_bf16 v[104:107], v[208:211], v[184:187], v[104:107]
    v_mfma_f32_16x16x32_bf16 v[140:143], v[208:211], v[188:191], v[140:143]
    ds_read_b64_tr_b16 v[208:209], v233 offset:256
    ds_read_b64_tr_b16 v[210:211], v233 offset:4864
    s_add_u32 m0, s24, 31744
    s_nop 0
    buffer_load_dwordx4 v232, s[12:15], s25 offen offset:0 lds
    s_add_u32 s25, s25, 36864
    s_waitcnt lgkmcnt(6)
    v_mfma_f32_16x16x32_bf16 v[36:39], v[212:215], v[176:179], v[36:39]
    v_mfma_f32_16x16x32_bf16 v[72:75], v[212:215], v[180:183], v[72:75]
    v_mfma_f32_16x16x32_bf16 v[108:111], v[212:215], v[184:187], v[108:111]
    v_mfma_f32_16x16x32_bf16 v[144:147], v[212:215], v[188:191], v[144:147]
    s_waitcnt vmcnt(18) lgkmcnt(0)
    s_barrier
    ds_read_b64_tr_b16 v[212:213], v233 offset:9216
    ds_read_b64_tr_b16 v[214:215], v233 offset:13824
    s_add_u32 m0, s24, 0
    s_nop 0
    buffer_load_dwordx4 v228, s[12:15], s25 offen offset:0 lds
    v_mfma_f32_16x16x32_bf16 v[40:43], v[216:219], v[176:179], v[40:43]
    v_mfma_f32_16x16x32_bf16 v[76:79], v[216:219], v[180:183], v[76:79]
    v_mfma_f32_16x16x32_bf16 v[112:115], v[216:219], v[184:187], v[112:115]
    v_mfma_f32_16x16x32_bf16 v[148:151], v[216:219], v[188:191], v[148:151]
    ds_read_b64_tr_b16 v[216:217], v233 offset:9248
    ds_read_b64_tr_b16 v[218:219], v233 offset:13856
    s_add_u32 m0, s24, 0
    s_nop 0
    buffer_load_dwordx4 v229, s[12:15], s25 offen offset:1024 lds
    v_mfma_f32_16x16x32_bf16 v[44:47], v[220:223], v[176:179], v[44:47]
    v_mfma_f32_16x16x32_bf16 v[80:83], v[220:223], v[180:183], v[80:83]
    v_mfma_f32_16x16x32_bf16 v[116:119], v[220:223], v[184:187], v[116:119]
    v_mfma_f32_16x16x32_bf16 v[152:155], v[220:223], v[188:191], v[152:155]
    ds_read_b64_tr_b16 v[220:221], v233 offset:9280
    ds_read_b64_tr_b16 v[222:223], v233 offset:13888
    s_add_u32 m0, s24, 0
    s_nop 0
    buffer_load_dwordx4 v230, s[12:15], s25 offen offset:2048 lds
    v_mfma_f32_16x16x32_bf16 v[48:51], v[208:211], v[176:179], v[48:51]
    v_mfma_f32_16x16x32_bf16 v[84:87], v[208:211], v[180:183], v[84:87]
    v_mfma_f32_16x16x32_bf16 v[120:123], v[208:211], v[184:187], v[120:123]
    v_mfma_f32_16x16x32_bf16 v[156:159], v[208:211], v[188:191], v[156:159]
    ds_read_b64_tr_b16 v[208:209], v233 offset:9312
    ds_read_b64_tr_b16 v[210:211], v233 offset:13920
    buffer_load_dwordx4 v[176:179], v224, s[8:11], s26 offen sc1
    s_waitcnt vmcnt(15) lgkmcnt(6)
    v_mfma_f32_16x16x32_bf16 v[16:19], v[212:215], v[192:195], v[16:19]
    v_mfma_f32_16x16x32_bf16 v[52:55], v[212:215], v[196:199], v[52:55]
    v_mfma_f32_16x16x32_bf16 v[88:91], v[212:215], v[200:203], v[88:91]
    v_mfma_f32_16x16x32_bf16 v[124:127], v[212:215], v[204:207], v[124:127]
    ds_read_b64_tr_b16 v[212:213], v233 offset:9344
    ds_read_b64_tr_b16 v[214:215], v233 offset:13952
    buffer_load_dwordx4 v[180:183], v225, s[8:11], s26 offen sc1
    s_waitcnt lgkmcnt(6)
    v_mfma_f32_16x16x32_bf16 v[20:23], v[216:219], v[192:195], v[20:23]
    v_mfma_f32_16x16x32_bf16 v[56:59], v[216:219], v[196:199], v[56:59]
    v_mfma_f32_16x16x32_bf16 v[92:95], v[216:219], v[200:203], v[92:95]
    v_mfma_f32_16x16x32_bf16 v[128:131], v[216:219], v[204:207], v[128:131]
    ds_read_b64_tr_b16 v[216:217], v233 offset:9376
    ds_read_b64_tr_b16 v[218:219], v233 offset:13984
    buffer_load_dwordx4 v[184:187], v226, s[8:11], s26 offen sc1
    s_waitcnt lgkmcnt(6)
    v_mfma_f32_16x16x32_bf16 v[24:27], v[220:223], v[192:195], v[24:27]
    v_mfma_f32_16x16x32_bf16 v[60:63], v[220:223], v[196:199], v[60:63]
    v_mfma_f32_16x16x32_bf16 v[96:99], v[220:223], v[200:203], v[96:99]
    v_mfma_f32_16x16x32_bf16 v[132:135], v[220:223], v[204:207], v[132:135]
    ds_read_b64_tr_b16 v[220:221], v233 offset:9408
    ds_read_b64_tr_b16 v[222:223], v233 offset:14016
    buffer_load_dwordx4 v[188:191], v227, s[8:11], s26 offen sc1
    s_add_u32 s26, s26, 1024
    s_waitcnt lgkmcnt(6)
    v_mfma_f32_16x16x32_bf16 v[28:31], v[208:211], v[192:195], v[28:31]
    v_mfma_f32_16x16x32_bf16 v[64:67], v[208:211], v[196:199], v[64:67]
    v_mfma_f32_16x16x32_bf16 v[100:103], v[208:211], v[200:203], v[100:103]
    v_mfma_f32_16x16x32_bf16 v[136:139], v[208:211], v[204:207], v[136:139]
    ds_read_b64_tr_b16 v[208:209], v233 offset:9440
    ds_read_b64_tr_b16 v[210:211], v233 offset:14048
    s_add_u32 m0, s24, 0
    s_nop 0
    buffer_load_dwordx4 v231, s[12:15], s25 offen offset:3072 lds
    s_waitcnt lgkmcnt(6)
    v_mfma_f32_16x16x32_bf16 v[32:35], v[212:215], v[192:195], v[32:35]
    v_mfma_f32_16x16x32_bf16 v[68:71], v[212:215], v[196:199], v[68:71]
    v_mfma_f32_16x16x32_bf16 v[104:107], v[212:215], v[200:203], v[104:107]
    v_mfma_f32_16x16x32_bf16 v[140:143], v[212:215], v[204:207], v[140:143]
    ds_read_b64_tr_b16 v[212:213], v233 offset:9472
    ds_read_b64_tr_b16 v[214:215], v233 offset:14080
    s_add_u32 m0, s24, 4096
    s_nop 0
    buffer_load_dwordx4 v232, s[12:15], s25 offen offset:0 lds
    s_add_u32 s25, s25, 36864
    s_waitcnt lgkmcnt(6)
    v_mfma_f32_16x16x32_bf16 v[36:39], v[216:219], v[192:195], v[36:39]
    v_mfma_f32_16x16x32_bf16 v[72:75], v[216:219], v[196:199], v[72:75]
    v_mfma_f32_16x16x32_bf16 v[108:111], v[216:219], v[200:203], v[108:111]
    v_mfma_f32_16x16x32_bf16 v[144:147], v[216:219], v[204:207], v[144:147]
    s_waitcnt vmcnt(18) lgkmcnt(0)
    s_barrier
    ds_read_b64_tr_b16 v[216:217], v233 offset:18432
    ds_read_b64_tr_b16 v[218:219], v233 offset:23040
    s_add_u32 m0, s24, 9216
    s_nop 0
    buffer_load_dwordx4 v228, s[12:15], s25 offen offset:0 lds
    v_mfma_f32_16x16x32_bf16 v[40:43], v[220:223], v[192:195], v[40:43]
    v_mfma_f32_16x16x32_bf16 v[76:79], v[220:223], v[196:199], v[76:79]
    v_mfma_f32_16x16x32_bf16 v[112:115], v[220:223], v[200:203], v[112:115]
    v_mfma_f32_16x16x32_bf16 v[148:151], v[220:223], v[204:207], v[148:151]
    ds_read_b64_tr_b16 v[220:221], v233 offset:18464
    ds_read_b64_tr_b16 v[222:223], v233 offset:23072
    s_add_u32 m0, s24, 9216
    s_nop 0
    buffer_load_dwordx4 v229, s[12:15], s25 offen offset:1024 lds
    v_mfma_f32_16x16x32_bf16 v[44:47], v[208:211], v[192:195], v[44:47]
    v_mfma_f32_16x16x32_bf16 v[80:83], v[208:211], v[196:199], v[80:83]
    v_mfma_f32_16x16x32_bf16 v[116:119], v[208:211], v[200:203], v[116:119]
    v_mfma_f32_16x16x32_bf16 v[152:155], v[208:211], v[204:207], v[152:155]
    ds_read_b64_tr_b16 v[208:209], v233 offset:18496
    ds_read_b64_tr_b16 v[210:211], v233 offset:23104
    s_add_u32 m0, s24, 9216
    s_nop 0
    buffer_load_dwordx4 v230, s[12:15], s25 offen offset:2048 lds
    v_mfma_f32_16x16x32_bf16 v[48:51], v[212:215], v[192:195], v[48:51]
    v_mfma_f32_16x16x32_bf16 v[84:87], v[212:215], v[196:199], v[84:87]
    v_mfma_f32_16x16x32_bf16 v[120:123], v[212:215], v[200:203], v[120:123]
    v_mfma_f32_16x16x32_bf16 v[156:159], v[212:215], v[204:207], v[156:159]
    ds_read_b64_tr_b16 v[212:213], v233 offset:18528
    ds_read_b64_tr_b16 v[214:215], v233 offset:23136
    buffer_load_dwordx4 v[192:195], v224, s[8:11], s26 offen sc1
    s_waitcnt vmcnt(15) lgkmcnt(6)
    v_mfma_f32_16x16x32_bf16 v[16:19], v[216:219], v[160:163], v[16:19]
    v_mfma_f32_16x16x32_bf16 v[52:55], v[216:219], v[164:167], v[52:55]
    v_mfma_f32_16x16x32_bf16 v[88:91], v[216:219], v[168:171], v[88:91]
    v_mfma_f32_16x16x32_bf16 v[124:127], v[216:219], v[172:175], v[124:127]
    ds_read_b64_tr_b16 v[216:217], v233 offset:18560
    ds_read_b64_tr_b16 v[218:219], v233 offset:23168
    buffer_load_dwordx4 v[196:199], v225, s[8:11], s26 offen sc1
    s_waitcnt lgkmcnt(6)
    v_mfma_f32_16x16x32_bf16 v[20:23], v[220:223], v[160:163], v[20:23]
    v_mfma_f32_16x16x32_bf16 v[56:59], v[220:223], v[164:167], v[56:59]
    v_mfma_f32_16x16x32_bf16 v[92:95], v[220:223], v[168:171], v[92:95]
    v_mfma_f32_16x16x32_bf16 v[128:131], v[220:223], v[172:175], v[128:131]
    ds_read_b64_tr_b16 v[220:221], v233 offset:18592
    ds_read_b64_tr_b16 v[222:223], v233 offset:23200
    buffer_load_dwordx4 v[200:203], v226, s[8:11], s26 offen sc1
    s_waitcnt lgkmcnt(6)
    v_mfma_f32_16x16x32_bf16 v[24:27], v[208:211], v[160:163], v[24:27]
    v_mfma_f32_16x16x32_bf16 v[60:63], v[208:211], v[164:167], v[60:63]
    v_mfma_f32_16x16x32_bf16 v[96:99], v[208:211], v[168:171], v[96:99]
    v_mfma_f32_16x16x32_bf16 v[132:135], v[208:211], v[172:175], v[132:135]
    ds_read_b64_tr_b16 v[208:209], v233 offset:18624
    ds_read_b64_tr_b16 v[210:211], v233 offset:23232
    buffer_load_dwordx4 v[204:207], v227, s[8:11], s26 offen sc1
    s_add_u32 s26, s26, 1024
    s_waitcnt lgkmcnt(6)
    v_mfma_f32_16x16x32_bf16 v[28:31], v[212:215], v[160:163], v[28:31]
    v_mfma_f32_16x16x32_bf16 v[64:67], v[212:215], v[164:167], v[64:67]
    v_mfma_f32_16x16x32_bf16 v[100:103], v[212:215], v[168:171], v[100:103]
    v_mfma_f32_16x16x32_bf16 v[136:139], v[212:215], v[172:175], v[136:139]
    ds_read_b64_tr_b16 v[212:213], v233 offset:18656
    ds_read_b64_tr_b16 v[214:215], v233 offset:23264
    s_add_u32 m0, s24, 9216
    s_nop 0
    buffer_load_dwordx4 v231, s[12:15], s25 offen offset:3072 lds
    s_waitcnt lgkmcnt(6)
    v_mfma_f32_16x16x32_bf16 v[32:35], v[216:219], v[160:163], v[32:35]
    v_mfma_f32_16x16x32_bf16 v[68:71], v[216:219], v[164:167], v[68:71]
    v_mfma_f32_16x16x32_bf16 v[104:107], v[216:219], v[168:171], v[104:107]
    v_mfma_f32_16x16x32_bf16 v[140:143], v[216:219], v[172:175], v[140:143]
    ds_read_b64_tr_b16 v[216:217], v233 offset:18688
    ds_read_b64_tr_b16 v[218:219], v233 offset:23296
    s_add_u32 m0, s24, 13312
    s_nop 0
    buffer_load_dwordx4 v232, s[12:15], s25 offen offset:0 lds
    s_add_u32 s25, s25, 36864
    s_waitcnt lgkmcnt(6)
    v_mfma_f32_16x16x32_bf16 v[36:39], v[220:223], v[160:163], v[36:39]
    v_mfma_f32_16x16x32_bf16 v[72:75], v[220:223], v[164:167], v[72:75]
    v_mfma_f32_16x16x32_bf16 v[108:111], v[220:223], v[168:171], v[108:111]
    v_mfma_f32_16x16x32_bf16 v[144:147], v[220:223], v[172:175], v[144:147]
    s_waitcnt vmcnt(18) lgkmcnt(0)
    s_barrier
    ds_read_b64_tr_b16 v[220:221], v233 offset:27648
    ds_read_b64_tr_b16 v[222:223], v233 offset:32256
    s_add_u32 m0, s24, 18432
    s_nop 0
    buffer_load_dwordx4 v228, s[12:15], s25 offen offset:0 lds
    v_mfma_f32_16x16x32_bf16 v[40:43], v[208:211], v[160:163], v[40:43]
    v_mfma_f32_16x16x32_bf16 v[76:79], v[208:211], v[164:167], v[76:79]
    v_mfma_f32_16x16x32_bf16 v[112:115], v[208:211], v[168:171], v[112:115]
    v_mfma_f32_16x16x32_bf16 v[148:151], v[208:211], v[172:175], v[148:151]
    ds_read_b64_tr_b16 v[208:209], v233 offset:27680
    ds_read_b64_tr_b16 v[210:211], v233 offset:32288
    s_add_u32 m0, s24, 18432
    s_nop 0
    buffer_load_dwordx4 v229, s[12:15], s25 offen offset:1024 lds
    v_mfma_f32_16x16x32_bf16 v[44:47], v[212:215], v[160:163], v[44:47]
    v_mfma_f32_16x16x32_bf16 v[80:83], v[212:215], v[164:167], v[80:83]
    v_mfma_f32_16x16x32_bf16 v[116:119], v[212:215], v[168:171], v[116:119]
    v_mfma_f32_16x16x32_bf16 v[152:155], v[212:215], v[172:175], v[152:155]
    ds_read_b64_tr_b16 v[212:213], v233 offset:27712
    ds_read_b64_tr_b16 v[214:215], v233 offset:32320
    s_add_u32 m0, s24, 18432
    s_nop 0
    buffer_load_dwordx4 v230, s[12:15], s25 offen offset:2048 lds
    v_mfma_f32_16x16x32_bf16 v[48:51], v[216:219], v[160:163], v[48:51]
    v_mfma_f32_16x16x32_bf16 v[84:87], v[216:219], v[164:167], v[84:87]
    v_mfma_f32_16x16x32_bf16 v[120:123], v[216:219], v[168:171], v[120:123]
    v_mfma_f32_16x16x32_bf16 v[156:159], v[216:219], v[172:175], v[156:159]
    ds_read_b64_tr_b16 v[216:217], v233 offset:27744
    ds_read_b64_tr_b16 v[218:219], v233 offset:32352
    buffer_load_dwordx4 v[160:163], v224, s[8:11], s26 offen sc1
    s_waitcnt vmcnt(15) lgkmcnt(6)
    v_mfma_f32_16x16x32_bf16 v[16:19], v[220:223], v[176:179], v[16:19]
    v_mfma_f32_16x16x32_bf16 v[52:55], v[220:223], v[180:183], v[52:55]
    v_mfma_f32_16x16x32_bf16 v[88:91], v[220:223], v[184:187], v[88:91]
    v_mfma_f32_16x16x32_bf16 v[124:127], v[220:223], v[188:191], v[124:127]
    ds_read_b64_tr_b16 v[220:221], v233 offset:27776
    ds_read_b64_tr_b16 v[222:223], v233 offset:32384
    buffer_load_dwordx4 v[164:167], v225, s[8:11], s26 offen sc1
    s_waitcnt lgkmcnt(6)
    v_mfma_f32_16x16x32_bf16 v[20:23], v[208:211], v[176:179], v[20:23]
    v_mfma_f32_16x16x32_bf16 v[56:59], v[208:211], v[180:183], v[56:59]
    v_mfma_f32_16x16x32_bf16 v[92:95], v[208:211], v[184:187], v[92:95]
    v_mfma_f32_16x16x32_bf16 v[128:131], v[208:211], v[188:191], v[128:131]
    ds_read_b64_tr_b16 v[208:209], v233 offset:27808
    ds_read_b64_tr_b16 v[210:211], v233 offset:32416
    buffer_load_dwordx4 v[168:171], v226, s[8:11], s26 offen sc1
    s_waitcnt lgkmcnt(6)
    v_mfma_f32_16x16x32_bf16 v[24:27], v[212:215], v[176:179], v[24:27]
    v_mfma_f32_16x16x32_bf16 v[60:63], v[212:215], v[180:183], v[60:63]
    v_mfma_f32_16x16x32_bf16 v[96:99], v[212:215], v[184:187], v[96:99]
    v_mfma_f32_16x16x32_bf16 v[132:135], v[212:215], v[188:191], v[132:135]
    ds_read_b64_tr_b16 v[212:213], v233 offset:27840
    ds_read_b64_tr_b16 v[214:215], v233 offset:32448
    buffer_load_dwordx4 v[172:175], v227, s[8:11], s26 offen sc1
    s_add_u32 s26, s26, 1024
    s_waitcnt lgkmcnt(6)
    v_mfma_f32_16x16x32_bf16 v[28:31], v[216:219], v[176:179], v[28:31]
    v_mfma_f32_16x16x32_bf16 v[64:67], v[216:219], v[180:183], v[64:67]
    v_mfma_f32_16x16x32_bf16 v[100:103], v[216:219], v[184:187], v[100:103]
    v_mfma_f32_16x16x32_bf16 v[136:139], v[216:219], v[188:191], v[136:139]
    ds_read_b64_tr_b16 v[216:217], v233 offset:27872
    ds_read_b64_tr_b16 v[218:219], v233 offset:32480
    s_add_u32 m0, s24, 18432
    s_nop 0
    buffer_load_dwordx4 v231, s[12:15], s25 offen offset:3072 lds
    s_waitcnt lgkmcnt(6)
    v_mfma_f32_16x16x32_bf16 v[32:35], v[220:223], v[176:179], v[32:35]
    v_mfma_f32_16x16x32_bf16 v[68:71], v[220:223], v[180:183], v[68:71]
    v_mfma_f32_16x16x32_bf16 v[104:107], v[220:223], v[184:187], v[104:107]
    v_mfma_f32_16x16x32_bf16 v[140:143], v[220:223], v[188:191], v[140:143]
    ds_read_b64_tr_b16 v[220:221], v233 offset:27904
    ds_read_b64_tr_b16 v[222:223], v233 offset:32512
    s_add_u32 m0, s24, 22528
    s_nop 0
    buffer_load_dwordx4 v232, s[12:15], s25 offen offset:0 lds
    s_add_u32 s25, s25, 36864
    s_waitcnt lgkmcnt(6)
    v_mfma_f32_16x16x32_bf16 v[36:39], v[208:211], v[176:179], v[36:39]
    v_mfma_f32_16x16x32_bf16 v[72:75], v[208:211], v[180:183], v[72:75]
    v_mfma_f32_16x16x32_bf16 v[108:111], v[208:211], v[184:187], v[108:111]
    v_mfma_f32_16x16x32_bf16 v[144:147], v[208:211], v[188:191], v[144:147]
    s_waitcnt vmcnt(18) lgkmcnt(0)
    s_barrier
    ds_read_b64_tr_b16 v[208:209], v233 offset:0
    ds_read_b64_tr_b16 v[210:211], v233 offset:4608
    s_add_u32 m0, s24, 27648
    s_nop 0
    buffer_load_dwordx4 v228, s[12:15], s25 offen offset:0 lds
    v_mfma_f32_16x16x32_bf16 v[40:43], v[212:215], v[176:179], v[40:43]
    v_mfma_f32_16x16x32_bf16 v[76:79], v[212:215], v[180:183], v[76:79]
    v_mfma_f32_16x16x32_bf16 v[112:115], v[212:215], v[184:187], v[112:115]
    v_mfma_f32_16x16x32_bf16 v[148:151], v[212:215], v[188:191], v[148:151]
    ds_read_b64_tr_b16 v[212:213], v233 offset:32
    ds_read_b64_tr_b16 v[214:215], v233 offset:4640
    s_add_u32 m0, s24, 27648
    s_nop 0
    buffer_load_dwordx4 v229, s[12:15], s25 offen offset:1024 lds
    v_mfma_f32_16x16x32_bf16 v[44:47], v[216:219], v[176:179], v[44:47]
    v_mfma_f32_16x16x32_bf16 v[80:83], v[216:219], v[180:183], v[80:83]
    v_mfma_f32_16x16x32_bf16 v[116:119], v[216:219], v[184:187], v[116:119]
    v_mfma_f32_16x16x32_bf16 v[152:155], v[216:219], v[188:191], v[152:155]
    ds_read_b64_tr_b16 v[216:217], v233 offset:64
    ds_read_b64_tr_b16 v[218:219], v233 offset:4672
    s_add_u32 m0, s24, 27648
    s_nop 0
    buffer_load_dwordx4 v230, s[12:15], s25 offen offset:2048 lds
    v_mfma_f32_16x16x32_bf16 v[48:51], v[220:223], v[176:179], v[48:51]
    v_mfma_f32_16x16x32_bf16 v[84:87], v[220:223], v[180:183], v[84:87]
    v_mfma_f32_16x16x32_bf16 v[120:123], v[220:223], v[184:187], v[120:123]
    v_mfma_f32_16x16x32_bf16 v[156:159], v[220:223], v[188:191], v[156:159]
    ds_read_b64_tr_b16 v[220:221], v233 offset:96
    ds_read_b64_tr_b16 v[222:223], v233 offset:4704
    buffer_load_dwordx4 v[176:179], v224, s[8:11], s26 offen sc1
    s_waitcnt vmcnt(15) lgkmcnt(6)
    v_mfma_f32_16x16x32_bf16 v[16:19], v[208:211], v[192:195], v[16:19]
    v_mfma_f32_16x16x32_bf16 v[52:55], v[208:211], v[196:199], v[52:55]
    v_mfma_f32_16x16x32_bf16 v[88:91], v[208:211], v[200:203], v[88:91]
    v_mfma_f32_16x16x32_bf16 v[124:127], v[208:211], v[204:207], v[124:127]
    ds_read_b64_tr_b16 v[208:209], v233 offset:128
    ds_read_b64_tr_b16 v[210:211], v233 offset:4736
    buffer_load_dwordx4 v[180:183], v225, s[8:11], s26 offen sc1
    s_waitcnt lgkmcnt(6)
    v_mfma_f32_16x16x32_bf16 v[20:23], v[212:215], v[192:195], v[20:23]
    v_mfma_f32_16x16x32_bf16 v[56:59], v[212:215], v[196:199], v[56:59]
    v_mfma_f32_16x16x32_bf16 v[92:95], v[212:215], v[200:203], v[92:95]
    v_mfma_f32_16x16x32_bf16 v[128:131], v[212:215], v[204:207], v[128:131]
    ds_read_b64_tr_b16 v[212:213], v233 offset:160
    ds_read_b64_tr_b16 v[214:215], v233 offset:4768
    buffer_load_dwordx4 v[184:187], v226, s[8:11], s26 offen sc1
    s_waitcnt lgkmcnt(6)
    v_mfma_f32_16x16x32_bf16 v[24:27], v[216:219], v[192:195], v[24:27]
    v_mfma_f32_16x16x32_bf16 v[60:63], v[216:219], v[196:199], v[60:63]
    v_mfma_f32_16x16x32_bf16 v[96:99], v[216:219], v[200:203], v[96:99]
    v_mfma_f32_16x16x32_bf16 v[132:135], v[216:219], v[204:207], v[132:135]
    ds_read_b64_tr_b16 v[216:217], v233 offset:192
    ds_read_b64_tr_b16 v[218:219], v233 offset:4800
    buffer_load_dwordx4 v[188:191], v227, s[8:11], s26 offen sc1
    s_add_u32 s26, s26, 1024
    s_waitcnt lgkmcnt(6)
    v_mfma_f32_16x16x32_bf16 v[28:31], v[220:223], v[192:195], v[28:31]
    v_mfma_f32_16x16x32_bf16 v[64:67], v[220:223], v[196:199], v[64:67]
    v_mfma_f32_16x16x32_bf16 v[100:103], v[220:223], v[200:203], v[100:103]
    v_mfma_f32_16x16x32_bf16 v[136:139], v[220:223], v[204:207], v[136:139]
    ds_read_b64_tr_b16 v[220:221], v233 offset:224
    ds_read_b64_tr_b16 v[222:223], v233 offset:4832
    s_add_u32 m0, s24, 27648
    s_nop 0
    buffer_load_dwordx4 v231, s[12:15], s25 offen offset:3072 lds
    s_waitcnt lgkmcnt(6)
    v_mfma_f32_16x16x32_bf16 v[32:35], v[208:211], v[192:195], v[32:35]
    v_mfma_f32_16x16x32_bf16 v[68:71], v[208:211], v[196:199], v[68:71]
    v_mfma_f32_16x16x32_bf16 v[104:107], v[208:211], v[200:203], v[104:107]
    v_mfma_f32_16x16x32_bf16 v[140:143], v[208:211], v[204:207], v[140:143]
    ds_read_b64_tr_b16 v[208:209], v233 offset:256
    ds_read_b64_tr_b16 v[210:211], v233 offset:4864
    s_add_u32 m0, s24, 31744
    s_nop 0
    buffer_load_dwordx4 v232, s[12:15], s25 offen offset:0 lds
    s_add_u32 s25, s25, 36864
    s_waitcnt lgkmcnt(6)
    v_mfma_f32_16x16x32_bf16 v[36:39], v[212:215], v[192:195], v[36:39]
    v_mfma_f32_16x16x32_bf16 v[72:75], v[212:215], v[196:199], v[72:75]
    v_mfma_f32_16x16x32_bf16 v[108:111], v[212:215], v[200:203], v[108:111]
    v_mfma_f32_16x16x32_bf16 v[144:147], v[212:215], v[204:207], v[144:147]
    s_waitcnt vmcnt(18) lgkmcnt(0)
    s_barrier
    ds_read_b64_tr_b16 v[212:213], v233 offset:9216
    ds_read_b64_tr_b16 v[214:215], v233 offset:13824
    s_add_u32 m0, s24, 0
    s_nop 0
    buffer_load_dwordx4 v228, s[12:15], s25 offen offset:0 lds
    v_mfma_f32_16x16x32_bf16 v[40:43], v[216:219], v[192:195], v[40:43]
    v_mfma_f32_16x16x32_bf16 v[76:79], v[216:219], v[196:199], v[76:79]
    v_mfma_f32_16x16x32_bf16 v[112:115], v[216:219], v[200:203], v[112:115]
    v_mfma_f32_16x16x32_bf16 v[148:151], v[216:219], v[204:207], v[148:151]
    ds_read_b64_tr_b16 v[216:217], v233 offset:9248
    ds_read_b64_tr_b16 v[218:219], v233 offset:13856
    s_add_u32 m0, s24, 0
    s_nop 0
    buffer_load_dwordx4 v229, s[12:15], s25 offen offset:1024 lds
    v_mfma_f32_16x16x32_bf16 v[44:47], v[220:223], v[192:195], v[44:47]
    v_mfma_f32_16x16x32_bf16 v[80:83], v[220:223], v[196:199], v[80:83]
    v_mfma_f32_16x16x32_bf16 v[116:119], v[220:223], v[200:203], v[116:119]
    v_mfma_f32_16x16x32_bf16 v[152:155], v[220:223], v[204:207], v[152:155]
    ds_read_b64_tr_b16 v[220:221], v233 offset:9280
    ds_read_b64_tr_b16 v[222:223], v233 offset:13888
    s_add_u32 m0, s24, 0
    s_nop 0
    buffer_load_dwordx4 v230, s[12:15], s25 offen offset:2048 lds
    v_mfma_f32_16x16x32_bf16 v[48:51], v[208:211], v[192:195], v[48:51]
    v_mfma_f32_16x16x32_bf16 v[84:87], v[208:211], v[196:199], v[84:87]
    v_mfma_f32_16x16x32_bf16 v[120:123], v[208:211], v[200:203], v[120:123]
    v_mfma_f32_16x16x32_bf16 v[156:159], v[208:211], v[204:207], v[156:159]
    ds_read_b64_tr_b16 v[208:209], v233 offset:9312
    ds_read_b64_tr_b16 v[210:211], v233 offset:13920
    buffer_load_dwordx4 v[192:195], v224, s[8:11], s26 offen sc1
    s_waitcnt vmcnt(15) lgkmcnt(6)
    v_mfma_f32_16x16x32_bf16 v[16:19], v[212:215], v[160:163], v[16:19]
    v_mfma_f32_16x16x32_bf16 v[52:55], v[212:215], v[164:167], v[52:55]
    v_mfma_f32_16x16x32_bf16 v[88:91], v[212:215], v[168:171], v[88:91]
    v_mfma_f32_16x16x32_bf16 v[124:127], v[212:215], v[172:175], v[124:127]
    ds_read_b64_tr_b16 v[212:213], v233 offset:9344
    ds_read_b64_tr_b16 v[214:215], v233 offset:13952
    buffer_load_dwordx4 v[196:199], v225, s[8:11], s26 offen sc1
    s_waitcnt lgkmcnt(6)
    v_mfma_f32_16x16x32_bf16 v[20:23], v[216:219], v[160:163], v[20:23]
    v_mfma_f32_16x16x32_bf16 v[56:59], v[216:219], v[164:167], v[56:59]
    v_mfma_f32_16x16x32_bf16 v[92:95], v[216:219], v[168:171], v[92:95]
    v_mfma_f32_16x16x32_bf16 v[128:131], v[216:219], v[172:175], v[128:131]
    ds_read_b64_tr_b16 v[216:217], v233 offset:9376
    ds_read_b64_tr_b16 v[218:219], v233 offset:13984
    buffer_load_dwordx4 v[200:203], v226, s[8:11], s26 offen sc1
    s_waitcnt lgkmcnt(6)
    v_mfma_f32_16x16x32_bf16 v[24:27], v[220:223], v[160:163], v[24:27]
    v_mfma_f32_16x16x32_bf16 v[60:63], v[220:223], v[164:167], v[60:63]
    v_mfma_f32_16x16x32_bf16 v[96:99], v[220:223], v[168:171], v[96:99]
    v_mfma_f32_16x16x32_bf16 v[132:135], v[220:223], v[172:175], v[132:135]
    ds_read_b64_tr_b16 v[220:221], v233 offset:9408
    ds_read_b64_tr_b16 v[222:223], v233 offset:14016
    buffer_load_dwordx4 v[204:207], v227, s[8:11], s26 offen sc1
    s_add_u32 s26, s26, 1024
    s_waitcnt lgkmcnt(6)
    v_mfma_f32_16x16x32_bf16 v[28:31], v[208:211], v[160:163], v[28:31]
    v_mfma_f32_16x16x32_bf16 v[64:67], v[208:211], v[164:167], v[64:67]
    v_mfma_f32_16x16x32_bf16 v[100:103], v[208:211], v[168:171], v[100:103]
    v_mfma_f32_16x16x32_bf16 v[136:139], v[208:211], v[172:175], v[136:139]
    ds_read_b64_tr_b16 v[208:209], v233 offset:9440
    ds_read_b64_tr_b16 v[210:211], v233 offset:14048
    s_add_u32 m0, s24, 0
    s_nop 0
    buffer_load_dwordx4 v231, s[12:15], s25 offen offset:3072 lds
    s_waitcnt lgkmcnt(6)
    v_mfma_f32_16x16x32_bf16 v[32:35], v[212:215], v[160:163], v[32:35]
    v_mfma_f32_16x16x32_bf16 v[68:71], v[212:215], v[164:167], v[68:71]
    v_mfma_f32_16x16x32_bf16 v[104:107], v[212:215], v[168:171], v[104:107]
    v_mfma_f32_16x16x32_bf16 v[140:143], v[212:215], v[172:175], v[140:143]
    ds_read_b64_tr_b16 v[212:213], v233 offset:9472
    ds_read_b64_tr_b16 v[214:215], v233 offset:14080
    s_add_u32 m0, s24, 4096
    s_nop 0
    buffer_load_dwordx4 v232, s[12:15], s25 offen offset:0 lds
    s_add_u32 s25, s25, 36864
    s_waitcnt lgkmcnt(6)
    v_mfma_f32_16x16x32_bf16 v[36:39], v[216:219], v[160:163], v[36:39]
    v_mfma_f32_16x16x32_bf16 v[72:75], v[216:219], v[164:167], v[72:75]
    v_mfma_f32_16x16x32_bf16 v[108:111], v[216:219], v[168:171], v[108:111]
    v_mfma_f32_16x16x32_bf16 v[144:147], v[216:219], v[172:175], v[144:147]
    s_waitcnt vmcnt(18) lgkmcnt(0)
    s_barrier
    ds_read_b64_tr_b16 v[216:217], v233 offset:18432
    ds_read_b64_tr_b16 v[218:219], v233 offset:23040
    s_add_u32 m0, s24, 9216
    s_nop 0
    buffer_load_dwordx4 v228, s[12:15], s25 offen offset:0 lds
    v_mfma_f32_16x16x32_bf16 v[40:43], v[220:223], v[160:163], v[40:43]
    v_mfma_f32_16x16x32_bf16 v[76:79], v[220:223], v[164:167], v[76:79]
    v_mfma_f32_16x16x32_bf16 v[112:115], v[220:223], v[168:171], v[112:115]
    v_mfma_f32_16x16x32_bf16 v[148:151], v[220:223], v[172:175], v[148:151]
    ds_read_b64_tr_b16 v[220:221], v233 offset:18464
    ds_read_b64_tr_b16 v[222:223], v233 offset:23072
    s_add_u32 m0, s24, 9216
    s_nop 0
    buffer_load_dwordx4 v229, s[12:15], s25 offen offset:1024 lds
    v_mfma_f32_16x16x32_bf16 v[44:47], v[208:211], v[160:163], v[44:47]
    v_mfma_f32_16x16x32_bf16 v[80:83], v[208:211], v[164:167], v[80:83]
    v_mfma_f32_16x16x32_bf16 v[116:119], v[208:211], v[168:171], v[116:119]
    v_mfma_f32_16x16x32_bf16 v[152:155], v[208:211], v[172:175], v[152:155]
    ds_read_b64_tr_b16 v[208:209], v233 offset:18496
    ds_read_b64_tr_b16 v[210:211], v233 offset:23104
    s_add_u32 m0, s24, 9216
    s_nop 0
    buffer_load_dwordx4 v230, s[12:15], s25 offen offset:2048 lds
    v_mfma_f32_16x16x32_bf16 v[48:51], v[212:215], v[160:163], v[48:51]
    v_mfma_f32_16x16x32_bf16 v[84:87], v[212:215], v[164:167], v[84:87]
    v_mfma_f32_16x16x32_bf16 v[120:123], v[212:215], v[168:171], v[120:123]
    v_mfma_f32_16x16x32_bf16 v[156:159], v[212:215], v[172:175], v[156:159]
    ds_read_b64_tr_b16 v[212:213], v233 offset:18528
    ds_read_b64_tr_b16 v[214:215], v233 offset:23136
    buffer_load_dwordx4 v[160:163], v224, s[8:11], s26 offen sc1
    s_waitcnt vmcnt(15) lgkmcnt(6)
    v_mfma_f32_16x16x32_bf16 v[16:19], v[216:219], v[176:179], v[16:19]
    v_mfma_f32_16x16x32_bf16 v[52:55], v[216:219], v[180:183], v[52:55]
    v_mfma_f32_16x16x32_bf16 v[88:91], v[216:219], v[184:187], v[88:91]
    v_mfma_f32_16x16x32_bf16 v[124:127], v[216:219], v[188:191], v[124:127]
    ds_read_b64_tr_b16 v[216:217], v233 offset:18560
    ds_read_b64_tr_b16 v[218:219], v233 offset:23168
    buffer_load_dwordx4 v[164:167], v225, s[8:11], s26 offen sc1
    s_waitcnt lgkmcnt(6)
    v_mfma_f32_16x16x32_bf16 v[20:23], v[220:223], v[176:179], v[20:23]
    v_mfma_f32_16x16x32_bf16 v[56:59], v[220:223], v[180:183], v[56:59]
    v_mfma_f32_16x16x32_bf16 v[92:95], v[220:223], v[184:187], v[92:95]
    v_mfma_f32_16x16x32_bf16 v[128:131], v[220:223], v[188:191], v[128:131]
    ds_read_b64_tr_b16 v[220:221], v233 offset:18592
    ds_read_b64_tr_b16 v[222:223], v233 offset:23200
    buffer_load_dwordx4 v[168:171], v226, s[8:11], s26 offen sc1
    s_waitcnt lgkmcnt(6)
    v_mfma_f32_16x16x32_bf16 v[24:27], v[208:211], v[176:179], v[24:27]
    v_mfma_f32_16x16x32_bf16 v[60:63], v[208:211], v[180:183], v[60:63]
    v_mfma_f32_16x16x32_bf16 v[96:99], v[208:211], v[184:187], v[96:99]
    v_mfma_f32_16x16x32_bf16 v[132:135], v[208:211], v[188:191], v[132:135]
    ds_read_b64_tr_b16 v[208:209], v233 offset:18624
    ds_read_b64_tr_b16 v[210:211], v233 offset:23232
    buffer_load_dwordx4 v[172:175], v227, s[8:11], s26 offen sc1
    s_add_u32 s26, s26, 1024
    s_waitcnt lgkmcnt(6)
    v_mfma_f32_16x16x32_bf16 v[28:31], v[212:215], v[176:179], v[28:31]
    v_mfma_f32_16x16x32_bf16 v[64:67], v[212:215], v[180:183], v[64:67]
    v_mfma_f32_16x16x32_bf16 v[100:103], v[212:215], v[184:187], v[100:103]
    v_mfma_f32_16x16x32_bf16 v[136:139], v[212:215], v[188:191], v[136:139]
    ds_read_b64_tr_b16 v[212:213], v233 offset:18656
    ds_read_b64_tr_b16 v[214:215], v233 offset:23264
    s_add_u32 m0, s24, 9216
    s_nop 0
    buffer_load_dwordx4 v231, s[12:15], s25 offen offset:3072 lds
    s_waitcnt lgkmcnt(6)
    v_mfma_f32_16x16x32_bf16 v[32:35], v[216:219], v[176:179], v[32:35]
    v_mfma_f32_16x16x32_bf16 v[68:71], v[216:219], v[180:183], v[68:71]
    v_mfma_f32_16x16x32_bf16 v[104:107], v[216:219], v[184:187], v[104:107]
    v_mfma_f32_16x16x32_bf16 v[140:143], v[216:219], v[188:191], v[140:143]
    ds_read_b64_tr_b16 v[216:217], v233 offset:18688
    ds_read_b64_tr_b16 v[218:219], v233 offset:23296
    s_add_u32 m0, s24, 13312
    s_nop 0
    buffer_load_dwordx4 v232, s[12:15], s25 offen offset:0 lds
    s_add_u32 s25, s25, 36864
    s_waitcnt lgkmcnt(6)
    v_mfma_f32_16x16x32_bf16 v[36:39], v[220:223], v[176:179], v[36:39]
    v_mfma_f32_16x16x32_bf16 v[72:75], v[220:223], v[180:183], v[72:75]
    v_mfma_f32_16x16x32_bf16 v[108:111], v[220:223], v[184:187], v[108:111]
    v_mfma_f32_16x16x32_bf16 v[144:147], v[220:223], v[188:191], v[144:147]
    s_waitcnt vmcnt(18) lgkmcnt(0)
    s_barrier
    ds_read_b64_tr_b16 v[220:221], v233 offset:27648
    ds_read_b64_tr_b16 v[222:223], v233 offset:32256
    s_add_u32 m0, s24, 18432
    s_nop 0
    buffer_load_dwordx4 v228, s[12:15], s25 offen offset:0 lds
    v_mfma_f32_16x16x32_bf16 v[40:43], v[208:211], v[176:179], v[40:43]
    v_mfma_f32_16x16x32_bf16 v[76:79], v[208:211], v[180:183], v[76:79]
    v_mfma_f32_16x16x32_bf16 v[112:115], v[208:211], v[184:187], v[112:115]
    v_mfma_f32_16x16x32_bf16 v[148:151], v[208:211], v[188:191], v[148:151]
    ds_read_b64_tr_b16 v[208:209], v233 offset:27680
    ds_read_b64_tr_b16 v[210:211], v233 offset:32288
    s_add_u32 m0, s24, 18432
    s_nop 0
    buffer_load_dwordx4 v229, s[12:15], s25 offen offset:1024 lds
    v_mfma_f32_16x16x32_bf16 v[44:47], v[212:215], v[176:179], v[44:47]
    v_mfma_f32_16x16x32_bf16 v[80:83], v[212:215], v[180:183], v[80:83]
    v_mfma_f32_16x16x32_bf16 v[116:119], v[212:215], v[184:187], v[116:119]
    v_mfma_f32_16x16x32_bf16 v[152:155], v[212:215], v[188:191], v[152:155]
    ds_read_b64_tr_b16 v[212:213], v233 offset:27712
    ds_read_b64_tr_b16 v[214:215], v233 offset:32320
    s_add_u32 m0, s24, 18432
    s_nop 0
    buffer_load_dwordx4 v230, s[12:15], s25 offen offset:2048 lds
    v_mfma_f32_16x16x32_bf16 v[48:51], v[216:219], v[176:179], v[48:51]
    v_mfma_f32_16x16x32_bf16 v[84:87], v[216:219], v[180:183], v[84:87]
    v_mfma_f32_16x16x32_bf16 v[120:123], v[216:219], v[184:187], v[120:123]
    v_mfma_f32_16x16x32_bf16 v[156:159], v[216:219], v[188:191], v[156:159]
    ds_read_b64_tr_b16 v[216:217], v233 offset:27744
    ds_read_b64_tr_b16 v[218:219], v233 offset:32352
    buffer_load_dwordx4 v[176:179], v224, s[8:11], s26 offen sc1
    s_waitcnt vmcnt(15) lgkmcnt(6)
    v_mfma_f32_16x16x32_bf16 v[16:19], v[220:223], v[192:195], v[16:19]
    v_mfma_f32_16x16x32_bf16 v[52:55], v[220:223], v[196:199], v[52:55]
    v_mfma_f32_16x16x32_bf16 v[88:91], v[220:223], v[200:203], v[88:91]
    v_mfma_f32_16x16x32_bf16 v[124:127], v[220:223], v[204:207], v[124:127]
    ds_read_b64_tr_b16 v[220:221], v233 offset:27776
    ds_read_b64_tr_b16 v[222:223], v233 offset:32384
    buffer_load_dwordx4 v[180:183], v225, s[8:11], s26 offen sc1
    s_waitcnt lgkmcnt(6)
    v_mfma_f32_16x16x32_bf16 v[20:23], v[208:211], v[192:195], v[20:23]
    v_mfma_f32_16x16x32_bf16 v[56:59], v[208:211], v[196:199], v[56:59]
    v_mfma_f32_16x16x32_bf16 v[92:95], v[208:211], v[200:203], v[92:95]
    v_mfma_f32_16x16x32_bf16 v[128:131], v[208:211], v[204:207], v[128:131]
    ds_read_b64_tr_b16 v[208:209], v233 offset:27808
    ds_read_b64_tr_b16 v[210:211], v233 offset:32416
    buffer_load_dwordx4 v[184:187], v226, s[8:11], s26 offen sc1
    s_waitcnt lgkmcnt(6)
    v_mfma_f32_16x16x32_bf16 v[24:27], v[212:215], v[192:195], v[24:27]
    v_mfma_f32_16x16x32_bf16 v[60:63], v[212:215], v[196:199], v[60:63]
    v_mfma_f32_16x16x32_bf16 v[96:99], v[212:215], v[200:203], v[96:99]
    v_mfma_f32_16x16x32_bf16 v[132:135], v[212:215], v[204:207], v[132:135]
    ds_read_b64_tr_b16 v[212:213], v233 offset:27840
    ds_read_b64_tr_b16 v[214:215], v233 offset:32448
    buffer_load_dwordx4 v[188:191], v227, s[8:11], s26 offen sc1
    s_add_u32 s26, s26, 1024
    s_waitcnt lgkmcnt(6)
    v_mfma_f32_16x16x32_bf16 v[28:31], v[216:219], v[192:195], v[28:31]
    v_mfma_f32_16x16x32_bf16 v[64:67], v[216:219], v[196:199], v[64:67]
    v_mfma_f32_16x16x32_bf16 v[100:103], v[216:219], v[200:203], v[100:103]
    v_mfma_f32_16x16x32_bf16 v[136:139], v[216:219], v[204:207], v[136:139]
    ds_read_b64_tr_b16 v[216:217], v233 offset:27872
    ds_read_b64_tr_b16 v[218:219], v233 offset:32480
    s_add_u32 m0, s24, 18432
    s_nop 0
    buffer_load_dwordx4 v231, s[12:15], s25 offen offset:3072 lds
    s_waitcnt lgkmcnt(6)
    v_mfma_f32_16x16x32_bf16 v[32:35], v[220:223], v[192:195], v[32:35]
    v_mfma_f32_16x16x32_bf16 v[68:71], v[220:223], v[196:199], v[68:71]
    v_mfma_f32_16x16x32_bf16 v[104:107], v[220:223], v[200:203], v[104:107]
    v_mfma_f32_16x16x32_bf16 v[140:143], v[220:223], v[204:207], v[140:143]
    ds_read_b64_tr_b16 v[220:221], v233 offset:27904
    ds_read_b64_tr_b16 v[222:223], v233 offset:32512
    s_add_u32 m0, s24, 22528
    s_nop 0
    buffer_load_dwordx4 v232, s[12:15], s25 offen offset:0 lds
    s_add_u32 s25, s25, 36864
    s_waitcnt lgkmcnt(6)
    v_mfma_f32_16x16x32_bf16 v[36:39], v[208:211], v[192:195], v[36:39]
    v_mfma_f32_16x16x32_bf16 v[72:75], v[208:211], v[196:199], v[72:75]
    v_mfma_f32_16x16x32_bf16 v[108:111], v[208:211], v[200:203], v[108:111]
    v_mfma_f32_16x16x32_bf16 v[144:147], v[208:211], v[204:207], v[144:147]
    s_waitcnt vmcnt(18) lgkmcnt(0)
    s_barrier
    ds_read_b64_tr_b16 v[208:209], v233 offset:0
    ds_read_b64_tr_b16 v[210:211], v233 offset:4608
    s_add_u32 m0, s24, 27648
    s_nop 0
    buffer_load_dwordx4 v228, s[12:15], s25 offen offset:0 lds
    v_mfma_f32_16x16x32_bf16 v[40:43], v[212:215], v[192:195], v[40:43]
    v_mfma_f32_16x16x32_bf16 v[76:79], v[212:215], v[196:199], v[76:79]
    v_mfma_f32_16x16x32_bf16 v[112:115], v[212:215], v[200:203], v[112:115]
    v_mfma_f32_16x16x32_bf16 v[148:151], v[212:215], v[204:207], v[148:151]
    ds_read_b64_tr_b16 v[212:213], v233 offset:32
    ds_read_b64_tr_b16 v[214:215], v233 offset:4640
    s_add_u32 m0, s24, 27648
    s_nop 0
    buffer_load_dwordx4 v229, s[12:15], s25 offen offset:1024 lds
    v_mfma_f32_16x16x32_bf16 v[44:47], v[216:219], v[192:195], v[44:47]
    v_mfma_f32_16x16x32_bf16 v[80:83], v[216:219], v[196:199], v[80:83]
    v_mfma_f32_16x16x32_bf16 v[116:119], v[216:219], v[200:203], v[116:119]
    v_mfma_f32_16x16x32_bf16 v[152:155], v[216:219], v[204:207], v[152:155]
    ds_read_b64_tr_b16 v[216:217], v233 offset:64
    ds_read_b64_tr_b16 v[218:219], v233 offset:4672
    s_add_u32 m0, s24, 27648
    s_nop 0
    buffer_load_dwordx4 v230, s[12:15], s25 offen offset:2048 lds
    v_mfma_f32_16x16x32_bf16 v[48:51], v[220:223], v[192:195], v[48:51]
    v_mfma_f32_16x16x32_bf16 v[84:87], v[220:223], v[196:199], v[84:87]
    v_mfma_f32_16x16x32_bf16 v[120:123], v[220:223], v[200:203], v[120:123]
    v_mfma_f32_16x16x32_bf16 v[156:159], v[220:223], v[204:207], v[156:159]
    ds_read_b64_tr_b16 v[220:221], v233 offset:96
    ds_read_b64_tr_b16 v[222:223], v233 offset:4704
    buffer_load_dwordx4 v[192:195], v224, s[8:11], s26 offen sc1
    s_waitcnt vmcnt(15) lgkmcnt(6)
    v_mfma_f32_16x16x32_bf16 v[16:19], v[208:211], v[160:163], v[16:19]
    v_mfma_f32_16x16x32_bf16 v[52:55], v[208:211], v[164:167], v[52:55]
    v_mfma_f32_16x16x32_bf16 v[88:91], v[208:211], v[168:171], v[88:91]
    v_mfma_f32_16x16x32_bf16 v[124:127], v[208:211], v[172:175], v[124:127]
    ds_read_b64_tr_b16 v[208:209], v233 offset:128
    ds_read_b64_tr_b16 v[210:211], v233 offset:4736
    buffer_load_dwordx4 v[196:199], v225, s[8:11], s26 offen sc1
    s_waitcnt lgkmcnt(6)
    v_mfma_f32_16x16x32_bf16 v[20:23], v[212:215], v[160:163], v[20:23]
    v_mfma_f32_16x16x32_bf16 v[56:59], v[212:215], v[164:167], v[56:59]
    v_mfma_f32_16x16x32_bf16 v[92:95], v[212:215], v[168:171], v[92:95]
    v_mfma_f32_16x16x32_bf16 v[128:131], v[212:215], v[172:175], v[128:131]
    ds_read_b64_tr_b16 v[212:213], v233 offset:160
    ds_read_b64_tr_b16 v[214:215], v233 offset:4768
    buffer_load_dwordx4 v[200:203], v226, s[8:11], s26 offen sc1
    s_waitcnt lgkmcnt(6)
    v_mfma_f32_16x16x32_bf16 v[24:27], v[216:219], v[160:163], v[24:27]
    v_mfma_f32_16x16x32_bf16 v[60:63], v[216:219], v[164:167], v[60:63]
    v_mfma_f32_16x16x32_bf16 v[96:99], v[216:219], v[168:171], v[96:99]
    v_mfma_f32_16x16x32_bf16 v[132:135], v[216:219], v[172:175], v[132:135]
    ds_read_b64_tr_b16 v[216:217], v233 offset:192
    ds_read_b64_tr_b16 v[218:219], v233 offset:4800
    buffer_load_dwordx4 v[204:207], v227, s[8:11], s26 offen sc1
    s_add_u32 s26, s26, 1024
    s_waitcnt lgkmcnt(6)
    v_mfma_f32_16x16x32_bf16 v[28:31], v[220:223], v[160:163], v[28:31]
    v_mfma_f32_16x16x32_bf16 v[64:67], v[220:223], v[164:167], v[64:67]
    v_mfma_f32_16x16x32_bf16 v[100:103], v[220:223], v[168:171], v[100:103]
    v_mfma_f32_16x16x32_bf16 v[136:139], v[220:223], v[172:175], v[136:139]
    ds_read_b64_tr_b16 v[220:221], v233 offset:224
    ds_read_b64_tr_b16 v[222:223], v233 offset:4832
    s_add_u32 m0, s24, 27648
    s_nop 0
    buffer_load_dwordx4 v231, s[12:15], s25 offen offset:3072 lds
    s_waitcnt lgkmcnt(6)
    v_mfma_f32_16x16x32_bf16 v[32:35], v[208:211], v[160:163], v[32:35]
    v_mfma_f32_16x16x32_bf16 v[68:71], v[208:211], v[164:167], v[68:71]
    v_mfma_f32_16x16x32_bf16 v[104:107], v[208:211], v[168:171], v[104:107]
    v_mfma_f32_16x16x32_bf16 v[140:143], v[208:211], v[172:175], v[140:143]
    ds_read_b64_tr_b16 v[208:209], v233 offset:256
    ds_read_b64_tr_b16 v[210:211], v233 offset:4864
    s_add_u32 m0, s24, 31744
    s_nop 0
    buffer_load_dwordx4 v232, s[12:15], s25 offen offset:0 lds
    s_add_u32 s25, s25, 36864
    s_waitcnt lgkmcnt(6)
    v_mfma_f32_16x16x32_bf16 v[36:39], v[212:215], v[160:163], v[36:39]
    v_mfma_f32_16x16x32_bf16 v[72:75], v[212:215], v[164:167], v[72:75]
    v_mfma_f32_16x16x32_bf16 v[108:111], v[212:215], v[168:171], v[108:111]
    v_mfma_f32_16x16x32_bf16 v[144:147], v[212:215], v[172:175], v[144:147]
    s_waitcnt vmcnt(18) lgkmcnt(0)
    s_barrier
    ds_read_b64_tr_b16 v[212:213], v233 offset:9216
    ds_read_b64_tr_b16 v[214:215], v233 offset:13824
    s_add_u32 m0, s24, 0
    s_nop 0
    buffer_load_dwordx4 v228, s[12:15], s25 offen offset:0 lds
    v_mfma_f32_16x16x32_bf16 v[40:43], v[216:219], v[160:163], v[40:43]
    v_mfma_f32_16x16x32_bf16 v[76:79], v[216:219], v[164:167], v[76:79]
    v_mfma_f32_16x16x32_bf16 v[112:115], v[216:219], v[168:171], v[112:115]
    v_mfma_f32_16x16x32_bf16 v[148:151], v[216:219], v[172:175], v[148:151]
    ds_read_b64_tr_b16 v[216:217], v233 offset:9248
    ds_read_b64_tr_b16 v[218:219], v233 offset:13856
    s_add_u32 m0, s24, 0
    s_nop 0
    buffer_load_dwordx4 v229, s[12:15], s25 offen offset:1024 lds
    v_mfma_f32_16x16x32_bf16 v[44:47], v[220:223], v[160:163], v[44:47]
    v_mfma_f32_16x16x32_bf16 v[80:83], v[220:223], v[164:167], v[80:83]
    v_mfma_f32_16x16x32_bf16 v[116:119], v[220:223], v[168:171], v[116:119]
    v_mfma_f32_16x16x32_bf16 v[152:155], v[220:223], v[172:175], v[152:155]
    ds_read_b64_tr_b16 v[220:221], v233 offset:9280
    ds_read_b64_tr_b16 v[222:223], v233 offset:13888
    s_add_u32 m0, s24, 0
    s_nop 0
    buffer_load_dwordx4 v230, s[12:15], s25 offen offset:2048 lds
    v_mfma_f32_16x16x32_bf16 v[48:51], v[208:211], v[160:163], v[48:51]
    v_mfma_f32_16x16x32_bf16 v[84:87], v[208:211], v[164:167], v[84:87]
    v_mfma_f32_16x16x32_bf16 v[120:123], v[208:211], v[168:171], v[120:123]
    v_mfma_f32_16x16x32_bf16 v[156:159], v[208:211], v[172:175], v[156:159]
    ds_read_b64_tr_b16 v[208:209], v233 offset:9312
    ds_read_b64_tr_b16 v[210:211], v233 offset:13920
    buffer_load_dwordx4 v[160:163], v224, s[8:11], s26 offen sc1
    s_waitcnt vmcnt(15) lgkmcnt(6)
    v_mfma_f32_16x16x32_bf16 v[16:19], v[212:215], v[176:179], v[16:19]
    v_mfma_f32_16x16x32_bf16 v[52:55], v[212:215], v[180:183], v[52:55]
    v_mfma_f32_16x16x32_bf16 v[88:91], v[212:215], v[184:187], v[88:91]
    v_mfma_f32_16x16x32_bf16 v[124:127], v[212:215], v[188:191], v[124:127]
    ds_read_b64_tr_b16 v[212:213], v233 offset:9344
    ds_read_b64_tr_b16 v[214:215], v233 offset:13952
    buffer_load_dwordx4 v[164:167], v225, s[8:11], s26 offen sc1
    s_waitcnt lgkmcnt(6)
    v_mfma_f32_16x16x32_bf16 v[20:23], v[216:219], v[176:179], v[20:23]
    v_mfma_f32_16x16x32_bf16 v[56:59], v[216:219], v[180:183], v[56:59]
    v_mfma_f32_16x16x32_bf16 v[92:95], v[216:219], v[184:187], v[92:95]
    v_mfma_f32_16x16x32_bf16 v[128:131], v[216:219], v[188:191], v[128:131]
    ds_read_b64_tr_b16 v[216:217], v233 offset:9376
    ds_read_b64_tr_b16 v[218:219], v233 offset:13984
    buffer_load_dwordx4 v[168:171], v226, s[8:11], s26 offen sc1
    s_waitcnt lgkmcnt(6)
    v_mfma_f32_16x16x32_bf16 v[24:27], v[220:223], v[176:179], v[24:27]
    v_mfma_f32_16x16x32_bf16 v[60:63], v[220:223], v[180:183], v[60:63]
    v_mfma_f32_16x16x32_bf16 v[96:99], v[220:223], v[184:187], v[96:99]
    v_mfma_f32_16x16x32_bf16 v[132:135], v[220:223], v[188:191], v[132:135]
    ds_read_b64_tr_b16 v[220:221], v233 offset:9408
    ds_read_b64_tr_b16 v[222:223], v233 offset:14016
    buffer_load_dwordx4 v[172:175], v227, s[8:11], s26 offen sc1
    s_add_u32 s26, s26, 1024
    s_waitcnt lgkmcnt(6)
    v_mfma_f32_16x16x32_bf16 v[28:31], v[208:211], v[176:179], v[28:31]
    v_mfma_f32_16x16x32_bf16 v[64:67], v[208:211], v[180:183], v[64:67]
    v_mfma_f32_16x16x32_bf16 v[100:103], v[208:211], v[184:187], v[100:103]
    v_mfma_f32_16x16x32_bf16 v[136:139], v[208:211], v[188:191], v[136:139]
    ds_read_b64_tr_b16 v[208:209], v233 offset:9440
    ds_read_b64_tr_b16 v[210:211], v233 offset:14048
    s_add_u32 m0, s24, 0
    s_nop 0
    buffer_load_dwordx4 v231, s[12:15], s25 offen offset:3072 lds
    s_waitcnt lgkmcnt(6)
    v_mfma_f32_16x16x32_bf16 v[32:35], v[212:215], v[176:179], v[32:35]
    v_mfma_f32_16x16x32_bf16 v[68:71], v[212:215], v[180:183], v[68:71]
    v_mfma_f32_16x16x32_bf16 v[104:107], v[212:215], v[184:187], v[104:107]
    v_mfma_f32_16x16x32_bf16 v[140:143], v[212:215], v[188:191], v[140:143]
    ds_read_b64_tr_b16 v[212:213], v233 offset:9472
    ds_read_b64_tr_b16 v[214:215], v233 offset:14080
    s_add_u32 m0, s24, 4096
    s_nop 0
    buffer_load_dwordx4 v232, s[12:15], s25 offen offset:0 lds
    s_add_u32 s25, s25, 36864
    s_waitcnt lgkmcnt(6)
    v_mfma_f32_16x16x32_bf16 v[36:39], v[216:219], v[176:179], v[36:39]
    v_mfma_f32_16x16x32_bf16 v[72:75], v[216:219], v[180:183], v[72:75]
    v_mfma_f32_16x16x32_bf16 v[108:111], v[216:219], v[184:187], v[108:111]
    v_mfma_f32_16x16x32_bf16 v[144:147], v[216:219], v[188:191], v[144:147]
    s_waitcnt vmcnt(18) lgkmcnt(0)
    s_barrier
    ds_read_b64_tr_b16 v[216:217], v233 offset:18432
    ds_read_b64_tr_b16 v[218:219], v233 offset:23040
    s_add_u32 m0, s24, 9216
    s_nop 0
    buffer_load_dwordx4 v228, s[12:15], s25 offen offset:0 lds
    v_mfma_f32_16x16x32_bf16 v[40:43], v[220:223], v[176:179], v[40:43]
    v_mfma_f32_16x16x32_bf16 v[76:79], v[220:223], v[180:183], v[76:79]
    v_mfma_f32_16x16x32_bf16 v[112:115], v[220:223], v[184:187], v[112:115]
    v_mfma_f32_16x16x32_bf16 v[148:151], v[220:223], v[188:191], v[148:151]
    ds_read_b64_tr_b16 v[220:221], v233 offset:18464
    ds_read_b64_tr_b16 v[222:223], v233 offset:23072
    s_add_u32 m0, s24, 9216
    s_nop 0
    buffer_load_dwordx4 v229, s[12:15], s25 offen offset:1024 lds
    v_mfma_f32_16x16x32_bf16 v[44:47], v[208:211], v[176:179], v[44:47]
    v_mfma_f32_16x16x32_bf16 v[80:83], v[208:211], v[180:183], v[80:83]
    v_mfma_f32_16x16x32_bf16 v[116:119], v[208:211], v[184:187], v[116:119]
    v_mfma_f32_16x16x32_bf16 v[152:155], v[208:211], v[188:191], v[152:155]
    ds_read_b64_tr_b16 v[208:209], v233 offset:18496
    ds_read_b64_tr_b16 v[210:211], v233 offset:23104
    s_add_u32 m0, s24, 9216
    s_nop 0
    buffer_load_dwordx4 v230, s[12:15], s25 offen offset:2048 lds
    v_mfma_f32_16x16x32_bf16 v[48:51], v[212:215], v[176:179], v[48:51]
    v_mfma_f32_16x16x32_bf16 v[84:87], v[212:215], v[180:183], v[84:87]
    v_mfma_f32_16x16x32_bf16 v[120:123], v[212:215], v[184:187], v[120:123]
    v_mfma_f32_16x16x32_bf16 v[156:159], v[212:215], v[188:191], v[156:159]
    ds_read_b64_tr_b16 v[212:213], v233 offset:18528
    ds_read_b64_tr_b16 v[214:215], v233 offset:23136
    buffer_load_dwordx4 v[176:179], v224, s[8:11], s26 offen sc1
    s_waitcnt vmcnt(15) lgkmcnt(6)
    v_mfma_f32_16x16x32_bf16 v[16:19], v[216:219], v[192:195], v[16:19]
    v_mfma_f32_16x16x32_bf16 v[52:55], v[216:219], v[196:199], v[52:55]
    v_mfma_f32_16x16x32_bf16 v[88:91], v[216:219], v[200:203], v[88:91]
    v_mfma_f32_16x16x32_bf16 v[124:127], v[216:219], v[204:207], v[124:127]
    ds_read_b64_tr_b16 v[216:217], v233 offset:18560
    ds_read_b64_tr_b16 v[218:219], v233 offset:23168
    buffer_load_dwordx4 v[180:183], v225, s[8:11], s26 offen sc1
    s_waitcnt lgkmcnt(6)
    v_mfma_f32_16x16x32_bf16 v[20:23], v[220:223], v[192:195], v[20:23]
    v_mfma_f32_16x16x32_bf16 v[56:59], v[220:223], v[196:199], v[56:59]
    v_mfma_f32_16x16x32_bf16 v[92:95], v[220:223], v[200:203], v[92:95]
    v_mfma_f32_16x16x32_bf16 v[128:131], v[220:223], v[204:207], v[128:131]
    ds_read_b64_tr_b16 v[220:221], v233 offset:18592
    ds_read_b64_tr_b16 v[222:223], v233 offset:23200
    buffer_load_dwordx4 v[184:187], v226, s[8:11], s26 offen sc1
    s_waitcnt lgkmcnt(6)
    v_mfma_f32_16x16x32_bf16 v[24:27], v[208:211], v[192:195], v[24:27]
    v_mfma_f32_16x16x32_bf16 v[60:63], v[208:211], v[196:199], v[60:63]
    v_mfma_f32_16x16x32_bf16 v[96:99], v[208:211], v[200:203], v[96:99]
    v_mfma_f32_16x16x32_bf16 v[132:135], v[208:211], v[204:207], v[132:135]
    ds_read_b64_tr_b16 v[208:209], v233 offset:18624
    ds_read_b64_tr_b16 v[210:211], v233 offset:23232
    buffer_load_dwordx4 v[188:191], v227, s[8:11], s26 offen sc1
    s_add_u32 s26, s26, 1024
    s_waitcnt lgkmcnt(6)
    v_mfma_f32_16x16x32_bf16 v[28:31], v[212:215], v[192:195], v[28:31]
    v_mfma_f32_16x16x32_bf16 v[64:67], v[212:215], v[196:199], v[64:67]
    v_mfma_f32_16x16x32_bf16 v[100:103], v[212:215], v[200:203], v[100:103]
    v_mfma_f32_16x16x32_bf16 v[136:139], v[212:215], v[204:207], v[136:139]
    ds_read_b64_tr_b16 v[212:213], v233 offset:18656
    ds_read_b64_tr_b16 v[214:215], v233 offset:23264
    s_add_u32 m0, s24, 9216
    s_nop 0
    buffer_load_dwordx4 v231, s[12:15], s25 offen offset:3072 lds
    s_waitcnt lgkmcnt(6)
    v_mfma_f32_16x16x32_bf16 v[32:35], v[216:219], v[192:195], v[32:35]
    v_mfma_f32_16x16x32_bf16 v[68:71], v[216:219], v[196:199], v[68:71]
    v_mfma_f32_16x16x32_bf16 v[104:107], v[216:219], v[200:203], v[104:107]
    v_mfma_f32_16x16x32_bf16 v[140:143], v[216:219], v[204:207], v[140:143]
    ds_read_b64_tr_b16 v[216:217], v233 offset:18688
    ds_read_b64_tr_b16 v[218:219], v233 offset:23296
    s_add_u32 m0, s24, 13312
    s_nop 0
    buffer_load_dwordx4 v232, s[12:15], s25 offen offset:0 lds
    s_add_u32 s25, s25, 36864
    s_waitcnt lgkmcnt(6)
    v_mfma_f32_16x16x32_bf16 v[36:39], v[220:223], v[192:195], v[36:39]
    v_mfma_f32_16x16x32_bf16 v[72:75], v[220:223], v[196:199], v[72:75]
    v_mfma_f32_16x16x32_bf16 v[108:111], v[220:223], v[200:203], v[108:111]
    v_mfma_f32_16x16x32_bf16 v[144:147], v[220:223], v[204:207], v[144:147]
    s_waitcnt vmcnt(18) lgkmcnt(0)
    s_barrier
    ds_read_b64_tr_b16 v[220:221], v233 offset:27648
    ds_read_b64_tr_b16 v[222:223], v233 offset:32256
    v_mfma_f32_16x16x32_bf16 v[40:43], v[208:211], v[192:195], v[40:43]
    v_mfma_f32_16x16x32_bf16 v[76:79], v[208:211], v[196:199], v[76:79]
    v_mfma_f32_16x16x32_bf16 v[112:115], v[208:211], v[200:203], v[112:115]
    v_mfma_f32_16x16x32_bf16 v[148:151], v[208:211], v[204:207], v[148:151]
    ds_read_b64_tr_b16 v[208:209], v233 offset:27680
    ds_read_b64_tr_b16 v[210:211], v233 offset:32288
    v_mfma_f32_16x16x32_bf16 v[44:47], v[212:215], v[192:195], v[44:47]
    v_mfma_f32_16x16x32_bf16 v[80:83], v[212:215], v[196:199], v[80:83]
    v_mfma_f32_16x16x32_bf16 v[116:119], v[212:215], v[200:203], v[116:119]
    v_mfma_f32_16x16x32_bf16 v[152:155], v[212:215], v[204:207], v[152:155]
    ds_read_b64_tr_b16 v[212:213], v233 offset:27712
    ds_read_b64_tr_b16 v[214:215], v233 offset:32320
    v_mfma_f32_16x16x32_bf16 v[48:51], v[216:219], v[192:195], v[48:51]
    v_mfma_f32_16x16x32_bf16 v[84:87], v[216:219], v[196:199], v[84:87]
    v_mfma_f32_16x16x32_bf16 v[120:123], v[216:219], v[200:203], v[120:123]
    v_mfma_f32_16x16x32_bf16 v[156:159], v[216:219], v[204:207], v[156:159]
    ds_read_b64_tr_b16 v[216:217], v233 offset:27744
    ds_read_b64_tr_b16 v[218:219], v233 offset:32352
    buffer_load_dwordx4 v[192:195], v224, s[8:11], s26 offen sc1
    s_waitcnt vmcnt(12) lgkmcnt(6)
    v_mfma_f32_16x16x32_bf16 v[16:19], v[220:223], v[160:163], v[16:19]
    v_mfma_f32_16x16x32_bf16 v[52:55], v[220:223], v[164:167], v[52:55]
    v_mfma_f32_16x16x32_bf16 v[88:91], v[220:223], v[168:171], v[88:91]
    v_mfma_f32_16x16x32_bf16 v[124:127], v[220:223], v[172:175], v[124:127]
    ds_read_b64_tr_b16 v[220:221], v233 offset:27776
    ds_read_b64_tr_b16 v[222:223], v233 offset:32384
    buffer_load_dwordx4 v[196:199], v225, s[8:11], s26 offen sc1
    s_waitcnt lgkmcnt(6)
    v_mfma_f32_16x16x32_bf16 v[20:23], v[208:211], v[160:163], v[20:23]
    v_mfma_f32_16x16x32_bf16 v[56:59], v[208:211], v[164:167], v[56:59]
    v_mfma_f32_16x16x32_bf16 v[92:95], v[208:211], v[168:171], v[92:95]
    v_mfma_f32_16x16x32_bf16 v[128:131], v[208:211], v[172:175], v[128:131]
    ds_read_b64_tr_b16 v[208:209], v233 offset:27808
    ds_read_b64_tr_b16 v[210:211], v233 offset:32416
    buffer_load_dwordx4 v[200:203], v226, s[8:11], s26 offen sc1
    s_waitcnt lgkmcnt(6)
    v_mfma_f32_16x16x32_bf16 v[24:27], v[212:215], v[160:163], v[24:27]
    v_mfma_f32_16x16x32_bf16 v[60:63], v[212:215], v[164:167], v[60:63]
    v_mfma_f32_16x16x32_bf16 v[96:99], v[212:215], v[168:171], v[96:99]
    v_mfma_f32_16x16x32_bf16 v[132:135], v[212:215], v[172:175], v[132:135]
    ds_read_b64_tr_b16 v[212:213], v233 offset:27840
    ds_read_b64_tr_b16 v[214:215], v233 offset:32448
    buffer_load_dwordx4 v[204:207], v227, s[8:11], s26 offen sc1
    s_add_u32 s26, s26, 1024
    s_waitcnt lgkmcnt(6)
    v_mfma_f32_16x16x32_bf16 v[28:31], v[216:219], v[160:163], v[28:31]
    v_mfma_f32_16x16x32_bf16 v[64:67], v[216:219], v[164:167], v[64:67]
    v_mfma_f32_16x16x32_bf16 v[100:103], v[216:219], v[168:171], v[100:103]
    v_mfma_f32_16x16x32_bf16 v[136:139], v[216:219], v[172:175], v[136:139]
    ds_read_b64_tr_b16 v[216:217], v233 offset:27872
    ds_read_b64_tr_b16 v[218:219], v233 offset:32480
    s_waitcnt lgkmcnt(6)
    v_mfma_f32_16x16x32_bf16 v[32:35], v[220:223], v[160:163], v[32:35]
    v_mfma_f32_16x16x32_bf16 v[68:71], v[220:223], v[164:167], v[68:71]
    v_mfma_f32_16x16x32_bf16 v[104:107], v[220:223], v[168:171], v[104:107]
    v_mfma_f32_16x16x32_bf16 v[140:143], v[220:223], v[172:175], v[140:143]
    ds_read_b64_tr_b16 v[220:221], v233 offset:27904
    ds_read_b64_tr_b16 v[222:223], v233 offset:32512
    s_waitcnt lgkmcnt(6)
    v_mfma_f32_16x16x32_bf16 v[36:39], v[208:211], v[160:163], v[36:39]
    v_mfma_f32_16x16x32_bf16 v[72:75], v[208:211], v[164:167], v[72:75]
    v_mfma_f32_16x16x32_bf16 v[108:111], v[208:211], v[168:171], v[108:111]
    v_mfma_f32_16x16x32_bf16 v[144:147], v[208:211], v[172:175], v[144:147]
    s_waitcnt vmcnt(13) lgkmcnt(0)
    s_barrier
    ds_read_b64_tr_b16 v[208:209], v233 offset:0
    ds_read_b64_tr_b16 v[210:211], v233 offset:4608
    v_mfma_f32_16x16x32_bf16 v[40:43], v[212:215], v[160:163], v[40:43]
    v_mfma_f32_16x16x32_bf16 v[76:79], v[212:215], v[164:167], v[76:79]
    v_mfma_f32_16x16x32_bf16 v[112:115], v[212:215], v[168:171], v[112:115]
    v_mfma_f32_16x16x32_bf16 v[148:151], v[212:215], v[172:175], v[148:151]
    ds_read_b64_tr_b16 v[212:213], v233 offset:32
    ds_read_b64_tr_b16 v[214:215], v233 offset:4640
    v_mfma_f32_16x16x32_bf16 v[44:47], v[216:219], v[160:163], v[44:47]
    v_mfma_f32_16x16x32_bf16 v[80:83], v[216:219], v[164:167], v[80:83]
    v_mfma_f32_16x16x32_bf16 v[116:119], v[216:219], v[168:171], v[116:119]
    v_mfma_f32_16x16x32_bf16 v[152:155], v[216:219], v[172:175], v[152:155]
    ds_read_b64_tr_b16 v[216:217], v233 offset:64
    ds_read_b64_tr_b16 v[218:219], v233 offset:4672
    v_mfma_f32_16x16x32_bf16 v[48:51], v[220:223], v[160:163], v[48:51]
    v_mfma_f32_16x16x32_bf16 v[84:87], v[220:223], v[164:167], v[84:87]
    v_mfma_f32_16x16x32_bf16 v[120:123], v[220:223], v[168:171], v[120:123]
    v_mfma_f32_16x16x32_bf16 v[156:159], v[220:223], v[172:175], v[156:159]
    ds_read_b64_tr_b16 v[220:221], v233 offset:96
    ds_read_b64_tr_b16 v[222:223], v233 offset:4704
    s_waitcnt vmcnt(6) lgkmcnt(6)
    v_mfma_f32_16x16x32_bf16 v[16:19], v[208:211], v[176:179], v[16:19]
    v_mfma_f32_16x16x32_bf16 v[52:55], v[208:211], v[180:183], v[52:55]
    v_mfma_f32_16x16x32_bf16 v[88:91], v[208:211], v[184:187], v[88:91]
    v_mfma_f32_16x16x32_bf16 v[124:127], v[208:211], v[188:191], v[124:127]
    ds_read_b64_tr_b16 v[208:209], v233 offset:128
    ds_read_b64_tr_b16 v[210:211], v233 offset:4736
    s_waitcnt lgkmcnt(6)
    v_mfma_f32_16x16x32_bf16 v[20:23], v[212:215], v[176:179], v[20:23]
    v_mfma_f32_16x16x32_bf16 v[56:59], v[212:215], v[180:183], v[56:59]
    v_mfma_f32_16x16x32_bf16 v[92:95], v[212:215], v[184:187], v[92:95]
    v_mfma_f32_16x16x32_bf16 v[128:131], v[212:215], v[188:191], v[128:131]
    ds_read_b64_tr_b16 v[212:213], v233 offset:160
    ds_read_b64_tr_b16 v[214:215], v233 offset:4768
    s_waitcnt lgkmcnt(6)
    v_mfma_f32_16x16x32_bf16 v[24:27], v[216:219], v[176:179], v[24:27]
    v_mfma_f32_16x16x32_bf16 v[60:63], v[216:219], v[180:183], v[60:63]
    v_mfma_f32_16x16x32_bf16 v[96:99], v[216:219], v[184:187], v[96:99]
    v_mfma_f32_16x16x32_bf16 v[132:135], v[216:219], v[188:191], v[132:135]
    ds_read_b64_tr_b16 v[216:217], v233 offset:192
    ds_read_b64_tr_b16 v[218:219], v233 offset:4800
    s_waitcnt lgkmcnt(6)
    v_mfma_f32_16x16x32_bf16 v[28:31], v[220:223], v[176:179], v[28:31]
    v_mfma_f32_16x16x32_bf16 v[64:67], v[220:223], v[180:183], v[64:67]
    v_mfma_f32_16x16x32_bf16 v[100:103], v[220:223], v[184:187], v[100:103]
    v_mfma_f32_16x16x32_bf16 v[136:139], v[220:223], v[188:191], v[136:139]
    ds_read_b64_tr_b16 v[220:221], v233 offset:224
    ds_read_b64_tr_b16 v[222:223], v233 offset:4832
    s_waitcnt lgkmcnt(6)
    v_mfma_f32_16x16x32_bf16 v[32:35], v[208:211], v[176:179], v[32:35]
    v_mfma_f32_16x16x32_bf16 v[68:71], v[208:211], v[180:183], v[68:71]
    v_mfma_f32_16x16x32_bf16 v[104:107], v[208:211], v[184:187], v[104:107]
    v_mfma_f32_16x16x32_bf16 v[140:143], v[208:211], v[188:191], v[140:143]
    ds_read_b64_tr_b16 v[208:209], v233 offset:256
    ds_read_b64_tr_b16 v[210:211], v233 offset:4864
    s_waitcnt lgkmcnt(6)
    v_mfma_f32_16x16x32_bf16 v[36:39], v[212:215], v[176:179], v[36:39]
    v_mfma_f32_16x16x32_bf16 v[72:75], v[212:215], v[180:183], v[72:75]
    v_mfma_f32_16x16x32_bf16 v[108:111], v[212:215], v[184:187], v[108:111]
    v_mfma_f32_16x16x32_bf16 v[144:147], v[212:215], v[188:191], v[144:147]
    s_waitcnt vmcnt(4) lgkmcnt(0)
    s_barrier
    ds_read_b64_tr_b16 v[212:213], v233 offset:9216
    ds_read_b64_tr_b16 v[214:215], v233 offset:13824
    v_mfma_f32_16x16x32_bf16 v[40:43], v[216:219], v[176:179], v[40:43]
    v_mfma_f32_16x16x32_bf16 v[76:79], v[216:219], v[180:183], v[76:79]
    v_mfma_f32_16x16x32_bf16 v[112:115], v[216:219], v[184:187], v[112:115]
    v_mfma_f32_16x16x32_bf16 v[148:151], v[216:219], v[188:191], v[148:151]
    ds_read_b64_tr_b16 v[216:217], v233 offset:9248
    ds_read_b64_tr_b16 v[218:219], v233 offset:13856
    v_mfma_f32_16x16x32_bf16 v[44:47], v[220:223], v[176:179], v[44:47]
    v_mfma_f32_16x16x32_bf16 v[80:83], v[220:223], v[180:183], v[80:83]
    v_mfma_f32_16x16x32_bf16 v[116:119], v[220:223], v[184:187], v[116:119]
    v_mfma_f32_16x16x32_bf16 v[152:155], v[220:223], v[188:191], v[152:155]
    ds_read_b64_tr_b16 v[220:221], v233 offset:9280
    ds_read_b64_tr_b16 v[222:223], v233 offset:13888
    v_mfma_f32_16x16x32_bf16 v[48:51], v[208:211], v[176:179], v[48:51]
    v_mfma_f32_16x16x32_bf16 v[84:87], v[208:211], v[180:183], v[84:87]
    v_mfma_f32_16x16x32_bf16 v[120:123], v[208:211], v[184:187], v[120:123]
    v_mfma_f32_16x16x32_bf16 v[156:159], v[208:211], v[188:191], v[156:159]
    ds_read_b64_tr_b16 v[208:209], v233 offset:9312
    ds_read_b64_tr_b16 v[210:211], v233 offset:13920
    s_waitcnt vmcnt(0) lgkmcnt(6)
    v_mfma_f32_16x16x32_bf16 v[16:19], v[212:215], v[192:195], v[16:19]
    v_mfma_f32_16x16x32_bf16 v[52:55], v[212:215], v[196:199], v[52:55]
    v_mfma_f32_16x16x32_bf16 v[88:91], v[212:215], v[200:203], v[88:91]
    v_mfma_f32_16x16x32_bf16 v[124:127], v[212:215], v[204:207], v[124:127]
    ds_read_b64_tr_b16 v[212:213], v233 offset:9344
    ds_read_b64_tr_b16 v[214:215], v233 offset:13952
    s_waitcnt lgkmcnt(6)
    v_mfma_f32_16x16x32_bf16 v[20:23], v[216:219], v[192:195], v[20:23]
    v_mfma_f32_16x16x32_bf16 v[56:59], v[216:219], v[196:199], v[56:59]
    v_mfma_f32_16x16x32_bf16 v[92:95], v[216:219], v[200:203], v[92:95]
    v_mfma_f32_16x16x32_bf16 v[128:131], v[216:219], v[204:207], v[128:131]
    ds_read_b64_tr_b16 v[216:217], v233 offset:9376
    ds_read_b64_tr_b16 v[218:219], v233 offset:13984
    s_waitcnt lgkmcnt(6)
    v_mfma_f32_16x16x32_bf16 v[24:27], v[220:223], v[192:195], v[24:27]
    v_mfma_f32_16x16x32_bf16 v[60:63], v[220:223], v[196:199], v[60:63]
    v_mfma_f32_16x16x32_bf16 v[96:99], v[220:223], v[200:203], v[96:99]
    v_mfma_f32_16x16x32_bf16 v[132:135], v[220:223], v[204:207], v[132:135]
    ds_read_b64_tr_b16 v[220:221], v233 offset:9408
    ds_read_b64_tr_b16 v[222:223], v233 offset:14016
    s_waitcnt lgkmcnt(6)
    v_mfma_f32_16x16x32_bf16 v[28:31], v[208:211], v[192:195], v[28:31]
    v_mfma_f32_16x16x32_bf16 v[64:67], v[208:211], v[196:199], v[64:67]
    v_mfma_f32_16x16x32_bf16 v[100:103], v[208:211], v[200:203], v[100:103]
    v_mfma_f32_16x16x32_bf16 v[136:139], v[208:211], v[204:207], v[136:139]
    ds_read_b64_tr_b16 v[208:209], v233 offset:9440
    ds_read_b64_tr_b16 v[210:211], v233 offset:14048
    s_waitcnt lgkmcnt(6)
    v_mfma_f32_16x16x32_bf16 v[32:35], v[212:215], v[192:195], v[32:35]
    v_mfma_f32_16x16x32_bf16 v[68:71], v[212:215], v[196:199], v[68:71]
    v_mfma_f32_16x16x32_bf16 v[104:107], v[212:215], v[200:203], v[104:107]
    v_mfma_f32_16x16x32_bf16 v[140:143], v[212:215], v[204:207], v[140:143]
    ds_read_b64_tr_b16 v[212:213], v233 offset:9472
    ds_read_b64_tr_b16 v[214:215], v233 offset:14080
    s_waitcnt lgkmcnt(6)
    v_mfma_f32_16x16x32_bf16 v[36:39], v[216:219], v[192:195], v[36:39]
    v_mfma_f32_16x16x32_bf16 v[72:75], v[216:219], v[196:199], v[72:75]
    v_mfma_f32_16x16x32_bf16 v[108:111], v[216:219], v[200:203], v[108:111]
    v_mfma_f32_16x16x32_bf16 v[144:147], v[216:219], v[204:207], v[144:147]
    s_waitcnt lgkmcnt(4)
    v_mfma_f32_16x16x32_bf16 v[40:43], v[220:223], v[192:195], v[40:43]
    v_mfma_f32_16x16x32_bf16 v[76:79], v[220:223], v[196:199], v[76:79]
    v_mfma_f32_16x16x32_bf16 v[112:115], v[220:223], v[200:203], v[112:115]
    v_mfma_f32_16x16x32_bf16 v[148:151], v[220:223], v[204:207], v[148:151]
    s_waitcnt lgkmcnt(2)
    v_mfma_f32_16x16x32_bf16 v[44:47], v[208:211], v[192:195], v[44:47]
    v_mfma_f32_16x16x32_bf16 v[80:83], v[208:211], v[196:199], v[80:83]
    v_mfma_f32_16x16x32_bf16 v[116:119], v[208:211], v[200:203], v[116:119]
    v_mfma_f32_16x16x32_bf16 v[152:155], v[208:211], v[204:207], v[152:155]
    s_waitcnt lgkmcnt(0)
    v_mfma_f32_16x16x32_bf16 v[48:51], v[212:215], v[192:195], v[48:51]
    v_mfma_f32_16x16x32_bf16 v[84:87], v[212:215], v[196:199], v[84:87]
    v_mfma_f32_16x16x32_bf16 v[120:123], v[212:215], v[200:203], v[120:123]
    v_mfma_f32_16x16x32_bf16 v[156:159], v[212:215], v[204:207], v[156:159]
    s_nop 7
    s_nop 7
    s_add_u32 s16, s86, 0x2800000
    s_addc_u32 s17, s87, 0
    s_mov_b32 s18, 0x1200000
    s_mov_b32 s19, 0x00020000
    s_and_b32 s28, s5, 1
    s_lshl_b32 s28, s28, 1
    s_lshr_b32 s29, s5, 1
    s_or_b32 s28, s28, s29
    s_cmp_eq_u32 s28, s27
    s_cselect_b32 s37, 1, 0
    s_cselect_b32 s18, 0, s18
    v_lshlrev_b32 v2, 4, v1
    s_mul_i32 s28, s27, 18432
    v_add_u32 v3, s28, v2
    s_xor_b32 s29, s27, 2
    s_mul_i32 s29, s29, 18432
    v_add_u32 v4, s29, v2
    s_lshl_b32 s28, s6, 1
    s_add_u32 s28, s28, s3
    s_lshl_b32 s28, s28, 2
    s_add_u32 s28, s28, s4
    s_mul_i32 s28, s28, 9216
    s_mul_i32 s29, s5, 4718592
    s_add_u32 s28, s28, s29
    s_barrier
    s_cmp_lg_u32 s6, 0
    s_cbranch_scc1 k3_hi
    ds_write_b128 v3, v[88:91] offset:0
    ds_write_b128 v3, v[92:95] offset:1024
    ds_write_b128 v3, v[96:99] offset:2048
    ds_write_b128 v3, v[100:103] offset:3072
    ds_write_b128 v3, v[104:107] offset:4096
    ds_write_b128 v3, v[108:111] offset:5120
    ds_write_b128 v3, v[112:115] offset:6144
    ds_write_b128 v3, v[116:119] offset:7168
    ds_write_b128 v3, v[120:123] offset:8192
    ds_write_b128 v3, v[124:127] offset:9216
    ds_write_b128 v3, v[128:131] offset:10240
    ds_write_b128 v3, v[132:135] offset:11264
    ds_write_b128 v3, v[136:139] offset:12288
    ds_write_b128 v3, v[140:143] offset:13312
    ds_write_b128 v3, v[144:147] offset:14336
    ds_write_b128 v3, v[148:151] offset:15360
    ds_write_b128 v3, v[152:155] offset:16384
    ds_write_b128 v3, v[156:159] offset:17408
    s_waitcnt lgkmcnt(0)
    s_barrier
    ds_read_b128 v[88:91], v4 offset:0
    ds_read_b128 v[92:95], v4 offset:1024
    ds_read_b128 v[96:99], v4 offset:2048
    ds_read_b128 v[100:103], v4 offset:3072
    ds_read_b128 v[104:107], v4 offset:4096
    ds_read_b128 v[108:111], v4 offset:5120
    ds_read_b128 v[112:115], v4 offset:6144
    ds_read_b128 v[116:119], v4 offset:7168
    ds_read_b128 v[120:123], v4 offset:8192
    s_waitcnt lgkmcnt(8)
    v_pk_add_f32 v[16:17], v[16:17], v[88:89]
    v_pk_add_f32 v[18:19], v[18:19], v[90:91]
    buffer_store_dwordx4 v[16:19], v2, s[16:19], s28 offen offset:0 sc1
    ds_read_b128 v[124:127], v4 offset:9216
    s_waitcnt lgkmcnt(8)
    v_pk_add_f32 v[20:21], v[20:21], v[92:93]
    v_pk_add_f32 v[22:23], v[22:23], v[94:95]
    buffer_store_dwordx4 v[20:23], v2, s[16:19], s28 offen offset:1024 sc1
    ds_read_b128 v[128:131], v4 offset:10240
    s_waitcnt lgkmcnt(8)
    v_pk_add_f32 v[24:25], v[24:25], v[96:97]
    v_pk_add_f32 v[26:27], v[26:27], v[98:99]
    buffer_store_dwordx4 v[24:27], v2, s[16:19], s28 offen offset:2048 sc1
    ds_read_b128 v[132:135], v4 offset:11264
    s_waitcnt lgkmcnt(8)
    v_pk_add_f32 v[28:29], v[28:29], v[100:101]
    v_pk_add_f32 v[30:31], v[30:31], v[102:103]
    buffer_store_dwordx4 v[28:31], v2, s[16:19], s28 offen offset:3072 sc1
    s_add_u32 s28, s28, 4096
    ds_read_b128 v[136:139], v4 offset:12288
    s_waitcnt lgkmcnt(8)
    v_pk_add_f32 v[32:33], v[32:33], v[104:105]
    v_pk_add_f32 v[34:35], v[34:35], v[106:107]
    buffer_store_dwordx4 v[32:35], v2, s[16:19], s28 offen offset:0 sc1
    ds_read_b128 v[140:143], v4 offset:13312
    s_waitcnt lgkmcnt(8)
    v_pk_add_f32 v[36:37], v[36:37], v[108:109]
    v_pk_add_f32 v[38:39], v[38:39], v[110:111]
    buffer_store_dwordx4 v[36:39], v2, s[16:19], s28 offen offset:1024 sc1
    ds_read_b128 v[144:147], v4 offset:14336
    s_waitcnt lgkmcnt(8)
    v_pk_add_f32 v[40:41], v[40:41], v[112:113]
    v_pk_add_f32 v[42:43], v[42:43], v[114:115]
    buffer_store_dwordx4 v[40:43], v2, s[16:19], s28 offen offset:2048 sc1
    ds_read_b128 v[148:151], v4 offset:15360
    s_waitcnt lgkmcnt(8)
    v_pk_add_f32 v[44:45], v[44:45], v[116:117]
    v_pk_add_f32 v[46:47], v[46:47], v[118:119]
    buffer_store_dwordx4 v[44:47], v2, s[16:19], s28 offen offset:3072 sc1
    s_add_u32 s28, s28, 4096
    ds_read_b128 v[152:155], v4 offset:16384
    s_waitcnt lgkmcnt(8)
    v_pk_add_f32 v[48:49], v[48:49], v[120:121]
    v_pk_add_f32 v[50:51], v[50:51], v[122:123]
    buffer_store_dwordx4 v[48:51], v2, s[16:19], s28 offen offset:0 sc1
    s_add_u32 s28, s28, 28672
    ds_read_b128 v[156:159], v4 offset:17408
    s_waitcnt lgkmcnt(8)
    v_pk_add_f32 v[52:53], v[52:53], v[124:125]
    v_pk_add_f32 v[54:55], v[54:55], v[126:127]
    buffer_store_dwordx4 v[52:55], v2, s[16:19], s28 offen offset:0 sc1
    s_waitcnt lgkmcnt(7)
    v_pk_add_f32 v[56:57], v[56:57], v[128:129]
    v_pk_add_f32 v[58:59], v[58:59], v[130:131]
    buffer_store_dwordx4 v[56:59], v2, s[16:19], s28 offen offset:1024 sc1
    s_waitcnt lgkmcnt(6)
    v_pk_add_f32 v[60:61], v[60:61], v[132:133]
    v_pk_add_f32 v[62:63], v[62:63], v[134:135]
    buffer_store_dwordx4 v[60:63], v2, s[16:19], s28 offen offset:2048 sc1
    s_waitcnt lgkmcnt(5)
    v_pk_add_f32 v[64:65], v[64:65], v[136:137]
    v_pk_add_f32 v[66:67], v[66:67], v[138:139]
    buffer_store_dwordx4 v[64:67], v2, s[16:19], s28 offen offset:3072 sc1
    s_add_u32 s28, s28, 4096
    s_waitcnt lgkmcnt(4)
    v_pk_add_f32 v[68:69], v[68:69], v[140:141]
    v_pk_add_f32 v[70:71], v[70:71], v[142:143]
    buffer_store_dwordx4 v[68:71], v2, s[16:19], s28 offen offset:0 sc1
    s_waitcnt lgkmcnt(3)
    v_pk_add_f32 v[72:73], v[72:73], v[144:145]
    v_pk_add_f32 v[74:75], v[74:75], v[146:147]
    buffer_store_dwordx4 v[72:75], v2, s[16:19], s28 offen offset:1024 sc1
    s_waitcnt lgkmcnt(2)
    v_pk_add_f32 v[76:77], v[76:77], v[148:149]
    v_pk_add_f32 v[78:79], v[78:79], v[150:151]
    buffer_store_dwordx4 v[76:79], v2, s[16:19], s28 offen offset:2048 sc1
    s_waitcnt lgkmcnt(1)
    v_pk_add_f32 v[80:81], v[80:81], v[152:153]
    v_pk_add_f32 v[82:83], v[82:83], v[154:155]
    buffer_store_dwordx4 v[80:83], v2, s[16:19], s28 offen offset:3072 sc1
    s_add_u32 s28, s28, 4096
    s_waitcnt lgkmcnt(0)
    v_pk_add_f32 v[84:85], v[84:85], v[156:157]
    v_pk_add_f32 v[86:87], v[86:87], v[158:159]
    buffer_store_dwordx4 v[84:87], v2, s[16:19], s28 offen offset:0 sc1
    s_add_u32 s28, s28, 28672
    s_lshr_b32 s3, s3, 3
    s_lshl_b32 s39, s3, 2
    s_add_u32 s39, s39, s4
    s_lshl_b32 s39, s39, 2
    s_add_u32 s38, s39, s5
    s_setprio 0
    s_waitcnt vmcnt(0)
    s_barrier
    s_cmp_lg_u32 s27, 0
    s_cbranch_scc1 k2_pb_8
    s_lshl_b32 s28, s38, 2
    s_add_u32 s28, s28, 16384
    v_mov_b32 v3, s28
    v_mov_b32 v2, s100
    s_mov_b64 exec, 1
    buffer_store_dword v2, v3, s[96:99], 0 offen sc1
    s_mov_b64 exec, -1
k2_pb_8:
    s_lshl_b32 s3, s3, 3
    s_lshl_b32 s28, s5, 1
    s_add_u32 s3, s3, s28
    s_add_u32 s32, s86, 0x240000
    s_addc_u32 s33, s87, 0
    s_mov_b32 s34, 0x2000
    s_mov_b32 s35, 0x00020000
    s_mul_i32 s40, s4, 288
    s_and_b32 s41, s27, 1
    s_mul_i32 s43, s41, 9216
    s_add_u32 s41, s41, s3
    v_lshlrev_b32 v10, 4, v1
    s_cmp_eq_u32 s37, 0
    s_cbranch_scc1 k2_own_9
    v_add_u32 v9, 55296, v10
    ds_write_b128 v9, v[16:19] offset:0
    ds_write_b128 v9, v[20:23] offset:1024
    ds_write_b128 v9, v[24:27] offset:2048
    ds_write_b128 v9, v[28:31] offset:3072
    ds_write_b128 v9, v[32:35] offset:4096
    ds_write_b128 v9, v[36:39] offset:5120
    ds_write_b128 v9, v[40:43] offset:6144
    ds_write_b128 v9, v[44:47] offset:7168
    ds_write_b128 v9, v[48:51] offset:8192
    ds_write_b128 v9, v[52:55] offset:9216
    ds_write_b128 v9, v[56:59] offset:10240
    ds_write_b128 v9, v[60:63] offset:11264
    ds_write_b128 v9, v[64:67] offset:12288
    ds_write_b128 v9, v[68:71] offset:13312
    ds_write_b128 v9, v[72:75] offset:14336
    ds_write_b128 v9, v[76:79] offset:15360
    ds_write_b128 v9, v[80:83] offset:16384
    ds_write_b128 v9, v[84:87] offset:17408
    s_waitcnt lgkmcnt(0)
k2_own_9:
    s_barrier
    s_add_u32 s43, s43, 55296
    v_add_u32 v15, s43, v10
    s_lshl_b32 s42, s41, 4
    v_and_b32 v11, 15, v1
    v_add_u32 v11, s42, v11
    v_lshrrev_b32 v12, 4, v1
    v_lshlrev_b32 v12, 3, v12
    v_lshlrev_b32 v13, 2, v11
    buffer_load_dword v14, v13, s[32:35], 0 offen
    s_add_u32 s8, s86, 0x2400000
    s_addc_u32 s9, s87, 0
    s_mov_b32 s10, 0x300000
    s_mov_b32 s11, 0x00020000
    s_mov_b32 s12, s68
    s_mov_b32 s13, s69
    s_mov_b32 s14, 0xa2000
    s_mov_b32 s15, 0x00020000
    s_mov_b32 s16, s82
    s_mov_b32 s17, s83
    s_mov_b32 s18, 0x240000
    s_mov_b32 s19, 0x00020000
    s_mul_i32 s25, s27, 331776
    s_add_u32 s25, s25, s40
    s_mul_i32 s26, s27, 12288
    v_mul_u32_u24 v11, 1152, v11
    v_add_u32 v11, v11, v12
    s_mul_i32 s28, s3, 24576
    v_add_u32 v212, s28, v10
    v_add_u32 v213, 24576, v212
    s_mul_i32 s28, s27, 27648
    s_add_u32 s28, s28, 0
    v_add_u32 v13, s28, v10
    s_xor_b32 s28, s27, 1
    s_mul_i32 s28, s28, 27648
    s_add_u32 s28, s28, 0
    v_add_u32 v12, s28, v10
    s_mul_i32 s31, s27, 27648
    s_mov_b32 s24, s31
    s_mov_b32 s28, 0
    s_add_u32 s29, s28, 0
    v_add_u32 v2, s29, v1
    v_mul_u32_u24 v3, 3641, v2
    v_lshrrev_b32 v3, 16, v3
    v_mul_u32_u24 v4, 18, v3
    v_sub_u32 v4, v2, v4
    v_and_b32 v5, 0x33, v3
    v_and_b32 v6, 4, v3
    v_lshlrev_b32 v6, 1, v6
    v_and_b32 v7, 8, v3
    v_lshrrev_b32 v7, 1, v7
    v_or3_b32 v3, v5, v6, v7
    v_lshlrev_b32 v4, 4, v4
    v_add_u32 v5, 0, v3
    v_mul_u32_u24 v6, 2731, v5
    v_lshrrev_b32 v6, 16, v6
    v_mul_u32_u24 v7, 24, v6
    v_sub_u32 v5, v5, v7
    v_min_u32 v5, 17, v5
    v_mul_u32_u24 v6, 18, v6
    v_add_u32 v5, v5, v6
    v_mul_u32_u24 v5, 1152, v5
    v_add_u32 v5, v5, v4
    v_subrev_u32 v214, 0, v5
    v_add_u32 v5, 32, v3
    v_mul_u32_u24 v6, 2731, v5
    v_lshrrev_b32 v6, 16, v6
    v_mul_u32_u24 v7, 24, v6
    v_sub_u32 v5, v5, v7
    v_min_u32 v5, 17, v5
    v_mul_u32_u24 v6, 18, v6
    v_add_u32 v5, v5, v6
    v_mul_u32_u24 v5, 1152, v5
    v_add_u32 v5, v5, v4
    v_subrev_u32 v223, 0, v5
    v_add_u32 v5, 64, v3
    v_mul_u32_u24 v6, 2731, v5
    v_lshrrev_b32 v6, 16, v6
    v_mul_u32_u24 v7, 24, v6
    v_sub_u32 v5, v5, v7
    v_min_u32 v5, 17, v5
    v_mul_u32_u24 v6, 18, v6
    v_add_u32 v5, v5, v6
    v_mul_u32_u24 v5, 1152, v5
    v_add_u32 v5, v5, v4
    v_subrev_u32 v232, 0, v5
    s_add_u32 s29, s28, 64
    v_add_u32 v2, s29, v1
    v_mul_u32_u24 v3, 3641, v2
    v_lshrrev_b32 v3, 16, v3
    v_mul_u32_u24 v4, 18, v3
    v_sub_u32 v4, v2, v4
    v_and_b32 v5, 0x33, v3
    v_and_b32 v6, 4, v3
    v_lshlrev_b32 v6, 1, v6
    v_and_b32 v7, 8, v3
    v_lshrrev_b32 v7, 1, v7
    v_or3_b32 v3, v5, v6, v7
    v_lshlrev_b32 v4, 4, v4
    v_add_u32 v5, 0, v3
    v_mul_u32_u24 v6, 2731, v5
    v_lshrrev_b32 v6, 16, v6
    v_mul_u32_u24 v7, 24, v6
    v_sub_u32 v5, v5, v7
    v_min_u32 v5, 17, v5
    v_mul_u32_u24 v6, 18, v6
    v_add_u32 v5, v5, v6
    v_mul_u32_u24 v5, 1152, v5
    v_add_u32 v5, v5, v4
    v_subrev_u32 v215, 1024, v5
    v_add_u32 v5, 32, v3
    v_mul_u32_u24 v6, 2731, v5
    v_lshrrev_b32 v6, 16, v6
    v_mul_u32_u24 v7, 24, v6
    v_sub_u32 v5, v5, v7
    v_min_u32 v5, 17, v5
    v_mul_u32_u24 v6, 18, v6
    v_add_u32 v5, v5, v6
    v_mul_u32_u24 v5, 1152, v5
    v_add_u32 v5, v5, v4
    v_subrev_u32 v224, 1024, v5
    v_add_u32 v5, 64, v3
    v_mul_u32_u24 v6, 2731, v5
    v_lshrrev_b32 v6, 16, v6
    v_mul_u32_u24 v7, 24, v6
    v_sub_u32 v5, v5, v7
    v_min_u32 v5, 17, v5
    v_mul_u32_u24 v6, 18, v6
    v_add_u32 v5, v5, v6
    v_mul_u32_u24 v5, 1152, v5
    v_add_u32 v5, v5, v4
    v_subrev_u32 v233, 1024, v5
    s_add_u32 s29, s28, 128
    v_add_u32 v2, s29, v1
    v_mul_u32_u24 v3, 3641, v2
    v_lshrrev_b32 v3, 16, v3
    v_mul_u32_u24 v4, 18, v3
    v_sub_u32 v4, v2, v4
    v_and_b32 v5, 0x33, v3
    v_and_b32 v6, 4, v3
    v_lshlrev_b32 v6, 1, v6
    v_and_b32 v7, 8, v3
    v_lshrrev_b32 v7, 1, v7
    v_or3_b32 v3, v5, v6, v7
    v_lshlrev_b32 v4, 4, v4
    v_add_u32 v5, 0, v3
    v_mul_u32_u24 v6, 2731, v5
    v_lshrrev_b32 v6, 16, v6
    v_mul_u32_u24 v7, 24, v6
    v_sub_u32 v5, v5, v7
    v_min_u32 v5, 17, v5
    v_mul_u32_u24 v6, 18, v6
    v_add_u32 v5, v5, v6
    v_mul_u32_u24 v5, 1152, v5
    v_add_u32 v5, v5, v4
    v_subrev_u32 v216, 2048, v5
    v_add_u32 v5, 32, v3
    v_mul_u32_u24 v6, 2731, v5
    v_lshrrev_b32 v6, 16, v6
    v_mul_u32_u24 v7, 24, v6
    v_sub_u32 v5, v5, v7
    v_min_u32 v5, 17, v5
    v_mul_u32_u24 v6, 18, v6
    v_add_u32 v5, v5, v6
    v_mul_u32_u24 v5, 1152, v5
    v_add_u32 v5, v5, v4
    v_subrev_u32 v225, 2048, v5
    v_add_u32 v5, 64, v3
    v_mul_u32_u24 v6, 2731, v5
    v_lshrrev_b32 v6, 16, v6
    v_mul_u32_u24 v7, 24, v6
    v_sub_u32 v5, v5, v7
    v_min_u32 v5, 17, v5
    v_mul_u32_u24 v6, 18, v6
    v_add_u32 v5, v5, v6
    v_mul_u32_u24 v5, 1152, v5
    v_add_u32 v5, v5, v4
    v_subrev_u32 v234, 2048, v5
    s_add_u32 s29, s28, 192
    v_add_u32 v2, s29, v1
    v_mul_u32_u24 v3, 3641, v2
    v_lshrrev_b32 v3, 16, v3
    v_mul_u32_u24 v4, 18, v3
    v_sub_u32 v4, v2, v4
    v_and_b32 v5, 0x33, v3
    v_and_b32 v6, 4, v3
    v_lshlrev_b32 v6, 1, v6
    v_and_b32 v7, 8, v3
    v_lshrrev_b32 v7, 1, v7
    v_or3_b32 v3, v5, v6, v7
    v_lshlrev_b32 v4, 4, v4
    v_add_u32 v5, 0, v3
    v_mul_u32_u24 v6, 2731, v5
    v_lshrrev_b32 v6, 16, v6
    v_mul_u32_u24 v7, 24, v6
    v_sub_u32 v5, v5, v7
    v_min_u32 v5, 17, v5
    v_mul_u32_u24 v6, 18, v6
    v_add_u32 v5, v5, v6
    v_mul_u32_u24 v5, 1152, v5
    v_add_u32 v5, v5, v4
    v_subrev_u32 v217, 3072, v5
    v_add_u32 v5, 32, v3
    v_mul_u32_u24 v6, 2731, v5
    v_lshrrev_b32 v6, 16, v6
    v_mul_u32_u24 v7, 24, v6
    v_sub_u32 v5, v5, v7
    v_min_u32 v5, 17, v5
    v_mul_u32_u24 v6, 18, v6
    v_add_u32 v5, v5, v6
    v_mul_u32_u24 v5, 1152, v5
    v_add_u32 v5, v5, v4
    v_subrev_u32 v226, 3072, v5
    v_add_u32 v5, 64, v3
    v_mul_u32_u24 v6, 2731, v5
    v_lshrrev_b32 v6, 16, v6
    v_mul_u32_u24 v7, 24, v6
    v_sub_u32 v5, v5, v7
    v_min_u32 v5, 17, v5
    v_mul_u32_u24 v6, 18, v6
    v_add_u32 v5, v5, v6
    v_mul_u32_u24 v5, 1152, v5
    v_add_u32 v5, v5, v4
    v_subrev_u32 v235, 3072, v5
    s_add_u32 s29, s28, 256
    v_add_u32 v2, s29, v1
    v_mul_u32_u24 v3, 3641, v2
    v_lshrrev_b32 v3, 16, v3
    v_mul_u32_u24 v4, 18, v3
    v_sub_u32 v4, v2, v4
    v_and_b32 v5, 0x33, v3
    v_and_b32 v6, 4, v3
    v_lshlrev_b32 v6, 1, v6
    v_and_b32 v7, 8, v3
    v_lshrrev_b32 v7, 1, v7
    v_or3_b32 v3, v5, v6, v7
    v_lshlrev_b32 v4, 4, v4
    v_add_u32 v5, 0, v3
    v_mul_u32_u24 v6, 2731, v5
    v_lshrrev_b32 v6, 16, v6
    v_mul_u32_u24 v7, 24, v6
    v_sub_u32 v5, v5, v7
    v_min_u32 v5, 17, v5
    v_mul_u32_u24 v6, 18, v6
    v_add_u32 v5, v5, v6
    v_mul_u32_u24 v5, 1152, v5
    v_add_u32 v5, v5, v4
    v_subrev_u32 v218, 0, v5
    v_add_u32 v5, 32, v3
    v_mul_u32_u24 v6, 2731, v5
    v_lshrrev_b32 v6, 16, v6
    v_mul_u32_u24 v7, 24, v6
    v_sub_u32 v5, v5, v7
    v_min_u32 v5, 17, v5
    v_mul_u32_u24 v6, 18, v6
    v_add_u32 v5, v5, v6
    v_mul_u32_u24 v5, 1152, v5
    v_add_u32 v5, v5, v4
    v_subrev_u32 v227, 0, v5
    v_add_u32 v5, 64, v3
    v_mul_u32_u24 v6, 2731, v5
    v_lshrrev_b32 v6, 16, v6
    v_mul_u32_u24 v7, 24, v6
    v_sub_u32 v5, v5, v7
    v_min_u32 v5, 17, v5
    v_mul_u32_u24 v6, 18, v6
    v_add_u32 v5, v5, v6
    v_mul_u32_u24 v5, 1152, v5
    v_add_u32 v5, v5, v4
    v_subrev_u32 v236, 0, v5
    s_add_u32 s29, s28, 320
    v_add_u32 v2, s29, v1
    v_mul_u32_u24 v3, 3641, v2
    v_lshrrev_b32 v3, 16, v3
    v_mul_u32_u24 v4, 18, v3
    v_sub_u32 v4, v2, v4
    v_and_b32 v5, 0x33, v3
    v_and_b32 v6, 4, v3
    v_lshlrev_b32 v6, 1, v6
    v_and_b32 v7, 8, v3
    v_lshrrev_b32 v7, 1, v7
    v_or3_b32 v3, v5, v6, v7
    v_lshlrev_b32 v4, 4, v4
    v_add_u32 v5, 0, v3
    v_mul_u32_u24 v6, 2731, v5
    v_lshrrev_b32 v6, 16, v6
    v_mul_u32_u24 v7, 24, v6
    v_sub_u32 v5, v5, v7
    v_min_u32 v5, 17, v5
    v_mul_u32_u24 v6, 18, v6
    v_add_u32 v5, v5, v6
    v_mul_u32_u24 v5, 1152, v5
    v_add_u32 v5, v5, v4
    v_subrev_u32 v219, 1024, v5
    v_add_u32 v5, 32, v3
    v_mul_u32_u24 v6, 2731, v5
    v_lshrrev_b32 v6, 16, v6
    v_mul_u32_u24 v7, 24, v6
    v_sub_u32 v5, v5, v7
    v_min_u32 v5, 17, v5
    v_mul_u32_u24 v6, 18, v6
    v_add_u32 v5, v5, v6
    v_mul_u32_u24 v5, 1152, v5
    v_add_u32 v5, v5, v4
    v_subrev_u32 v228, 1024, v5
    v_add_u32 v5, 64, v3
    v_mul_u32_u24 v6, 2731, v5
    v_lshrrev_b32 v6, 16, v6
    v_mul_u32_u24 v7, 24, v6
    v_sub_u32 v5, v5, v7
    v_min_u32 v5, 17, v5
    v_mul_u32_u24 v6, 18, v6
    v_add_u32 v5, v5, v6
    v_mul_u32_u24 v5, 1152, v5
    v_add_u32 v5, v5, v4
    v_subrev_u32 v237, 1024, v5
    s_add_u32 s29, s28, 384
    v_add_u32 v2, s29, v1
    v_mul_u32_u24 v3, 3641, v2
    v_lshrrev_b32 v3, 16, v3
    v_mul_u32_u24 v4, 18, v3
    v_sub_u32 v4, v2, v4
    v_and_b32 v5, 0x33, v3
    v_and_b32 v6, 4, v3
    v_lshlrev_b32 v6, 1, v6
    v_and_b32 v7, 8, v3
    v_lshrrev_b32 v7, 1, v7
    v_or3_b32 v3, v5, v6, v7
    v_lshlrev_b32 v4, 4, v4
    v_add_u32 v5, 0, v3
    v_mul_u32_u24 v6, 2731, v5
    v_lshrrev_b32 v6, 16, v6
    v_mul_u32_u24 v7, 24, v6
    v_sub_u32 v5, v5, v7
    v_min_u32 v5, 17, v5
    v_mul_u32_u24 v6, 18, v6
    v_add_u32 v5, v5, v6
    v_mul_u32_u24 v5, 1152, v5
    v_add_u32 v5, v5, v4
    v_subrev_u32 v220, 2048, v5
    v_add_u32 v5, 32, v3
    v_mul_u32_u24 v6, 2731, v5
    v_lshrrev_b32 v6, 16, v6
    v_mul_u32_u24 v7, 24, v6
    v_sub_u32 v5, v5, v7
    v_min_u32 v5, 17, v5
    v_mul_u32_u24 v6, 18, v6
    v_add_u32 v5, v5, v6
    v_mul_u32_u24 v5, 1152, v5
    v_add_u32 v5, v5, v4
    v_subrev_u32 v229, 2048, v5
    v_add_u32 v5, 64, v3
    v_mul_u32_u24 v6, 2731, v5
    v_lshrrev_b32 v6, 16, v6
    v_mul_u32_u24 v7, 24, v6
    v_sub_u32 v5, v5, v7
    v_min_u32 v5, 17, v5
    v_mul_u32_u24 v6, 18, v6
    v_add_u32 v5, v5, v6
    v_mul_u32_u24 v5, 1152, v5
    v_add_u32 v5, v5, v4
    v_subrev_u32 v238, 2048, v5
    s_add_u32 s29, s28, 448
    v_add_u32 v2, s29, v1
    v_mul_u32_u24 v3, 3641, v2
    v_lshrrev_b32 v3, 16, v3
    v_mul_u32_u24 v4, 18, v3
    v_sub_u32 v4, v2, v4
    v_and_b32 v5, 0x33, v3
    v_and_b32 v6, 4, v3
    v_lshlrev_b32 v6, 1, v6
    v_and_b32 v7, 8, v3
    v_lshrrev_b32 v7, 1, v7
    v_or3_b32 v3, v5, v6, v7
    v_lshlrev_b32 v4, 4, v4
    v_add_u32 v5, 0, v3
    v_mul_u32_u24 v6, 2731, v5
    v_lshrrev_b32 v6, 16, v6
    v_mul_u32_u24 v7, 24, v6
    v_sub_u32 v5, v5, v7
    v_min_u32 v5, 17, v5
    v_mul_u32_u24 v6, 18, v6
    v_add_u32 v5, v5, v6
    v_mul_u32_u24 v5, 1152, v5
    v_add_u32 v5, v5, v4
    v_subrev_u32 v221, 3072, v5
    v_add_u32 v5, 32, v3
    v_mul_u32_u24 v6, 2731, v5
    v_lshrrev_b32 v6, 16, v6
    v_mul_u32_u24 v7, 24, v6
    v_sub_u32 v5, v5, v7
    v_min_u32 v5, 17, v5
    v_mul_u32_u24 v6, 18, v6
    v_add_u32 v5, v5, v6
    v_mul_u32_u24 v5, 1152, v5
    v_add_u32 v5, v5, v4
    v_subrev_u32 v230, 3072, v5
    v_add_u32 v5, 64, v3
    v_mul_u32_u24 v6, 2731, v5
    v_lshrrev_b32 v6, 16, v6
    v_mul_u32_u24 v7, 24, v6
    v_sub_u32 v5, v5, v7
    v_min_u32 v5, 17, v5
    v_mul_u32_u24 v6, 18, v6
    v_add_u32 v5, v5, v6
    v_mul_u32_u24 v5, 1152, v5
    v_add_u32 v5, v5, v4
    v_subrev_u32 v239, 3072, v5
    s_add_u32 s29, s28, 512
    v_add_u32 v2, s29, v1
    v_mul_u32_u24 v3, 3641, v2
    v_lshrrev_b32 v3, 16, v3
    v_mul_u32_u24 v4, 18, v3
    v_sub_u32 v4, v2, v4
    v_and_b32 v5, 0x33, v3
    v_and_b32 v6, 4, v3
    v_lshlrev_b32 v6, 1, v6
    v_and_b32 v7, 8, v3
    v_lshrrev_b32 v7, 1, v7
    v_or3_b32 v3, v5, v6, v7
    v_lshlrev_b32 v4, 4, v4
    v_add_u32 v5, 0, v3
    v_mul_u32_u24 v6, 2731, v5
    v_lshrrev_b32 v6, 16, v6
    v_mul_u32_u24 v7, 24, v6
    v_sub_u32 v5, v5, v7
    v_min_u32 v5, 17, v5
    v_mul_u32_u24 v6, 18, v6
    v_add_u32 v5, v5, v6
    v_mul_u32_u24 v5, 1152, v5
    v_add_u32 v5, v5, v4
    v_subrev_u32 v222, 0, v5
    v_add_u32 v5, 32, v3
    v_mul_u32_u24 v6, 2731, v5
    v_lshrrev_b32 v6, 16, v6
    v_mul_u32_u24 v7, 24, v6
    v_sub_u32 v5, v5, v7
    v_min_u32 v5, 17, v5
    v_mul_u32_u24 v6, 18, v6
    v_add_u32 v5, v5, v6
    v_mul_u32_u24 v5, 1152, v5
    v_add_u32 v5, v5, v4
    v_subrev_u32 v231, 0, v5
    v_add_u32 v5, 64, v3
    v_mul_u32_u24 v6, 2731, v5
    v_lshrrev_b32 v6, 16, v6
    v_mul_u32_u24 v7, 24, v6
    v_sub_u32 v5, v5, v7
    v_min_u32 v5, 17, v5
    v_mul_u32_u24 v6, 18, v6
    v_add_u32 v5, v5, v6
    v_mul_u32_u24 v5, 1152, v5
    v_add_u32 v5, v5, v4
    v_subrev_u32 v240, 0, v5
    v_lshrrev_b32 v2, 4, v1
    v_and_b32 v3, 15, v1
    v_lshrrev_b32 v4, 2, v3
    v_lshrrev_b32 v5, 1, v2
    v_lshlrev_b32 v5, 4, v5
    v_and_b32 v6, 1, v2
    v_lshlrev_b32 v6, 2, v6
    v_add3_u32 v4, v4, v5, v6
    v_mul_u32_u24 v4, 288, v4
    v_and_b32 v3, 3, v3
    v_lshlrev_b32 v3, 3, v3
    v_add_u32 v241, v4, v3
    v_add_u32 v241, s31, v241
    s_lshr_b32 s38, s3, 4
    s_lshl_b32 s38, s38, 5
    v_mov_b32 v16, 0
    v_mov_b32 v17, 0
    v_mov_b32 v18, 0
    v_mov_b32 v19, 0
    v_mov_b32 v20, 0
    v_mov_b32 v21, 0
    v_mov_b32 v22, 0
    v_mov_b32 v23, 0
    v_mov_b32 v24, 0
    v_mov_b32 v25, 0
    v_mov_b32 v26, 0
    v_mov_b32 v27, 0
    v_mov_b32 v28, 0
    v_mov_b32 v29, 0
    v_mov_b32 v30, 0
    v_mov_b32 v31, 0
    v_mov_b32 v32, 0
    v_mov_b32 v33, 0
    v_mov_b32 v34, 0
    v_mov_b32 v35, 0
    v_mov_b32 v36, 0
    v_mov_b32 v37, 0
    v_mov_b32 v38, 0
    v_mov_b32 v39, 0
    v_mov_b32 v40, 0
    v_mov_b32 v41, 0
    v_mov_b32 v42, 0
    v_mov_b32 v43, 0
    v_mov_b32 v44, 0
    v_mov_b32 v45, 0
    v_mov_b32 v46, 0
    v_mov_b32 v47, 0
    v_mov_b32 v48, 0
    v_mov_b32 v49, 0
    v_mov_b32 v50, 0
    v_mov_b32 v51, 0
    v_mov_b32 v52, 0
    v_mov_b32 v53, 0
    v_mov_b32 v54, 0
    v_mov_b32 v55, 0
    v_mov_b32 v56, 0
    v_mov_b32 v57, 0
    v_mov_b32 v58, 0
    v_mov_b32 v59, 0
    v_mov_b32 v60, 0
    v_mov_b32 v61, 0
    v_mov_b32 v62, 0
    v_mov_b32 v63, 0
    v_mov_b32 v64, 0
    v_mov_b32 v65, 0
    v_mov_b32 v66, 0
    v_mov_b32 v67, 0
    v_mov_b32 v68, 0
    v_mov_b32 v69, 0
    v_mov_b32 v70, 0
    v_mov_b32 v71, 0
    v_mov_b32 v72, 0
    v_mov_b32 v73, 0
    v_mov_b32 v74, 0
    v_mov_b32 v75, 0
    v_mov_b32 v76, 0
    v_mov_b32 v77, 0
    v_mov_b32 v78, 0
    v_mov_b32 v79, 0
    v_mov_b32 v80, 0
    v_mov_b32 v81, 0
    v_mov_b32 v82, 0
    v_mov_b32 v83, 0
    v_mov_b32 v84, 0
    v_mov_b32 v85, 0
    v_mov_b32 v86, 0
    v_mov_b32 v87, 0
    s_add_u32 m0, s24, 0
    s_nop 0
    buffer_load_dwordx4 v214, s[12:15], s25 offen offset:0 lds
    s_add_u32 m0, s24, 0
    s_nop 0
    buffer_load_dwordx4 v215, s[12:15], s25 offen offset:1024 lds
    s_add_u32 m0, s24, 0
    s_nop 0
    buffer_load_dwordx4 v216, s[12:15], s25 offen offset:2048 lds
    s_add_u32 m0, s24, 0
    s_nop 0
    buffer_load_dwordx4 v217, s[12:15], s25 offen offset:3072 lds
    s_add_u32 m0, s24, 4096
    s_nop 0
    buffer_load_dwordx4 v218, s[12:15], s25 offen offset:0 lds
    s_add_u32 m0, s24, 4096
    s_nop 0
    buffer_load_dwordx4 v219, s[12:15], s25 offen offset:1024 lds
    s_add_u32 m0, s24, 4096
    s_nop 0
    buffer_load_dwordx4 v220, s[12:15], s25 offen offset:2048 lds
    s_add_u32 m0, s24, 4096
    s_nop 0
    buffer_load_dwordx4 v221, s[12:15], s25 offen offset:3072 lds
    s_add_u32 m0, s24, 8192
    s_nop 0
    buffer_load_dwordx4 v222, s[12:15], s25 offen offset:0 lds
    s_add_u32 m0, s24, 9216
    s_nop 0
    buffer_load_dwordx4 v223, s[12:15], s25 offen offset:0 lds
    s_add_u32 m0, s24, 9216
    s_nop 0
    buffer_load_dwordx4 v224, s[12:15], s25 offen offset:1024 lds
    s_add_u32 m0, s24, 9216
    s_nop 0
    buffer_load_dwordx4 v225, s[12:15], s25 offen offset:2048 lds
    s_add_u32 m0, s24, 9216
    s_nop 0
    buffer_load_dwordx4 v226, s[12:15], s25 offen offset:3072 lds
    s_add_u32 m0, s24, 13312
    s_nop 0
    buffer_load_dwordx4 v227, s[12:15], s25 offen offset:0 lds
    s_add_u32 m0, s24, 13312
    s_nop 0
    buffer_load_dwordx4 v228, s[12:15], s25 offen offset:1024 lds
    s_add_u32 m0, s24, 13312
    s_nop 0
    buffer_load_dwordx4 v229, s[12:15], s25 offen offset:2048 lds
    s_add_u32 m0, s24, 13312
    s_nop 0
    buffer_load_dwordx4 v230, s[12:15], s25 offen offset:3072 lds
    s_add_u32 m0, s24, 17408
    s_nop 0
    buffer_load_dwordx4 v231, s[12:15], s25 offen offset:0 lds
    s_add_u32 m0, s24, 18432
    s_nop 0
    buffer_load_dwordx4 v232, s[12:15], s25 offen offset:0 lds
    s_add_u32 m0, s24, 18432
    s_nop 0
    buffer_load_dwordx4 v233, s[12:15], s25 offen offset:1024 lds
    s_add_u32 m0, s24, 18432
    s_nop 0
    buffer_load_dwordx4 v234, s[12:15], s25 offen offset:2048 lds
    s_add_u32 m0, s24, 18432
    s_nop 0
    buffer_load_dwordx4 v235, s[12:15], s25 offen offset:3072 lds
    s_add_u32 m0, s24, 22528
    s_nop 0
    buffer_load_dwordx4 v236, s[12:15], s25 offen offset:0 lds
    s_add_u32 m0, s24, 22528
    s_nop 0
    buffer_load_dwordx4 v237, s[12:15], s25 offen offset:1024 lds
    s_add_u32 m0, s24, 22528
    s_nop 0
    buffer_load_dwordx4 v238, s[12:15], s25 offen offset:2048 lds
    s_add_u32 m0, s24, 22528
    s_nop 0
    buffer_load_dwordx4 v239, s[12:15], s25 offen offset:3072 lds
    s_add_u32 m0, s24, 26624
    s_nop 0
    buffer_load_dwordx4 v240, s[12:15], s25 offen offset:0 lds
    s_add_u32 s25, s25, 82944
    s_mov_b32 s96, s84
    s_mov_b32 s97, s85
    s_mov_b32 s98, 0x100
    s_mov_b32 s99, 0x00020000
    v_mov_b32 v3, 0
    s_mov_b32 s101, 262144
k2_ng_12:
    buffer_load_dword v2, v3, s[96:99], 0 offen sc1
    s_waitcnt vmcnt(0)
    v_readfirstlane_b32 s100, v2
    s_cmp_lg_u32 s100, 0
    s_cbranch_scc1 k2_ngd_13
    s_sub_u32 s101, s101, 1
    s_cbranch_scc1 k2_ngd_13
    s_sleep 1
    s_branch k2_ng_12
k2_ngd_13:
    s_add_u32 s96, s86, 0x300000
    s_addc_u32 s97, s87, 0
    s_mov_b32 s98, 0x10000
    s_mov_b32 s99, 0x00020000
    s_lshl_b32 s28, s27, 4
    s_add_u32 s28, s28, s38
    s_lshl_b32 s28, s28, 2
    s_add_u32 s28, s28, 12288
    v_lshlrev_b32 v3, 2, v1
    v_add_u32 v3, s28, v3
    s_mov_b32 s36, 0x1111
    s_mov_b32 s101, 262144
k2_tl_10:
    s_mov_b64 exec, 0xffff
    buffer_load_dword v2, v3, s[96:99], 0 offen sc1
    s_waitcnt vmcnt(0)
    v_cmp_eq_u32 vcc, s100, v2
    s_mov_b64 exec, -1
    s_nop 0
    s_mov_b32 s28, vcc_lo
    s_lshr_b32 s29, s28, 1
    s_and_b32 s28, s28, s29
    s_lshr_b32 s29, s28, 2
    s_and_b32 s28, s28, s29
    s_and_b32 s29, s28, s36
    s_cbranch_scc1 k2_tlg_11
    s_mov_b32 s29, s36
    s_sub_u32 s101, s101, 1
    s_cbranch_scc1 k2_tlg_11
    s_sleep 1
    s_branch k2_tl_10
k2_tlg_11:
    s_bitcmp1_b32 s29, 0
    s_cbranch_scc0 k2_tls_14
    s_add_u32 s30, s26, 0
    buffer_load_dwordx4 v[88:91], v212, s[8:11], s30 offen offset:0 sc1
    buffer_load_dwordx4 v[92:95], v213, s[8:11], s30 offen offset:0 sc1
    buffer_load_dwordx4 v[96:99], v212, s[8:11], s30 offen offset:1024 sc1
    buffer_load_dwordx4 v[100:103], v213, s[8:11], s30 offen offset:1024 sc1
    buffer_load_dwordx4 v[104:107], v212, s[8:11], s30 offen offset:2048 sc1
    buffer_load_dwordx4 v[108:111], v213, s[8:11], s30 offen offset:2048 sc1
k2_tls_14:
    s_bitcmp1_b32 s29, 4
    s_cbranch_scc0 k2_tls_15
    s_add_u32 s30, s26, 3072
    buffer_load_dwordx4 v[112:115], v212, s[8:11], s30 offen offset:0 sc1
    buffer_load_dwordx4 v[116:119], v213, s[8:11], s30 offen offset:0 sc1
    buffer_load_dwordx4 v[120:123], v212, s[8:11], s30 offen offset:1024 sc1
    buffer_load_dwordx4 v[124:127], v213, s[8:11], s30 offen offset:1024 sc1
    buffer_load_dwordx4 v[128:131], v212, s[8:11], s30 offen offset:2048 sc1
    buffer_load_dwordx4 v[132:135], v213, s[8:11], s30 offen offset:2048 sc1
k2_tls_15:
    s_bitcmp1_b32 s29, 8
    s_cbranch_scc0 k2_tls_16
    s_add_u32 s30, s26, 6144
    buffer_load_dwordx4 v[136:139], v212, s[8:11], s30 offen offset:0 sc1
    buffer_load_dwordx4 v[140:143], v213, s[8:11], s30 offen offset:0 sc1
    buffer_load_dwordx4 v[144:147], v212, s[8:11], s30 offen offset:1024 sc1
    buffer_load_dwordx4 v[148:151], v213, s[8:11], s30 offen offset:1024 sc1
    buffer_load_dwordx4 v[152:155], v212, s[8:11], s30 offen offset:2048 sc1
    buffer_load_dwordx4 v[156:159], v213, s[8:11], s30 offen offset:2048 sc1
k2_tls_16:
    s_bitcmp1_b32 s29, 12
    s_cbranch_scc0 k2_tls_17
    s_add_u32 s30, s26, 9216
    buffer_load_dwordx4 v[160:163], v212, s[8:11], s30 offen offset:0 sc1
    buffer_load_dwordx4 v[164:167], v213, s[8:11], s30 offen offset:0 sc1
    buffer_load_dwordx4 v[168:171], v212, s[8:11], s30 offen offset:1024 sc1
    buffer_load_dwordx4 v[172:175], v213, s[8:11], s30 offen offset:1024 sc1
    buffer_load_dwordx4 v[176:179], v212, s[8:11], s30 offen offset:2048 sc1
    buffer_load_dwordx4 v[180:183], v213, s[8:11], s30 offen offset:2048 sc1
k2_tls_17:
    s_andn2_b32 s36, s36, s29
    s_cbranch_scc1 k2_tl_10
    s_waitcnt vmcnt(0)
    ds_read_b64_tr_b16 v[184:185], v241 offset:0
    ds_read_b64_tr_b16 v[186:187], v241 offset:2304
    ds_read_b64_tr_b16 v[188:189], v241 offset:32
    ds_read_b64_tr_b16 v[190:191], v241 offset:2336
    ds_read_b64_tr_b16 v[192:193], v241 offset:64
    ds_read_b64_tr_b16 v[194:195], v241 offset:2368
    ds_read_b64_tr_b16 v[196:197], v241 offset:96
    ds_read_b64_tr_b16 v[198:199], v241 offset:2400
    ds_read_b64_tr_b16 v[200:201], v241 offset:128
    ds_read_b64_tr_b16 v[202:203], v241 offset:2432
    ds_read_b64_tr_b16 v[204:205], v241 offset:160
    ds_read_b64_tr_b16 v[206:207], v241 offset:2464
    s_waitcnt lgkmcnt(10)
    v_mfma_f32_16x16x32_bf16 v[16:19], v[184:187], v[88:91], v[16:19]
    ds_read_b64_tr_b16 v[208:209], v241 offset:192
    ds_read_b64_tr_b16 v[210:211], v241 offset:2496
    v_mfma_f32_16x16x32_bf16 v[52:55], v[184:187], v[92:95], v[52:55]
    s_waitcnt lgkmcnt(10)
    v_mfma_f32_16x16x32_bf16 v[20:23], v[188:191], v[88:91], v[20:23]
    ds_read_b64_tr_b16 v[184:185], v241 offset:224
    ds_read_b64_tr_b16 v[186:187], v241 offset:2528
    v_mfma_f32_16x16x32_bf16 v[56:59], v[188:191], v[92:95], v[56:59]
    s_waitcnt lgkmcnt(10)
    v_mfma_f32_16x16x32_bf16 v[24:27], v[192:195], v[88:91], v[24:27]
    ds_read_b64_tr_b16 v[188:189], v241 offset:256
    ds_read_b64_tr_b16 v[190:191], v241 offset:2560
    v_mfma_f32_16x16x32_bf16 v[60:63], v[192:195], v[92:95], v[60:63]
    s_waitcnt lgkmcnt(10)
    v_mfma_f32_16x16x32_bf16 v[28:31], v[196:199], v[88:91], v[28:31]
    ds_read_b64_tr_b16 v[192:193], v241 offset:9216
    ds_read_b64_tr_b16 v[194:195], v241 offset:11520
    v_mfma_f32_16x16x32_bf16 v[64:67], v[196:199], v[92:95], v[64:67]
    s_waitcnt lgkmcnt(10)
    v_mfma_f32_16x16x32_bf16 v[32:35], v[200:203], v[88:91], v[32:35]
    ds_read_b64_tr_b16 v[196:197], v241 offset:9248
    ds_read_b64_tr_b16 v[198:199], v241 offset:11552
    v_mfma_f32_16x16x32_bf16 v[68:71], v[200:203], v[92:95], v[68:71]
    s_waitcnt lgkmcnt(10)
    v_mfma_f32_16x16x32_bf16 v[36:39], v[204:207], v[88:91], v[36:39]
    ds_read_b64_tr_b16 v[200:201], v241 offset:9280
    ds_read_b64_tr_b16 v[202:203], v241 offset:11584
    v_mfma_f32_16x16x32_bf16 v[72:75], v[204:207], v[92:95], v[72:75]
    s_waitcnt lgkmcnt(10)
    v_mfma_f32_16x16x32_bf16 v[40:43], v[208:211], v[88:91], v[40:43]
    ds_read_b64_tr_b16 v[204:205], v241 offset:9312
    ds_read_b64_tr_b16 v[206:207], v241 offset:11616
    v_mfma_f32_16x16x32_bf16 v[76:79], v[208:211], v[92:95], v[76:79]
    s_waitcnt lgkmcnt(10)
    v_mfma_f32_16x16x32_bf16 v[44:47], v[184:187], v[88:91], v[44:47]
    ds_read_b64_tr_b16 v[208:209], v241 offset:9344
    ds_read_b64_tr_b16 v[210:211], v241 offset:11648
    v_mfma_f32_16x16x32_bf16 v[80:83], v[184:187], v[92:95], v[80:83]
    s_waitcnt lgkmcnt(10)
    v_mfma_f32_16x16x32_bf16 v[48:51], v[188:191], v[88:91], v[48:51]
    ds_read_b64_tr_b16 v[184:185], v241 offset:9376
    ds_read_b64_tr_b16 v[186:187], v241 offset:11680
    v_mfma_f32_16x16x32_bf16 v[84:87], v[188:191], v[92:95], v[84:87]
    s_add_u32 m0, s24, 0
    s_nop 0
    buffer_load_dwordx4 v214, s[12:15], s25 offen offset:0 lds
    s_waitcnt lgkmcnt(10)
    v_mfma_f32_16x16x32_bf16 v[16:19], v[192:195], v[96:99], v[16:19]
    ds_read_b64_tr_b16 v[188:189], v241 offset:9408
    ds_read_b64_tr_b16 v[190:191], v241 offset:11712
    v_mfma_f32_16x16x32_bf16 v[52:55], v[192:195], v[100:103], v[52:55]
    s_add_u32 m0, s24, 0
    s_nop 0
    buffer_load_dwordx4 v215, s[12:15], s25 offen offset:1024 lds
    s_waitcnt lgkmcnt(10)
    v_mfma_f32_16x16x32_bf16 v[20:23], v[196:199], v[96:99], v[20:23]
    ds_read_b64_tr_b16 v[192:193], v241 offset:9440
    ds_read_b64_tr_b16 v[194:195], v241 offset:11744
    v_mfma_f32_16x16x32_bf16 v[56:59], v[196:199], v[100:103], v[56:59]
    s_add_u32 m0, s24, 0
    s_nop 0
    buffer_load_dwordx4 v216, s[12:15], s25 offen offset:2048 lds
    s_waitcnt lgkmcnt(10)
    v_mfma_f32_16x16x32_bf16 v[24:27], v[200:203], v[96:99], v[24:27]
    ds_read_b64_tr_b16 v[196:197], v241 offset:9472
    ds_read_b64_tr_b16 v[198:199], v241 offset:11776
    v_mfma_f32_16x16x32_bf16 v[60:63], v[200:203], v[100:103], v[60:63]
    s_add_u32 m0, s24, 0
    s_nop 0
    buffer_load_dwordx4 v217, s[12:15], s25 offen offset:3072 lds
    s_waitcnt lgkmcnt(10)
    v_mfma_f32_16x16x32_bf16 v[28:31], v[204:207], v[96:99], v[28:31]
    s_add_u32 m0, s24, 4096
    s_nop 0
    buffer_load_dwordx4 v218, s[12:15], s25 offen offset:0 lds
    s_add_u32 m0, s24, 4096
    s_nop 0
    buffer_load_dwordx4 v219, s[12:15], s25 offen offset:1024 lds
    s_add_u32 m0, s24, 4096
    s_nop 0
    buffer_load_dwordx4 v220, s[12:15], s25 offen offset:2048 lds
    s_add_u32 m0, s24, 4096
    s_nop 0
    buffer_load_dwordx4 v221, s[12:15], s25 offen offset:3072 lds
    s_add_u32 m0, s24, 8192
    s_nop 0
    buffer_load_dwordx4 v222, s[12:15], s25 offen offset:0 lds
    ds_read_b64_tr_b16 v[200:201], v241 offset:18432
    ds_read_b64_tr_b16 v[202:203], v241 offset:20736
    v_mfma_f32_16x16x32_bf16 v[64:67], v[204:207], v[100:103], v[64:67]
    s_waitcnt lgkmcnt(10)
    v_mfma_f32_16x16x32_bf16 v[32:35], v[208:211], v[96:99], v[32:35]
    ds_read_b64_tr_b16 v[204:205], v241 offset:18464
    ds_read_b64_tr_b16 v[206:207], v241 offset:20768
    v_mfma_f32_16x16x32_bf16 v[68:71], v[208:211], v[100:103], v[68:71]
    s_waitcnt lgkmcnt(10)
    v_mfma_f32_16x16x32_bf16 v[36:39], v[184:187], v[96:99], v[36:39]
    ds_read_b64_tr_b16 v[208:209], v241 offset:18496
    ds_read_b64_tr_b16 v[210:211], v241 offset:20800
    v_mfma_f32_16x16x32_bf16 v[72:75], v[184:187], v[100:103], v[72:75]
    s_waitcnt lgkmcnt(10)
    v_mfma_f32_16x16x32_bf16 v[40:43], v[188:191], v[96:99], v[40:43]
    ds_read_b64_tr_b16 v[184:185], v241 offset:18528
    ds_read_b64_tr_b16 v[186:187], v241 offset:20832
    v_mfma_f32_16x16x32_bf16 v[76:79], v[188:191], v[100:103], v[76:79]
    s_waitcnt lgkmcnt(10)
    v_mfma_f32_16x16x32_bf16 v[44:47], v[192:195], v[96:99], v[44:47]
    ds_read_b64_tr_b16 v[188:189], v241 offset:18560
    ds_read_b64_tr_b16 v[190:191], v241 offset:20864
    v_mfma_f32_16x16x32_bf16 v[80:83], v[192:195], v[100:103], v[80:83]
    s_waitcnt lgkmcnt(10)
    v_mfma_f32_16x16x32_bf16 v[48:51], v[196:199], v[96:99], v[48:51]
    ds_read_b64_tr_b16 v[192:193], v241 offset:18592
    ds_read_b64_tr_b16 v[194:195], v241 offset:20896
    v_mfma_f32_16x16x32_bf16 v[84:87], v[196:199], v[100:103], v[84:87]
    s_add_u32 m0, s24, 9216
    s_nop 0
    buffer_load_dwordx4 v223, s[12:15], s25 offen offset:0 lds
    s_waitcnt lgkmcnt(10)
    v_mfma_f32_16x16x32_bf16 v[16:19], v[200:203], v[104:107], v[16:19]
    ds_read_b64_tr_b16 v[196:197], v241 offset:18624
    ds_read_b64_tr_b16 v[198:199], v241 offset:20928
    v_mfma_f32_16x16x32_bf16 v[52:55], v[200:203], v[108:111], v[52:55]
    s_add_u32 m0, s24, 9216
    s_nop 0
    buffer_load_dwordx4 v224, s[12:15], s25 offen offset:1024 lds
    s_waitcnt lgkmcnt(10)
    v_mfma_f32_16x16x32_bf16 v[20:23], v[204:207], v[104:107], v[20:23]
    ds_read_b64_tr_b16 v[200:201], v241 offset:18656
    ds_read_b64_tr_b16 v[202:203], v241 offset:20960
    v_mfma_f32_16x16x32_bf16 v[56:59], v[204:207], v[108:111], v[56:59]
    s_add_u32 m0, s24, 9216
    s_nop 0
    buffer_load_dwordx4 v225, s[12:15], s25 offen offset:2048 lds
    s_waitcnt lgkmcnt(10)
    v_mfma_f32_16x16x32_bf16 v[24:27], v[208:211], v[104:107], v[24:27]
    ds_read_b64_tr_b16 v[204:205], v241 offset:18688
    ds_read_b64_tr_b16 v[206:207], v241 offset:20992
    v_mfma_f32_16x16x32_bf16 v[60:63], v[208:211], v[108:111], v[60:63]
    s_add_u32 m0, s24, 9216
    s_nop 0
    buffer_load_dwordx4 v226, s[12:15], s25 offen offset:3072 lds
    s_waitcnt lgkmcnt(10)
    v_mfma_f32_16x16x32_bf16 v[28:31], v[184:187], v[104:107], v[28:31]
    s_add_u32 m0, s24, 13312
    s_nop 0
    buffer_load_dwordx4 v227, s[12:15], s25 offen offset:0 lds
    s_add_u32 m0, s24, 13312
    s_nop 0
    buffer_load_dwordx4 v228, s[12:15], s25 offen offset:1024 lds
    s_add_u32 m0, s24, 13312
    s_nop 0
    buffer_load_dwordx4 v229, s[12:15], s25 offen offset:2048 lds
    s_add_u32 m0, s24, 13312
    s_nop 0
    buffer_load_dwordx4 v230, s[12:15], s25 offen offset:3072 lds
    s_add_u32 m0, s24, 17408
    s_nop 0
    buffer_load_dwordx4 v231, s[12:15], s25 offen offset:0 lds
    s_waitcnt vmcnt(9)
    ds_read_b64_tr_b16 v[208:209], v241 offset:0
    ds_read_b64_tr_b16 v[210:211], v241 offset:2304
    v_mfma_f32_16x16x32_bf16 v[64:67], v[184:187], v[108:111], v[64:67]
    s_waitcnt lgkmcnt(10)
    v_mfma_f32_16x16x32_bf16 v[32:35], v[188:191], v[104:107], v[32:35]
    ds_read_b64_tr_b16 v[184:185], v241 offset:32
    ds_read_b64_tr_b16 v[186:187], v241 offset:2336
    v_mfma_f32_16x16x32_bf16 v[68:71], v[188:191], v[108:111], v[68:71]
    s_waitcnt lgkmcnt(10)
    v_mfma_f32_16x16x32_bf16 v[36:39], v[192:195], v[104:107], v[36:39]
    ds_read_b64_tr_b16 v[188:189], v241 offset:64
    ds_read_b64_tr_b16 v[190:191], v241 offset:2368
    v_mfma_f32_16x16x32_bf16 v[72:75], v[192:195], v[108:111], v[72:75]
    s_waitcnt lgkmcnt(10)
    v_mfma_f32_16x16x32_bf16 v[40:43], v[196:199], v[104:107], v[40:43]
    ds_read_b64_tr_b16 v[192:193], v241 offset:96
    ds_read_b64_tr_b16 v[194:195], v241 offset:2400
    v_mfma_f32_16x16x32_bf16 v[76:79], v[196:199], v[108:111], v[76:79]
    s_waitcnt lgkmcnt(10)
    v_mfma_f32_16x16x32_bf16 v[44:47], v[200:203], v[104:107], v[44:47]
    ds_read_b64_tr_b16 v[196:197], v241 offset:128
    ds_read_b64_tr_b16 v[198:199], v241 offset:2432
    v_mfma_f32_16x16x32_bf16 v[80:83], v[200:203], v[108:111], v[80:83]
    s_waitcnt lgkmcnt(10)
    v_mfma_f32_16x16x32_bf16 v[48:51], v[204:207], v[104:107], v[48:51]
    ds_read_b64_tr_b16 v[200:201], v241 offset:160
    ds_read_b64_tr_b16 v[202:203], v241 offset:2464
    v_mfma_f32_16x16x32_bf16 v[84:87], v[204:207], v[108:111], v[84:87]
    s_add_u32 m0, s24, 18432
    s_nop 0
    buffer_load_dwordx4 v232, s[12:15], s25 offen offset:0 lds
    s_waitcnt lgkmcnt(10)
    v_mfma_f32_16x16x32_bf16 v[16:19], v[208:211], v[112:115], v[16:19]
    ds_read_b64_tr_b16 v[204:205], v241 offset:192
    ds_read_b64_tr_b16 v[206:207], v241 offset:2496
    v_mfma_f32_16x16x32_bf16 v[52:55], v[208:211], v[116:119], v[52:55]
    s_add_u32 m0, s24, 18432
    s_nop 0
    buffer_load_dwordx4 v233, s[12:15], s25 offen offset:1024 lds
    s_waitcnt lgkmcnt(10)
    v_mfma_f32_16x16x32_bf16 v[20:23], v[184:187], v[112:115], v[20:23]
    ds_read_b64_tr_b16 v[208:209], v241 offset:224
    ds_read_b64_tr_b16 v[210:211], v241 offset:2528
    v_mfma_f32_16x16x32_bf16 v[56:59], v[184:187], v[116:119], v[56:59]
    s_add_u32 m0, s24, 18432
    s_nop 0
    buffer_load_dwordx4 v234, s[12:15], s25 offen offset:2048 lds
    s_waitcnt lgkmcnt(10)
    v_mfma_f32_16x16x32_bf16 v[24:27], v[188:191], v[112:115], v[24:27]
    ds_read_b64_tr_b16 v[184:185], v241 offset:256
    ds_read_b64_tr_b16 v[186:187], v241 offset:2560
    v_mfma_f32_16x16x32_bf16 v[60:63], v[188:191], v[116:119], v[60:63]
    s_add_u32 m0, s24, 18432
    s_nop 0
    buffer_load_dwordx4 v235, s[12:15], s25 offen offset:3072 lds
    s_waitcnt lgkmcnt(10)
    v_mfma_f32_16x16x32_bf16 v[28:31], v[192:195], v[112:115], v[28:31]
    s_add_u32 m0, s24, 22528
    s_nop 0
    buffer_load_dwordx4 v236, s[12:15], s25 offen offset:0 lds
    s_add_u32 m0, s24, 22528
    s_nop 0
    buffer_load_dwordx4 v237, s[12:15], s25 offen offset:1024 lds
    s_add_u32 m0, s24, 22528
    s_nop 0
    buffer_load_dwordx4 v238, s[12:15], s25 offen offset:2048 lds
    s_add_u32 m0, s24, 22528
    s_nop 0
    buffer_load_dwordx4 v239, s[12:15], s25 offen offset:3072 lds
    s_add_u32 m0, s24, 26624
    s_nop 0
    buffer_load_dwordx4 v240, s[12:15], s25 offen offset:0 lds
    s_add_u32 s25, s25, 82944
    s_waitcnt vmcnt(9)
    ds_read_b64_tr_b16 v[188:189], v241 offset:9216
    ds_read_b64_tr_b16 v[190:191], v241 offset:11520
    v_mfma_f32_16x16x32_bf16 v[64:67], v[192:195], v[116:119], v[64:67]
    s_waitcnt lgkmcnt(10)
    v_mfma_f32_16x16x32_bf16 v[32:35], v[196:199], v[112:115], v[32:35]
    ds_read_b64_tr_b16 v[192:193], v241 offset:9248
    ds_read_b64_tr_b16 v[194:195], v241 offset:11552
    v_mfma_f32_16x16x32_bf16 v[68:71], v[196:199], v[116:119], v[68:71]
    s_waitcnt lgkmcnt(10)
    v_mfma_f32_16x16x32_bf16 v[36:39], v[200:203], v[112:115], v[36:39]
    ds_read_b64_tr_b16 v[196:197], v241 offset:9280
    ds_read_b64_tr_b16 v[198:199], v241 offset:11584
    v_mfma_f32_16x16x32_bf16 v[72:75], v[200:203], v[116:119], v[72:75]
    s_waitcnt lgkmcnt(10)
    v_mfma_f32_16x16x32_bf16 v[40:43], v[204:207], v[112:115], v[40:43]
    ds_read_b64_tr_b16 v[200:201], v241 offset:9312
    ds_read_b64_tr_b16 v[202:203], v241 offset:11616
    v_mfma_f32_16x16x32_bf16 v[76:79], v[204:207], v[116:119], v[76:79]
    s_waitcnt lgkmcnt(10)
    v_mfma_f32_16x16x32_bf16 v[44:47], v[208:211], v[112:115], v[44:47]
    ds_read_b64_tr_b16 v[204:205], v241 offset:9344
    ds_read_b64_tr_b16 v[206:207], v241 offset:11648
    v_mfma_f32_16x16x32_bf16 v[80:83], v[208:211], v[116:119], v[80:83]
    s_waitcnt lgkmcnt(10)
    v_mfma_f32_16x16x32_bf16 v[48:51], v[184:187], v[112:115], v[48:51]
    ds_read_b64_tr_b16 v[208:209], v241 offset:9376
    ds_read_b64_tr_b16 v[210:211], v241 offset:11680
    v_mfma_f32_16x16x32_bf16 v[84:87], v[184:187], v[116:119], v[84:87]
    s_add_u32 m0, s24, 0
    s_nop 0
    buffer_load_dwordx4 v214, s[12:15], s25 offen offset:0 lds
    s_waitcnt lgkmcnt(10)
    v_mfma_f32_16x16x32_bf16 v[16:19], v[188:191], v[120:123], v[16:19]
    ds_read_b64_tr_b16 v[184:185], v241 offset:9408
    ds_read_b64_tr_b16 v[186:187], v241 offset:11712
    v_mfma_f32_16x16x32_bf16 v[52:55], v[188:191], v[124:127], v[52:55]
    s_add_u32 m0, s24, 0
    s_nop 0
    buffer_load_dwordx4 v215, s[12:15], s25 offen offset:1024 lds
    s_waitcnt lgkmcnt(10)
    v_mfma_f32_16x16x32_bf16 v[20:23], v[192:195], v[120:123], v[20:23]
    ds_read_b64_tr_b16 v[188:189], v241 offset:9440
    ds_read_b64_tr_b16 v[190:191], v241 offset:11744
    v_mfma_f32_16x16x32_bf16 v[56:59], v[192:195], v[124:127], v[56:59]
    s_add_u32 m0, s24, 0
    s_nop 0
    buffer_load_dwordx4 v216, s[12:15], s25 offen offset:2048 lds
    s_waitcnt lgkmcnt(10)
    v_mfma_f32_16x16x32_bf16 v[24:27], v[196:199], v[120:123], v[24:27]
    ds_read_b64_tr_b16 v[192:193], v241 offset:9472
    ds_read_b64_tr_b16 v[194:195], v241 offset:11776
    v_mfma_f32_16x16x32_bf16 v[60:63], v[196:199], v[124:127], v[60:63]
    s_add_u32 m0, s24, 0
    s_nop 0
    buffer_load_dwordx4 v217, s[12:15], s25 offen offset:3072 lds
    s_waitcnt lgkmcnt(10)
    v_mfma_f32_16x16x32_bf16 v[28:31], v[200:203], v[120:123], v[28:31]
    s_add_u32 m0, s24, 4096
    s_nop 0
    buffer_load_dwordx4 v218, s[12:15], s25 offen offset:0 lds
    s_add_u32 m0, s24, 4096
    s_nop 0
    buffer_load_dwordx4 v219, s[12:15], s25 offen offset:1024 lds
    s_add_u32 m0, s24, 4096
    s_nop 0
    buffer_load_dwordx4 v220, s[12:15], s25 offen offset:2048 lds
    s_add_u32 m0, s24, 4096
    s_nop 0
    buffer_load_dwordx4 v221, s[12:15], s25 offen offset:3072 lds
    s_add_u32 m0, s24, 8192
    s_nop 0
    buffer_load_dwordx4 v222, s[12:15], s25 offen offset:0 lds
    s_waitcnt vmcnt(9)
    ds_read_b64_tr_b16 v[196:197], v241 offset:18432
    ds_read_b64_tr_b16 v[198:199], v241 offset:20736
    v_mfma_f32_16x16x32_bf16 v[64:67], v[200:203], v[124:127], v[64:67]
    s_waitcnt lgkmcnt(10)
    v_mfma_f32_16x16x32_bf16 v[32:35], v[204:207], v[120:123], v[32:35]
    ds_read_b64_tr_b16 v[200:201], v241 offset:18464
    ds_read_b64_tr_b16 v[202:203], v241 offset:20768
    v_mfma_f32_16x16x32_bf16 v[68:71], v[204:207], v[124:127], v[68:71]
    s_waitcnt lgkmcnt(10)
    v_mfma_f32_16x16x32_bf16 v[36:39], v[208:211], v[120:123], v[36:39]
    ds_read_b64_tr_b16 v[204:205], v241 offset:18496
    ds_read_b64_tr_b16 v[206:207], v241 offset:20800
    v_mfma_f32_16x16x32_bf16 v[72:75], v[208:211], v[124:127], v[72:75]
    s_waitcnt lgkmcnt(10)
    v_mfma_f32_16x16x32_bf16 v[40:43], v[184:187], v[120:123], v[40:43]
    ds_read_b64_tr_b16 v[208:209], v241 offset:18528
    ds_read_b64_tr_b16 v[210:211], v241 offset:20832
    v_mfma_f32_16x16x32_bf16 v[76:79], v[184:187], v[124:127], v[76:79]
    s_waitcnt lgkmcnt(10)
    v_mfma_f32_16x16x32_bf16 v[44:47], v[188:191], v[120:123], v[44:47]
    ds_read_b64_tr_b16 v[184:185], v241 offset:18560
    ds_read_b64_tr_b16 v[186:187], v241 offset:20864
    v_mfma_f32_16x16x32_bf16 v[80:83], v[188:191], v[124:127], v[80:83]
    s_waitcnt lgkmcnt(10)
    v_mfma_f32_16x16x32_bf16 v[48:51], v[192:195], v[120:123], v[48:51]
    ds_read_b64_tr_b16 v[188:189], v241 offset:18592
    ds_read_b64_tr_b16 v[190:191], v241 offset:20896
    v_mfma_f32_16x16x32_bf16 v[84:87], v[192:195], v[124:127], v[84:87]
    s_add_u32 m0, s24, 9216
    s_nop 0
    buffer_load_dwordx4 v223, s[12:15], s25 offen offset:0 lds
    s_waitcnt lgkmcnt(10)
    v_mfma_f32_16x16x32_bf16 v[16:19], v[196:199], v[128:131], v[16:19]
    ds_read_b64_tr_b16 v[192:193], v241 offset:18624
    ds_read_b64_tr_b16 v[194:195], v241 offset:20928
    v_mfma_f32_16x16x32_bf16 v[52:55], v[196:199], v[132:135], v[52:55]
    s_add_u32 m0, s24, 9216
    s_nop 0
    buffer_load_dwordx4 v224, s[12:15], s25 offen offset:1024 lds
    s_waitcnt lgkmcnt(10)
    v_mfma_f32_16x16x32_bf16 v[20:23], v[200:203], v[128:131], v[20:23]
    ds_read_b64_tr_b16 v[196:197], v241 offset:18656
    ds_read_b64_tr_b16 v[198:199], v241 offset:20960
    v_mfma_f32_16x16x32_bf16 v[56:59], v[200:203], v[132:135], v[56:59]
    s_add_u32 m0, s24, 9216
    s_nop 0
    buffer_load_dwordx4 v225, s[12:15], s25 offen offset:2048 lds
    s_waitcnt lgkmcnt(10)
    v_mfma_f32_16x16x32_bf16 v[24:27], v[204:207], v[128:131], v[24:27]
    ds_read_b64_tr_b16 v[200:201], v241 offset:18688
    ds_read_b64_tr_b16 v[202:203], v241 offset:20992
    v_mfma_f32_16x16x32_bf16 v[60:63], v[204:207], v[132:135], v[60:63]
    s_add_u32 m0, s24, 9216
    s_nop 0
    buffer_load_dwordx4 v226, s[12:15], s25 offen offset:3072 lds
    s_waitcnt lgkmcnt(10)
    v_mfma_f32_16x16x32_bf16 v[28:31], v[208:211], v[128:131], v[28:31]
    s_add_u32 m0, s24, 13312
    s_nop 0
    buffer_load_dwordx4 v227, s[12:15], s25 offen offset:0 lds
    s_add_u32 m0, s24, 13312
    s_nop 0
    buffer_load_dwordx4 v228, s[12:15], s25 offen offset:1024 lds
    s_add_u32 m0, s24, 13312
    s_nop 0
    buffer_load_dwordx4 v229, s[12:15], s25 offen offset:2048 lds
    s_add_u32 m0, s24, 13312
    s_nop 0
    buffer_load_dwordx4 v230, s[12:15], s25 offen offset:3072 lds
    s_add_u32 m0, s24, 17408
    s_nop 0
    buffer_load_dwordx4 v231, s[12:15], s25 offen offset:0 lds
    s_waitcnt vmcnt(9)
    ds_read_b64_tr_b16 v[204:205], v241 offset:0
    ds_read_b64_tr_b16 v[206:207], v241 offset:2304
    v_mfma_f32_16x16x32_bf16 v[64:67], v[208:211], v[132:135], v[64:67]
    s_waitcnt lgkmcnt(10)
    v_mfma_f32_16x16x32_bf16 v[32:35], v[184:187], v[128:131], v[32:35]
    ds_read_b64_tr_b16 v[208:209], v241 offset:32
    ds_read_b64_tr_b16 v[210:211], v241 offset:2336
    v_mfma_f32_16x16x32_bf16 v[68:71], v[184:187], v[132:135], v[68:71]
    s_waitcnt lgkmcnt(10)
    v_mfma_f32_16x16x32_bf16 v[36:39], v[188:191], v[128:131], v[36:39]
    ds_read_b64_tr_b16 v[184:185], v241 offset:64
    ds_read_b64_tr_b16 v[186:187], v241 offset:2368
    v_mfma_f32_16x16x32_bf16 v[72:75], v[188:191], v[132:135], v[72:75]
    s_waitcnt lgkmcnt(10)
    v_mfma_f32_16x16x32_bf16 v[40:43], v[192:195], v[128:131], v[40:43]
    ds_read_b64_tr_b16 v[188:189], v241 offset:96
    ds_read_b64_tr_b16 v[190:191], v241 offset:2400
    v_mfma_f32_16x16x32_bf16 v[76:79], v[192:195], v[132:135], v[76:79]
    s_waitcnt lgkmcnt(10)
    v_mfma_f32_16x16x32_bf16 v[44:47], v[196:199], v[128:131], v[44:47]
    ds_read_b64_tr_b16 v[192:193], v241 offset:128
    ds_read_b64_tr_b16 v[194:195], v241 offset:2432
    v_mfma_f32_16x16x32_bf16 v[80:83], v[196:199], v[132:135], v[80:83]
    s_waitcnt lgkmcnt(10)
    v_mfma_f32_16x16x32_bf16 v[48:51], v[200:203], v[128:131], v[48:51]
    ds_read_b64_tr_b16 v[196:197], v241 offset:160
    ds_read_b64_tr_b16 v[198:199], v241 offset:2464
    v_mfma_f32_16x16x32_bf16 v[84:87], v[200:203], v[132:135], v[84:87]
    s_add_u32 m0, s24, 18432
    s_nop 0
    buffer_load_dwordx4 v232, s[12:15], s25 offen offset:0 lds
    s_waitcnt lgkmcnt(10)
    v_mfma_f32_16x16x32_bf16 v[16:19], v[204:207], v[136:139], v[16:19]
    ds_read_b64_tr_b16 v[200:201], v241 offset:192
    ds_read_b64_tr_b16 v[202:203], v241 offset:2496
    v_mfma_f32_16x16x32_bf16 v[52:55], v[204:207], v[140:143], v[52:55]
    s_add_u32 m0, s24, 18432
    s_nop 0
    buffer_load_dwordx4 v233, s[12:15], s25 offen offset:1024 lds
    s_waitcnt lgkmcnt(10)
    v_mfma_f32_16x16x32_bf16 v[20:23], v[208:211], v[136:139], v[20:23]
    ds_read_b64_tr_b16 v[204:205], v241 offset:224
    ds_read_b64_tr_b16 v[206:207], v241 offset:2528
    v_mfma_f32_16x16x32_bf16 v[56:59], v[208:211], v[140:143], v[56:59]
    s_add_u32 m0, s24, 18432
    s_nop 0
    buffer_load_dwordx4 v234, s[12:15], s25 offen offset:2048 lds
    s_waitcnt lgkmcnt(10)
    v_mfma_f32_16x16x32_bf16 v[24:27], v[184:187], v[136:139], v[24:27]
    ds_read_b64_tr_b16 v[208:209], v241 offset:256
    ds_read_b64_tr_b16 v[210:211], v241 offset:2560
    v_mfma_f32_16x16x32_bf16 v[60:63], v[184:187], v[140:143], v[60:63]
    s_add_u32 m0, s24, 18432
    s_nop 0
    buffer_load_dwordx4 v235, s[12:15], s25 offen offset:3072 lds
    s_waitcnt lgkmcnt(10)
    v_mfma_f32_16x16x32_bf16 v[28:31], v[188:191], v[136:139], v[28:31]
    s_add_u32 m0, s24, 22528
    s_nop 0
    buffer_load_dwordx4 v236, s[12:15], s25 offen offset:0 lds
    s_add_u32 m0, s24, 22528
    s_nop 0
    buffer_load_dwordx4 v237, s[12:15], s25 offen offset:1024 lds
    s_add_u32 m0, s24, 22528
    s_nop 0
    buffer_load_dwordx4 v238, s[12:15], s25 offen offset:2048 lds
    s_add_u32 m0, s24, 22528
    s_nop 0
    buffer_load_dwordx4 v239, s[12:15], s25 offen offset:3072 lds
    s_add_u32 m0, s24, 26624
    s_nop 0
    buffer_load_dwordx4 v240, s[12:15], s25 offen offset:0 lds
    s_add_u32 s25, s25, 82944
    s_waitcnt vmcnt(9)
    ds_read_b64_tr_b16 v[184:185], v241 offset:9216
    ds_read_b64_tr_b16 v[186:187], v241 offset:11520
    v_mfma_f32_16x16x32_bf16 v[64:67], v[188:191], v[140:143], v[64:67]
    s_waitcnt lgkmcnt(10)
    v_mfma_f32_16x16x32_bf16 v[32:35], v[192:195], v[136:139], v[32:35]
    ds_read_b64_tr_b16 v[188:189], v241 offset:9248
    ds_read_b64_tr_b16 v[190:191], v241 offset:11552
    v_mfma_f32_16x16x32_bf16 v[68:71], v[192:195], v[140:143], v[68:71]
    s_waitcnt lgkmcnt(10)
    v_mfma_f32_16x16x32_bf16 v[36:39], v[196:199], v[136:139], v[36:39]
    ds_read_b64_tr_b16 v[192:193], v241 offset:9280
    ds_read_b64_tr_b16 v[194:195], v241 offset:11584
    v_mfma_f32_16x16x32_bf16 v[72:75], v[196:199], v[140:143], v[72:75]
    s_waitcnt lgkmcnt(10)
    v_mfma_f32_16x16x32_bf16 v[40:43], v[200:203], v[136:139], v[40:43]
    ds_read_b64_tr_b16 v[196:197], v241 offset:9312
    ds_read_b64_tr_b16 v[198:199], v241 offset:11616
    v_mfma_f32_16x16x32_bf16 v[76:79], v[200:203], v[140:143], v[76:79]
    s_waitcnt lgkmcnt(10)
    v_mfma_f32_16x16x32_bf16 v[44:47], v[204:207], v[136:139], v[44:47]
    ds_read_b64_tr_b16 v[200:201], v241 offset:9344
    ds_read_b64_tr_b16 v[202:203], v241 offset:11648
    v_mfma_f32_16x16x32_bf16 v[80:83], v[204:207], v[140:143], v[80:83]
    s_waitcnt lgkmcnt(10)
    v_mfma_f32_16x16x32_bf16 v[48:51], v[208:211], v[136:139], v[48:51]
    ds_read_b64_tr_b16 v[204:205], v241 offset:9376
    ds_read_b64_tr_b16 v[206:207], v241 offset:11680
    v_mfma_f32_16x16x32_bf16 v[84:87], v[208:211], v[140:143], v[84:87]
    s_add_u32 m0, s24, 0
    s_nop 0
    buffer_load_dwordx4 v214, s[12:15], s25 offen offset:0 lds
    s_waitcnt lgkmcnt(10)
    v_mfma_f32_16x16x32_bf16 v[16:19], v[184:187], v[144:147], v[16:19]
    ds_read_b64_tr_b16 v[208:209], v241 offset:9408
    ds_read_b64_tr_b16 v[210:211], v241 offset:11712
    v_mfma_f32_16x16x32_bf16 v[52:55], v[184:187], v[148:151], v[52:55]
    s_add_u32 m0, s24, 0
    s_nop 0
    buffer_load_dwordx4 v215, s[12:15], s25 offen offset:1024 lds
    s_waitcnt lgkmcnt(10)
    v_mfma_f32_16x16x32_bf16 v[20:23], v[188:191], v[144:147], v[20:23]
    ds_read_b64_tr_b16 v[184:185], v241 offset:9440
    ds_read_b64_tr_b16 v[186:187], v241 offset:11744
    v_mfma_f32_16x16x32_bf16 v[56:59], v[188:191], v[148:151], v[56:59]
    s_add_u32 m0, s24, 0
    s_nop 0
    buffer_load_dwordx4 v216, s[12:15], s25 offen offset:2048 lds
    s_waitcnt lgkmcnt(10)
    v_mfma_f32_16x16x32_bf16 v[24:27], v[192:195], v[144:147], v[24:27]
    ds_read_b64_tr_b16 v[188:189], v241 offset:9472
    ds_read_b64_tr_b16 v[190:191], v241 offset:11776
    v_mfma_f32_16x16x32_bf16 v[60:63], v[192:195], v[148:151], v[60:63]
    s_add_u32 m0, s24, 0
    s_nop 0
    buffer_load_dwordx4 v217, s[12:15], s25 offen offset:3072 lds
    s_waitcnt lgkmcnt(10)
    v_mfma_f32_16x16x32_bf16 v[28:31], v[196:199], v[144:147], v[28:31]
    s_add_u32 m0, s24, 4096
    s_nop 0
    buffer_load_dwordx4 v218, s[12:15], s25 offen offset:0 lds
    s_add_u32 m0, s24, 4096
    s_nop 0
    buffer_load_dwordx4 v219, s[12:15], s25 offen offset:1024 lds
    s_add_u32 m0, s24, 4096
    s_nop 0
    buffer_load_dwordx4 v220, s[12:15], s25 offen offset:2048 lds
    s_add_u32 m0, s24, 4096
    s_nop 0
    buffer_load_dwordx4 v221, s[12:15], s25 offen offset:3072 lds
    s_add_u32 m0, s24, 8192
    s_nop 0
    buffer_load_dwordx4 v222, s[12:15], s25 offen offset:0 lds
    s_waitcnt vmcnt(9)
    ds_read_b64_tr_b16 v[192:193], v241 offset:18432
    ds_read_b64_tr_b16 v[194:195], v241 offset:20736
    v_mfma_f32_16x16x32_bf16 v[64:67], v[196:199], v[148:151], v[64:67]
    s_waitcnt lgkmcnt(10)
    v_mfma_f32_16x16x32_bf16 v[32:35], v[200:203], v[144:147], v[32:35]
    ds_read_b64_tr_b16 v[196:197], v241 offset:18464
    ds_read_b64_tr_b16 v[198:199], v241 offset:20768
    v_mfma_f32_16x16x32_bf16 v[68:71], v[200:203], v[148:151], v[68:71]
    s_waitcnt lgkmcnt(10)
    v_mfma_f32_16x16x32_bf16 v[36:39], v[204:207], v[144:147], v[36:39]
    ds_read_b64_tr_b16 v[200:201], v241 offset:18496
    ds_read_b64_tr_b16 v[202:203], v241 offset:20800
    v_mfma_f32_16x16x32_bf16 v[72:75], v[204:207], v[148:151], v[72:75]
    s_waitcnt lgkmcnt(10)
    v_mfma_f32_16x16x32_bf16 v[40:43], v[208:211], v[144:147], v[40:43]
    ds_read_b64_tr_b16 v[204:205], v241 offset:18528
    ds_read_b64_tr_b16 v[206:207], v241 offset:20832
    v_mfma_f32_16x16x32_bf16 v[76:79], v[208:211], v[148:151], v[76:79]
    s_waitcnt lgkmcnt(10)
    v_mfma_f32_16x16x32_bf16 v[44:47], v[184:187], v[144:147], v[44:47]
    ds_read_b64_tr_b16 v[208:209], v241 offset:18560
    ds_read_b64_tr_b16 v[210:211], v241 offset:20864
    v_mfma_f32_16x16x32_bf16 v[80:83], v[184:187], v[148:151], v[80:83]
    s_waitcnt lgkmcnt(10)
    v_mfma_f32_16x16x32_bf16 v[48:51], v[188:191], v[144:147], v[48:51]
    ds_read_b64_tr_b16 v[184:185], v241 offset:18592
    ds_read_b64_tr_b16 v[186:187], v241 offset:20896
    v_mfma_f32_16x16x32_bf16 v[84:87], v[188:191], v[148:151], v[84:87]
    s_add_u32 m0, s24, 9216
    s_nop 0
    buffer_load_dwordx4 v223, s[12:15], s25 offen offset:0 lds
    s_waitcnt lgkmcnt(10)
    v_mfma_f32_16x16x32_bf16 v[16:19], v[192:195], v[152:155], v[16:19]
    ds_read_b64_tr_b16 v[188:189], v241 offset:18624
    ds_read_b64_tr_b16 v[190:191], v241 offset:20928
    v_mfma_f32_16x16x32_bf16 v[52:55], v[192:195], v[156:159], v[52:55]
    s_add_u32 m0, s24, 9216
    s_nop 0
    buffer_load_dwordx4 v224, s[12:15], s25 offen offset:1024 lds
    s_waitcnt lgkmcnt(10)
    v_mfma_f32_16x16x32_bf16 v[20:23], v[196:199], v[152:155], v[20:23]
    ds_read_b64_tr_b16 v[192:193], v241 offset:18656
    ds_read_b64_tr_b16 v[194:195], v241 offset:20960
    v_mfma_f32_16x16x32_bf16 v[56:59], v[196:199], v[156:159], v[56:59]
    s_add_u32 m0, s24, 9216
    s_nop 0
    buffer_load_dwordx4 v225, s[12:15], s25 offen offset:2048 lds
    s_waitcnt lgkmcnt(10)
    v_mfma_f32_16x16x32_bf16 v[24:27], v[200:203], v[152:155], v[24:27]
    ds_read_b64_tr_b16 v[196:197], v241 offset:18688
    ds_read_b64_tr_b16 v[198:199], v241 offset:20992
    v_mfma_f32_16x16x32_bf16 v[60:63], v[200:203], v[156:159], v[60:63]
    s_add_u32 m0, s24, 9216
    s_nop 0
    buffer_load_dwordx4 v226, s[12:15], s25 offen offset:3072 lds
    s_waitcnt lgkmcnt(10)
    v_mfma_f32_16x16x32_bf16 v[28:31], v[204:207], v[152:155], v[28:31]
    s_add_u32 m0, s24, 13312
    s_nop 0
    buffer_load_dwordx4 v227, s[12:15], s25 offen offset:0 lds
    s_add_u32 m0, s24, 13312
    s_nop 0
    buffer_load_dwordx4 v228, s[12:15], s25 offen offset:1024 lds
    s_add_u32 m0, s24, 13312
    s_nop 0
    buffer_load_dwordx4 v229, s[12:15], s25 offen offset:2048 lds
    s_add_u32 m0, s24, 13312
    s_nop 0
    buffer_load_dwordx4 v230, s[12:15], s25 offen offset:3072 lds
    s_add_u32 m0, s24, 17408
    s_nop 0
    buffer_load_dwordx4 v231, s[12:15], s25 offen offset:0 lds
    s_waitcnt vmcnt(9)
    ds_read_b64_tr_b16 v[200:201], v241 offset:0
    ds_read_b64_tr_b16 v[202:203], v241 offset:2304
    v_mfma_f32_16x16x32_bf16 v[64:67], v[204:207], v[156:159], v[64:67]
    s_waitcnt lgkmcnt(10)
    v_mfma_f32_16x16x32_bf16 v[32:35], v[208:211], v[152:155], v[32:35]
    ds_read_b64_tr_b16 v[204:205], v241 offset:32
    ds_read_b64_tr_b16 v[206:207], v241 offset:2336
    v_mfma_f32_16x16x32_bf16 v[68:71], v[208:211], v[156:159], v[68:71]
    s_waitcnt lgkmcnt(10)
    v_mfma_f32_16x16x32_bf16 v[36:39], v[184:187], v[152:155], v[36:39]
    ds_read_b64_tr_b16 v[208:209], v241 offset:64
    ds_read_b64_tr_b16 v[210:211], v241 offset:2368
    v_mfma_f32_16x16x32_bf16 v[72:75], v[184:187], v[156:159], v[72:75]
    s_waitcnt lgkmcnt(10)
    v_mfma_f32_16x16x32_bf16 v[40:43], v[188:191], v[152:155], v[40:43]
    ds_read_b64_tr_b16 v[184:185], v241 offset:96
    ds_read_b64_tr_b16 v[186:187], v241 offset:2400
    v_mfma_f32_16x16x32_bf16 v[76:79], v[188:191], v[156:159], v[76:79]
    s_waitcnt lgkmcnt(10)
    v_mfma_f32_16x16x32_bf16 v[44:47], v[192:195], v[152:155], v[44:47]
    ds_read_b64_tr_b16 v[188:189], v241 offset:128
    ds_read_b64_tr_b16 v[190:191], v241 offset:2432
    v_mfma_f32_16x16x32_bf16 v[80:83], v[192:195], v[156:159], v[80:83]
    s_waitcnt lgkmcnt(10)
    v_mfma_f32_16x16x32_bf16 v[48:51], v[196:199], v[152:155], v[48:51]
    ds_read_b64_tr_b16 v[192:193], v241 offset:160
    ds_read_b64_tr_b16 v[194:195], v241 offset:2464
    v_mfma_f32_16x16x32_bf16 v[84:87], v[196:199], v[156:159], v[84:87]
    s_add_u32 m0, s24, 18432
    s_nop 0
    buffer_load_dwordx4 v232, s[12:15], s25 offen offset:0 lds
    s_waitcnt lgkmcnt(10)
    v_mfma_f32_16x16x32_bf16 v[16:19], v[200:203], v[160:163], v[16:19]
    ds_read_b64_tr_b16 v[196:197], v241 offset:192
    ds_read_b64_tr_b16 v[198:199], v241 offset:2496
    v_mfma_f32_16x16x32_bf16 v[52:55], v[200:203], v[164:167], v[52:55]
    s_add_u32 m0, s24, 18432
    s_nop 0
    buffer_load_dwordx4 v233, s[12:15], s25 offen offset:1024 lds
    s_waitcnt lgkmcnt(10)
    v_mfma_f32_16x16x32_bf16 v[20:23], v[204:207], v[160:163], v[20:23]
    ds_read_b64_tr_b16 v[200:201], v241 offset:224
    ds_read_b64_tr_b16 v[202:203], v241 offset:2528
    v_mfma_f32_16x16x32_bf16 v[56:59], v[204:207], v[164:167], v[56:59]
    s_add_u32 m0, s24, 18432
    s_nop 0
    buffer_load_dwordx4 v234, s[12:15], s25 offen offset:2048 lds
    s_waitcnt lgkmcnt(10)
    v_mfma_f32_16x16x32_bf16 v[24:27], v[208:211], v[160:163], v[24:27]
    ds_read_b64_tr_b16 v[204:205], v241 offset:256
    ds_read_b64_tr_b16 v[206:207], v241 offset:2560
    v_mfma_f32_16x16x32_bf16 v[60:63], v[208:211], v[164:167], v[60:63]
    s_add_u32 m0, s24, 18432
    s_nop 0
    buffer_load_dwordx4 v235, s[12:15], s25 offen offset:3072 lds
    s_waitcnt lgkmcnt(10)
    v_mfma_f32_16x16x32_bf16 v[28:31], v[184:187], v[160:163], v[28:31]
    s_add_u32 m0, s24, 22528
    s_nop 0
    buffer_load_dwordx4 v236, s[12:15], s25 offen offset:0 lds
    s_add_u32 m0, s24, 22528
    s_nop 0
    buffer_load_dwordx4 v237, s[12:15], s25 offen offset:1024 lds
    s_add_u32 m0, s24, 22528
    s_nop 0
    buffer_load_dwordx4 v238, s[12:15], s25 offen offset:2048 lds
    s_add_u32 m0, s24, 22528
    s_nop 0
    buffer_load_dwordx4 v239, s[12:15], s25 offen offset:3072 lds
    s_add_u32 m0, s24, 26624
    s_nop 0
    buffer_load_dwordx4 v240, s[12:15], s25 offen offset:0 lds
    s_add_u32 s25, s25, 82944
    s_waitcnt vmcnt(9)
    ds_read_b64_tr_b16 v[208:209], v241 offset:9216
    ds_read_b64_tr_b16 v[210:211], v241 offset:11520
    v_mfma_f32_16x16x32_bf16 v[64:67], v[184:187], v[164:167], v[64:67]
    s_waitcnt lgkmcnt(10)
    v_mfma_f32_16x16x32_bf16 v[32:35], v[188:191], v[160:163], v[32:35]
    ds_read_b64_tr_b16 v[184:185], v241 offset:9248
    ds_read_b64_tr_b16 v[186:187], v241 offset:11552
    v_mfma_f32_16x16x32_bf16 v[68:71], v[188:191], v[164:167], v[68:71]
    s_waitcnt lgkmcnt(10)
    v_mfma_f32_16x16x32_bf16 v[36:39], v[192:195], v[160:163], v[36:39]
    ds_read_b64_tr_b16 v[188:189], v241 offset:9280
    ds_read_b64_tr_b16 v[190:191], v241 offset:11584
    v_mfma_f32_16x16x32_bf16 v[72:75], v[192:195], v[164:167], v[72:75]
    s_waitcnt lgkmcnt(10)
    v_mfma_f32_16x16x32_bf16 v[40:43], v[196:199], v[160:163], v[40:43]
    ds_read_b64_tr_b16 v[192:193], v241 offset:9312
    ds_read_b64_tr_b16 v[194:195], v241 offset:11616
    v_mfma_f32_16x16x32_bf16 v[76:79], v[196:199], v[164:167], v[76:79]
    s_waitcnt lgkmcnt(10)
    v_mfma_f32_16x16x32_bf16 v[44:47], v[200:203], v[160:163], v[44:47]
    ds_read_b64_tr_b16 v[196:197], v241 offset:9344
    ds_read_b64_tr_b16 v[198:199], v241 offset:11648
    v_mfma_f32_16x16x32_bf16 v[80:83], v[200:203], v[164:167], v[80:83]
    s_waitcnt lgkmcnt(10)
    v_mfma_f32_16x16x32_bf16 v[48:51], v[204:207], v[160:163], v[48:51]
    ds_read_b64_tr_b16 v[200:201], v241 offset:9376
    ds_read_b64_tr_b16 v[202:203], v241 offset:11680
    v_mfma_f32_16x16x32_bf16 v[84:87], v[204:207], v[164:167], v[84:87]
    s_waitcnt lgkmcnt(10)
    v_mfma_f32_16x16x32_bf16 v[16:19], v[208:211], v[168:171], v[16:19]
    ds_read_b64_tr_b16 v[204:205], v241 offset:9408
    ds_read_b64_tr_b16 v[206:207], v241 offset:11712
    v_mfma_f32_16x16x32_bf16 v[52:55], v[208:211], v[172:175], v[52:55]
    s_waitcnt lgkmcnt(10)
    v_mfma_f32_16x16x32_bf16 v[20:23], v[184:187], v[168:171], v[20:23]
    ds_read_b64_tr_b16 v[208:209], v241 offset:9440
    ds_read_b64_tr_b16 v[210:211], v241 offset:11744
    v_mfma_f32_16x16x32_bf16 v[56:59], v[184:187], v[172:175], v[56:59]
    s_waitcnt lgkmcnt(10)
    v_mfma_f32_16x16x32_bf16 v[24:27], v[188:191], v[168:171], v[24:27]
    ds_read_b64_tr_b16 v[184:185], v241 offset:9472
    ds_read_b64_tr_b16 v[186:187], v241 offset:11776
    v_mfma_f32_16x16x32_bf16 v[60:63], v[188:191], v[172:175], v[60:63]
    s_waitcnt lgkmcnt(10)
    v_mfma_f32_16x16x32_bf16 v[28:31], v[192:195], v[168:171], v[28:31]
    s_waitcnt vmcnt(0)
    ds_read_b64_tr_b16 v[188:189], v241 offset:18432
    ds_read_b64_tr_b16 v[190:191], v241 offset:20736
    v_mfma_f32_16x16x32_bf16 v[64:67], v[192:195], v[172:175], v[64:67]
    s_waitcnt lgkmcnt(10)
    v_mfma_f32_16x16x32_bf16 v[32:35], v[196:199], v[168:171], v[32:35]
    ds_read_b64_tr_b16 v[192:193], v241 offset:18464
    ds_read_b64_tr_b16 v[194:195], v241 offset:20768
    v_mfma_f32_16x16x32_bf16 v[68:71], v[196:199], v[172:175], v[68:71]
    s_waitcnt lgkmcnt(10)
    v_mfma_f32_16x16x32_bf16 v[36:39], v[200:203], v[168:171], v[36:39]
    ds_read_b64_tr_b16 v[196:197], v241 offset:18496
    ds_read_b64_tr_b16 v[198:199], v241 offset:20800
    v_mfma_f32_16x16x32_bf16 v[72:75], v[200:203], v[172:175], v[72:75]
    s_waitcnt lgkmcnt(10)
    v_mfma_f32_16x16x32_bf16 v[40:43], v[204:207], v[168:171], v[40:43]
    ds_read_b64_tr_b16 v[200:201], v241 offset:18528
    ds_read_b64_tr_b16 v[202:203], v241 offset:20832
    v_mfma_f32_16x16x32_bf16 v[76:79], v[204:207], v[172:175], v[76:79]
    s_waitcnt lgkmcnt(10)
    v_mfma_f32_16x16x32_bf16 v[44:47], v[208:211], v[168:171], v[44:47]
    ds_read_b64_tr_b16 v[204:205], v241 offset:18560
    ds_read_b64_tr_b16 v[206:207], v241 offset:20864
    v_mfma_f32_16x16x32_bf16 v[80:83], v[208:211], v[172:175], v[80:83]
    s_waitcnt lgkmcnt(10)
    v_mfma_f32_16x16x32_bf16 v[48:51], v[184:187], v[168:171], v[48:51]
    ds_read_b64_tr_b16 v[208:209], v241 offset:18592
    ds_read_b64_tr_b16 v[210:211], v241 offset:20896
    v_mfma_f32_16x16x32_bf16 v[84:87], v[184:187], v[172:175], v[84:87]
    s_waitcnt lgkmcnt(10)
    v_mfma_f32_16x16x32_bf16 v[16:19], v[188:191], v[176:179], v[16:19]
    ds_read_b64_tr_b16 v[184:185], v241 offset:18624
    ds_read_b64_tr_b16 v[186:187], v241 offset:20928
    v_mfma_f32_16x16x32_bf16 v[52:55], v[188:191], v[180:183], v[52:55]
    s_waitcnt lgkmcnt(10)
    v_mfma_f32_16x16x32_bf16 v[20:23], v[192:195], v[176:179], v[20:23]
    ds_read_b64_tr_b16 v[188:189], v241 offset:18656
    ds_read_b64_tr_b16 v[190:191], v241 offset:20960
    v_mfma_f32_16x16x32_bf16 v[56:59], v[192:195], v[180:183], v[56:59]
    s_waitcnt lgkmcnt(10)
    v_mfma_f32_16x16x32_bf16 v[24:27], v[196:199], v[176:179], v[24:27]
    ds_read_b64_tr_b16 v[192:193], v241 offset:18688
    ds_read_b64_tr_b16 v[194:195], v241 offset:20992
    v_mfma_f32_16x16x32_bf16 v[60:63], v[196:199], v[180:183], v[60:63]
    s_waitcnt lgkmcnt(10)
    v_mfma_f32_16x16x32_bf16 v[28:31], v[200:203], v[176:179], v[28:31]
    v_mfma_f32_16x16x32_bf16 v[64:67], v[200:203], v[180:183], v[64:67]
    s_waitcnt lgkmcnt(8)
    v_mfma_f32_16x16x32_bf16 v[32:35], v[204:207], v[176:179], v[32:35]
    v_mfma_f32_16x16x32_bf16 v[68:71], v[204:207], v[180:183], v[68:71]
    s_waitcnt lgkmcnt(6)
    v_mfma_f32_16x16x32_bf16 v[36:39], v[208:211], v[176:179], v[36:39]
    v_mfma_f32_16x16x32_bf16 v[72:75], v[208:211], v[180:183], v[72:75]
    s_waitcnt lgkmcnt(4)
    v_mfma_f32_16x16x32_bf16 v[40:43], v[184:187], v[176:179], v[40:43]
    v_mfma_f32_16x16x32_bf16 v[76:79], v[184:187], v[180:183], v[76:79]
    s_waitcnt lgkmcnt(2)
    v_mfma_f32_16x16x32_bf16 v[44:47], v[188:191], v[176:179], v[44:47]
    v_mfma_f32_16x16x32_bf16 v[80:83], v[188:191], v[180:183], v[80:83]
    s_waitcnt lgkmcnt(0)
    v_mfma_f32_16x16x32_bf16 v[48:51], v[192:195], v[176:179], v[48:51]
    v_mfma_f32_16x16x32_bf16 v[84:87], v[192:195], v[180:183], v[84:87]
    s_nop 7
    s_nop 7
    s_waitcnt vmcnt(0)
    s_cmp_lg_u32 s27, 0
    s_cbranch_scc1 kt_w1
    ds_write_b128 v13, v[52:55] offset:0
    ds_write_b128 v13, v[56:59] offset:1024
    ds_write_b128 v13, v[60:63] offset:2048
    ds_write_b128 v13, v[64:67] offset:3072
    ds_write_b128 v13, v[68:71] offset:4096
    ds_write_b128 v13, v[72:75] offset:5120
    ds_write_b128 v13, v[76:79] offset:6144
    ds_write_b128 v13, v[80:83] offset:7168
    ds_write_b128 v13, v[84:87] offset:8192
    s_waitcnt lgkmcnt(0)
    s_barrier
    ds_read_b128 v[52:55], v12 offset:0
    ds_read_b128 v[56:59], v12 offset:1024
    ds_read_b128 v[60:63], v12 offset:2048
    ds_read_b128 v[64:67], v12 offset:3072
    ds_read_b128 v[68:71], v12 offset:4096
    ds_read_b128 v[72:75], v12 offset:5120
    ds_read_b128 v[76:79], v12 offset:6144
    ds_read_b128 v[80:83], v12 offset:7168
    ds_read_b128 v[84:87], v12 offset:8192
    ds_read_b128 v[88:91], v15 offset:0
    ds_read_b128 v[92:95], v15 offset:1024
    ds_read_b128 v[96:99], v15 offset:2048
    ds_read_b128 v[100:103], v15 offset:3072
    ds_read_b128 v[104:107], v15 offset:4096
    ds_read_b128 v[108:111], v15 offset:5120
    ds_read_b128 v[112:115], v15 offset:6144
    ds_read_b128 v[116:119], v15 offset:7168
    ds_read_b128 v[120:123], v15 offset:8192
    s_waitcnt lgkmcnt(15)
    v_pk_add_f32 v[16:17], v[16:17], v[52:53]
    v_pk_add_f32 v[18:19], v[18:19], v[54:55]
    v_cvt_pk_bf16_f32 v7, v16, v17
    v_lshlrev_b32 v16, 16, v7
    v_and_b32 v17, 0xffff0000, v7
    v_cvt_pk_bf16_f32 v7, v18, v19
    v_lshlrev_b32 v18, 16, v7
    v_and_b32 v19, 0xffff0000, v7
    v_mul_f32 v16, v14, v16
    v_mul_f32 v17, v14, v17
    v_mul_f32 v18, v14, v18
    v_mul_f32 v19, v14, v19
    v_cvt_pk_bf16_f32 v7, v16, v17
    v_lshlrev_b32 v16, 16, v7
    v_and_b32 v17, 0xffff0000, v7
    v_cvt_pk_bf16_f32 v7, v18, v19
    v_lshlrev_b32 v18, 16, v7
    v_and_b32 v19, 0xffff0000, v7
    s_waitcnt lgkmcnt(15)
    v_pk_add_f32 v[20:21], v[20:21], v[56:57]
    v_pk_add_f32 v[22:23], v[22:23], v[58:59]
    v_cvt_pk_bf16_f32 v7, v20, v21
    v_lshlrev_b32 v20, 16, v7
    v_and_b32 v21, 0xffff0000, v7
    v_cvt_pk_bf16_f32 v7, v22, v23
    v_lshlrev_b32 v22, 16, v7
    v_and_b32 v23, 0xffff0000, v7
    v_mul_f32 v20, v14, v20
    v_mul_f32 v21, v14, v21
    v_mul_f32 v22, v14, v22
    v_mul_f32 v23, v14, v23
    v_cvt_pk_bf16_f32 v7, v20, v21
    v_lshlrev_b32 v20, 16, v7
    v_and_b32 v21, 0xffff0000, v7
    v_cvt_pk_bf16_f32 v7, v22, v23
    v_lshlrev_b32 v22, 16, v7
    v_and_b32 v23, 0xffff0000, v7
    s_waitcnt lgkmcnt(15)
    v_pk_add_f32 v[24:25], v[24:25], v[60:61]
    v_pk_add_f32 v[26:27], v[26:27], v[62:63]
    v_cvt_pk_bf16_f32 v7, v24, v25
    v_lshlrev_b32 v24, 16, v7
    v_and_b32 v25, 0xffff0000, v7
    v_cvt_pk_bf16_f32 v7, v26, v27
    v_lshlrev_b32 v26, 16, v7
    v_and_b32 v27, 0xffff0000, v7
    v_mul_f32 v24, v14, v24
    v_mul_f32 v25, v14, v25
    v_mul_f32 v26, v14, v26
    v_mul_f32 v27, v14, v27
    v_cvt_pk_bf16_f32 v7, v24, v25
    v_lshlrev_b32 v24, 16, v7
    v_and_b32 v25, 0xffff0000, v7
    v_cvt_pk_bf16_f32 v7, v26, v27
    v_lshlrev_b32 v26, 16, v7
    v_and_b32 v27, 0xffff0000, v7
    s_waitcnt lgkmcnt(14)
    v_pk_add_f32 v[28:29], v[28:29], v[64:65]
    v_pk_add_f32 v[30:31], v[30:31], v[66:67]
    v_cvt_pk_bf16_f32 v7, v28, v29
    v_lshlrev_b32 v28, 16, v7
    v_and_b32 v29, 0xffff0000, v7
    v_cvt_pk_bf16_f32 v7, v30, v31
    v_lshlrev_b32 v30, 16, v7
    v_and_b32 v31, 0xffff0000, v7
    v_mul_f32 v28, v14, v28
    v_mul_f32 v29, v14, v29
    v_mul_f32 v30, v14, v30
    v_mul_f32 v31, v14, v31
    v_cvt_pk_bf16_f32 v7, v28, v29
    v_lshlrev_b32 v28, 16, v7
    v_and_b32 v29, 0xffff0000, v7
    v_cvt_pk_bf16_f32 v7, v30, v31
    v_lshlrev_b32 v30, 16, v7
    v_and_b32 v31, 0xffff0000, v7
    s_waitcnt lgkmcnt(13)
    v_pk_add_f32 v[32:33], v[32:33], v[68:69]
    v_pk_add_f32 v[34:35], v[34:35], v[70:71]
    v_cvt_pk_bf16_f32 v7, v32, v33
    v_lshlrev_b32 v32, 16, v7
    v_and_b32 v33, 0xffff0000, v7
    v_cvt_pk_bf16_f32 v7, v34, v35
    v_lshlrev_b32 v34, 16, v7
    v_and_b32 v35, 0xffff0000, v7
    v_mul_f32 v32, v14, v32
    v_mul_f32 v33, v14, v33
    v_mul_f32 v34, v14, v34
    v_mul_f32 v35, v14, v35
    v_cvt_pk_bf16_f32 v7, v32, v33
    v_lshlrev_b32 v32, 16, v7
    v_and_b32 v33, 0xffff0000, v7
    v_cvt_pk_bf16_f32 v7, v34, v35
    v_lshlrev_b32 v34, 16, v7
    v_and_b32 v35, 0xffff0000, v7
    s_waitcnt lgkmcnt(12)
    v_pk_add_f32 v[36:37], v[36:37], v[72:73]
    v_pk_add_f32 v[38:39], v[38:39], v[74:75]
    v_cvt_pk_bf16_f32 v7, v36, v37
    v_lshlrev_b32 v36, 16, v7
    v_and_b32 v37, 0xffff0000, v7
    v_cvt_pk_bf16_f32 v7, v38, v39
    v_lshlrev_b32 v38, 16, v7
    v_and_b32 v39, 0xffff0000, v7
    v_mul_f32 v36, v14, v36
    v_mul_f32 v37, v14, v37
    v_mul_f32 v38, v14, v38
    v_mul_f32 v39, v14, v39
    v_cvt_pk_bf16_f32 v7, v36, v37
    v_lshlrev_b32 v36, 16, v7
    v_and_b32 v37, 0xffff0000, v7
    v_cvt_pk_bf16_f32 v7, v38, v39
    v_lshlrev_b32 v38, 16, v7
    v_and_b32 v39, 0xffff0000, v7
    s_waitcnt lgkmcnt(11)
    v_pk_add_f32 v[40:41], v[40:41], v[76:77]
    v_pk_add_f32 v[42:43], v[42:43], v[78:79]
    v_cvt_pk_bf16_f32 v7, v40, v41
    v_lshlrev_b32 v40, 16, v7
    v_and_b32 v41, 0xffff0000, v7
    v_cvt_pk_bf16_f32 v7, v42, v43
    v_lshlrev_b32 v42, 16, v7
    v_and_b32 v43, 0xffff0000, v7
    v_mul_f32 v40, v14, v40
    v_mul_f32 v41, v14, v41
    v_mul_f32 v42, v14, v42
    v_mul_f32 v43, v14, v43
    v_cvt_pk_bf16_f32 v7, v40, v41
    v_lshlrev_b32 v40, 16, v7
    v_and_b32 v41, 0xffff0000, v7
    v_cvt_pk_bf16_f32 v7, v42, v43
    v_lshlrev_b32 v42, 16, v7
    v_and_b32 v43, 0xffff0000, v7
    s_waitcnt lgkmcnt(10)
    v_pk_add_f32 v[44:45], v[44:45], v[80:81]
    v_pk_add_f32 v[46:47], v[46:47], v[82:83]
    v_cvt_pk_bf16_f32 v7, v44, v45
    v_lshlrev_b32 v44, 16, v7
    v_and_b32 v45, 0xffff0000, v7
    v_cvt_pk_bf16_f32 v7, v46, v47
    v_lshlrev_b32 v46, 16, v7
    v_and_b32 v47, 0xffff0000, v7
    v_mul_f32 v44, v14, v44
    v_mul_f32 v45, v14, v45
    v_mul_f32 v46, v14, v46
    v_mul_f32 v47, v14, v47
    v_cvt_pk_bf16_f32 v7, v44, v45
    v_lshlrev_b32 v44, 16, v7
    v_and_b32 v45, 0xffff0000, v7
    v_cvt_pk_bf16_f32 v7, v46, v47
    v_lshlrev_b32 v46, 16, v7
    v_and_b32 v47, 0xffff0000, v7
    s_waitcnt lgkmcnt(9)
    v_pk_add_f32 v[48:49], v[48:49], v[84:85]
    v_pk_add_f32 v[50:51], v[50:51], v[86:87]
    v_cvt_pk_bf16_f32 v7, v48, v49
    v_lshlrev_b32 v48, 16, v7
    v_and_b32 v49, 0xffff0000, v7
    v_cvt_pk_bf16_f32 v7, v50, v51
    v_lshlrev_b32 v50, 16, v7
    v_and_b32 v51, 0xffff0000, v7
    v_mul_f32 v48, v14, v48
    v_mul_f32 v49, v14, v49
    v_mul_f32 v50, v14, v50
    v_mul_f32 v51, v14, v51
    v_cvt_pk_bf16_f32 v7, v48, v49
    v_lshlrev_b32 v48, 16, v7
    v_and_b32 v49, 0xffff0000, v7
    v_cvt_pk_bf16_f32 v7, v50, v51
    v_lshlrev_b32 v50, 16, v7
    v_and_b32 v51, 0xffff0000, v7
    s_waitcnt lgkmcnt(8)
    v_pk_add_f32 v[16:17], v[16:17], v[88:89]
    v_pk_add_f32 v[18:19], v[18:19], v[90:91]
    v_cvt_pk_bf16_f32 v16, v16, v17
    v_cvt_pk_bf16_f32 v17, v18, v19
    buffer_store_dwordx2 v[16:17], v11, s[16:19], s40 offen offset:0
    s_waitcnt lgkmcnt(7)
    v_pk_add_f32 v[20:21], v[20:21], v[92:93]
    v_pk_add_f32 v[22:23], v[22:23], v[94:95]
    v_cvt_pk_bf16_f32 v20, v20, v21
    v_cvt_pk_bf16_f32 v21, v22, v23
    buffer_store_dwordx2 v[20:21], v11, s[16:19], s40 offen offset:32
    s_waitcnt lgkmcnt(6)
    v_pk_add_f32 v[24:25], v[24:25], v[96:97]
    v_pk_add_f32 v[26:27], v[26:27], v[98:99]
    v_cvt_pk_bf16_f32 v24, v24, v25
    v_cvt_pk_bf16_f32 v25, v26, v27
    buffer_store_dwordx2 v[24:25], v11, s[16:19], s40 offen offset:64
    s_waitcnt lgkmcnt(5)
    v_pk_add_f32 v[28:29], v[28:29], v[100:101]
    v_pk_add_f32 v[30:31], v[30:31], v[102:103]
    v_cvt_pk_bf16_f32 v28, v28, v29
    v_cvt_pk_bf16_f32 v29, v30, v31
    buffer_store_dwordx2 v[28:29], v11, s[16:19], s40 offen offset:96
    s_waitcnt lgkmcnt(4)
    v_pk_add_f32 v[32:33], v[32:33], v[104:105]
    v_pk_add_f32 v[34:35], v[34:35], v[106:107]
    v_cvt_pk_bf16_f32 v32, v32, v33
    v_cvt_pk_bf16_f32 v33, v34, v35
    buffer_store_dwordx2 v[32:33], v11, s[16:19], s40 offen offset:128
    s_waitcnt lgkmcnt(3)
    v_pk_add_f32 v[36:37], v[36:37], v[108:109]
    v_pk_add_f32 v[38:39], v[38:39], v[110:111]
    v_cvt_pk_bf16_f32 v36, v36, v37
    v_cvt_pk_bf16_f32 v37, v38, v39
    buffer_store_dwordx2 v[36:37], v11, s[16:19], s40 offen offset:160
    s_waitcnt lgkmcnt(2)
    v_pk_add_f32 v[40:41], v[40:41], v[112:113]
    v_pk_add_f32 v[42:43], v[42:43], v[114:115]
    v_cvt_pk_bf16_f32 v40, v40, v41
    v_cvt_pk_bf16_f32 v41, v42, v43
    buffer_store_dwordx2 v[40:41], v11, s[16:19], s40 offen offset:192
    s_waitcnt lgkmcnt(1)
    v_pk_add_f32 v[44:45], v[44:45], v[116:117]
    v_pk_add_f32 v[46:47], v[46:47], v[118:119]
    v_cvt_pk_bf16_f32 v44, v44, v45
    v_cvt_pk_bf16_f32 v45, v46, v47
    buffer_store_dwordx2 v[44:45], v11, s[16:19], s40 offen offset:224
    s_waitcnt lgkmcnt(0)
    v_pk_add_f32 v[48:49], v[48:49], v[120:121]
    v_pk_add_f32 v[50:51], v[50:51], v[122:123]
    v_cvt_pk_bf16_f32 v48, v48, v49
    v_cvt_pk_bf16_f32 v49, v50, v51
    buffer_store_dwordx2 v[48:49], v11, s[16:19], s40 offen offset:256
    s_endpgm
kt_w1:
    ds_write_b128 v13, v[16:19] offset:0
    ds_write_b128 v13, v[20:23] offset:1024
    ds_write_b128 v13, v[24:27] offset:2048
    ds_write_b128 v13, v[28:31] offset:3072
    ds_write_b128 v13, v[32:35] offset:4096
    ds_write_b128 v13, v[36:39] offset:5120
    ds_write_b128 v13, v[40:43] offset:6144
    ds_write_b128 v13, v[44:47] offset:7168
    ds_write_b128 v13, v[48:51] offset:8192
    s_waitcnt lgkmcnt(0)
    s_barrier
    ds_read_b128 v[16:19], v12 offset:0
    ds_read_b128 v[20:23], v12 offset:1024
    ds_read_b128 v[24:27], v12 offset:2048
    ds_read_b128 v[28:31], v12 offset:3072
    ds_read_b128 v[32:35], v12 offset:4096
    ds_read_b128 v[36:39], v12 offset:5120
    ds_read_b128 v[40:43], v12 offset:6144
    ds_read_b128 v[44:47], v12 offset:7168
    ds_read_b128 v[48:51], v12 offset:8192
    ds_read_b128 v[88:91], v15 offset:0
    ds_read_b128 v[92:95], v15 offset:1024
    ds_read_b128 v[96:99], v15 offset:2048
    ds_read_b128 v[100:103], v15 offset:3072
    ds_read_b128 v[104:107], v15 offset:4096
    ds_read_b128 v[108:111], v15 offset:5120
    ds_read_b128 v[112:115], v15 offset:6144
    ds_read_b128 v[116:119], v15 offset:7168
    ds_read_b128 v[120:123], v15 offset:8192
    s_waitcnt lgkmcnt(15)
    v_pk_add_f32 v[52:53], v[52:53], v[16:17]
    v_pk_add_f32 v[54:55], v[54:55], v[18:19]
    v_cvt_pk_bf16_f32 v7, v52, v53
    v_lshlrev_b32 v52, 16, v7
    v_and_b32 v53, 0xffff0000, v7
    v_cvt_pk_bf16_f32 v7, v54, v55
    v_lshlrev_b32 v54, 16, v7
    v_and_b32 v55, 0xffff0000, v7
    v_mul_f32 v52, v14, v52
    v_mul_f32 v53, v14, v53
    v_mul_f32 v54, v14, v54
    v_mul_f32 v55, v14, v55
    v_cvt_pk_bf16_f32 v7, v52, v53
    v_lshlrev_b32 v52, 16, v7
    v_and_b32 v53, 0xffff0000, v7
    v_cvt_pk_bf16_f32 v7, v54, v55
    v_lshlrev_b32 v54, 16, v7
    v_and_b32 v55, 0xffff0000, v7
    s_waitcnt lgkmcnt(15)
    v_pk_add_f32 v[56:57], v[56:57], v[20:21]
    v_pk_add_f32 v[58:59], v[58:59], v[22:23]
    v_cvt_pk_bf16_f32 v7, v56, v57
    v_lshlrev_b32 v56, 16, v7
    v_and_b32 v57, 0xffff0000, v7
    v_cvt_pk_bf16_f32 v7, v58, v59
    v_lshlrev_b32 v58, 16, v7
    v_and_b32 v59, 0xffff0000, v7
    v_mul_f32 v56, v14, v56
    v_mul_f32 v57, v14, v57
    v_mul_f32 v58, v14, v58
    v_mul_f32 v59, v14, v59
    v_cvt_pk_bf16_f32 v7, v56, v57
    v_lshlrev_b32 v56, 16, v7
    v_and_b32 v57, 0xffff0000, v7
    v_cvt_pk_bf16_f32 v7, v58, v59
    v_lshlrev_b32 v58, 16, v7
    v_and_b32 v59, 0xffff0000, v7
    s_waitcnt lgkmcnt(15)
    v_pk_add_f32 v[60:61], v[60:61], v[24:25]
    v_pk_add_f32 v[62:63], v[62:63], v[26:27]
    v_cvt_pk_bf16_f32 v7, v60, v61
    v_lshlrev_b32 v60, 16, v7
    v_and_b32 v61, 0xffff0000, v7
    v_cvt_pk_bf16_f32 v7, v62, v63
    v_lshlrev_b32 v62, 16, v7
    v_and_b32 v63, 0xffff0000, v7
    v_mul_f32 v60, v14, v60
    v_mul_f32 v61, v14, v61
    v_mul_f32 v62, v14, v62
    v_mul_f32 v63, v14, v63
    v_cvt_pk_bf16_f32 v7, v60, v61
    v_lshlrev_b32 v60, 16, v7
    v_and_b32 v61, 0xffff0000, v7
    v_cvt_pk_bf16_f32 v7, v62, v63
    v_lshlrev_b32 v62, 16, v7
    v_and_b32 v63, 0xffff0000, v7
    s_waitcnt lgkmcnt(14)
    v_pk_add_f32 v[64:65], v[64:65], v[28:29]
    v_pk_add_f32 v[66:67], v[66:67], v[30:31]
    v_cvt_pk_bf16_f32 v7, v64, v65
    v_lshlrev_b32 v64, 16, v7
    v_and_b32 v65, 0xffff0000, v7
    v_cvt_pk_bf16_f32 v7, v66, v67
    v_lshlrev_b32 v66, 16, v7
    v_and_b32 v67, 0xffff0000, v7
    v_mul_f32 v64, v14, v64
    v_mul_f32 v65, v14, v65
    v_mul_f32 v66, v14, v66
    v_mul_f32 v67, v14, v67
    v_cvt_pk_bf16_f32 v7, v64, v65
    v_lshlrev_b32 v64, 16, v7
    v_and_b32 v65, 0xffff0000, v7
    v_cvt_pk_bf16_f32 v7, v66, v67
    v_lshlrev_b32 v66, 16, v7
    v_and_b32 v67, 0xffff0000, v7
    s_waitcnt lgkmcnt(13)
    v_pk_add_f32 v[68:69], v[68:69], v[32:33]
    v_pk_add_f32 v[70:71], v[70:71], v[34:35]
    v_cvt_pk_bf16_f32 v7, v68, v69
    v_lshlrev_b32 v68, 16, v7
    v_and_b32 v69, 0xffff0000, v7
    v_cvt_pk_bf16_f32 v7, v70, v71
    v_lshlrev_b32 v70, 16, v7
    v_and_b32 v71, 0xffff0000, v7
    v_mul_f32 v68, v14, v68
    v_mul_f32 v69, v14, v69
    v_mul_f32 v70, v14, v70
    v_mul_f32 v71, v14, v71
    v_cvt_pk_bf16_f32 v7, v68, v69
    v_lshlrev_b32 v68, 16, v7
    v_and_b32 v69, 0xffff0000, v7
    v_cvt_pk_bf16_f32 v7, v70, v71
    v_lshlrev_b32 v70, 16, v7
    v_and_b32 v71, 0xffff0000, v7
    s_waitcnt lgkmcnt(12)
    v_pk_add_f32 v[72:73], v[72:73], v[36:37]
    v_pk_add_f32 v[74:75], v[74:75], v[38:39]
    v_cvt_pk_bf16_f32 v7, v72, v73
    v_lshlrev_b32 v72, 16, v7
    v_and_b32 v73, 0xffff0000, v7
    v_cvt_pk_bf16_f32 v7, v74, v75
    v_lshlrev_b32 v74, 16, v7
    v_and_b32 v75, 0xffff0000, v7
    v_mul_f32 v72, v14, v72
    v_mul_f32 v73, v14, v73
    v_mul_f32 v74, v14, v74
    v_mul_f32 v75, v14, v75
    v_cvt_pk_bf16_f32 v7, v72, v73
    v_lshlrev_b32 v72, 16, v7
    v_and_b32 v73, 0xffff0000, v7
    v_cvt_pk_bf16_f32 v7, v74, v75
    v_lshlrev_b32 v74, 16, v7
    v_and_b32 v75, 0xffff0000, v7
    s_waitcnt lgkmcnt(11)
    v_pk_add_f32 v[76:77], v[76:77], v[40:41]
    v_pk_add_f32 v[78:79], v[78:79], v[42:43]
    v_cvt_pk_bf16_f32 v7, v76, v77
    v_lshlrev_b32 v76, 16, v7
    v_and_b32 v77, 0xffff0000, v7
    v_cvt_pk_bf16_f32 v7, v78, v79
    v_lshlrev_b32 v78, 16, v7
    v_and_b32 v79, 0xffff0000, v7
    v_mul_f32 v76, v14, v76
    v_mul_f32 v77, v14, v77
    v_mul_f32 v78, v14, v78
    v_mul_f32 v79, v14, v79
    v_cvt_pk_bf16_f32 v7, v76, v77
    v_lshlrev_b32 v76, 16, v7
    v_and_b32 v77, 0xffff0000, v7
    v_cvt_pk_bf16_f32 v7, v78, v79
    v_lshlrev_b32 v78, 16, v7
    v_and_b32 v79, 0xffff0000, v7
    s_waitcnt lgkmcnt(10)
    v_pk_add_f32 v[80:81], v[80:81], v[44:45]
    v_pk_add_f32 v[82:83], v[82:83], v[46:47]
    v_cvt_pk_bf16_f32 v7, v80, v81
    v_lshlrev_b32 v80, 16, v7
    v_and_b32 v81, 0xffff0000, v7
    v_cvt_pk_bf16_f32 v7, v82, v83
    v_lshlrev_b32 v82, 16, v7
    v_and_b32 v83, 0xffff0000, v7
    v_mul_f32 v80, v14, v80
    v_mul_f32 v81, v14, v81
    v_mul_f32 v82, v14, v82
    v_mul_f32 v83, v14, v83
    v_cvt_pk_bf16_f32 v7, v80, v81
    v_lshlrev_b32 v80, 16, v7
    v_and_b32 v81, 0xffff0000, v7
    v_cvt_pk_bf16_f32 v7, v82, v83
    v_lshlrev_b32 v82, 16, v7
    v_and_b32 v83, 0xffff0000, v7
    s_waitcnt lgkmcnt(9)
    v_pk_add_f32 v[84:85], v[84:85], v[48:49]
    v_pk_add_f32 v[86:87], v[86:87], v[50:51]
    v_cvt_pk_bf16_f32 v7, v84, v85
    v_lshlrev_b32 v84, 16, v7
    v_and_b32 v85, 0xffff0000, v7
    v_cvt_pk_bf16_f32 v7, v86, v87
    v_lshlrev_b32 v86, 16, v7
    v_and_b32 v87, 0xffff0000, v7
    v_mul_f32 v84, v14, v84
    v_mul_f32 v85, v14, v85
    v_mul_f32 v86, v14, v86
    v_mul_f32 v87, v14, v87
    v_cvt_pk_bf16_f32 v7, v84, v85
    v_lshlrev_b32 v84, 16, v7
    v_and_b32 v85, 0xffff0000, v7
    v_cvt_pk_bf16_f32 v7, v86, v87
    v_lshlrev_b32 v86, 16, v7
    v_and_b32 v87, 0xffff0000, v7
    s_waitcnt lgkmcnt(8)
    v_pk_add_f32 v[52:53], v[52:53], v[88:89]
    v_pk_add_f32 v[54:55], v[54:55], v[90:91]
    v_cvt_pk_bf16_f32 v52, v52, v53
    v_cvt_pk_bf16_f32 v53, v54, v55
    buffer_store_dwordx2 v[52:53], v11, s[16:19], s40 offen offset:0
    s_waitcnt lgkmcnt(7)
    v_pk_add_f32 v[56:57], v[56:57], v[92:93]
    v_pk_add_f32 v[58:59], v[58:59], v[94:95]
    v_cvt_pk_bf16_f32 v56, v56, v57
    v_cvt_pk_bf16_f32 v57, v58, v59
    buffer_store_dwordx2 v[56:57], v11, s[16:19], s40 offen offset:32
    s_waitcnt lgkmcnt(6)
    v_pk_add_f32 v[60:61], v[60:61], v[96:97]
    v_pk_add_f32 v[62:63], v[62:63], v[98:99]
    v_cvt_pk_bf16_f32 v60, v60, v61
    v_cvt_pk_bf16_f32 v61, v62, v63
    buffer_store_dwordx2 v[60:61], v11, s[16:19], s40 offen offset:64
    s_waitcnt lgkmcnt(5)
    v_pk_add_f32 v[64:65], v[64:65], v[100:101]
    v_pk_add_f32 v[66:67], v[66:67], v[102:103]
    v_cvt_pk_bf16_f32 v64, v64, v65
    v_cvt_pk_bf16_f32 v65, v66, v67
    buffer_store_dwordx2 v[64:65], v11, s[16:19], s40 offen offset:96
    s_waitcnt lgkmcnt(4)
    v_pk_add_f32 v[68:69], v[68:69], v[104:105]
    v_pk_add_f32 v[70:71], v[70:71], v[106:107]
    v_cvt_pk_bf16_f32 v68, v68, v69
    v_cvt_pk_bf16_f32 v69, v70, v71
    buffer_store_dwordx2 v[68:69], v11, s[16:19], s40 offen offset:128
    s_waitcnt lgkmcnt(3)
    v_pk_add_f32 v[72:73], v[72:73], v[108:109]
    v_pk_add_f32 v[74:75], v[74:75], v[110:111]
    v_cvt_pk_bf16_f32 v72, v72, v73
    v_cvt_pk_bf16_f32 v73, v74, v75
    buffer_store_dwordx2 v[72:73], v11, s[16:19], s40 offen offset:160
    s_waitcnt lgkmcnt(2)
    v_pk_add_f32 v[76:77], v[76:77], v[112:113]
    v_pk_add_f32 v[78:79], v[78:79], v[114:115]
    v_cvt_pk_bf16_f32 v76, v76, v77
    v_cvt_pk_bf16_f32 v77, v78, v79
    buffer_store_dwordx2 v[76:77], v11, s[16:19], s40 offen offset:192
    s_waitcnt lgkmcnt(1)
    v_pk_add_f32 v[80:81], v[80:81], v[116:117]
    v_pk_add_f32 v[82:83], v[82:83], v[118:119]
    v_cvt_pk_bf16_f32 v80, v80, v81
    v_cvt_pk_bf16_f32 v81, v82, v83
    buffer_store_dwordx2 v[80:81], v11, s[16:19], s40 offen offset:224
    s_waitcnt lgkmcnt(0)
    v_pk_add_f32 v[84:85], v[84:85], v[120:121]
    v_pk_add_f32 v[86:87], v[86:87], v[122:123]
    v_cvt_pk_bf16_f32 v84, v84, v85
    v_cvt_pk_bf16_f32 v85, v86, v87
    buffer_store_dwordx2 v[84:85], v11, s[16:19], s40 offen offset:256
    s_endpgm
k3_hi:
    ds_write_b128 v3, v[16:19] offset:0
    ds_write_b128 v3, v[20:23] offset:1024
    ds_write_b128 v3, v[24:27] offset:2048
    ds_write_b128 v3, v[28:31] offset:3072
    ds_write_b128 v3, v[32:35] offset:4096
    ds_write_b128 v3, v[36:39] offset:5120
    ds_write_b128 v3, v[40:43] offset:6144
    ds_write_b128 v3, v[44:47] offset:7168
    ds_write_b128 v3, v[48:51] offset:8192
    ds_write_b128 v3, v[52:55] offset:9216
    ds_write_b128 v3, v[56:59] offset:10240
    ds_write_b128 v3, v[60:63] offset:11264
    ds_write_b128 v3, v[64:67] offset:12288
    ds_write_b128 v3, v[68:71] offset:13312
    ds_write_b128 v3, v[72:75] offset:14336
    ds_write_b128 v3, v[76:79] offset:15360
    ds_write_b128 v3, v[80:83] offset:16384
    ds_write_b128 v3, v[84:87] offset:17408
    s_waitcnt lgkmcnt(0)
    s_barrier
    ds_read_b128 v[16:19], v4 offset:0
    ds_read_b128 v[20:23], v4 offset:1024
    ds_read_b128 v[24:27], v4 offset:2048
    ds_read_b128 v[28:31], v4 offset:3072
    ds_read_b128 v[32:35], v4 offset:4096
    ds_read_b128 v[36:39], v4 offset:5120
    ds_read_b128 v[40:43], v4 offset:6144
    ds_read_b128 v[44:47], v4 offset:7168
    ds_read_b128 v[48:51], v4 offset:8192
    s_waitcnt lgkmcnt(8)
    v_pk_add_f32 v[88:89], v[88:89], v[16:17]
    v_pk_add_f32 v[90:91], v[90:91], v[18:19]
    buffer_store_dwordx4 v[88:91], v2, s[16:19], s28 offen offset:0 sc1
    ds_read_b128 v[52:55], v4 offset:9216
    s_waitcnt lgkmcnt(8)
    v_pk_add_f32 v[92:93], v[92:93], v[20:21]
    v_pk_add_f32 v[94:95], v[94:95], v[22:23]
    buffer_store_dwordx4 v[92:95], v2, s[16:19], s28 offen offset:1024 sc1
    ds_read_b128 v[56:59], v4 offset:10240
    s_waitcnt lgkmcnt(8)
    v_pk_add_f32 v[96:97], v[96:97], v[24:25]
    v_pk_add_f32 v[98:99], v[98:99], v[26:27]
    buffer_store_dwordx4 v[96:99], v2, s[16:19], s28 offen offset:2048 sc1
    ds_read_b128 v[60:63], v4 offset:11264
    s_waitcnt lgkmcnt(8)
    v_pk_add_f32 v[100:101], v[100:101], v[28:29]
    v_pk_add_f32 v[102:103], v[102:103], v[30:31]
    buffer_store_dwordx4 v[100:103], v2, s[16:19], s28 offen offset:3072 sc1
    s_add_u32 s28, s28, 4096
    ds_read_b128 v[64:67], v4 offset:12288
    s_waitcnt lgkmcnt(8)
    v_pk_add_f32 v[104:105], v[104:105], v[32:33]
    v_pk_add_f32 v[106:107], v[106:107], v[34:35]
    buffer_store_dwordx4 v[104:107], v2, s[16:19], s28 offen offset:0 sc1
    ds_read_b128 v[68:71], v4 offset:13312
    s_waitcnt lgkmcnt(8)
    v_pk_add_f32 v[108:109], v[108:109], v[36:37]
    v_pk_add_f32 v[110:111], v[110:111], v[38:39]
    buffer_store_dwordx4 v[108:111], v2, s[16:19], s28 offen offset:1024 sc1
    ds_read_b128 v[72:75], v4 offset:14336
    s_waitcnt lgkmcnt(8)
    v_pk_add_f32 v[112:113], v[112:113], v[40:41]
    v_pk_add_f32 v[114:115], v[114:115], v[42:43]
    buffer_store_dwordx4 v[112:115], v2, s[16:19], s28 offen offset:2048 sc1
    ds_read_b128 v[76:79], v4 offset:15360
    s_waitcnt lgkmcnt(8)
    v_pk_add_f32 v[116:117], v[116:117], v[44:45]
    v_pk_add_f32 v[118:119], v[118:119], v[46:47]
    buffer_store_dwordx4 v[116:119], v2, s[16:19], s28 offen offset:3072 sc1
    s_add_u32 s28, s28, 4096
    ds_read_b128 v[80:83], v4 offset:16384
    s_waitcnt lgkmcnt(8)
    v_pk_add_f32 v[120:121], v[120:121], v[48:49]
    v_pk_add_f32 v[122:123], v[122:123], v[50:51]
    buffer_store_dwordx4 v[120:123], v2, s[16:19], s28 offen offset:0 sc1
    s_add_u32 s28, s28, 28672
    ds_read_b128 v[84:87], v4 offset:17408
    s_waitcnt lgkmcnt(8)
    v_pk_add_f32 v[124:125], v[124:125], v[52:53]
    v_pk_add_f32 v[126:127], v[126:127], v[54:55]
    buffer_store_dwordx4 v[124:127], v2, s[16:19], s28 offen offset:0 sc1
    s_waitcnt lgkmcnt(7)
    v_pk_add_f32 v[128:129], v[128:129], v[56:57]
    v_pk_add_f32 v[130:131], v[130:131], v[58:59]
    buffer_store_dwordx4 v[128:131], v2, s[16:19], s28 offen offset:1024 sc1
    s_waitcnt lgkmcnt(6)
    v_pk_add_f32 v[132:133], v[132:133], v[60:61]
    v_pk_add_f32 v[134:135], v[134:135], v[62:63]
    buffer_store_dwordx4 v[132:135], v2, s[16:19], s28 offen offset:2048 sc1
    s_waitcnt lgkmcnt(5)
    v_pk_add_f32 v[136:137], v[136:137], v[64:65]
    v_pk_add_f32 v[138:139], v[138:139], v[66:67]
    buffer_store_dwordx4 v[136:139], v2, s[16:19], s28 offen offset:3072 sc1
    s_add_u32 s28, s28, 4096
    s_waitcnt lgkmcnt(4)
    v_pk_add_f32 v[140:141], v[140:141], v[68:69]
    v_pk_add_f32 v[142:143], v[142:143], v[70:71]
    buffer_store_dwordx4 v[140:143], v2, s[16:19], s28 offen offset:0 sc1
    s_waitcnt lgkmcnt(3)
    v_pk_add_f32 v[144:145], v[144:145], v[72:73]
    v_pk_add_f32 v[146:147], v[146:147], v[74:75]
    buffer_store_dwordx4 v[144:147], v2, s[16:19], s28 offen offset:1024 sc1
    s_waitcnt lgkmcnt(2)
    v_pk_add_f32 v[148:149], v[148:149], v[76:77]
    v_pk_add_f32 v[150:151], v[150:151], v[78:79]
    buffer_store_dwordx4 v[148:151], v2, s[16:19], s28 offen offset:2048 sc1
    s_waitcnt lgkmcnt(1)
    v_pk_add_f32 v[152:153], v[152:153], v[80:81]
    v_pk_add_f32 v[154:155], v[154:155], v[82:83]
    buffer_store_dwordx4 v[152:155], v2, s[16:19], s28 offen offset:3072 sc1
    s_add_u32 s28, s28, 4096
    s_waitcnt lgkmcnt(0)
    v_pk_add_f32 v[156:157], v[156:157], v[84:85]
    v_pk_add_f32 v[158:159], v[158:159], v[86:87]
    buffer_store_dwordx4 v[156:159], v2, s[16:19], s28 offen offset:0 sc1
    s_add_u32 s28, s28, 28672
    s_lshr_b32 s3, s3, 3
    s_lshl_b32 s39, s3, 2
    s_add_u32 s39, s39, s4
    s_lshl_b32 s39, s39, 2
    s_add_u32 s38, s39, s5
    s_setprio 0
    s_waitcnt vmcnt(0)
    s_barrier
    s_cmp_lg_u32 s27, 0
    s_cbranch_scc1 k2_pb_18
    s_lshl_b32 s28, s38, 2
    s_add_u32 s28, s28, 16384
    v_mov_b32 v3, s28
    v_mov_b32 v2, s100
    s_mov_b64 exec, 1
    buffer_store_dword v2, v3, s[96:99], 0 offen sc1
    s_mov_b64 exec, -1
k2_pb_18:
    s_lshl_b32 s3, s3, 3
    s_lshl_b32 s28, s5, 1
    s_add_u32 s3, s3, s28
    s_add_u32 s32, s86, 0x240000
    s_addc_u32 s33, s87, 0
    s_mov_b32 s34, 0x2000
    s_mov_b32 s35, 0x00020000
    s_mul_i32 s40, s4, 288
    s_and_b32 s41, s27, 1
    s_mul_i32 s43, s41, 9216
    s_add_u32 s41, s41, s3
    v_lshlrev_b32 v10, 4, v1
    s_cmp_eq_u32 s37, 0
    s_cbranch_scc1 k2_own_19
    v_add_u32 v9, 55296, v10
    ds_write_b128 v9, v[88:91] offset:0
    ds_write_b128 v9, v[92:95] offset:1024
    ds_write_b128 v9, v[96:99] offset:2048
    ds_write_b128 v9, v[100:103] offset:3072
    ds_write_b128 v9, v[104:107] offset:4096
    ds_write_b128 v9, v[108:111] offset:5120
    ds_write_b128 v9, v[112:115] offset:6144
    ds_write_b128 v9, v[116:119] offset:7168
    ds_write_b128 v9, v[120:123] offset:8192
    ds_write_b128 v9, v[124:127] offset:9216
    ds_write_b128 v9, v[128:131] offset:10240
    ds_write_b128 v9, v[132:135] offset:11264
    ds_write_b128 v9, v[136:139] offset:12288
    ds_write_b128 v9, v[140:143] offset:13312
    ds_write_b128 v9, v[144:147] offset:14336
    ds_write_b128 v9, v[148:151] offset:15360
    ds_write_b128 v9, v[152:155] offset:16384
    ds_write_b128 v9, v[156:159] offset:17408
    s_waitcnt lgkmcnt(0)
k2_own_19:
    s_barrier
    s_add_u32 s43, s43, 55296
    v_add_u32 v15, s43, v10
    s_lshl_b32 s42, s41, 4
    v_and_b32 v11, 15, v1
    v_add_u32 v11, s42, v11
    v_lshrrev_b32 v12, 4, v1
    v_lshlrev_b32 v12, 3, v12
    v_lshlrev_b32 v13, 2, v11
    buffer_load_dword v14, v13, s[32:35], 0 offen
    s_add_u32 s8, s86, 0x2800000
    s_addc_u32 s9, s87, 0
    s_mov_b32 s10, 0x1200000
    s_mov_b32 s11, 0x00020000
    s_mov_b32 s20, s78
    s_mov_b32 s21, s79
    s_mov_b32 s22, 0x480
    s_mov_b32 s23, 0x00020000
    s_mov_b32 s12, s68
    s_mov_b32 s13, s69
    s_mov_b32 s14, 0xa2000
    s_mov_b32 s15, 0x00020000
    buffer_load_dwordx2 v[160:161], v12, s[20:23], s40 offen offset:0
    buffer_load_dwordx2 v[162:163], v12, s[20:23], s40 offen offset:32
    buffer_load_dwordx2 v[164:165], v12, s[20:23], s40 offen offset:64
    buffer_load_dwordx2 v[166:167], v12, s[20:23], s40 offen offset:96
    buffer_load_dwordx2 v[168:169], v12, s[20:23], s40 offen offset:128
    buffer_load_dwordx2 v[170:171], v12, s[20:23], s40 offen offset:160
    buffer_load_dwordx2 v[172:173], v12, s[20:23], s40 offen offset:192
    buffer_load_dwordx2 v[174:175], v12, s[20:23], s40 offen offset:224
    buffer_load_dwordx2 v[176:177], v12, s[20:23], s40 offen offset:256
    s_bfe_u32 s28, s2, 0x50003
    s_lshl_b32 s28, s28, 1
    s_and_b32 s29, s27, 1
    s_add_u32 s28, s28, s29
    s_lshl_b32 s28, s28, 10
    buffer_load_dwordx4 v[16:19], v10, s[12:15], s28 offen
    s_add_u32 s28, s28, 65536
    buffer_load_dwordx4 v[16:19], v10, s[12:15], s28 offen
    s_add_u32 s28, s28, 65536
    buffer_load_dwordx4 v[16:19], v10, s[12:15], s28 offen
    s_add_u32 s28, s28, 65536
    buffer_load_dwordx4 v[16:19], v10, s[12:15], s28 offen
    s_add_u32 s28, s28, 65536
    buffer_load_dwordx4 v[16:19], v10, s[12:15], s28 offen
    s_add_u32 s28, s28, 65536
    buffer_load_dwordx4 v[16:19], v10, s[12:15], s28 offen
    s_add_u32 s28, s28, 65536
    buffer_load_dwordx4 v[16:19], v10, s[12:15], s28 offen
    s_add_u32 s28, s28, 65536
    buffer_load_dwordx4 v[16:19], v10, s[12:15], s28 offen
    s_add_u32 s28, s28, 65536
    buffer_load_dwordx4 v[16:19], v10, s[12:15], s28 offen
    s_add_u32 s28, s28, 65536
    buffer_load_dwordx4 v[16:19], v10, s[12:15], s28 offen
    s_add_u32 s28, s28, 65536
    buffer_load_dwordx4 v[16:19], v10, s[12:15], s28 offen
    s_mov_b32 s96, s84
    s_mov_b32 s97, s85
    s_mov_b32 s98, 0x100
    s_mov_b32 s99, 0x00020000
    v_mov_b32 v3, 0
    s_mov_b32 s101, 262144
k2_ng_22:
    buffer_load_dword v2, v3, s[96:99], 0 offen sc1
    s_waitcnt vmcnt(0)
    v_readfirstlane_b32 s100, v2
    s_cmp_lg_u32 s100, 0
    s_cbranch_scc1 k2_ngd_23
    s_sub_u32 s101, s101, 1
    s_cbranch_scc1 k2_ngd_23
    s_sleep 1
    s_branch k2_ng_22
k2_ngd_23:
    s_add_u32 s96, s86, 0x300000
    s_addc_u32 s97, s87, 0
    s_mov_b32 s98, 0x10000
    s_mov_b32 s99, 0x00020000
    s_lshl_b32 s28, s39, 2
    s_add_u32 s28, s28, 16384
    v_lshlrev_b32 v3, 2, v1
    v_add_u32 v3, s28, v3
    s_mov_b32 s28, 15
    s_mov_b32 s29, 0
    s_mov_b64 exec, s[28:29]
    s_mov_b32 s101, 262144
k2_asl_20:
    buffer_load_dword v2, v3, s[96:99], 0 offen sc1
    s_waitcnt vmcnt(0)
    v_cmp_ne_u32 vcc, s100, v2
    s_cbranch_vccz k2_asd_21
    s_sub_u32 s101, s101, 1
    s_cbranch_scc1 k2_asd_21
    s_sleep 1
    s_branch k2_asl_20
k2_asd_21:
    s_mov_b64 exec, -1
    s_lshl_b32 s42, s41, 2
    s_add_u32 s42, s42, s4
    s_mul_i32 s42, s42, 9216
    s_cmp_eq_u32 s5, 0
    s_cbranch_scc1 k2_slo_24
    s_add_u32 s28, s42, 0
    s_add_u32 s29, s28, 4096
    s_add_u32 s30, s28, 8192
    buffer_load_dwordx4 v[16:19], v10, s[8:11], s28 offen offset:0 sc1
    buffer_load_dwordx4 v[20:23], v10, s[8:11], s28 offen offset:1024 sc1
    buffer_load_dwordx4 v[24:27], v10, s[8:11], s28 offen offset:2048 sc1
    buffer_load_dwordx4 v[28:31], v10, s[8:11], s28 offen offset:3072 sc1
    buffer_load_dwordx4 v[32:35], v10, s[8:11], s29 offen offset:0 sc1
    buffer_load_dwordx4 v[36:39], v10, s[8:11], s29 offen offset:1024 sc1
    buffer_load_dwordx4 v[40:43], v10, s[8:11], s29 offen offset:2048 sc1
    buffer_load_dwordx4 v[44:47], v10, s[8:11], s29 offen offset:3072 sc1
    buffer_load_dwordx4 v[48:51], v10, s[8:11], s30 offen offset:0 sc1
    s_branch k2_sld_25
k2_slo_24:
    ds_read_b128 v[16:19], v15 offset:0
    ds_read_b128 v[20:23], v15 offset:1024
    ds_read_b128 v[24:27], v15 offset:2048
    ds_read_b128 v[28:31], v15 offset:3072
    ds_read_b128 v[32:35], v15 offset:4096
    ds_read_b128 v[36:39], v15 offset:5120
    ds_read_b128 v[40:43], v15 offset:6144
    ds_read_b128 v[44:47], v15 offset:7168
    ds_read_b128 v[48:51], v15 offset:8192
k2_sld_25:
    s_cmp_eq_u32 s5, 1
    s_cbranch_scc1 k2_slo_26
    s_add_u32 s28, s42, 4718592
    s_add_u32 s29, s28, 4096
    s_add_u32 s30, s28, 8192
    buffer_load_dwordx4 v[52:55], v10, s[8:11], s28 offen offset:0 sc1
    buffer_load_dwordx4 v[56:59], v10, s[8:11], s28 offen offset:1024 sc1
    buffer_load_dwordx4 v[60:63], v10, s[8:11], s28 offen offset:2048 sc1
    buffer_load_dwordx4 v[64:67], v10, s[8:11], s28 offen offset:3072 sc1
    buffer_load_dwordx4 v[68:71], v10, s[8:11], s29 offen offset:0 sc1
    buffer_load_dwordx4 v[72:75], v10, s[8:11], s29 offen offset:1024 sc1
    buffer_load_dwordx4 v[76:79], v10, s[8:11], s29 offen offset:2048 sc1
    buffer_load_dwordx4 v[80:83], v10, s[8:11], s29 offen offset:3072 sc1
    buffer_load_dwordx4 v[84:87], v10, s[8:11], s30 offen offset:0 sc1
    s_branch k2_sld_27
k2_slo_26:
    ds_read_b128 v[52:55], v15 offset:0
    ds_read_b128 v[56:59], v15 offset:1024
    ds_read_b128 v[60:63], v15 offset:2048
    ds_read_b128 v[64:67], v15 offset:3072
    ds_read_b128 v[68:71], v15 offset:4096
    ds_read_b128 v[72:75], v15 offset:5120
    ds_read_b128 v[76:79], v15 offset:6144
    ds_read_b128 v[80:83], v15 offset:7168
    ds_read_b128 v[84:87], v15 offset:8192
k2_sld_27:
    s_cmp_eq_u32 s5, 2
    s_cbranch_scc1 k2_slo_28
    s_add_u32 s28, s42, 9437184
    s_add_u32 s29, s28, 4096
    s_add_u32 s30, s28, 8192
    buffer_load_dwordx4 v[88:91], v10, s[8:11], s28 offen offset:0 sc1
    buffer_load_dwordx4 v[92:95], v10, s[8:11], s28 offen offset:1024 sc1
    buffer_load_dwordx4 v[96:99], v10, s[8:11], s28 offen offset:2048 sc1
    buffer_load_dwordx4 v[100:103], v10, s[8:11], s28 offen offset:3072 sc1
    buffer_load_dwordx4 v[104:107], v10, s[8:11], s29 offen offset:0 sc1
    buffer_load_dwordx4 v[108:111], v10, s[8:11], s29 offen offset:1024 sc1
    buffer_load_dwordx4 v[112:115], v10, s[8:11], s29 offen offset:2048 sc1
    buffer_load_dwordx4 v[116:119], v10, s[8:11], s29 offen offset:3072 sc1
    buffer_load_dwordx4 v[120:123], v10, s[8:11], s30 offen offset:0 sc1
    s_branch k2_sld_29
k2_slo_28:
    ds_read_b128 v[88:91], v15 offset:0
    ds_read_b128 v[92:95], v15 offset:1024
    ds_read_b128 v[96:99], v15 offset:2048
    ds_read_b128 v[100:103], v15 offset:3072
    ds_read_b128 v[104:107], v15 offset:4096
    ds_read_b128 v[108:111], v15 offset:5120
    ds_read_b128 v[112:115], v15 offset:6144
    ds_read_b128 v[116:119], v15 offset:7168
    ds_read_b128 v[120:123], v15 offset:8192
k2_sld_29:
    s_cmp_eq_u32 s5, 3
    s_cbranch_scc1 k2_slo_30
    s_add_u32 s28, s42, 14155776
    s_add_u32 s29, s28, 4096
    s_add_u32 s30, s28, 8192
    buffer_load_dwordx4 v[124:127], v10, s[8:11], s28 offen offset:0 sc1
    buffer_load_dwordx4 v[128:131], v10, s[8:11], s28 offen offset:1024 sc1
    buffer_load_dwordx4 v[132:135], v10, s[8:11], s28 offen offset:2048 sc1
    buffer_load_dwordx4 v[136:139], v10, s[8:11], s28 offen offset:3072 sc1
    buffer_load_dwordx4 v[140:143], v10, s[8:11], s29 offen offset:0 sc1
    buffer_load_dwordx4 v[144:147], v10, s[8:11], s29 offen offset:1024 sc1
    buffer_load_dwordx4 v[148:151], v10, s[8:11], s29 offen offset:2048 sc1
    buffer_load_dwordx4 v[152:155], v10, s[8:11], s29 offen offset:3072 sc1
    buffer_load_dwordx4 v[156:159], v10, s[8:11], s30 offen offset:0 sc1
    s_branch k2_sld_31
k2_slo_30:
    ds_read_b128 v[124:127], v15 offset:0
    ds_read_b128 v[128:131], v15 offset:1024
    ds_read_b128 v[132:135], v15 offset:2048
    ds_read_b128 v[136:139], v15 offset:3072
    ds_read_b128 v[140:143], v15 offset:4096
    ds_read_b128 v[144:147], v15 offset:5120
    ds_read_b128 v[148:151], v15 offset:6144
    ds_read_b128 v[152:155], v15 offset:7168
    ds_read_b128 v[156:159], v15 offset:8192
k2_sld_31:
    v_sub_f32 v6, 1.0, v14
    v_cvt_pk_bf16_f32 v6, v6, v6
    v_lshlrev_b32 v6, 16, v6
    s_waitcnt vmcnt(0) lgkmcnt(0)
    v_lshlrev_b32 v180, 16, v160
    v_and_b32 v181, 0xffff0000, v160
    v_lshlrev_b32 v182, 16, v161
    v_and_b32 v183, 0xffff0000, v161
    v_pk_add_f32 v[16:17], v[16:17], v[52:53]
    v_pk_add_f32 v[18:19], v[18:19], v[54:55]
    v_pk_add_f32 v[88:89], v[88:89], v[124:125]
    v_pk_add_f32 v[90:91], v[90:91], v[126:127]
    v_pk_add_f32 v[16:17], v[16:17], v[88:89]
    v_pk_add_f32 v[18:19], v[18:19], v[90:91]
    v_cvt_pk_bf16_f32 v7, v16, v17
    v_lshlrev_b32 v16, 16, v7
    v_and_b32 v17, 0xffff0000, v7
    v_cvt_pk_bf16_f32 v7, v18, v19
    v_lshlrev_b32 v18, 16, v7
    v_and_b32 v19, 0xffff0000, v7
    v_pk_add_f32 v[16:17], v[16:17], v[180:181]
    v_pk_add_f32 v[18:19], v[18:19], v[182:183]
    v_cvt_pk_bf16_f32 v7, v16, v17
    v_lshlrev_b32 v16, 16, v7
    v_and_b32 v17, 0xffff0000, v7
    v_cvt_pk_bf16_f32 v7, v18, v19
    v_lshlrev_b32 v18, 16, v7
    v_and_b32 v19, 0xffff0000, v7
    v_mul_f32 v16, v6, v16
    v_mul_f32 v17, v6, v17
    v_mul_f32 v18, v6, v18
    v_mul_f32 v19, v6, v19
    v_cvt_pk_bf16_f32 v7, v16, v17
    v_lshlrev_b32 v16, 16, v7
    v_and_b32 v17, 0xffff0000, v7
    v_cvt_pk_bf16_f32 v7, v18, v19
    v_lshlrev_b32 v18, 16, v7
    v_and_b32 v19, 0xffff0000, v7
    ds_write_b128 v15, v[16:19] offset:0
    v_lshlrev_b32 v180, 16, v162
    v_and_b32 v181, 0xffff0000, v162
    v_lshlrev_b32 v182, 16, v163
    v_and_b32 v183, 0xffff0000, v163
    v_pk_add_f32 v[20:21], v[20:21], v[56:57]
    v_pk_add_f32 v[22:23], v[22:23], v[58:59]
    v_pk_add_f32 v[92:93], v[92:93], v[128:129]
    v_pk_add_f32 v[94:95], v[94:95], v[130:131]
    v_pk_add_f32 v[20:21], v[20:21], v[92:93]
    v_pk_add_f32 v[22:23], v[22:23], v[94:95]
    v_cvt_pk_bf16_f32 v7, v20, v21
    v_lshlrev_b32 v20, 16, v7
    v_and_b32 v21, 0xffff0000, v7
    v_cvt_pk_bf16_f32 v7, v22, v23
    v_lshlrev_b32 v22, 16, v7
    v_and_b32 v23, 0xffff0000, v7
    v_pk_add_f32 v[20:21], v[20:21], v[180:181]
    v_pk_add_f32 v[22:23], v[22:23], v[182:183]
    v_cvt_pk_bf16_f32 v7, v20, v21
    v_lshlrev_b32 v20, 16, v7
    v_and_b32 v21, 0xffff0000, v7
    v_cvt_pk_bf16_f32 v7, v22, v23
    v_lshlrev_b32 v22, 16, v7
    v_and_b32 v23, 0xffff0000, v7
    v_mul_f32 v20, v6, v20
    v_mul_f32 v21, v6, v21
    v_mul_f32 v22, v6, v22
    v_mul_f32 v23, v6, v23
    v_cvt_pk_bf16_f32 v7, v20, v21
    v_lshlrev_b32 v20, 16, v7
    v_and_b32 v21, 0xffff0000, v7
    v_cvt_pk_bf16_f32 v7, v22, v23
    v_lshlrev_b32 v22, 16, v7
    v_and_b32 v23, 0xffff0000, v7
    ds_write_b128 v15, v[20:23] offset:1024
    v_lshlrev_b32 v180, 16, v164
    v_and_b32 v181, 0xffff0000, v164
    v_lshlrev_b32 v182, 16, v165
    v_and_b32 v183, 0xffff0000, v165
    v_pk_add_f32 v[24:25], v[24:25], v[60:61]
    v_pk_add_f32 v[26:27], v[26:27], v[62:63]
    v_pk_add_f32 v[96:97], v[96:97], v[132:133]
    v_pk_add_f32 v[98:99], v[98:99], v[134:135]
    v_pk_add_f32 v[24:25], v[24:25], v[96:97]
    v_pk_add_f32 v[26:27], v[26:27], v[98:99]
    v_cvt_pk_bf16_f32 v7, v24, v25
    v_lshlrev_b32 v24, 16, v7
    v_and_b32 v25, 0xffff0000, v7
    v_cvt_pk_bf16_f32 v7, v26, v27
    v_lshlrev_b32 v26, 16, v7
    v_and_b32 v27, 0xffff0000, v7
    v_pk_add_f32 v[24:25], v[24:25], v[180:181]
    v_pk_add_f32 v[26:27], v[26:27], v[182:183]
    v_cvt_pk_bf16_f32 v7, v24, v25
    v_lshlrev_b32 v24, 16, v7
    v_and_b32 v25, 0xffff0000, v7
    v_cvt_pk_bf16_f32 v7, v26, v27
    v_lshlrev_b32 v26, 16, v7
    v_and_b32 v27, 0xffff0000, v7
    v_mul_f32 v24, v6, v24
    v_mul_f32 v25, v6, v25
    v_mul_f32 v26, v6, v26
    v_mul_f32 v27, v6, v27
    v_cvt_pk_bf16_f32 v7, v24, v25
    v_lshlrev_b32 v24, 16, v7
    v_and_b32 v25, 0xffff0000, v7
    v_cvt_pk_bf16_f32 v7, v26, v27
    v_lshlrev_b32 v26, 16, v7
    v_and_b32 v27, 0xffff0000, v7
    ds_write_b128 v15, v[24:27] offset:2048
    v_lshlrev_b32 v180, 16, v166
    v_and_b32 v181, 0xffff0000, v166
    v_lshlrev_b32 v182, 16, v167
    v_and_b32 v183, 0xffff0000, v167
    v_pk_add_f32 v[28:29], v[28:29], v[64:65]
    v_pk_add_f32 v[30:31], v[30:31], v[66:67]
    v_pk_add_f32 v[100:101], v[100:101], v[136:137]
    v_pk_add_f32 v[102:103], v[102:103], v[138:139]
    v_pk_add_f32 v[28:29], v[28:29], v[100:101]
    v_pk_add_f32 v[30:31], v[30:31], v[102:103]
    v_cvt_pk_bf16_f32 v7, v28, v29
    v_lshlrev_b32 v28, 16, v7
    v_and_b32 v29, 0xffff0000, v7
    v_cvt_pk_bf16_f32 v7, v30, v31
    v_lshlrev_b32 v30, 16, v7
    v_and_b32 v31, 0xffff0000, v7
    v_pk_add_f32 v[28:29], v[28:29], v[180:181]
    v_pk_add_f32 v[30:31], v[30:31], v[182:183]
    v_cvt_pk_bf16_f32 v7, v28, v29
    v_lshlrev_b32 v28, 16, v7
    v_and_b32 v29, 0xffff0000, v7
    v_cvt_pk_bf16_f32 v7, v30, v31
    v_lshlrev_b32 v30, 16, v7
    v_and_b32 v31, 0xffff0000, v7
    v_mul_f32 v28, v6, v28
    v_mul_f32 v29, v6, v29
    v_mul_f32 v30, v6, v30
    v_mul_f32 v31, v6, v31
    v_cvt_pk_bf16_f32 v7, v28, v29
    v_lshlrev_b32 v28, 16, v7
    v_and_b32 v29, 0xffff0000, v7
    v_cvt_pk_bf16_f32 v7, v30, v31
    v_lshlrev_b32 v30, 16, v7
    v_and_b32 v31, 0xffff0000, v7
    ds_write_b128 v15, v[28:31] offset:3072
    v_lshlrev_b32 v180, 16, v168
    v_and_b32 v181, 0xffff0000, v168
    v_lshlrev_b32 v182, 16, v169
    v_and_b32 v183, 0xffff0000, v169
    v_pk_add_f32 v[32:33], v[32:33], v[68:69]
    v_pk_add_f32 v[34:35], v[34:35], v[70:71]
    v_pk_add_f32 v[104:105], v[104:105], v[140:141]
    v_pk_add_f32 v[106:107], v[106:107], v[142:143]
    v_pk_add_f32 v[32:33], v[32:33], v[104:105]
    v_pk_add_f32 v[34:35], v[34:35], v[106:107]
    v_cvt_pk_bf16_f32 v7, v32, v33
    v_lshlrev_b32 v32, 16, v7
    v_and_b32 v33, 0xffff0000, v7
    v_cvt_pk_bf16_f32 v7, v34, v35
    v_lshlrev_b32 v34, 16, v7
    v_and_b32 v35, 0xffff0000, v7
    v_pk_add_f32 v[32:33], v[32:33], v[180:181]
    v_pk_add_f32 v[34:35], v[34:35], v[182:183]
    v_cvt_pk_bf16_f32 v7, v32, v33
    v_lshlrev_b32 v32, 16, v7
    v_and_b32 v33, 0xffff0000, v7
    v_cvt_pk_bf16_f32 v7, v34, v35
    v_lshlrev_b32 v34, 16, v7
    v_and_b32 v35, 0xffff0000, v7
    v_mul_f32 v32, v6, v32
    v_mul_f32 v33, v6, v33
    v_mul_f32 v34, v6, v34
    v_mul_f32 v35, v6, v35
    v_cvt_pk_bf16_f32 v7, v32, v33
    v_lshlrev_b32 v32, 16, v7
    v_and_b32 v33, 0xffff0000, v7
    v_cvt_pk_bf16_f32 v7, v34, v35
    v_lshlrev_b32 v34, 16, v7
    v_and_b32 v35, 0xffff0000, v7
    ds_write_b128 v15, v[32:35] offset:4096
    v_lshlrev_b32 v180, 16, v170
    v_and_b32 v181, 0xffff0000, v170
    v_lshlrev_b32 v182, 16, v171
    v_and_b32 v183, 0xffff0000, v171
    v_pk_add_f32 v[36:37], v[36:37], v[72:73]
    v_pk_add_f32 v[38:39], v[38:39], v[74:75]
    v_pk_add_f32 v[108:109], v[108:109], v[144:145]
    v_pk_add_f32 v[110:111], v[110:111], v[146:147]
    v_pk_add_f32 v[36:37], v[36:37], v[108:109]
    v_pk_add_f32 v[38:39], v[38:39], v[110:111]
    v_cvt_pk_bf16_f32 v7, v36, v37
    v_lshlrev_b32 v36, 16, v7
    v_and_b32 v37, 0xffff0000, v7
    v_cvt_pk_bf16_f32 v7, v38, v39
    v_lshlrev_b32 v38, 16, v7
    v_and_b32 v39, 0xffff0000, v7
    v_pk_add_f32 v[36:37], v[36:37], v[180:181]
    v_pk_add_f32 v[38:39], v[38:39], v[182:183]
    v_cvt_pk_bf16_f32 v7, v36, v37
    v_lshlrev_b32 v36, 16, v7
    v_and_b32 v37, 0xffff0000, v7
    v_cvt_pk_bf16_f32 v7, v38, v39
    v_lshlrev_b32 v38, 16, v7
    v_and_b32 v39, 0xffff0000, v7
    v_mul_f32 v36, v6, v36
    v_mul_f32 v37, v6, v37
    v_mul_f32 v38, v6, v38
    v_mul_f32 v39, v6, v39
    v_cvt_pk_bf16_f32 v7, v36, v37
    v_lshlrev_b32 v36, 16, v7
    v_and_b32 v37, 0xffff0000, v7
    v_cvt_pk_bf16_f32 v7, v38, v39
    v_lshlrev_b32 v38, 16, v7
    v_and_b32 v39, 0xffff0000, v7
    ds_write_b128 v15, v[36:39] offset:5120
    v_lshlrev_b32 v180, 16, v172
    v_and_b32 v181, 0xffff0000, v172
    v_lshlrev_b32 v182, 16, v173
    v_and_b32 v183, 0xffff0000, v173
    v_pk_add_f32 v[40:41], v[40:41], v[76:77]
    v_pk_add_f32 v[42:43], v[42:43], v[78:79]
    v_pk_add_f32 v[112:113], v[112:113], v[148:149]
    v_pk_add_f32 v[114:115], v[114:115], v[150:151]
    v_pk_add_f32 v[40:41], v[40:41], v[112:113]
    v_pk_add_f32 v[42:43], v[42:43], v[114:115]
    v_cvt_pk_bf16_f32 v7, v40, v41
    v_lshlrev_b32 v40, 16, v7
    v_and_b32 v41, 0xffff0000, v7
    v_cvt_pk_bf16_f32 v7, v42, v43
    v_lshlrev_b32 v42, 16, v7
    v_and_b32 v43, 0xffff0000, v7
    v_pk_add_f32 v[40:41], v[40:41], v[180:181]
    v_pk_add_f32 v[42:43], v[42:43], v[182:183]
    v_cvt_pk_bf16_f32 v7, v40, v41
    v_lshlrev_b32 v40, 16, v7
    v_and_b32 v41, 0xffff0000, v7
    v_cvt_pk_bf16_f32 v7, v42, v43
    v_lshlrev_b32 v42, 16, v7
    v_and_b32 v43, 0xffff0000, v7
    v_mul_f32 v40, v6, v40
    v_mul_f32 v41, v6, v41
    v_mul_f32 v42, v6, v42
    v_mul_f32 v43, v6, v43
    v_cvt_pk_bf16_f32 v7, v40, v41
    v_lshlrev_b32 v40, 16, v7
    v_and_b32 v41, 0xffff0000, v7
    v_cvt_pk_bf16_f32 v7, v42, v43
    v_lshlrev_b32 v42, 16, v7
    v_and_b32 v43, 0xffff0000, v7
    ds_write_b128 v15, v[40:43] offset:6144
    v_lshlrev_b32 v180, 16, v174
    v_and_b32 v181, 0xffff0000, v174
    v_lshlrev_b32 v182, 16, v175
    v_and_b32 v183, 0xffff0000, v175
    v_pk_add_f32 v[44:45], v[44:45], v[80:81]
    v_pk_add_f32 v[46:47], v[46:47], v[82:83]
    v_pk_add_f32 v[116:117], v[116:117], v[152:153]
    v_pk_add_f32 v[118:119], v[118:119], v[154:155]
    v_pk_add_f32 v[44:45], v[44:45], v[116:117]
    v_pk_add_f32 v[46:47], v[46:47], v[118:119]
    v_cvt_pk_bf16_f32 v7, v44, v45
    v_lshlrev_b32 v44, 16, v7
    v_and_b32 v45, 0xffff0000, v7
    v_cvt_pk_bf16_f32 v7, v46, v47
    v_lshlrev_b32 v46, 16, v7
    v_and_b32 v47, 0xffff0000, v7
    v_pk_add_f32 v[44:45], v[44:45], v[180:181]
    v_pk_add_f32 v[46:47], v[46:47], v[182:183]
    v_cvt_pk_bf16_f32 v7, v44, v45
    v_lshlrev_b32 v44, 16, v7
    v_and_b32 v45, 0xffff0000, v7
    v_cvt_pk_bf16_f32 v7, v46, v47
    v_lshlrev_b32 v46, 16, v7
    v_and_b32 v47, 0xffff0000, v7
    v_mul_f32 v44, v6, v44
    v_mul_f32 v45, v6, v45
    v_mul_f32 v46, v6, v46
    v_mul_f32 v47, v6, v47
    v_cvt_pk_bf16_f32 v7, v44, v45
    v_lshlrev_b32 v44, 16, v7
    v_and_b32 v45, 0xffff0000, v7
    v_cvt_pk_bf16_f32 v7, v46, v47
    v_lshlrev_b32 v46, 16, v7
    v_and_b32 v47, 0xffff0000, v7
    ds_write_b128 v15, v[44:47] offset:7168
    v_lshlrev_b32 v180, 16, v176
    v_and_b32 v181, 0xffff0000, v176
    v_lshlrev_b32 v182, 16, v177
    v_and_b32 v183, 0xffff0000, v177
    v_pk_add_f32 v[48:49], v[48:49], v[84:85]
    v_pk_add_f32 v[50:51], v[50:51], v[86:87]
    v_pk_add_f32 v[120:121], v[120:121], v[156:157]
    v_pk_add_f32 v[122:123], v[122:123], v[158:159]
    v_pk_add_f32 v[48:49], v[48:49], v[120:121]
    v_pk_add_f32 v[50:51], v[50:51], v[122:123]
    v_cvt_pk_bf16_f32 v7, v48, v49
    v_lshlrev_b32 v48, 16, v7
    v_and_b32 v49, 0xffff0000, v7
    v_cvt_pk_bf16_f32 v7, v50, v51
    v_lshlrev_b32 v50, 16, v7
    v_and_b32 v51, 0xffff0000, v7
    v_pk_add_f32 v[48:49], v[48:49], v[180:181]
    v_pk_add_f32 v[50:51], v[50:51], v[182:183]
    v_cvt_pk_bf16_f32 v7, v48, v49
    v_lshlrev_b32 v48, 16, v7
    v_and_b32 v49, 0xffff0000, v7
    v_cvt_pk_bf16_f32 v7, v50, v51
    v_lshlrev_b32 v50, 16, v7
    v_and_b32 v51, 0xffff0000, v7
    v_mul_f32 v48, v6, v48
    v_mul_f32 v49, v6, v49
    v_mul_f32 v50, v6, v50
    v_mul_f32 v51, v6, v51
    v_cvt_pk_bf16_f32 v7, v48, v49
    v_lshlrev_b32 v48, 16, v7
    v_and_b32 v49, 0xffff0000, v7
    v_cvt_pk_bf16_f32 v7, v50, v51
    v_lshlrev_b32 v50, 16, v7
    v_and_b32 v51, 0xffff0000, v7
    ds_write_b128 v15, v[48:51] offset:8192
    s_waitcnt lgkmcnt(0)
    s_barrier
    s_endpgm
k2_attn:
    s_and_b32 s3, s2, 255
    s_and_b32 s4, s3, 7
    s_lshr_b32 s5, s3, 6
    s_lshl_b32 s5, s5, 3
    s_add_u32 s4, s4, s5
    s_bfe_u32 s5, s3, 0x30003
    s_add_u32 s8, s86, 0x400000
    s_addc_u32 s9, s87, 0
    s_mov_b32 s10, 0x400000
    s_mov_b32 s11, 0x00020000
    s_add_u32 s12, s86, 0x800000
    s_addc_u32 s13, s87, 0
    s_mov_b32 s14, 0x800000
    s_mov_b32 s15, 0x00020000
    s_add_u32 s16, s86, 0x2400000
    s_addc_u32 s17, s87, 0
    s_mov_b32 s18, 0x300000
    s_mov_b32 s19, 0x00020000
    s_mov_b32 s40, -1
    s_mov_b32 s41, 0
    s_mov_b32 s31, 0
    s_lshl_b32 s24, s27, 12
    s_lshl_b32 s29, s4, 18
    s_mov_b32 s33, s29
    v_lshlrev_b32 v2, 4, v1
    v_add_u32 v150, s24, v2
    s_mov_b32 m0, s24
    s_nop 0
    buffer_load_dwordx4 v150, s[12:15], s29 offen offset:0 lds
    buffer_load_dwordx4 v150, s[12:15], s29 offen offset:1024 lds
    buffer_load_dwordx4 v150, s[12:15], s29 offen offset:2048 lds
    buffer_load_dwordx4 v150, s[12:15], s29 offen offset:3072 lds
    s_add_u32 s29, s29, 16384
    s_add_u32 m0, s24, 16384
    s_nop 0
    buffer_load_dwordx4 v150, s[12:15], s29 offen offset:0 lds
    buffer_load_dwordx4 v150, s[12:15], s29 offen offset:1024 lds
    buffer_load_dwordx4 v150, s[12:15], s29 offen offset:2048 lds
    buffer_load_dwordx4 v150, s[12:15], s29 offen offset:3072 lds
    s_add_u32 s29, s29, 16384
    s_lshl_b32 s34, s4, 6
    s_lshl_b32 s35, s5, 3
    s_add_u32 s34, s34, s35
    s_lshl_b32 s35, s27, 1
    s_add_u32 s34, s34, s35
    s_lshl_b32 s34, s34, 11
    buffer_load_dwordx4 v[96:99], v2, s[8:11], s34 offen offset:0
    buffer_load_dwordx4 v[100:103], v2, s[8:11], s34 offen offset:1024
    buffer_load_dwordx4 v[104:107], v2, s[8:11], s34 offen offset:2048
    buffer_load_dwordx4 v[108:111], v2, s[8:11], s34 offen offset:3072
    v_mov_b32 v148, v2
    v_lshrrev_b32 v3, 5, v1
    v_lshlrev_b32 v3, 2, v3
    v_bfe_u32 v4, v1, 2, 2
    v_add_u32 v3, v3, v4
    v_lshlrev_b32 v3, 6, v3
    v_bfe_u32 v4, v1, 4, 1
    v_lshlrev_b32 v4, 5, v4
    v_and_b32 v5, 3, v1
    v_lshlrev_b32 v5, 3, v5
    v_add3_u32 v3, v3, v4, v5
    v_add_u32 v149, 2048, v3
    v_mov_b32 v144, v148
    v_mov_b32 v145, v149
    v_add_u32 v146, 16384, v148
    v_add_u32 v147, 16384, v149
    s_mov_b32 s28, 16384
    v_mov_b32 v16, 0
    v_mov_b32 v17, 0
    v_mov_b32 v18, 0
    v_mov_b32 v19, 0
    v_mov_b32 v20, 0
    v_mov_b32 v21, 0
    v_mov_b32 v22, 0
    v_mov_b32 v23, 0
    v_mov_b32 v24, 0
    v_mov_b32 v25, 0
    v_mov_b32 v26, 0
    v_mov_b32 v27, 0
    v_mov_b32 v28, 0
    v_mov_b32 v29, 0
    v_mov_b32 v30, 0
    v_mov_b32 v31, 0
    v_mov_b32 v32, 0
    v_mov_b32 v33, 0
    v_mov_b32 v34, 0
    v_mov_b32 v35, 0
    v_mov_b32 v36, 0
    v_mov_b32 v37, 0
    v_mov_b32 v38, 0
    v_mov_b32 v39, 0
    v_mov_b32 v40, 0
    v_mov_b32 v41, 0
    v_mov_b32 v42, 0
    v_mov_b32 v43, 0
    v_mov_b32 v44, 0
    v_mov_b32 v45, 0
    v_mov_b32 v46, 0
    v_mov_b32 v47, 0
    s_cmp_lg_u32 s27, 0
    s_cbranch_scc1 k2_an_32
    s_mov_b32 s96, s84
    s_mov_b32 s97, s85
    s_mov_b32 s98, 0x100
    s_mov_b32 s99, 0x00020000
    v_mov_b32 v3, 0
    s_mov_b32 s101, 262144
k2_ng_33:
    buffer_load_dword v2, v3, s[96:99], 0 offen sc1
    s_waitcnt vmcnt(0)
    v_readfirstlane_b32 s100, v2
    s_cmp_lg_u32 s100, 0
    s_cbranch_scc1 k2_ngd_34
    s_sub_u32 s101, s101, 1
    s_cbranch_scc1 k2_ngd_34
    s_sleep 1
    s_branch k2_ng_33
k2_ngd_34:
    s_add_u32 s96, s86, 0x300000
    s_addc_u32 s97, s87, 0
    s_mov_b32 s98, 0x10000
    s_mov_b32 s99, 0x00020000
k2_an_32:
    s_waitcnt vmcnt(0)
    v_cndmask_b32 v100, 0, v100, s[40:41]
    v_mov_b32 v101, 0
    v_mov_b32 v102, 0
    v_mov_b32 v103, 0
    v_cndmask_b32 v108, 0, v108, s[40:41]
    v_mov_b32 v109, 0
    v_mov_b32 v110, 0
    v_mov_b32 v111, 0
    s_barrier
    ds_read_b128 v[112:115], v144 offset:0
    ds_read_b128 v[116:119], v144 offset:1024
    ds_read_b128 v[120:123], v144 offset:4096
    ds_read_b128 v[124:127], v144 offset:5120
    ds_read_b64_tr_b16 v[128:129], v145 offset:0
    ds_read_b64_tr_b16 v[130:131], v145 offset:512
    ds_read_b64_tr_b16 v[132:133], v145 offset:1024
    ds_read_b64_tr_b16 v[134:135], v145 offset:1536
    s_waitcnt lgkmcnt(0)
    v_mfma_f32_32x32x16_bf16 v[48:63], v[112:115], v[96:99], 0
    v_mfma_f32_32x32x16_bf16 v[48:63], v[116:119], v[100:103], v[48:63]
    v_mfma_f32_32x32x16_bf16 v[64:79], v[112:115], v[104:107], 0
    v_mfma_f32_32x32x16_bf16 v[64:79], v[116:119], v[108:111], v[64:79]
    s_nop 7
    s_nop 7
    v_max3_f32 v2, v48, v49, v50
    v_max3_f32 v2, v2, v51, v52
    v_max3_f32 v2, v2, v53, v54
    v_max3_f32 v2, v2, v55, v56
    v_max3_f32 v2, v2, v57, v58
    v_max3_f32 v2, v2, v59, v60
    v_max3_f32 v2, v2, v61, v62
    v_max_f32 v6, v2, v63
    v_max3_f32 v2, v64, v65, v66
    v_max3_f32 v2, v2, v67, v68
    v_max3_f32 v2, v2, v69, v70
    v_max3_f32 v2, v2, v71, v72
    v_max3_f32 v2, v2, v73, v74
    v_max3_f32 v2, v2, v75, v76
    v_max3_f32 v2, v2, v77, v78
    v_max_f32 v7, v2, v79
    v_mov_b32 v3, v6
    v_mov_b32 v4, v6
    s_nop 1
    v_permlane32_swap_b32 v3, v4
    s_nop 1
    v_max_f32 v3, v3, v4
    v_sub_f32 v3, 0, v3
    v_cvt_pk_bf16_f32 v4, v3, v3
    v_lshlrev_b32 v4, 16, v4
    v_sub_f32 v3, v3, v4
    v_cvt_pk_bf16_f32 v3, v4, v3
    v_cndmask_b32 v101, 0, v3, s[40:41]
    v_mov_b32 v3, v7
    v_mov_b32 v4, v7
    s_nop 1
    v_permlane32_swap_b32 v3, v4
    s_nop 1
    v_max_f32 v3, v3, v4
    v_sub_f32 v3, 0, v3
    v_cvt_pk_bf16_f32 v4, v3, v3
    v_lshlrev_b32 v4, 16, v4
    v_sub_f32 v3, v3, v4
    v_cvt_pk_bf16_f32 v3, v4, v3
    v_cndmask_b32 v109, 0, v3, s[40:41]
    s_nop 1
    v_mfma_f32_32x32x16_bf16 v[48:63], v[112:115], v[96:99], 0
    v_mfma_f32_32x32x16_bf16 v[48:63], v[116:119], v[100:103], v[48:63]
    s_nop 7
    s_nop 7
    v_mfma_f32_32x32x16_bf16 v[64:79], v[112:115], v[104:107], 0
    v_exp_f32 v48, v48
    v_exp_f32 v49, v49
    v_exp_f32 v50, v50
    v_exp_f32 v51, v51
    v_cvt_pk_bf16_f32 v80, v48, v49
    v_exp_f32 v52, v52
    v_mfma_f32_32x32x16_bf16 v[64:79], v[116:119], v[108:111], v[64:79]
    v_exp_f32 v53, v53
    v_cvt_pk_bf16_f32 v81, v50, v51
    v_exp_f32 v54, v54
    v_exp_f32 v55, v55
    v_cvt_pk_bf16_f32 v82, v52, v53
    v_exp_f32 v56, v56
    v_exp_f32 v57, v57
    v_cvt_pk_bf16_f32 v83, v54, v55
    v_exp_f32 v58, v58
    v_exp_f32 v59, v59
    v_cvt_pk_bf16_f32 v84, v56, v57
    v_exp_f32 v60, v60
    v_exp_f32 v61, v61
    v_cvt_pk_bf16_f32 v85, v58, v59
    v_exp_f32 v62, v62
    v_exp_f32 v63, v63
    v_cvt_pk_bf16_f32 v86, v60, v61
    v_cvt_pk_bf16_f32 v87, v62, v63
    s_mov_b32 s30, 16
ka_loop:
    s_waitcnt lgkmcnt(0)
    ds_read_b128 v[112:115], v144 offset:8192
    ds_read_b128 v[116:119], v144 offset:9216
    ds_read_b64_tr_b16 v[136:137], v145 offset:4096
    ds_read_b64_tr_b16 v[138:139], v145 offset:4608
    ds_read_b64_tr_b16 v[140:141], v145 offset:5120
    ds_read_b64_tr_b16 v[142:143], v145 offset:5632
    v_mfma_f32_32x32x16_bf16 v[48:63], v[120:123], v[96:99], 0
    v_exp_f32 v64, v64
    v_exp_f32 v65, v65
    v_exp_f32 v66, v66
    v_exp_f32 v67, v67
    v_cvt_pk_bf16_f32 v88, v64, v65
    v_exp_f32 v68, v68
    v_mfma_f32_32x32x16_bf16 v[48:63], v[124:127], v[100:103], v[48:63]
    v_exp_f32 v69, v69
    v_cvt_pk_bf16_f32 v89, v66, v67
    v_exp_f32 v70, v70
    v_exp_f32 v71, v71
    v_cvt_pk_bf16_f32 v90, v68, v69
    v_exp_f32 v72, v72
    v_mfma_f32_32x32x16_bf16 v[16:31], v[128:131], v[80:83], v[16:31]
    v_exp_f32 v73, v73
    v_cvt_pk_bf16_f32 v91, v70, v71
    v_exp_f32 v74, v74
    v_exp_f32 v75, v75
    v_cvt_pk_bf16_f32 v92, v72, v73
    v_exp_f32 v76, v76
    v_mfma_f32_32x32x16_bf16 v[16:31], v[132:135], v[84:87], v[16:31]
    v_exp_f32 v77, v77
    v_cvt_pk_bf16_f32 v93, v74, v75
    v_exp_f32 v78, v78
    v_exp_f32 v79, v79
    v_cvt_pk_bf16_f32 v94, v76, v77
    v_cvt_pk_bf16_f32 v95, v78, v79
    v_mfma_f32_32x32x16_bf16 v[64:79], v[120:123], v[104:107], 0
    v_exp_f32 v48, v48
    v_exp_f32 v49, v49
    v_exp_f32 v50, v50
    v_exp_f32 v51, v51
    v_cvt_pk_bf16_f32 v80, v48, v49
    v_exp_f32 v52, v52
    v_mfma_f32_32x32x16_bf16 v[64:79], v[124:127], v[108:111], v[64:79]
    v_exp_f32 v53, v53
    v_cvt_pk_bf16_f32 v81, v50, v51
    v_exp_f32 v54, v54
    v_exp_f32 v55, v55
    v_cvt_pk_bf16_f32 v82, v52, v53
    v_exp_f32 v56, v56
    v_mfma_f32_32x32x16_bf16 v[32:47], v[128:131], v[88:91], v[32:47]
    v_exp_f32 v57, v57
    v_cvt_pk_bf16_f32 v83, v54, v55
    v_exp_f32 v58, v58
    v_exp_f32 v59, v59
    v_cvt_pk_bf16_f32 v84, v56, v57
    v_exp_f32 v60, v60
    v_mfma_f32_32x32x16_bf16 v[32:47], v[132:135], v[92:95], v[32:47]
    v_exp_f32 v61, v61
    v_cvt_pk_bf16_f32 v85, v58, v59
    v_exp_f32 v62, v62
    v_exp_f32 v63, v63
    v_cvt_pk_bf16_f32 v86, v60, v61
    v_cvt_pk_bf16_f32 v87, v62, v63
    s_waitcnt lgkmcnt(0)
    ds_read_b128 v[120:123], v144 offset:12288
    ds_read_b128 v[124:127], v144 offset:13312
    ds_read_b64_tr_b16 v[128:129], v145 offset:8192
    ds_read_b64_tr_b16 v[130:131], v145 offset:8704
    ds_read_b64_tr_b16 v[132:133], v145 offset:9216
    ds_read_b64_tr_b16 v[134:135], v145 offset:9728
    v_mfma_f32_32x32x16_bf16 v[48:63], v[112:115], v[96:99], 0
    v_exp_f32 v64, v64
    v_exp_f32 v65, v65
    v_exp_f32 v66, v66
    v_exp_f32 v67, v67
    v_cvt_pk_bf16_f32 v88, v64, v65
    v_exp_f32 v68, v68
    v_mfma_f32_32x32x16_bf16 v[48:63], v[116:119], v[100:103], v[48:63]
    v_exp_f32 v69, v69
    v_cvt_pk_bf16_f32 v89, v66, v67
    v_exp_f32 v70, v70
    v_exp_f32 v71, v71
    v_cvt_pk_bf16_f32 v90, v68, v69
    v_exp_f32 v72, v72
    v_mfma_f32_32x32x16_bf16 v[16:31], v[136:139], v[80:83], v[16:31]
    v_exp_f32 v73, v73
    v_cvt_pk_bf16_f32 v91, v70, v71
    v_exp_f32 v74, v74
    v_exp_f32 v75, v75
    v_cvt_pk_bf16_f32 v92, v72, v73
    v_exp_f32 v76, v76
    v_mfma_f32_32x32x16_bf16 v[16:31], v[140:143], v[84:87], v[16:31]
    v_exp_f32 v77, v77
    v_cvt_pk_bf16_f32 v93, v74, v75
    v_exp_f32 v78, v78
    v_exp_f32 v79, v79
    v_cvt_pk_bf16_f32 v94, v76, v77
    v_cvt_pk_bf16_f32 v95, v78, v79
    v_mfma_f32_32x32x16_bf16 v[64:79], v[112:115], v[104:107], 0
    v_exp_f32 v48, v48
    v_exp_f32 v49, v49
    v_exp_f32 v50, v50
    v_exp_f32 v51, v51
    v_cvt_pk_bf16_f32 v80, v48, v49
    v_exp_f32 v52, v52
    v_mfma_f32_32x32x16_bf16 v[64:79], v[116:119], v[108:111], v[64:79]
    v_exp_f32 v53, v53
    v_cvt_pk_bf16_f32 v81, v50, v51
    v_exp_f32 v54, v54
    v_exp_f32 v55, v55
    v_cvt_pk_bf16_f32 v82, v52, v53
    v_exp_f32 v56, v56
    v_mfma_f32_32x32x16_bf16 v[32:47], v[136:139], v[88:91], v[32:47]
    v_exp_f32 v57, v57
    v_cvt_pk_bf16_f32 v83, v54, v55
    v_exp_f32 v58, v58
    v_exp_f32 v59, v59
    v_cvt_pk_bf16_f32 v84, v56, v57
    v_exp_f32 v60, v60
    v_mfma_f32_32x32x16_bf16 v[32:47], v[140:143], v[92:95], v[32:47]
    v_exp_f32 v61, v61
    v_cvt_pk_bf16_f32 v85, v58, v59
    v_exp_f32 v62, v62
    v_exp_f32 v63, v63
    v_cvt_pk_bf16_f32 v86, v60, v61
    v_cvt_pk_bf16_f32 v87, v62, v63
    s_waitcnt lgkmcnt(0)
    s_waitcnt vmcnt(0)
    s_barrier
    s_add_u32 s32, s28, 16384
    s_cmp_eq_u32 s32, 49152
    s_cmov_b32 s32, 0
    s_add_u32 m0, s32, s24
    s_nop 0
    buffer_load_dwordx4 v150, s[12:15], s29 offen offset:0 lds
    buffer_load_dwordx4 v150, s[12:15], s29 offen offset:1024 lds
    buffer_load_dwordx4 v150, s[12:15], s29 offen offset:2048 lds
    buffer_load_dwordx4 v150, s[12:15], s29 offen offset:3072 lds
    s_add_u32 s29, s29, 16384
    ds_read_b128 v[112:115], v146 offset:0
    ds_read_b128 v[116:119], v146 offset:1024
    ds_read_b64_tr_b16 v[136:137], v145 offset:12288
    ds_read_b64_tr_b16 v[138:139], v145 offset:12800
    ds_read_b64_tr_b16 v[140:141], v145 offset:13312
    ds_read_b64_tr_b16 v[142:143], v145 offset:13824
    v_mfma_f32_32x32x16_bf16 v[48:63], v[120:123], v[96:99], 0
    v_exp_f32 v64, v64
    v_exp_f32 v65, v65
    v_exp_f32 v66, v66
    v_exp_f32 v67, v67
    v_cvt_pk_bf16_f32 v88, v64, v65
    v_exp_f32 v68, v68
    v_mfma_f32_32x32x16_bf16 v[48:63], v[124:127], v[100:103], v[48:63]
    v_exp_f32 v69, v69
    v_cvt_pk_bf16_f32 v89, v66, v67
    v_exp_f32 v70, v70
    v_exp_f32 v71, v71
    v_cvt_pk_bf16_f32 v90, v68, v69
    v_exp_f32 v72, v72
    v_mfma_f32_32x32x16_bf16 v[16:31], v[128:131], v[80:83], v[16:31]
    v_exp_f32 v73, v73
    v_cvt_pk_bf16_f32 v91, v70, v71
    v_exp_f32 v74, v74
    v_exp_f32 v75, v75
    v_cvt_pk_bf16_f32 v92, v72, v73
    v_exp_f32 v76, v76
    v_mfma_f32_32x32x16_bf16 v[16:31], v[132:135], v[84:87], v[16:31]
    v_exp_f32 v77, v77
    v_cvt_pk_bf16_f32 v93, v74, v75
    v_exp_f32 v78, v78
    v_exp_f32 v79, v79
    v_cvt_pk_bf16_f32 v94, v76, v77
    v_cvt_pk_bf16_f32 v95, v78, v79
    v_mfma_f32_32x32x16_bf16 v[64:79], v[120:123], v[104:107], 0
    v_exp_f32 v48, v48
    v_exp_f32 v49, v49
    v_exp_f32 v50, v50
    v_exp_f32 v51, v51
    v_cvt_pk_bf16_f32 v80, v48, v49
    v_exp_f32 v52, v52
    v_mfma_f32_32x32x16_bf16 v[64:79], v[124:127], v[108:111], v[64:79]
    v_exp_f32 v53, v53
    v_cvt_pk_bf16_f32 v81, v50, v51
    v_exp_f32 v54, v54
    v_exp_f32 v55, v55
    v_cvt_pk_bf16_f32 v82, v52, v53
    v_exp_f32 v56, v56
    v_mfma_f32_32x32x16_bf16 v[32:47], v[128:131], v[88:91], v[32:47]
    v_exp_f32 v57, v57
    v_cvt_pk_bf16_f32 v83, v54, v55
    v_exp_f32 v58, v58
    v_exp_f32 v59, v59
    v_cvt_pk_bf16_f32 v84, v56, v57
    v_exp_f32 v60, v60
    v_mfma_f32_32x32x16_bf16 v[32:47], v[132:135], v[92:95], v[32:47]
    v_exp_f32 v61, v61
    v_cvt_pk_bf16_f32 v85, v58, v59
    v_exp_f32 v62, v62
    v_exp_f32 v63, v63
    v_cvt_pk_bf16_f32 v86, v60, v61
    v_cvt_pk_bf16_f32 v87, v62, v63
    s_waitcnt lgkmcnt(0)
    ds_read_b128 v[120:123], v146 offset:4096
    ds_read_b128 v[124:127], v146 offset:5120
    ds_read_b64_tr_b16 v[128:129], v147 offset:0
    ds_read_b64_tr_b16 v[130:131], v147 offset:512
    ds_read_b64_tr_b16 v[132:133], v147 offset:1024
    ds_read_b64_tr_b16 v[134:135], v147 offset:1536
    v_mfma_f32_32x32x16_bf16 v[48:63], v[112:115], v[96:99], 0
    v_exp_f32 v64, v64
    v_exp_f32 v65, v65
    v_exp_f32 v66, v66
    v_exp_f32 v67, v67
    v_cvt_pk_bf16_f32 v88, v64, v65
    v_exp_f32 v68, v68
    v_mfma_f32_32x32x16_bf16 v[48:63], v[116:119], v[100:103], v[48:63]
    v_exp_f32 v69, v69
    v_cvt_pk_bf16_f32 v89, v66, v67
    v_exp_f32 v70, v70
    v_exp_f32 v71, v71
    v_cvt_pk_bf16_f32 v90, v68, v69
    v_exp_f32 v72, v72
    v_mfma_f32_32x32x16_bf16 v[16:31], v[136:139], v[80:83], v[16:31]
    v_exp_f32 v73, v73
    v_cvt_pk_bf16_f32 v91, v70, v71
    v_exp_f32 v74, v74
    v_exp_f32 v75, v75
    v_cvt_pk_bf16_f32 v92, v72, v73
    v_exp_f32 v76, v76
    v_mfma_f32_32x32x16_bf16 v[16:31], v[140:143], v[84:87], v[16:31]
    v_exp_f32 v77, v77
    v_cvt_pk_bf16_f32 v93, v74, v75
    v_exp_f32 v78, v78
    v_exp_f32 v79, v79
    v_cvt_pk_bf16_f32 v94, v76, v77
    v_cvt_pk_bf16_f32 v95, v78, v79
    v_mfma_f32_32x32x16_bf16 v[64:79], v[112:115], v[104:107], 0
    v_exp_f32 v48, v48
    v_exp_f32 v49, v49
    v_exp_f32 v50, v50
    v_exp_f32 v51, v51
    v_cvt_pk_bf16_f32 v80, v48, v49
    v_exp_f32 v52, v52
    v_mfma_f32_32x32x16_bf16 v[64:79], v[116:119], v[108:111], v[64:79]
    v_exp_f32 v53, v53
    v_cvt_pk_bf16_f32 v81, v50, v51
    v_exp_f32 v54, v54
    v_exp_f32 v55, v55
    v_cvt_pk_bf16_f32 v82, v52, v53
    v_exp_f32 v56, v56
    v_mfma_f32_32x32x16_bf16 v[32:47], v[136:139], v[88:91], v[32:47]
    v_exp_f32 v57, v57
    v_cvt_pk_bf16_f32 v83, v54, v55
    v_exp_f32 v58, v58
    v_exp_f32 v59, v59
    v_cvt_pk_bf16_f32 v84, v56, v57
    v_exp_f32 v60, v60
    v_mfma_f32_32x32x16_bf16 v[32:47], v[140:143], v[92:95], v[32:47]
    v_exp_f32 v61, v61
    v_cvt_pk_bf16_f32 v85, v58, v59
    v_exp_f32 v62, v62
    v_exp_f32 v63, v63
    v_cvt_pk_bf16_f32 v86, v60, v61
    v_cvt_pk_bf16_f32 v87, v62, v63
    v_mov_b32 v144, v146
    v_mov_b32 v145, v147
    s_mov_b32 s28, s32
    v_add_u32 v146, s28, v148
    v_add_u32 v147, s28, v149
    s_sub_u32 s30, s30, 1
    s_cmp_lg_u32 s30, 0
    s_cbranch_scc1 ka_loop
ka_fin:
    s_waitcnt vmcnt(0) lgkmcnt(0)
    s_nop 7
    s_nop 7
    v_mov_b32 v8, v26
    v_mov_b32 v9, v26
    v_mov_b32 v10, v42
    v_mov_b32 v11, v42
    s_nop 1
    v_permlane32_swap_b32 v8, v9
    v_permlane32_swap_b32 v10, v11
    s_nop 1
    s_cmp_lg_u32 s31, 0
    s_cbranch_scc1 ka_store
    v_max_f32 v2, v8, v10
    v_mov_b32 v3, 0x53800000
    v_cmp_nlt_f32 vcc, v8, v3
    s_nop 1
    s_mov_b64 s[36:37], vcc
    v_cmp_nlt_f32 vcc, v10, v3
    s_nop 1
    s_or_b64 s[36:37], vcc, s[36:37]
    s_cbranch_scc1 ka_fallback
ka_store:
    v_rcp_f32 v8, v8
    v_rcp_f32 v10, v10
    s_lshl_b32 s34, s5, 8
    s_lshl_b32 s35, s27, 6
    s_add_u32 s34, s34, s35
    s_mul_i32 s35, s4, 3
    v_and_b32 v2, 31, v1
    v_add_u32 v2, s34, v2
    v_lshrrev_b32 v3, 5, v1
    v_add_u32 v3, s35, v3
    v_lshrrev_b32 v4, 4, v2
    v_mul_u32_u24 v4, 24576, v4
    v_and_b32 v2, 15, v2
    v_lshlrev_b32 v2, 4, v2
    v_lshrrev_b32 v5, 2, v3
    v_lshlrev_b32 v5, 10, v5
    v_and_b32 v3, 3, v3
    v_lshlrev_b32 v3, 8, v3
    v_add3_u32 v2, v2, v4, v5
    v_add_u32 v52, v2, v3
    v_add_u32 v2, s34, v1
    v_mov_b32 v3, s35
    v_add_u32 v3, 2, v3
    v_lshrrev_b32 v4, 4, v2
    v_mul_u32_u24 v4, 24576, v4
    v_and_b32 v2, 15, v2
    v_lshlrev_b32 v2, 4, v2
    v_lshrrev_b32 v5, 2, v3
    v_lshlrev_b32 v5, 10, v5
    v_and_b32 v3, 3, v3
    v_lshlrev_b32 v3, 8, v3
    v_add3_u32 v2, v2, v4, v5
    v_add_u32 v53, v2, v3
    v_mul_f32 v16, v16, v8
    v_mul_f32 v17, v17, v8
    v_mul_f32 v18, v18, v8
    v_mul_f32 v19, v19, v8
    v_mul_f32 v20, v20, v8
    v_mul_f32 v21, v21, v8
    v_mul_f32 v22, v22, v8
    v_mul_f32 v23, v23, v8
    v_mul_f32 v24, v24, v8
    v_mul_f32 v25, v25, v8
    v_cvt_pk_bf16_f32 v16, v16, v17
    v_cvt_pk_bf16_f32 v17, v18, v19
    v_cvt_pk_bf16_f32 v18, v20, v21
    v_cvt_pk_bf16_f32 v19, v22, v23
    v_cvt_pk_bf16_f32 v20, v24, v25
    v_mul_f32 v32, v32, v10
    v_mul_f32 v33, v33, v10
    v_mul_f32 v34, v34, v10
    v_mul_f32 v35, v35, v10
    v_mul_f32 v36, v36, v10
    v_mul_f32 v37, v37, v10
    v_mul_f32 v38, v38, v10
    v_mul_f32 v39, v39, v10
    v_mul_f32 v40, v40, v10
    v_mul_f32 v41, v41, v10
    v_cvt_pk_bf16_f32 v32, v32, v33
    v_cvt_pk_bf16_f32 v33, v34, v35
    v_cvt_pk_bf16_f32 v34, v36, v37
    v_cvt_pk_bf16_f32 v35, v38, v39
    v_cvt_pk_bf16_f32 v36, v40, v41
    v_mov_b32 v48, v20
    v_mov_b32 v49, 0
    v_mov_b32 v50, 0
    v_mov_b32 v51, 0
    s_nop 1
    v_permlane32_swap_b32 v16, v18
    v_permlane32_swap_b32 v17, v19
    v_permlane32_swap_b32 v32, v34
    v_permlane32_swap_b32 v33, v35
    v_permlane32_swap_b32 v48, v36
    s_mov_b32 s35, 49152
    s_nop 1
    buffer_store_dwordx4 v[16:19], v52, s[16:19], 0 offen sc1
    buffer_store_dwordx4 v[32:35], v52, s[16:19], s35 offen sc1
    buffer_store_dwordx4 v[48:51], v53, s[16:19], 0 offen sc1
    s_lshl_b32 s6, s5, 5
    s_add_u32 s6, s6, s4
    s_waitcnt vmcnt(0)
    s_barrier
    s_cmp_lg_u32 s27, 0
    s_cbranch_scc1 k2_pb_35
    s_lshl_b32 s28, s6, 2
    s_add_u32 s28, s28, 12288
    v_mov_b32 v3, s28
    v_mov_b32 v2, s100
    s_mov_b64 exec, 1
    buffer_store_dword v2, v3, s[96:99], 0 offen sc1
    s_mov_b64 exec, -1
k2_pb_35:
    s_endpgm
ka_fallback:
    s_mov_b32 s31, 1
    v_mov_b32 v101, 0
    v_mov_b32 v109, 0
    v_mov_b32 v6, 0xff800000
    v_mov_b32 v7, 0xff800000
    s_add_u32 s38, s24, 49152
    v_lshlrev_b32 v12, 4, v1
    v_add_u32 v13, s38, v148
    v_add_u32 v14, s38, v149
    s_mov_b32 s29, s33
    s_mov_b32 s30, 64
ka_fb0:
    s_mov_b32 m0, s38
    s_nop 0
    buffer_load_dwordx4 v12, s[12:15], s29 offen offset:0 lds
    buffer_load_dwordx4 v12, s[12:15], s29 offen offset:1024 lds
    buffer_load_dwordx4 v12, s[12:15], s29 offen offset:2048 lds
    buffer_load_dwordx4 v12, s[12:15], s29 offen offset:3072 lds
    s_add_u32 s29, s29, 4096
    s_waitcnt vmcnt(0)
    ds_read_b128 v[112:115], v13 offset:0
    ds_read_b128 v[116:119], v13 offset:1024
    s_waitcnt lgkmcnt(0)
    v_mfma_f32_32x32x16_bf16 v[48:63], v[112:115], v[96:99], 0
    v_mfma_f32_32x32x16_bf16 v[48:63], v[116:119], v[100:103], v[48:63]
    v_mfma_f32_32x32x16_bf16 v[64:79], v[112:115], v[104:107], 0
    v_mfma_f32_32x32x16_bf16 v[64:79], v[116:119], v[108:111], v[64:79]
    s_nop 7
    s_nop 7
    v_max3_f32 v2, v48, v49, v50
    v_max3_f32 v2, v2, v51, v52
    v_max3_f32 v2, v2, v53, v54
    v_max3_f32 v2, v2, v55, v56
    v_max3_f32 v2, v2, v57, v58
    v_max3_f32 v2, v2, v59, v60
    v_max3_f32 v2, v2, v61, v62
    v_max3_f32 v6, v2, v63, v6
    v_max3_f32 v2, v64, v65, v66
    v_max3_f32 v2, v2, v67, v68
    v_max3_f32 v2, v2, v69, v70
    v_max3_f32 v2, v2, v71, v72
    v_max3_f32 v2, v2, v73, v74
    v_max3_f32 v2, v2, v75, v76
    v_max3_f32 v2, v2, v77, v78
    v_max3_f32 v7, v2, v79, v7
    s_sub_u32 s30, s30, 1
    s_cmp_lg_u32 s30, 0
    s_cbranch_scc1 ka_fb0
    v_mov_b32 v3, v6
    v_mov_b32 v4, v6
    s_nop 1
    v_permlane32_swap_b32 v3, v4
    s_nop 1
    v_max_f32 v3, v3, v4
    v_sub_f32 v3, 0, v3
    v_cvt_pk_bf16_f32 v4, v3, v3
    v_lshlrev_b32 v4, 16, v4
    v_sub_f32 v3, v3, v4
    v_cvt_pk_bf16_f32 v3, v4, v3
    v_cndmask_b32 v101, 0, v3, s[40:41]
    v_mov_b32 v3, v7
    v_mov_b32 v4, v7
    s_nop 1
    v_permlane32_swap_b32 v3, v4
    s_nop 1
    v_max_f32 v3, v3, v4
    v_sub_f32 v3, 0, v3
    v_cvt_pk_bf16_f32 v4, v3, v3
    v_lshlrev_b32 v4, 16, v4
    v_sub_f32 v3, v3, v4
    v_cvt_pk_bf16_f32 v3, v4, v3
    v_cndmask_b32 v109, 0, v3, s[40:41]
    v_mov_b32 v16, 0
    v_mov_b32 v17, 0
    v_mov_b32 v18, 0
    v_mov_b32 v19, 0
    v_mov_b32 v20, 0
    v_mov_b32 v21, 0
    v_mov_b32 v22, 0
    v_mov_b32 v23, 0
    v_mov_b32 v24, 0
    v_mov_b32 v25, 0
    v_mov_b32 v26, 0
    v_mov_b32 v27, 0
    v_mov_b32 v28, 0
    v_mov_b32 v29, 0
    v_mov_b32 v30, 0
    v_mov_b32 v31, 0
    v_mov_b32 v32, 0
    v_mov_b32 v33, 0
    v_mov_b32 v34, 0
    v_mov_b32 v35, 0
    v_mov_b32 v36, 0
    v_mov_b32 v37, 0
    v_mov_b32 v38, 0
    v_mov_b32 v39, 0
    v_mov_b32 v40, 0
    v_mov_b32 v41, 0
    v_mov_b32 v42, 0
    v_mov_b32 v43, 0
    v_mov_b32 v44, 0
    v_mov_b32 v45, 0
    v_mov_b32 v46, 0
    v_mov_b32 v47, 0
    s_nop 1
    s_mov_b32 s29, s33
    s_mov_b32 s30, 64
ka_fb1:
    s_mov_b32 m0, s38
    s_nop 0
    buffer_load_dwordx4 v12, s[12:15], s29 offen offset:0 lds
    buffer_load_dwordx4 v12, s[12:15], s29 offen offset:1024 lds
    buffer_load_dwordx4 v12, s[12:15], s29 offen offset:2048 lds
    buffer_load_dwordx4 v12, s[12:15], s29 offen offset:3072 lds
    s_add_u32 s29, s29, 4096
    s_waitcnt vmcnt(0)
    ds_read_b128 v[112:115], v13 offset:0
    ds_read_b128 v[116:119], v13 offset:1024
    ds_read_b64_tr_b16 v[128:129], v14 offset:0
    ds_read_b64_tr_b16 v[130:131], v14 offset:512
    ds_read_b64_tr_b16 v[132:133], v14 offset:1024
    ds_read_b64_tr_b16 v[134:135], v14 offset:1536
    s_waitcnt lgkmcnt(0)
    v_mfma_f32_32x32x16_bf16 v[48:63], v[112:115], v[96:99], 0
    v_mfma_f32_32x32x16_bf16 v[48:63], v[116:119], v[100:103], v[48:63]
    v_mfma_f32_32x32x16_bf16 v[64:79], v[112:115], v[104:107], 0
    v_mfma_f32_32x32x16_bf16 v[64:79], v[116:119], v[108:111], v[64:79]
    s_nop 7
    s_nop 7
    v_exp_f32 v48, v48
    v_exp_f32 v49, v49
    v_exp_f32 v50, v50
    v_exp_f32 v51, v51
    v_cvt_pk_bf16_f32 v80, v48, v49
    v_exp_f32 v52, v52
    v_exp_f32 v53, v53
    v_cvt_pk_bf16_f32 v81, v50, v51
    v_exp_f32 v54, v54
    v_exp_f32 v55, v55
    v_cvt_pk_bf16_f32 v82, v52, v53
    v_exp_f32 v56, v56
    v_exp_f32 v57, v57
    v_cvt_pk_bf16_f32 v83, v54, v55
    v_exp_f32 v58, v58
    v_exp_f32 v59, v59
    v_cvt_pk_bf16_f32 v84, v56, v57
    v_exp_f32 v60, v60
    v_exp_f32 v61, v61
    v_cvt_pk_bf16_f32 v85, v58, v59
    v_exp_f32 v62, v62
    v_exp_f32 v63, v63
    v_cvt_pk_bf16_f32 v86, v60, v61
    v_cvt_pk_bf16_f32 v87, v62, v63
    v_exp_f32 v64, v64
    v_exp_f32 v65, v65
    v_exp_f32 v66, v66
    v_exp_f32 v67, v67
    v_cvt_pk_bf16_f32 v88, v64, v65
    v_exp_f32 v68, v68
    v_exp_f32 v69, v69
    v_cvt_pk_bf16_f32 v89, v66, v67
    v_exp_f32 v70, v70
    v_exp_f32 v71, v71
    v_cvt_pk_bf16_f32 v90, v68, v69
    v_exp_f32 v72, v72
    v_exp_f32 v73, v73
    v_cvt_pk_bf16_f32 v91, v70, v71
    v_exp_f32 v74, v74
    v_exp_f32 v75, v75
    v_cvt_pk_bf16_f32 v92, v72, v73
    v_exp_f32 v76, v76
    v_exp_f32 v77, v77
    v_cvt_pk_bf16_f32 v93, v74, v75
    v_exp_f32 v78, v78
    v_exp_f32 v79, v79
    v_cvt_pk_bf16_f32 v94, v76, v77
    v_cvt_pk_bf16_f32 v95, v78, v79
    s_nop 1
    v_mfma_f32_32x32x16_bf16 v[16:31], v[128:131], v[80:83], v[16:31]
    v_mfma_f32_32x32x16_bf16 v[16:31], v[132:135], v[84:87], v[16:31]
    v_mfma_f32_32x32x16_bf16 v[32:47], v[128:131], v[88:91], v[32:47]
    v_mfma_f32_32x32x16_bf16 v[32:47], v[132:135], v[92:95], v[32:47]
    s_sub_u32 s30, s30, 1
    s_cmp_lg_u32 s30, 0
    s_cbranch_scc1 ka_fb1
    s_branch ka_fin
k2_exit:
    s_endpgm
.section .rodata,"a"
.p2align 6
.amdhsa_kernel k1_kernel
  .amdhsa_next_free_vgpr 248
  .amdhsa_next_free_sgpr 102
  .amdhsa_accum_offset 248
  .amdhsa_group_segment_fixed_size 0
  .amdhsa_kernarg_size 96
  .amdhsa_user_sgpr_count 2
  .amdhsa_user_sgpr_kernarg_segment_ptr 1
  .amdhsa_system_sgpr_workgroup_id_x 1
.end_amdhsa_kernel
.p2align 6
.amdhsa_kernel k2_kernel
  .amdhsa_next_free_vgpr 252
  .amdhsa_next_free_sgpr 102
  .amdhsa_accum_offset 252
  .amdhsa_group_segment_fixed_size 0
  .amdhsa_kernarg_size 96
  .amdhsa_user_sgpr_count 2
  .amdhsa_user_sgpr_kernarg_segment_ptr 1
  .amdhsa_system_sgpr_workgroup_id_x 1
.end_amdhsa_kernel
```
